```python
import torch

def _softmax(x, axis=-1):
    return torch.softmax(x, dim=axis)
def _gelu(x):
    return torch.nn.functional.gelu(x, approximate="tanh")
def _silu(x):
    return torch.nn.functional.silu(x)
def _sigmoid(x):
    return torch.sigmoid(x)
def _layernorm(x, axis=-1, eps=1e-5):
    m = x.mean(dim=axis, keepdim=True)
    v = x.var(dim=axis, keepdim=True, unbiased=False)
    return (x - m) / torch.sqrt(v + eps)
def _scatter_add(tgt, idx, src, axis=0):
    return tgt.clone().index_add_(axis, idx, src)
def _segment_sum(src, seg, n):
    out = torch.zeros((n,) + src.shape[1:], dtype=src.dtype)
    return out.index_add_(0, seg, src)
def _pad(x, pw):
    flat = tuple(v for pair in reversed(pw) for v in pair)
    return torch.nn.functional.pad(x, flat)

kernel_name = 'concat_heads__compressed_kv_cla__linear_kernel_hedgehog__prompt'

def setup_inputs():

    _w = (lambda a: (lambda t: t.to(torch.bfloat16) if t.is_floating_point() else t)(torch.as_tensor(a)))
    def _A_setup():
        B, H, Sq, Sk, D, M = 1, 16, 2048, 2048, 256, 448
        Dc = 4 * D
        return {
            "x": _w((lambda *s: torch.randn(*s, dtype=torch.bfloat16) * 0.8)(B, Sq, M)),
            "c_kv": _w((lambda *s: torch.randn(*s, dtype=torch.bfloat16) * 0.4)(B, Sk, Dc)),
            "w_q": _w((lambda *s: torch.randn(*s, dtype=torch.bfloat16) * 6.4)(M, H, D) * (M ** -0.5)),
            "w_uk": _w((lambda *s: torch.randn(*s, dtype=torch.bfloat16) * 6.4)(Dc, H, D) * (Dc ** -0.5)),
            "w_uv": _w((lambda *s: torch.randn(*s, dtype=torch.bfloat16) * 0.4)(Dc, H, D) * (Dc ** -0.5)),
            "w_o": _w((lambda *s: torch.randn(*s, dtype=torch.bfloat16) * 0.4)(H, D, M) * ((H * D) ** -0.5)),
        }
    _A_in = _A_setup()

    def _B_setup():
        B, S, D, H = 1, 2048, 448, 16
        Dh = D // H
        return {
            "x": _w((lambda *s: torch.randn(*s, dtype=torch.bfloat16) * 0.4)(B, S, D)),
            "wqkv": _w((lambda *s: torch.randn(*s, dtype=torch.bfloat16) * 0.4)(D, 3 * D)),
            "w_phi": _w((lambda *s: torch.randn(*s, dtype=torch.bfloat16) * 0.4)(H, Dh, Dh) * (Dh ** -0.5)),
            "wo": _w((lambda *s: torch.randn(*s, dtype=torch.bfloat16) * 0.05)(D, D)),
        }
    _B_in = _B_setup()

    return {
        "A_x": _A_in["x"],
        "A_c_kv": _A_in["c_kv"],
        "A_w_q": _A_in["w_q"],
        "A_w_uk": _A_in["w_uk"],
        "A_w_uv": _A_in["w_uv"],
        "A_w_o": _A_in["w_o"],
        "B_x": _B_in["x"],
        "B_wqkv": _B_in["wqkv"],
        "B_w_phi": _B_in["w_phi"],
        "B_wo": _B_in["wo"],
    }

def reference(A_x, A_c_kv, A_w_q, A_w_uk, A_w_uv, A_w_o, B_x, B_wqkv, B_w_phi, B_wo):
    def _A_ref(x, c_kv, w_q, w_uk, w_uv, w_o):
        B, Sq, M = x.shape[0], x.shape[1], x.shape[2]
        Sk = c_kv.shape[1]
        H, D = w_q.shape[1], w_q.shape[2]
        q = torch.einsum("bqm,mhd->bhqd", x, w_q)
        k = torch.einsum("bkc,chd->bhkd", c_kv, w_uk)
        v = torch.einsum("bkc,chd->bhkd", c_kv, w_uv)
        scores = torch.einsum("bhqd,bhkd->bhqk", q, k) * (D ** -0.5)
        off = Sk - Sq
        qi = torch.arange(Sq)[:, None]
        kj = torch.arange(Sk)[None, :]
        cmask = kj <= (qi + off)
        scores = torch.where(cmask[None, None], scores, -1e9)
        p = _softmax(scores, axis=-1)
        ctx = torch.einsum("bhqk,bhkd->bhqd", p, v)
        return torch.einsum("bhqd,hdm->bqm", ctx, w_o)

    def _B_ref(x, wqkv, w_phi, wo):
        B, S, D = x.shape
        H = 16; Dh = D // H
        qkv = (lambda x, *d: x.permute(*d))((x @ wqkv).reshape(B, S, 3, H, Dh), 2, 0, 3, 1, 4)
        q, k, v = qkv[0], qkv[1], qkv[2]
        pq = torch.einsum("bhsd,hdf->bhsf", q, w_phi)
        pk = torch.einsum("bhsd,hdf->bhsf", k, w_phi)
        phi_q = torch.concatenate([_softmax(pq, axis=-1), _softmax(-pq, axis=-1)], axis=-1)
        phi_k = torch.concatenate([_softmax(pk, axis=-1), _softmax(-pk, axis=-1)], axis=-1)
        kv = torch.einsum("bhsf,bhsd->bhfd", phi_k, v)
        z  = torch.einsum("bhsf->bhf", phi_k)
        num = torch.einsum("bhqf,bhfd->bhqd", phi_q, kv)
        den = torch.einsum("bhqf,bhf->bhq", phi_q, z)[..., None] + 1e-6
        o = num / den
        return (lambda x, *d: x.permute(*d))(o, 0, 2, 1, 3).reshape(B, S, D) @ wo

    a = _A_ref(A_x, A_c_kv, A_w_q, A_w_uk, A_w_uv, A_w_o)
    b = _B_ref(B_x, B_wqkv, B_w_phi, B_wo)
    return torch.concatenate([a, b], axis=-1)
```

```asm
; @launch grid=(256,1,1) block=(256,1,1) lds=163840
.amdgcn_target "amdgcn-amd-amdhsa--gfx950"
.text
.globl concat_heads__compressed_kv_cla__linear_kernel_hedgehog__prompt_kernel
.p2align 12
.p2align 8
.type concat_heads__compressed_kv_cla__linear_kernel_hedgehog__prompt_kernel,@function
concat_heads__compressed_kv_cla__linear_kernel_hedgehog__prompt_kernel:
    s_cmp_ge_u32 s2, 256
    s_cbranch_scc1 F_end
    s_load_dwordx16 s[4:19], s[0:1], 0
    s_load_dwordx4 s[20:23], s[0:1], 64
    s_load_dwordx2 s[24:25], s[0:1], 96
    s_load_dwordx2 s[100:101], s[0:1], 88
    s_getpc_b64 s[30:31]
F_pc:
    v_lshrrev_b32 v19, 6, v0
    v_and_b32 v30, 63, v0
    v_readfirstlane_b32 s29, v19
    v_lshlrev_b32 v15, 4, v30
    s_lshr_b32 s66, s2, 3
    s_lshl_b32 s66, s66, 2
    s_add_u32 s66, s66, s29
    s_lshl_b32 s66, s66, 10
    v_and_b32 v16, 0x380, v15
    v_add_u32 v16, s66, v16
    global_load_dword v17, v16, s[30:31]
    s_and_b32 s26, s2, 7
    s_lshl_b32 s26, s26, 1
    s_lshr_b32 s66, s2, 7
    s_add_u32 s26, s26, s66
    s_lshr_b32 s27, s2, 3
    s_and_b32 s27, s27, 7
    s_lshr_b32 s28, s2, 6
    s_and_b32 s28, s28, 1
    v_lshrrev_b32 v20, 3, v30
    s_lshl_b32 s66, s29, 5
    v_add_u32 v20, s66, v20
    v_lshrrev_b32 v21, 4, v30
    v_and_b32 v22, 7, v30
    v_xor_b32 v21, v21, v22
    v_lshlrev_b32 v21, 4, v21
    v_xor_b32 v22, 64, v21
    v_mul_u32_u24 v23, 2048, v20
    s_mul_i32 s66, s29, 458752
    v_add_u32 v23, s66, v23
    v_add_u32 v1, v23, v21
    v_add_u32 v2, v23, v22
    v_add_u32 v2, 15360, v2
    v_add_u32 v3, v23, v21
    v_add_u32 v3, 30720, v3
    v_add_u32 v4, v23, v22
    v_add_u32 v4, 46080, v4
    v_mul_u32_u24 v23, 896, v20
    v_add_u32 v24, v23, v21
    v_add_u32 v25, v23, v22
    v_add_u32 v25, 6144, v25
    v_add_u32 v26, v23, v21
    v_add_u32 v26, 12288, v26
    v_add_u32 v27, v23, v22
    v_add_u32 v27, 18432, v27
    v_lshrrev_b32 v20, 2, v30
    v_and_b32 v20, 3, v20
    s_and_b32 s66, s29, 1
    s_lshl_b32 s66, s66, 17
    s_lshr_b32 s67, s29, 1
    s_lshl_b32 s67, s67, 8
    s_add_u32 s66, s66, s67
    v_lshlrev_b32 v21, 13, v20
    v_add_u32 v21, s66, v21
    v_lshrrev_b32 v22, 4, v30
    v_lshl_add_u32 v21, v22, 6, v21
    v_and_b32 v23, 3, v30
    v_lshl_add_u32 v5, v23, 4, v21
    v_add_u32 v6, 31744, v5
    v_xor_b32 v7, 32, v5
    v_add_u32 v7, 63488, v7
    v_add_u32 v8, 31744, v7
    s_lshl_b32 s63, s29, 12
    s_add_u32 s60, s63, 65536
    s_add_u32 s61, s63, 98304
    s_add_u32 s62, s63, 131072
    v_min_u32 v20, 17, v30
    v_lshlrev_b32 v20, 7, v20
    v_mov_b32 v21, 0
    s_mul_i32 s67, s2, 2304
    s_add_u32 s67, s67, 82837504
    s_cmp_eq_u32 s29, 0
    s_cselect_b32 s67, s67, 1073741824
    s_waitcnt lgkmcnt(0)
    s_mov_b32 s32, s6
    s_and_b32 s33, s7, 0xffff
    s_mov_b32 s34, 4194304
    s_mov_b32 s35, 0x20000
    s_cmp_eq_u32 s28, 0
    s_cselect_b32 s10, s12, s10
    s_cselect_b32 s11, s13, s11
    s_mov_b32 s36, s10
    s_and_b32 s37, s11, 0xffff
    s_mov_b32 s38, 8388608
    s_mov_b32 s39, 0x20000
    s_mov_b32 s40, s24
    s_and_b32 s41, s25, 0xffff
    s_mov_b32 s42, 268435456
    s_mov_b32 s43, 0x20000
    s_lshl_b32 s56, s27, 16
    s_lshl_b32 s57, s26, 9
    buffer_store_dword v21, v20, s[40:43], s67 offen sc1
    s_add_u32 m0, s63, 0
    s_nop 0
    buffer_load_dwordx4 v5, s[36:39], s57 offen offset:0 lds
    buffer_load_dwordx4 v6, s[36:39], s57 offen offset:1024 lds
    buffer_load_dwordx4 v7, s[36:39], s57 offen offset:2048 lds
    buffer_load_dwordx4 v8, s[36:39], s57 offen offset:3072 lds
    s_add_u32 s57, s57, 262144
    s_add_u32 s66, s56, 0
    s_add_u32 m0, s60, 0
    s_nop 0
    buffer_load_dwordx4 v1, s[32:35], s66 offen offset:0 lds
    buffer_load_dwordx4 v2, s[32:35], s66 offen offset:1024 lds
    buffer_load_dwordx4 v3, s[32:35], s66 offen offset:2048 lds
    buffer_load_dwordx4 v4, s[32:35], s66 offen offset:3072 lds
    s_mov_b32 s88, s100
    s_and_b32 s89, s101, 0xffff
    s_mov_b32 s90, 256
    s_mov_b32 s91, 0x20000
    s_lshl_b32 s74, s26, 1
    s_add_u32 s74, s74, s28
    s_lshl_b32 s74, s74, 3
    s_add_u32 s74, s74, s27
    s_lshl_b32 s74, s74, 2
    s_add_u32 s74, s74, s29
    s_cmp_lt_u32 s74, 896
    s_cbranch_scc0 F_wtb
    s_mov_b32 s52, s14
    s_and_b32 s53, s15, 0xffff
    s_mov_b32 s54, 3670016
    s_mov_b32 s55, 0x20000
    s_and_b32 s66, s74, 127
    s_mul_i32 s66, s66, 28672
    s_lshr_b32 s67, s74, 7
    s_branch F_wtc
F_wtb:
    s_mov_b32 s52, s22
    s_and_b32 s53, s23, 0xffff
    s_mov_b32 s54, 401408
    s_mov_b32 s55, 0x20000
    s_bfe_u32 s66, s74, 0x40001
    s_mul_i32 s66, s66, 25088
    s_bfe_u32 s67, s74, 0x20005
    s_lshl_b32 s67, s67, 1
    s_and_b32 s64, s74, 1
    s_add_u32 s67, s67, s64
F_wtc:
    s_lshl_b32 s67, s67, 7
    s_add_u32 s3, s67, s66
    s_lshl_b32 s74, s74, 12
    s_add_u32 s74, s74, 41943040
    s_cmp_eq_u32 s28, 0
    s_cselect_b32 s4, s4, s16
    s_cselect_b32 s5, s5, s17
    s_cselect_b32 s8, s8, s18
    s_cselect_b32 s9, s9, s19
    s_mov_b32 s66, 1204224
    s_cselect_b32 s66, 3670016, s66
    s_mov_b32 s44, s4
    s_and_b32 s45, s5, 0xffff
    s_mov_b32 s46, 1835008
    s_mov_b32 s47, 0x20000
    s_mov_b32 s48, s8
    s_and_b32 s49, s9, 0xffff
    s_mov_b32 s50, 0
    s_mov_b32 s51, 0x20000
    s_mov_b32 s50, s66
    v_and_b32 v20, 15, v30
    v_lshrrev_b32 v21, 4, v30
    v_lshrrev_b32 v22, 1, v20
    v_xor_b32 v22, v22, v21
    v_lshlrev_b32 v22, 4, v22
    v_lshl_add_u32 v22, v20, 7, v22
    s_lshr_b32 s66, s29, 1
    s_lshl_b32 s66, s66, 14
    s_sub_u32 s66, s66, s63
    v_add_u32 v9, s66, v22
    v_xor_b32 v22, 64, v22
    v_add_u32 v10, s66, v22
    v_lshrrev_b32 v22, 2, v20
    v_lshlrev_b32 v22, 6, v22
    v_and_b32 v23, 3, v20
    v_lshl_add_u32 v22, v23, 3, v22
    v_and_b32 v23, 1, v21
    v_lshl_add_u32 v22, v23, 5, v22
    v_mov_b32 v31, v22
    v_lshl_add_u32 v22, v21, 11, v22
    s_and_b32 s66, s29, 1
    s_lshl_b32 s66, s66, 13
    v_add_u32 v13, s66, v22
    v_xor_b32 v14, 32, v13
    v_add_u32 v11, s60, v9
    v_add_u32 v12, s60, v10
    s_cmp_eq_u32 s28, 1
    s_cbranch_scc1 F_kb
    s_lshl_b32 s59, s26, 9
    s_sub_u32 s66, 15, s27
    s_mul_i32 s58, s66, 114688
    s_mul_i32 s69, s27, 114688
    s_sub_u32 s69, s69, s58
    s_lshl_b32 s65, s26, 21
    s_lshl_b32 s66, s27, 15
    s_add_u32 s65, s65, s66
    s_lshr_b32 s66, s29, 1
    s_lshl_b32 s66, s66, 20
    s_add_u32 s65, s65, s66
    s_and_b32 s66, s29, 1
    s_lshl_b32 s66, s66, 13
    s_add_u32 s65, s65, s66
    s_add_u32 s65, s65, 16384
    s_lshr_b32 s66, s2, 7
    s_lshl_b32 s66, s66, 6
    s_and_b32 s67, s2, 63
    s_add_u32 s66, s66, s67
    s_lshl_b32 s66, s66, 2
    s_add_u32 s66, s66, s29
    s_mul_i32 s76, s66, 3584
    s_mul_i32 s77, s66, 7168
    s_mov_b32 s78, s3
    v_bfe_u32 v20, v30, 1, 3
    v_lshrrev_b32 v21, 4, v30
    v_lshlrev_b32 v21, 2, v21
    v_sub_u32 v20, v20, v21
    v_and_b32 v21, 1, v30
    v_lshlrev_b32 v21, 4, v21
    v_mov_b32 v22, 0x3f80
    v_lshlrev_b32 v21, v21, v22
    v_cmp_eq_i32 vcc, 0, v20
    s_nop 1
    v_cndmask_b32 v22, 0, v21, vcc
    v_accvgpr_write_b32 a240, v22
    v_cmp_eq_i32 vcc, 1, v20
    s_nop 1
    v_cndmask_b32 v22, 0, v21, vcc
    v_accvgpr_write_b32 a241, v22
    v_cmp_eq_i32 vcc, 2, v20
    s_nop 1
    v_cndmask_b32 v22, 0, v21, vcc
    v_accvgpr_write_b32 a242, v22
    v_cmp_eq_i32 vcc, 3, v20
    s_nop 1
    v_cndmask_b32 v22, 0, v21, vcc
    v_accvgpr_write_b32 a243, v22
    v_cmp_eq_i32 vcc, -8, v20
    s_nop 1
    v_cndmask_b32 v22, 0, v21, vcc
    v_accvgpr_write_b32 a244, v22
    v_cmp_eq_i32 vcc, -7, v20
    s_nop 1
    v_cndmask_b32 v22, 0, v21, vcc
    v_accvgpr_write_b32 a245, v22
    v_cmp_eq_i32 vcc, -6, v20
    s_nop 1
    v_cndmask_b32 v22, 0, v21, vcc
    v_accvgpr_write_b32 a246, v22
    v_cmp_eq_i32 vcc, -5, v20
    s_nop 1
    v_cndmask_b32 v22, 0, v21, vcc
    v_accvgpr_write_b32 a247, v22
    s_nop 1
    v_min_u32 v16, 2, v30
    v_lshlrev_b32 v16, 7, v16
    v_min_u32 v18, 5, v30
    v_lshlrev_b32 v18, 7, v18
    v_min_u32 v19, 2, v30
    v_mul_u32_u24 v19, 896, v19
    s_lshr_b32 s66, s2, 7
    s_lshl_b32 s66, s66, 3
    s_add_u32 s66, s66, s27
    s_lshl_b32 s66, s66, 2
    s_add_u32 s66, s66, s29
    s_lshl_b32 s66, s66, 9
    s_add_u32 s66, s66, F_vloop_x-F_pc
    v_min_u32 v20, 3, v30
    v_lshlrev_b32 v20, 7, v20
    v_add_u32 v20, s66, v20
    v_lshlrev_b32 v21, 8, v30
    v_mov_b32 v22, 1
    s_lshl_b32 s75, s29, 8
    s_add_u32 s75, s75, s2
    s_add_u32 s98, s27, 5
    s_add_u32 s66, s56, 2097152
    s_add_u32 m0, s60, 16384
    s_nop 0
    buffer_load_dwordx4 v1, s[32:35], s66 offen offset:0 lds
    buffer_load_dwordx4 v2, s[32:35], s66 offen offset:1024 lds
    buffer_load_dwordx4 v3, s[32:35], s66 offen offset:2048 lds
    buffer_load_dwordx4 v4, s[32:35], s66 offen offset:3072 lds
    s_add_u32 s56, s56, 128
    s_add_u32 m0, s63, 16384
    s_nop 0
    buffer_load_dwordx4 v5, s[36:39], s57 offen offset:0 lds
    buffer_load_dwordx4 v6, s[36:39], s57 offen offset:1024 lds
    buffer_load_dwordx4 v7, s[36:39], s57 offen offset:2048 lds
    buffer_load_dwordx4 v8, s[36:39], s57 offen offset:3072 lds
    s_add_u32 s57, s57, 262144
    s_add_u32 m0, s63, 32768
    s_nop 0
    buffer_load_dwordx4 v5, s[36:39], s57 offen offset:0 lds
    buffer_load_dwordx4 v6, s[36:39], s57 offen offset:1024 lds
    buffer_load_dwordx4 v7, s[36:39], s57 offen offset:2048 lds
    buffer_load_dwordx4 v8, s[36:39], s57 offen offset:3072 lds
    s_add_u32 s57, s57, 262144
    s_add_u32 s66, s56, 0
    s_add_u32 m0, s61, 0
    s_nop 0
    buffer_load_dwordx4 v1, s[32:35], s66 offen offset:0 lds
    buffer_load_dwordx4 v2, s[32:35], s66 offen offset:1024 lds
    buffer_load_dwordx4 v3, s[32:35], s66 offen offset:2048 lds
    buffer_load_dwordx4 v4, s[32:35], s66 offen offset:3072 lds
    s_lshl_b32 s66, s2, 2
    s_add_u32 s66, s66, s29
    s_lshl_b32 s66, s66, 12
    v_lshlrev_b32 v23, 2, v15
    v_and_b32 v23, 2559, v23
    buffer_load_dword a248, v23, s[32:35], s66 offen
    s_lshl_b32 s67, s27, 2
    s_add_u32 s67, s67, s29
    s_mul_i32 s67, s67, 32768
    s_lshl_b32 s99, s26, 9
    s_add_u32 s67, s67, s99
    s_add_u32 s67, s67, 786432
    v_lshrrev_b32 v23, 2, v30
    v_min_u32 v23, 3, v23
    v_lshlrev_b32 v23, 6, v23
    v_and_or_b32 v23, v30, 3, v23
    v_lshlrev_b32 v23, 7, v23
    buffer_load_dword a249, v23, s[36:39], s67 offen
    s_waitcnt vmcnt(10)
    s_barrier
    ds_read_b128 a[96:99], v11 offset:0
    ds_read_b64_tr_b16 a[32:33], v13 offset:0
    ds_read_b64_tr_b16 a[34:35], v13 offset:1024
    ds_read_b128 a[100:103], v12 offset:0
    ds_read_b64_tr_b16 a[36:37], v14 offset:0
    ds_read_b64_tr_b16 a[38:39], v14 offset:1024
    ds_read_b128 a[104:107], v11 offset:2048
    ds_read_b64_tr_b16 a[40:41], v13 offset:256
    ds_read_b64_tr_b16 a[42:43], v13 offset:1280
    ds_read_b128 a[108:111], v12 offset:2048
    ds_read_b64_tr_b16 a[44:45], v14 offset:256
    ds_read_b64_tr_b16 a[46:47], v14 offset:1280
    ds_read_b128 a[112:115], v11 offset:4096
    ds_read_b64_tr_b16 a[48:49], v13 offset:512
    ds_read_b64_tr_b16 a[50:51], v13 offset:1536
    ds_read_b128 a[116:119], v12 offset:4096
    ds_read_b64_tr_b16 a[52:53], v14 offset:512
    ds_read_b64_tr_b16 a[54:55], v14 offset:1536
    ds_read_b128 a[120:123], v11 offset:6144
    ds_read_b64_tr_b16 a[56:57], v13 offset:768
    ds_read_b64_tr_b16 a[58:59], v13 offset:1792
    ds_read_b128 a[124:127], v12 offset:6144
    ds_read_b64_tr_b16 a[60:61], v14 offset:768
    ds_read_b64_tr_b16 a[62:63], v14 offset:1792
    ds_read_b64_tr_b16 a[64:65], v13 offset:16384
    ds_read_b64_tr_b16 a[66:67], v13 offset:17408
    ds_read_b64_tr_b16 a[68:69], v14 offset:16384
    ds_read_b64_tr_b16 a[70:71], v14 offset:17408
    ds_read_b64_tr_b16 a[72:73], v13 offset:16640
    ds_read_b64_tr_b16 a[74:75], v13 offset:17664
    ds_read_b64_tr_b16 a[76:77], v14 offset:16640
    ds_read_b64_tr_b16 a[78:79], v14 offset:17664
    ds_read_b64_tr_b16 a[80:81], v13 offset:16896
    ds_read_b64_tr_b16 a[82:83], v13 offset:17920
    ds_read_b64_tr_b16 a[84:85], v14 offset:16896
    ds_read_b64_tr_b16 a[86:87], v14 offset:17920
    ds_read_b64_tr_b16 a[88:89], v13 offset:17152
    ds_read_b64_tr_b16 a[90:91], v13 offset:18176
    ds_read_b64_tr_b16 a[92:93], v14 offset:17152
    ds_read_b64_tr_b16 a[94:95], v14 offset:18176
    s_waitcnt vmcnt(6) lgkmcnt(0)
    s_barrier
    v_mfma_f32_16x16x32_bf16 v[32:35], a[96:99], a[32:35], 0
    s_add_u32 s66, s56, 2097152
    ds_read_b128 a[128:131], v11 offset:8192
    s_add_u32 m0, s61, 16384
    v_mfma_f32_16x16x32_bf16 v[32:35], a[100:103], a[64:67], v[32:35]
    buffer_load_dwordx4 v1, s[32:35], s66 offen offset:0 lds
    v_mfma_f32_16x16x32_bf16 v[36:39], a[108:111], a[64:67], 0
    ds_read_b64_tr_b16 a[160:161], v13 offset:32768
    v_mfma_f32_16x16x32_bf16 v[36:39], a[104:107], a[32:35], v[36:39]
    v_mfma_f32_16x16x32_bf16 v[44:47], a[104:107], a[36:39], 0
    ds_read_b64_tr_b16 a[162:163], v13 offset:33792
    v_mfma_f32_16x16x32_bf16 v[44:47], a[108:111], a[68:71], v[44:47]
    v_mfma_f32_16x16x32_bf16 v[40:43], a[100:103], a[68:71], 0
    buffer_load_dwordx4 v2, s[32:35], s66 offen offset:1024 lds
    v_mfma_f32_16x16x32_bf16 v[40:43], a[96:99], a[36:39], v[40:43]
    ds_read_b128 a[132:135], v12 offset:8192
    v_mfma_f32_16x16x32_bf16 v[48:51], a[96:99], a[40:43], 0
    ds_read_b64_tr_b16 a[164:165], v14 offset:32768
    v_mfma_f32_16x16x32_bf16 v[48:51], a[100:103], a[72:75], v[48:51]
    v_mfma_f32_16x16x32_bf16 v[52:55], a[108:111], a[72:75], 0
    ds_read_b64_tr_b16 a[166:167], v14 offset:33792
    v_mfma_f32_16x16x32_bf16 v[52:55], a[104:107], a[40:43], v[52:55]
    buffer_load_dwordx4 v3, s[32:35], s66 offen offset:2048 lds
    v_mfma_f32_16x16x32_bf16 v[60:63], a[104:107], a[44:47], 0
    ds_read_b128 a[136:139], v11 offset:10240
    v_mfma_f32_16x16x32_bf16 v[60:63], a[108:111], a[76:79], v[60:63]
    v_mfma_f32_16x16x32_bf16 v[56:59], a[100:103], a[76:79], 0
    ds_read_b64_tr_b16 a[168:169], v13 offset:33024
    v_mfma_f32_16x16x32_bf16 v[56:59], a[96:99], a[44:47], v[56:59]
    v_mfma_f32_16x16x32_bf16 v[64:67], a[96:99], a[48:51], 0
    buffer_load_dwordx4 v4, s[32:35], s66 offen offset:3072 lds
    v_mfma_f32_16x16x32_bf16 v[64:67], a[100:103], a[80:83], v[64:67]
    ds_read_b64_tr_b16 a[170:171], v13 offset:34048
    v_mfma_f32_16x16x32_bf16 v[68:71], a[108:111], a[80:83], 0
    ds_read_b128 a[140:143], v12 offset:10240
    v_mfma_f32_16x16x32_bf16 v[68:71], a[104:107], a[48:51], v[68:71]
    s_add_u32 s56, s56, 128
    s_add_u32 m0, s63, 49152
    v_mfma_f32_16x16x32_bf16 v[76:79], a[104:107], a[52:55], 0
    ds_read_b64_tr_b16 a[172:173], v14 offset:33024
    v_mfma_f32_16x16x32_bf16 v[76:79], a[108:111], a[84:87], v[76:79]
    buffer_load_dwordx4 v5, s[36:39], s57 offen offset:0 lds
    v_mfma_f32_16x16x32_bf16 v[72:75], a[100:103], a[84:87], 0
    ds_read_b64_tr_b16 a[174:175], v14 offset:34048
    v_mfma_f32_16x16x32_bf16 v[72:75], a[96:99], a[52:55], v[72:75]
    v_mfma_f32_16x16x32_bf16 v[80:83], a[96:99], a[56:59], 0
    ds_read_b128 a[144:147], v11 offset:12288
    v_mfma_f32_16x16x32_bf16 v[80:83], a[100:103], a[88:91], v[80:83]
    v_mfma_f32_16x16x32_bf16 v[84:87], a[108:111], a[88:91], 0
    buffer_load_dwordx4 v6, s[36:39], s57 offen offset:1024 lds
    v_mfma_f32_16x16x32_bf16 v[84:87], a[104:107], a[56:59], v[84:87]
    ds_read_b64_tr_b16 a[176:177], v13 offset:33280
    v_mfma_f32_16x16x32_bf16 v[92:95], a[104:107], a[60:63], 0
    ds_read_b64_tr_b16 a[178:179], v13 offset:34304
    v_mfma_f32_16x16x32_bf16 v[92:95], a[108:111], a[92:95], v[92:95]
    v_mfma_f32_16x16x32_bf16 v[88:91], a[100:103], a[92:95], 0
    ds_read_b128 a[148:151], v12 offset:12288
    v_mfma_f32_16x16x32_bf16 v[88:91], a[96:99], a[60:63], v[88:91]
    buffer_load_dwordx4 v7, s[36:39], s57 offen offset:2048 lds
    v_mfma_f32_16x16x32_bf16 v[96:99], a[112:115], a[60:63], 0
    ds_read_b64_tr_b16 a[180:181], v14 offset:33280
    v_mfma_f32_16x16x32_bf16 v[96:99], a[116:119], a[92:95], v[96:99]
    v_mfma_f32_16x16x32_bf16 v[100:103], a[124:127], a[92:95], 0
    ds_read_b64_tr_b16 a[182:183], v14 offset:34304
    v_mfma_f32_16x16x32_bf16 v[100:103], a[120:123], a[60:63], v[100:103]
    v_mfma_f32_16x16x32_bf16 v[108:111], a[120:123], a[56:59], 0
    buffer_load_dwordx4 v8, s[36:39], s57 offen offset:3072 lds
    v_mfma_f32_16x16x32_bf16 v[108:111], a[124:127], a[88:91], v[108:111]
    ds_read_b128 a[152:155], v11 offset:14336
    v_mfma_f32_16x16x32_bf16 v[104:107], a[116:119], a[88:91], 0
    ds_read_b64_tr_b16 a[184:185], v13 offset:33536
    v_mfma_f32_16x16x32_bf16 v[104:107], a[112:115], a[56:59], v[104:107]
    s_add_u32 s57, s57, 262144
    s_add_u32 m0, s63, 0
    v_mfma_f32_16x16x32_bf16 v[112:115], a[112:115], a[52:55], 0
    ds_read_b64_tr_b16 a[186:187], v13 offset:34560
    v_mfma_f32_16x16x32_bf16 v[112:115], a[116:119], a[84:87], v[112:115]
    buffer_load_dwordx4 v5, s[36:39], s57 offen offset:0 lds
    v_mfma_f32_16x16x32_bf16 v[116:119], a[124:127], a[84:87], 0
    ds_read_b128 a[156:159], v12 offset:14336
    v_mfma_f32_16x16x32_bf16 v[116:119], a[120:123], a[52:55], v[116:119]
    v_mfma_f32_16x16x32_bf16 v[124:127], a[120:123], a[48:51], 0
    ds_read_b64_tr_b16 a[188:189], v14 offset:33536
    v_mfma_f32_16x16x32_bf16 v[124:127], a[124:127], a[80:83], v[124:127]
    v_mfma_f32_16x16x32_bf16 v[120:123], a[116:119], a[80:83], 0
    buffer_load_dwordx4 v6, s[36:39], s57 offen offset:1024 lds
    v_mfma_f32_16x16x32_bf16 v[120:123], a[112:115], a[48:51], v[120:123]
    ds_read_b64_tr_b16 a[190:191], v14 offset:34560
    v_mfma_f32_16x16x32_bf16 v[128:131], a[112:115], a[44:47], 0
    v_add_u32 v11, s61, v9
    v_add_u32 v12, s61, v10
    v_mfma_f32_16x16x32_bf16 v[128:131], a[116:119], a[76:79], v[128:131]
    v_mfma_f32_16x16x32_bf16 v[132:135], a[124:127], a[76:79], 0
    v_mfma_f32_16x16x32_bf16 v[132:135], a[120:123], a[44:47], v[132:135]
    buffer_load_dwordx4 v7, s[36:39], s57 offen offset:2048 lds
    v_mfma_f32_16x16x32_bf16 v[140:143], a[120:123], a[40:43], 0
    v_mfma_f32_16x16x32_bf16 v[140:143], a[124:127], a[72:75], v[140:143]
    v_mfma_f32_16x16x32_bf16 v[136:139], a[116:119], a[72:75], 0
    v_mfma_f32_16x16x32_bf16 v[136:139], a[112:115], a[40:43], v[136:139]
    v_mfma_f32_16x16x32_bf16 v[144:147], a[112:115], a[36:39], 0
    buffer_load_dwordx4 v8, s[36:39], s57 offen offset:3072 lds
    v_mfma_f32_16x16x32_bf16 v[144:147], a[116:119], a[68:71], v[144:147]
    v_mfma_f32_16x16x32_bf16 v[148:151], a[124:127], a[68:71], 0
    v_mfma_f32_16x16x32_bf16 v[148:151], a[120:123], a[36:39], v[148:151]
    s_add_u32 s57, s57, 262144
    v_mfma_f32_16x16x32_bf16 v[156:159], a[120:123], a[32:35], 0
    v_mfma_f32_16x16x32_bf16 v[156:159], a[124:127], a[64:67], v[156:159]
    v_mfma_f32_16x16x32_bf16 v[152:155], a[116:119], a[64:67], 0
    v_mfma_f32_16x16x32_bf16 v[152:155], a[112:115], a[32:35], v[152:155]
    s_waitcnt vmcnt(4) lgkmcnt(0)
    s_barrier
    v_mfma_f32_16x16x32_bf16 v[160:163], a[128:131], a[32:35], 0
    s_add_u32 s66, s56, 0
    ds_read_b128 a[96:99], v11 offset:0
    s_add_u32 m0, s62, 0
    v_mfma_f32_16x16x32_bf16 v[160:163], a[132:135], a[64:67], v[160:163]
    buffer_load_dwordx4 v1, s[32:35], s66 offen offset:0 lds
    v_mfma_f32_16x16x32_bf16 v[164:167], a[140:143], a[64:67], 0
    ds_read_b64_tr_b16 a[192:193], v13 offset:49152
    v_mfma_f32_16x16x32_bf16 v[164:167], a[136:139], a[32:35], v[164:167]
    v_mfma_f32_16x16x32_bf16 v[172:175], a[136:139], a[36:39], 0
    ds_read_b64_tr_b16 a[194:195], v13 offset:50176
    v_mfma_f32_16x16x32_bf16 v[172:175], a[140:143], a[68:71], v[172:175]
    v_mfma_f32_16x16x32_bf16 v[168:171], a[132:135], a[68:71], 0
    buffer_load_dwordx4 v2, s[32:35], s66 offen offset:1024 lds
    v_mfma_f32_16x16x32_bf16 v[168:171], a[128:131], a[36:39], v[168:171]
    ds_read_b128 a[100:103], v12 offset:0
    v_mfma_f32_16x16x32_bf16 v[176:179], a[128:131], a[40:43], 0
    ds_read_b64_tr_b16 a[196:197], v14 offset:49152
    v_mfma_f32_16x16x32_bf16 v[176:179], a[132:135], a[72:75], v[176:179]
    v_mfma_f32_16x16x32_bf16 v[180:183], a[140:143], a[72:75], 0
    ds_read_b64_tr_b16 a[198:199], v14 offset:50176
    v_mfma_f32_16x16x32_bf16 v[180:183], a[136:139], a[40:43], v[180:183]
    buffer_load_dwordx4 v3, s[32:35], s66 offen offset:2048 lds
    v_mfma_f32_16x16x32_bf16 v[188:191], a[136:139], a[44:47], 0
    ds_read_b128 a[104:107], v11 offset:2048
    v_mfma_f32_16x16x32_bf16 v[188:191], a[140:143], a[76:79], v[188:191]
    v_mfma_f32_16x16x32_bf16 v[184:187], a[132:135], a[76:79], 0
    ds_read_b64_tr_b16 a[200:201], v13 offset:49408
    v_mfma_f32_16x16x32_bf16 v[184:187], a[128:131], a[44:47], v[184:187]
    v_mfma_f32_16x16x32_bf16 v[192:195], a[128:131], a[48:51], 0
    buffer_load_dwordx4 v4, s[32:35], s66 offen offset:3072 lds
    v_mfma_f32_16x16x32_bf16 v[192:195], a[132:135], a[80:83], v[192:195]
    ds_read_b64_tr_b16 a[202:203], v13 offset:50432
    v_mfma_f32_16x16x32_bf16 v[196:199], a[140:143], a[80:83], 0
    ds_read_b128 a[108:111], v12 offset:2048
    v_mfma_f32_16x16x32_bf16 v[196:199], a[136:139], a[48:51], v[196:199]
    s_add_u32 s66, s56, 2097152
    s_add_u32 m0, s62, 16384
    v_mfma_f32_16x16x32_bf16 v[204:207], a[136:139], a[52:55], 0
    ds_read_b64_tr_b16 a[204:205], v14 offset:49408
    v_mfma_f32_16x16x32_bf16 v[204:207], a[140:143], a[84:87], v[204:207]
    buffer_load_dwordx4 v1, s[32:35], s66 offen offset:0 lds
    v_mfma_f32_16x16x32_bf16 v[200:203], a[132:135], a[84:87], 0
    ds_read_b64_tr_b16 a[206:207], v14 offset:50432
    v_mfma_f32_16x16x32_bf16 v[200:203], a[128:131], a[52:55], v[200:203]
    v_mfma_f32_16x16x32_bf16 v[208:211], a[128:131], a[56:59], 0
    ds_read_b128 a[112:115], v11 offset:4096
    v_mfma_f32_16x16x32_bf16 v[208:211], a[132:135], a[88:91], v[208:211]
    v_mfma_f32_16x16x32_bf16 v[212:215], a[140:143], a[88:91], 0
    buffer_load_dwordx4 v2, s[32:35], s66 offen offset:1024 lds
    v_mfma_f32_16x16x32_bf16 v[212:215], a[136:139], a[56:59], v[212:215]
    ds_read_b64_tr_b16 a[208:209], v13 offset:49664
    v_mfma_f32_16x16x32_bf16 v[220:223], a[136:139], a[60:63], 0
    ds_read_b64_tr_b16 a[210:211], v13 offset:50688
    v_mfma_f32_16x16x32_bf16 v[220:223], a[140:143], a[92:95], v[220:223]
    v_mfma_f32_16x16x32_bf16 v[216:219], a[132:135], a[92:95], 0
    ds_read_b128 a[116:119], v12 offset:4096
    v_mfma_f32_16x16x32_bf16 v[216:219], a[128:131], a[60:63], v[216:219]
    buffer_load_dwordx4 v3, s[32:35], s66 offen offset:2048 lds
    v_mfma_f32_16x16x32_bf16 v[224:227], a[144:147], a[60:63], 0
    ds_read_b64_tr_b16 a[212:213], v14 offset:49664
    v_mfma_f32_16x16x32_bf16 v[224:227], a[148:151], a[92:95], v[224:227]
    v_mfma_f32_16x16x32_bf16 v[228:231], a[156:159], a[92:95], 0
    ds_read_b64_tr_b16 a[214:215], v14 offset:50688
    v_mfma_f32_16x16x32_bf16 v[228:231], a[152:155], a[60:63], v[228:231]
    v_mfma_f32_16x16x32_bf16 v[236:239], a[152:155], a[56:59], 0
    buffer_load_dwordx4 v4, s[32:35], s66 offen offset:3072 lds
    v_mfma_f32_16x16x32_bf16 v[236:239], a[156:159], a[88:91], v[236:239]
    ds_read_b128 a[120:123], v11 offset:6144
    v_mfma_f32_16x16x32_bf16 v[232:235], a[148:151], a[88:91], 0
    ds_read_b64_tr_b16 a[216:217], v13 offset:49920
    v_mfma_f32_16x16x32_bf16 v[232:235], a[144:147], a[56:59], v[232:235]
    s_add_u32 s56, s56, 128
    s_add_u32 m0, s63, 16384
    v_mfma_f32_16x16x32_bf16 v[240:243], a[144:147], a[52:55], 0
    ds_read_b64_tr_b16 a[218:219], v13 offset:50944
    v_mfma_f32_16x16x32_bf16 v[240:243], a[148:151], a[84:87], v[240:243]
    buffer_load_dwordx4 v5, s[36:39], s57 offen offset:0 lds
    v_mfma_f32_16x16x32_bf16 v[244:247], a[156:159], a[84:87], 0
    ds_read_b128 a[124:127], v12 offset:6144
    v_mfma_f32_16x16x32_bf16 v[244:247], a[152:155], a[52:55], v[244:247]
    v_mfma_f32_16x16x32_bf16 v[252:255], a[152:155], a[48:51], 0
    ds_read_b64_tr_b16 a[220:221], v14 offset:49920
    v_mfma_f32_16x16x32_bf16 v[252:255], a[156:159], a[80:83], v[252:255]
    v_mfma_f32_16x16x32_bf16 v[248:251], a[148:151], a[80:83], 0
    buffer_load_dwordx4 v6, s[36:39], s57 offen offset:1024 lds
    v_mfma_f32_16x16x32_bf16 v[248:251], a[144:147], a[48:51], v[248:251]
    ds_read_b64_tr_b16 a[222:223], v14 offset:50944
    v_mfma_f32_16x16x32_bf16 a[0:3], a[144:147], a[44:47], 0
    v_mfma_f32_16x16x32_bf16 a[0:3], a[148:151], a[76:79], a[0:3]
    v_mfma_f32_16x16x32_bf16 a[4:7], a[156:159], a[76:79], 0
    v_mfma_f32_16x16x32_bf16 a[4:7], a[152:155], a[44:47], a[4:7]
    buffer_load_dwordx4 v7, s[36:39], s57 offen offset:2048 lds
    v_mfma_f32_16x16x32_bf16 a[12:15], a[152:155], a[40:43], 0
    v_mfma_f32_16x16x32_bf16 a[12:15], a[156:159], a[72:75], a[12:15]
    v_mfma_f32_16x16x32_bf16 a[8:11], a[148:151], a[72:75], 0
    v_mfma_f32_16x16x32_bf16 a[8:11], a[144:147], a[40:43], a[8:11]
    v_mfma_f32_16x16x32_bf16 a[16:19], a[144:147], a[36:39], 0
    buffer_load_dwordx4 v8, s[36:39], s57 offen offset:3072 lds
    v_mfma_f32_16x16x32_bf16 a[16:19], a[148:151], a[68:71], a[16:19]
    v_mfma_f32_16x16x32_bf16 a[20:23], a[156:159], a[68:71], 0
    v_mfma_f32_16x16x32_bf16 a[20:23], a[152:155], a[36:39], a[20:23]
    s_add_u32 s57, s57, 262144
    v_mfma_f32_16x16x32_bf16 a[28:31], a[152:155], a[32:35], 0
    v_mfma_f32_16x16x32_bf16 a[28:31], a[156:159], a[64:67], a[28:31]
    s_mov_b32 s67, s60
    s_mov_b32 s60, s61
    s_mov_b32 s61, s62
    v_mfma_f32_16x16x32_bf16 a[24:27], a[148:151], a[64:67], 0
    s_mov_b32 s62, s67
    v_mfma_f32_16x16x32_bf16 a[24:27], a[144:147], a[32:35], a[24:27]
    s_waitcnt vmcnt(12) lgkmcnt(0)
    s_barrier
    v_mfma_f32_16x16x32_bf16 v[32:35], a[96:99], a[160:163], v[32:35]
    s_add_u32 m0, s63, 32768
    ds_read_b128 a[128:131], v11 offset:8192
    v_mfma_f32_16x16x32_bf16 v[32:35], a[100:103], a[192:195], v[32:35]
    buffer_load_dwordx4 v5, s[36:39], s57 offen offset:0 lds
    v_mfma_f32_16x16x32_bf16 v[36:39], a[108:111], a[192:195], v[36:39]
    ds_read_b64_tr_b16 a[32:33], v13 offset:0
    v_mfma_f32_16x16x32_bf16 v[36:39], a[104:107], a[160:163], v[36:39]
    v_mfma_f32_16x16x32_bf16 v[44:47], a[104:107], a[164:167], v[44:47]
    ds_read_b64_tr_b16 a[34:35], v13 offset:1024
    v_mfma_f32_16x16x32_bf16 v[44:47], a[108:111], a[196:199], v[44:47]
    buffer_load_dwordx4 v6, s[36:39], s57 offen offset:1024 lds
    v_mfma_f32_16x16x32_bf16 v[40:43], a[100:103], a[196:199], v[40:43]
    ds_read_b128 a[132:135], v12 offset:8192
    v_mfma_f32_16x16x32_bf16 v[40:43], a[96:99], a[164:167], v[40:43]
    v_mfma_f32_16x16x32_bf16 v[48:51], a[96:99], a[168:171], v[48:51]
    ds_read_b64_tr_b16 a[36:37], v14 offset:0
    v_mfma_f32_16x16x32_bf16 v[48:51], a[100:103], a[200:203], v[48:51]
    buffer_load_dwordx4 v7, s[36:39], s57 offen offset:2048 lds
    v_mfma_f32_16x16x32_bf16 v[52:55], a[108:111], a[200:203], v[52:55]
    ds_read_b64_tr_b16 a[38:39], v14 offset:1024
    v_mfma_f32_16x16x32_bf16 v[52:55], a[104:107], a[168:171], v[52:55]
    v_mfma_f32_16x16x32_bf16 v[60:63], a[104:107], a[172:175], v[60:63]
    ds_read_b128 a[136:139], v11 offset:10240
    v_mfma_f32_16x16x32_bf16 v[60:63], a[108:111], a[204:207], v[60:63]
    buffer_load_dwordx4 v8, s[36:39], s57 offen offset:3072 lds
    v_mfma_f32_16x16x32_bf16 v[56:59], a[100:103], a[204:207], v[56:59]
    ds_read_b64_tr_b16 a[40:41], v13 offset:256
    v_mfma_f32_16x16x32_bf16 v[56:59], a[96:99], a[172:175], v[56:59]
    s_add_u32 s57, s57, 262144
    s_add_u32 s66, s56, 0
    s_add_u32 m0, s62, 0
    v_mfma_f32_16x16x32_bf16 v[64:67], a[96:99], a[176:179], v[64:67]
    ds_read_b64_tr_b16 a[42:43], v13 offset:1280
    v_mfma_f32_16x16x32_bf16 v[64:67], a[100:103], a[208:211], v[64:67]
    buffer_load_dwordx4 v1, s[32:35], s66 offen offset:0 lds
    v_mfma_f32_16x16x32_bf16 v[68:71], a[108:111], a[208:211], v[68:71]
    ds_read_b128 a[140:143], v12 offset:10240
    v_mfma_f32_16x16x32_bf16 v[68:71], a[104:107], a[176:179], v[68:71]
    v_mfma_f32_16x16x32_bf16 v[76:79], a[104:107], a[180:183], v[76:79]
    ds_read_b64_tr_b16 a[44:45], v14 offset:256
    v_mfma_f32_16x16x32_bf16 v[76:79], a[108:111], a[212:215], v[76:79]
    buffer_load_dwordx4 v2, s[32:35], s66 offen offset:1024 lds
    v_mfma_f32_16x16x32_bf16 v[72:75], a[100:103], a[212:215], v[72:75]
    ds_read_b64_tr_b16 a[46:47], v14 offset:1280
    v_mfma_f32_16x16x32_bf16 v[72:75], a[96:99], a[180:183], v[72:75]
    v_mfma_f32_16x16x32_bf16 v[80:83], a[96:99], a[184:187], v[80:83]
    ds_read_b128 a[144:147], v11 offset:12288
    v_mfma_f32_16x16x32_bf16 v[80:83], a[100:103], a[216:219], v[80:83]
    buffer_load_dwordx4 v3, s[32:35], s66 offen offset:2048 lds
    v_mfma_f32_16x16x32_bf16 v[84:87], a[108:111], a[216:219], v[84:87]
    ds_read_b64_tr_b16 a[48:49], v13 offset:512
    v_mfma_f32_16x16x32_bf16 v[84:87], a[104:107], a[184:187], v[84:87]
    v_mfma_f32_16x16x32_bf16 v[92:95], a[104:107], a[188:191], v[92:95]
    ds_read_b64_tr_b16 a[50:51], v13 offset:1536
    v_mfma_f32_16x16x32_bf16 v[92:95], a[108:111], a[220:223], v[92:95]
    buffer_load_dwordx4 v4, s[32:35], s66 offen offset:3072 lds
    v_mfma_f32_16x16x32_bf16 v[88:91], a[100:103], a[220:223], v[88:91]
    ds_read_b128 a[148:151], v12 offset:12288
    v_mfma_f32_16x16x32_bf16 v[88:91], a[96:99], a[188:191], v[88:91]
    s_add_u32 s66, s56, 2097152
    s_add_u32 m0, s62, 16384
    v_mfma_f32_16x16x32_bf16 v[96:99], a[112:115], a[188:191], v[96:99]
    ds_read_b64_tr_b16 a[52:53], v14 offset:512
    v_mfma_f32_16x16x32_bf16 v[96:99], a[116:119], a[220:223], v[96:99]
    buffer_load_dwordx4 v1, s[32:35], s66 offen offset:0 lds
    v_mfma_f32_16x16x32_bf16 v[100:103], a[124:127], a[220:223], v[100:103]
    ds_read_b64_tr_b16 a[54:55], v14 offset:1536
    v_mfma_f32_16x16x32_bf16 v[100:103], a[120:123], a[188:191], v[100:103]
    v_mfma_f32_16x16x32_bf16 v[108:111], a[120:123], a[184:187], v[108:111]
    ds_read_b128 a[152:155], v11 offset:14336
    v_mfma_f32_16x16x32_bf16 v[108:111], a[124:127], a[216:219], v[108:111]
    buffer_load_dwordx4 v2, s[32:35], s66 offen offset:1024 lds
    v_mfma_f32_16x16x32_bf16 v[104:107], a[116:119], a[216:219], v[104:107]
    ds_read_b64_tr_b16 a[56:57], v13 offset:768
    v_mfma_f32_16x16x32_bf16 v[104:107], a[112:115], a[184:187], v[104:107]
    v_mfma_f32_16x16x32_bf16 v[112:115], a[112:115], a[180:183], v[112:115]
    ds_read_b64_tr_b16 a[58:59], v13 offset:1792
    v_mfma_f32_16x16x32_bf16 v[112:115], a[116:119], a[212:215], v[112:115]
    buffer_load_dwordx4 v3, s[32:35], s66 offen offset:2048 lds
    v_mfma_f32_16x16x32_bf16 v[116:119], a[124:127], a[212:215], v[116:119]
    ds_read_b128 a[156:159], v12 offset:14336
    v_mfma_f32_16x16x32_bf16 v[116:119], a[120:123], a[180:183], v[116:119]
    v_mfma_f32_16x16x32_bf16 v[124:127], a[120:123], a[176:179], v[124:127]
    ds_read_b64_tr_b16 a[60:61], v14 offset:768
    v_mfma_f32_16x16x32_bf16 v[124:127], a[124:127], a[208:211], v[124:127]
    buffer_load_dwordx4 v4, s[32:35], s66 offen offset:3072 lds
    v_mfma_f32_16x16x32_bf16 v[120:123], a[116:119], a[208:211], v[120:123]
    ds_read_b64_tr_b16 a[62:63], v14 offset:1792
    v_mfma_f32_16x16x32_bf16 v[120:123], a[112:115], a[176:179], v[120:123]
    s_add_u32 s56, s56, 128
    s_add_u32 m0, s63, 49152
    v_mfma_f32_16x16x32_bf16 v[128:131], a[112:115], a[172:175], v[128:131]
    v_add_u32 v11, s61, v9
    v_add_u32 v12, s61, v10
    v_mfma_f32_16x16x32_bf16 v[128:131], a[116:119], a[204:207], v[128:131]
    buffer_load_dwordx4 v5, s[36:39], s57 offen offset:0 lds
    v_mfma_f32_16x16x32_bf16 v[132:135], a[124:127], a[204:207], v[132:135]
    v_mfma_f32_16x16x32_bf16 v[132:135], a[120:123], a[172:175], v[132:135]
    v_mfma_f32_16x16x32_bf16 v[140:143], a[120:123], a[168:171], v[140:143]
    v_mfma_f32_16x16x32_bf16 v[140:143], a[124:127], a[200:203], v[140:143]
    buffer_load_dwordx4 v6, s[36:39], s57 offen offset:1024 lds
    v_mfma_f32_16x16x32_bf16 v[136:139], a[116:119], a[200:203], v[136:139]
    v_mfma_f32_16x16x32_bf16 v[136:139], a[112:115], a[168:171], v[136:139]
    v_mfma_f32_16x16x32_bf16 v[144:147], a[112:115], a[164:167], v[144:147]
    v_mfma_f32_16x16x32_bf16 v[144:147], a[116:119], a[196:199], v[144:147]
    buffer_load_dwordx4 v7, s[36:39], s57 offen offset:2048 lds
    v_mfma_f32_16x16x32_bf16 v[148:151], a[124:127], a[196:199], v[148:151]
    v_mfma_f32_16x16x32_bf16 v[148:151], a[120:123], a[164:167], v[148:151]
    v_mfma_f32_16x16x32_bf16 v[156:159], a[120:123], a[160:163], v[156:159]
    v_mfma_f32_16x16x32_bf16 v[156:159], a[124:127], a[192:195], v[156:159]
    buffer_load_dwordx4 v8, s[36:39], s57 offen offset:3072 lds
    v_mfma_f32_16x16x32_bf16 v[152:155], a[116:119], a[192:195], v[152:155]
    v_mfma_f32_16x16x32_bf16 v[152:155], a[112:115], a[160:163], v[152:155]
    s_add_u32 s57, s57, 262144
    s_mov_b32 s64, 12
    .p2align 5
    s_nop 0
    s_nop 0
    s_nop 0
    s_nop 0
F_vloop:
    s_waitcnt vmcnt(16) lgkmcnt(0)
    s_barrier
    v_mfma_f32_16x16x32_bf16 v[160:163], a[128:131], a[160:163], v[160:163]
    ds_read_b128 a[96:99], v11 offset:0
    v_mfma_f32_16x16x32_bf16 v[160:163], a[132:135], a[192:195], v[160:163]
    v_mfma_f32_16x16x32_bf16 v[164:167], a[140:143], a[192:195], v[164:167]
    s_mov_b32 m0, s60
    ds_read_b64_tr_b16 a[64:65], v13 offset:16384
    v_mfma_f32_16x16x32_bf16 v[164:167], a[136:139], a[160:163], v[164:167]
    buffer_load_dwordx4 v1, s[32:35], s56 offen offset:0  lds
    v_mfma_f32_16x16x32_bf16 v[172:175], a[136:139], a[164:167], v[172:175]
    ds_read_b64_tr_b16 a[66:67], v13 offset:17408
    v_mfma_f32_16x16x32_bf16 v[172:175], a[140:143], a[196:199], v[172:175]
    v_mfma_f32_16x16x32_bf16 v[168:171], a[132:135], a[196:199], v[168:171]
    ds_read_b128 a[100:103], v12 offset:0
    v_mfma_f32_16x16x32_bf16 v[168:171], a[128:131], a[164:167], v[168:171]
    buffer_load_dword a248, v16, s[44:47], s76 offen
    v_mfma_f32_16x16x32_bf16 v[176:179], a[128:131], a[168:171], v[176:179]
    s_add_u32 s76, s76, 384
    ds_read_b64_tr_b16 a[68:69], v14 offset:16384
    v_mfma_f32_16x16x32_bf16 v[176:179], a[132:135], a[200:203], v[176:179]
    v_mfma_f32_16x16x32_bf16 v[180:183], a[140:143], a[200:203], v[180:183]
    ds_read_b64_tr_b16 a[70:71], v14 offset:17408
    v_mfma_f32_16x16x32_bf16 v[180:183], a[136:139], a[168:171], v[180:183]
    buffer_load_dwordx4 v2, s[32:35], s56 offen offset:1024  lds
    v_mfma_f32_16x16x32_bf16 v[188:191], a[136:139], a[172:175], v[188:191]
    ds_read_b128 a[104:107], v11 offset:2048
    v_mfma_f32_16x16x32_bf16 v[188:191], a[140:143], a[204:207], v[188:191]
    v_mfma_f32_16x16x32_bf16 v[184:187], a[132:135], a[204:207], v[184:187]
    ds_read_b64_tr_b16 a[72:73], v13 offset:16640
    v_mfma_f32_16x16x32_bf16 v[184:187], a[128:131], a[172:175], v[184:187]
    v_mfma_f32_16x16x32_bf16 v[192:195], a[128:131], a[176:179], v[192:195]
    ds_read_b64_tr_b16 a[74:75], v13 offset:17664
    v_mfma_f32_16x16x32_bf16 v[192:195], a[132:135], a[208:211], v[192:195]
    v_mfma_f32_16x16x32_bf16 v[196:199], a[140:143], a[208:211], v[196:199]
    ds_read_b128 a[108:111], v12 offset:2048
    v_mfma_f32_16x16x32_bf16 v[196:199], a[136:139], a[176:179], v[196:199]
    buffer_load_dwordx4 v3, s[32:35], s56 offen offset:2048  lds
    v_mfma_f32_16x16x32_bf16 v[204:207], a[136:139], a[180:183], v[204:207]
    ds_read_b64_tr_b16 a[76:77], v14 offset:16640
    v_mfma_f32_16x16x32_bf16 v[204:207], a[140:143], a[212:215], v[204:207]
    v_mfma_f32_16x16x32_bf16 v[200:203], a[132:135], a[212:215], v[200:203]
    ds_read_b64_tr_b16 a[78:79], v14 offset:17664
    v_mfma_f32_16x16x32_bf16 v[200:203], a[128:131], a[180:183], v[200:203]
    v_mfma_f32_16x16x32_bf16 v[208:211], a[128:131], a[184:187], v[208:211]
    ds_read_b128 a[112:115], v11 offset:4096
    v_mfma_f32_16x16x32_bf16 v[208:211], a[132:135], a[216:219], v[208:211]
    v_mfma_f32_16x16x32_bf16 v[212:215], a[140:143], a[216:219], v[212:215]
    ds_read_b64_tr_b16 a[80:81], v13 offset:16896
    v_mfma_f32_16x16x32_bf16 v[212:215], a[136:139], a[184:187], v[212:215]
    buffer_load_dwordx4 v4, s[32:35], s56 offen offset:3072  lds
    v_mfma_f32_16x16x32_bf16 v[220:223], a[136:139], a[188:191], v[220:223]
    ds_read_b64_tr_b16 a[82:83], v13 offset:17920
    v_mfma_f32_16x16x32_bf16 v[220:223], a[140:143], a[220:223], v[220:223]
    v_mfma_f32_16x16x32_bf16 v[216:219], a[132:135], a[220:223], v[216:219]
    ds_read_b128 a[116:119], v12 offset:4096
    v_mfma_f32_16x16x32_bf16 v[216:219], a[128:131], a[188:191], v[216:219]
    v_mfma_f32_16x16x32_bf16 v[224:227], a[144:147], a[188:191], v[224:227]
    ds_read_b64_tr_b16 a[84:85], v14 offset:16896
    v_mfma_f32_16x16x32_bf16 v[224:227], a[148:151], a[220:223], v[224:227]
    v_mfma_f32_16x16x32_bf16 v[228:231], a[156:159], a[220:223], v[228:231]
    s_add_u32 m0, s63, 0
    ds_read_b64_tr_b16 a[86:87], v14 offset:17920
    v_mfma_f32_16x16x32_bf16 v[228:231], a[152:155], a[188:191], v[228:231]
    buffer_load_dwordx4 v5, s[36:39], s57 offen offset:0  lds
    v_mfma_f32_16x16x32_bf16 v[236:239], a[152:155], a[184:187], v[236:239]
    ds_read_b128 a[120:123], v11 offset:6144
    v_mfma_f32_16x16x32_bf16 v[236:239], a[156:159], a[216:219], v[236:239]
    v_mfma_f32_16x16x32_bf16 v[232:235], a[148:151], a[216:219], v[232:235]
    ds_read_b64_tr_b16 a[88:89], v13 offset:17152
    v_mfma_f32_16x16x32_bf16 v[232:235], a[144:147], a[184:187], v[232:235]
    buffer_load_dword a251, v19, s[52:55], s78 offen
    v_mfma_f32_16x16x32_bf16 v[240:243], a[144:147], a[180:183], v[240:243]
    s_add_u32 s78, s78, 2688
    ds_read_b64_tr_b16 a[90:91], v13 offset:18176
    v_mfma_f32_16x16x32_bf16 v[240:243], a[148:151], a[212:215], v[240:243]
    v_mfma_f32_16x16x32_bf16 v[244:247], a[156:159], a[212:215], v[244:247]
    ds_read_b128 a[124:127], v12 offset:6144
    v_mfma_f32_16x16x32_bf16 v[244:247], a[152:155], a[180:183], v[244:247]
    buffer_load_dwordx4 v6, s[36:39], s57 offen offset:1024  lds
    v_mfma_f32_16x16x32_bf16 v[252:255], a[152:155], a[176:179], v[252:255]
    ds_read_b64_tr_b16 a[92:93], v14 offset:17152
    v_mfma_f32_16x16x32_bf16 v[252:255], a[156:159], a[208:211], v[252:255]
    v_mfma_f32_16x16x32_bf16 v[248:251], a[148:151], a[208:211], v[248:251]
    ds_read_b64_tr_b16 a[94:95], v14 offset:18176
    v_mfma_f32_16x16x32_bf16 v[248:251], a[144:147], a[176:179], v[248:251]
    v_mfma_f32_16x16x32_bf16 a[0:3], a[144:147], a[172:175], a[0:3]
    v_mfma_f32_16x16x32_bf16 a[0:3], a[148:151], a[204:207], a[0:3]
    v_mfma_f32_16x16x32_bf16 a[4:7], a[156:159], a[204:207], a[4:7]
    v_mfma_f32_16x16x32_bf16 a[4:7], a[152:155], a[172:175], a[4:7]
    buffer_load_dwordx4 v7, s[36:39], s57 offen offset:2048  lds
    v_mfma_f32_16x16x32_bf16 a[12:15], a[152:155], a[168:171], a[12:15]
    v_mfma_f32_16x16x32_bf16 a[12:15], a[156:159], a[200:203], a[12:15]
    v_mfma_f32_16x16x32_bf16 a[8:11], a[148:151], a[200:203], a[8:11]
    v_mfma_f32_16x16x32_bf16 a[8:11], a[144:147], a[168:171], a[8:11]
    v_mfma_f32_16x16x32_bf16 a[16:19], a[144:147], a[164:167], a[16:19]
    v_mfma_f32_16x16x32_bf16 a[16:19], a[148:151], a[196:199], a[16:19]
    v_mfma_f32_16x16x32_bf16 a[20:23], a[156:159], a[196:199], a[20:23]
    v_mfma_f32_16x16x32_bf16 a[20:23], a[152:155], a[164:167], a[20:23]
    buffer_load_dwordx4 v8, s[36:39], s57 offen offset:3072  lds
    v_mfma_f32_16x16x32_bf16 a[28:31], a[152:155], a[160:163], a[28:31]
    s_add_u32 s57, s57, 262144
    v_mfma_f32_16x16x32_bf16 a[28:31], a[156:159], a[192:195], a[28:31]
    s_mov_b32 s67, s60
    s_mov_b32 s60, s61
    s_mov_b32 s61, s62
    v_mfma_f32_16x16x32_bf16 a[24:27], a[148:151], a[192:195], a[24:27]
    s_mov_b32 s62, s67
    v_mfma_f32_16x16x32_bf16 a[24:27], a[144:147], a[160:163], a[24:27]
    s_waitcnt vmcnt(18) lgkmcnt(0)
    s_barrier
    v_mfma_f32_16x16x32_bf16 v[32:35], a[96:99], a[32:35], v[32:35]
    ds_read_b128 a[128:131], v11 offset:8192
    v_mfma_f32_16x16x32_bf16 v[32:35], a[100:103], a[64:67], v[32:35]
    s_add_u32 s66, s56, 2097152
    v_mfma_f32_16x16x32_bf16 v[36:39], a[108:111], a[64:67], v[36:39]
    s_add_u32 m0, s62, 16384
    ds_read_b64_tr_b16 a[160:161], v13 offset:32768
    v_mfma_f32_16x16x32_bf16 v[36:39], a[104:107], a[32:35], v[36:39]
    buffer_load_dwordx4 v1, s[32:35], s66 offen offset:0  lds
    v_mfma_f32_16x16x32_bf16 v[44:47], a[104:107], a[36:39], v[44:47]
    ds_read_b64_tr_b16 a[162:163], v13 offset:33792
    v_mfma_f32_16x16x32_bf16 v[44:47], a[108:111], a[68:71], v[44:47]
    v_mfma_f32_16x16x32_bf16 v[40:43], a[100:103], a[68:71], v[40:43]
    ds_read_b128 a[132:135], v12 offset:8192
    v_mfma_f32_16x16x32_bf16 v[40:43], a[96:99], a[36:39], v[40:43]
    buffer_load_dword a250, v18, s[48:51], s77 offen
    v_mfma_f32_16x16x32_bf16 v[48:51], a[96:99], a[40:43], v[48:51]
    s_add_u32 s77, s77, 768
    ds_read_b64_tr_b16 a[164:165], v14 offset:32768
    v_mfma_f32_16x16x32_bf16 v[48:51], a[100:103], a[72:75], v[48:51]
    v_mfma_f32_16x16x32_bf16 v[52:55], a[108:111], a[72:75], v[52:55]
    ds_read_b64_tr_b16 a[166:167], v14 offset:33792
    v_mfma_f32_16x16x32_bf16 v[52:55], a[104:107], a[40:43], v[52:55]
    buffer_load_dwordx4 v2, s[32:35], s66 offen offset:1024  lds
    v_mfma_f32_16x16x32_bf16 v[60:63], a[104:107], a[44:47], v[60:63]
    ds_read_b128 a[136:139], v11 offset:10240
    v_mfma_f32_16x16x32_bf16 v[60:63], a[108:111], a[76:79], v[60:63]
    v_mfma_f32_16x16x32_bf16 v[56:59], a[100:103], a[76:79], v[56:59]
    ds_read_b64_tr_b16 a[168:169], v13 offset:33024
    v_mfma_f32_16x16x32_bf16 v[56:59], a[96:99], a[44:47], v[56:59]
    v_mfma_f32_16x16x32_bf16 v[64:67], a[96:99], a[48:51], v[64:67]
    ds_read_b64_tr_b16 a[170:171], v13 offset:34048
    v_mfma_f32_16x16x32_bf16 v[64:67], a[100:103], a[80:83], v[64:67]
    v_mfma_f32_16x16x32_bf16 v[68:71], a[108:111], a[80:83], v[68:71]
    ds_read_b128 a[140:143], v12 offset:10240
    v_mfma_f32_16x16x32_bf16 v[68:71], a[104:107], a[48:51], v[68:71]
    buffer_load_dwordx4 v3, s[32:35], s66 offen offset:2048  lds
    v_mfma_f32_16x16x32_bf16 v[76:79], a[104:107], a[52:55], v[76:79]
    ds_read_b64_tr_b16 a[172:173], v14 offset:33024
    v_mfma_f32_16x16x32_bf16 v[76:79], a[108:111], a[84:87], v[76:79]
    v_mfma_f32_16x16x32_bf16 v[72:75], a[100:103], a[84:87], v[72:75]
    ds_read_b64_tr_b16 a[174:175], v14 offset:34048
    v_mfma_f32_16x16x32_bf16 v[72:75], a[96:99], a[52:55], v[72:75]
    v_mfma_f32_16x16x32_bf16 v[80:83], a[96:99], a[56:59], v[80:83]
    ds_read_b128 a[144:147], v11 offset:12288
    v_mfma_f32_16x16x32_bf16 v[80:83], a[100:103], a[88:91], v[80:83]
    v_mfma_f32_16x16x32_bf16 v[84:87], a[108:111], a[88:91], v[84:87]
    ds_read_b64_tr_b16 a[176:177], v13 offset:33280
    v_mfma_f32_16x16x32_bf16 v[84:87], a[104:107], a[56:59], v[84:87]
    buffer_load_dwordx4 v4, s[32:35], s66 offen offset:3072  lds
    v_mfma_f32_16x16x32_bf16 v[92:95], a[104:107], a[60:63], v[92:95]
    s_add_u32 s56, s56, 128
    ds_read_b64_tr_b16 a[178:179], v13 offset:34304
    v_mfma_f32_16x16x32_bf16 v[92:95], a[108:111], a[92:95], v[92:95]
    v_mfma_f32_16x16x32_bf16 v[88:91], a[100:103], a[92:95], v[88:91]
    ds_read_b128 a[148:151], v12 offset:12288
    v_mfma_f32_16x16x32_bf16 v[88:91], a[96:99], a[60:63], v[88:91]
    v_mfma_f32_16x16x32_bf16 v[96:99], a[112:115], a[60:63], v[96:99]
    ds_read_b64_tr_b16 a[180:181], v14 offset:33280
    v_mfma_f32_16x16x32_bf16 v[96:99], a[116:119], a[92:95], v[96:99]
    v_mfma_f32_16x16x32_bf16 v[100:103], a[124:127], a[92:95], v[100:103]
    s_add_u32 m0, s63, 16384
    ds_read_b64_tr_b16 a[182:183], v14 offset:34304
    v_mfma_f32_16x16x32_bf16 v[100:103], a[120:123], a[60:63], v[100:103]
    buffer_load_dwordx4 v5, s[36:39], s57 offen offset:0  lds
    v_mfma_f32_16x16x32_bf16 v[108:111], a[120:123], a[56:59], v[108:111]
    ds_read_b128 a[152:155], v11 offset:14336
    v_mfma_f32_16x16x32_bf16 v[108:111], a[124:127], a[88:91], v[108:111]
    v_mfma_f32_16x16x32_bf16 v[104:107], a[116:119], a[88:91], v[104:107]
    ds_read_b64_tr_b16 a[184:185], v13 offset:33536
    v_mfma_f32_16x16x32_bf16 v[104:107], a[112:115], a[56:59], v[104:107]
    global_load_dword a249, v20, s[30:31]
    v_mfma_f32_16x16x32_bf16 v[112:115], a[112:115], a[52:55], v[112:115]
    ds_read_b64_tr_b16 a[186:187], v13 offset:34560
    v_mfma_f32_16x16x32_bf16 v[112:115], a[116:119], a[84:87], v[112:115]
    v_mfma_f32_16x16x32_bf16 v[116:119], a[124:127], a[84:87], v[116:119]
    ds_read_b128 a[156:159], v12 offset:14336
    v_mfma_f32_16x16x32_bf16 v[116:119], a[120:123], a[52:55], v[116:119]
    buffer_load_dwordx4 v6, s[36:39], s57 offen offset:1024  lds
    v_mfma_f32_16x16x32_bf16 v[124:127], a[120:123], a[48:51], v[124:127]
    ds_read_b64_tr_b16 a[188:189], v14 offset:33536
    v_mfma_f32_16x16x32_bf16 v[124:127], a[124:127], a[80:83], v[124:127]
    v_mfma_f32_16x16x32_bf16 v[120:123], a[116:119], a[80:83], v[120:123]
    ds_read_b64_tr_b16 a[190:191], v14 offset:34560
    v_mfma_f32_16x16x32_bf16 v[120:123], a[112:115], a[48:51], v[120:123]
    v_mfma_f32_16x16x32_bf16 v[128:131], a[112:115], a[44:47], v[128:131]
    v_add_u32 v11, s61, v9
    v_add_u32 v12, s61, v10
    v_mfma_f32_16x16x32_bf16 v[128:131], a[116:119], a[76:79], v[128:131]
    v_mfma_f32_16x16x32_bf16 v[132:135], a[124:127], a[76:79], v[132:135]
    v_mfma_f32_16x16x32_bf16 v[132:135], a[120:123], a[44:47], v[132:135]
    buffer_load_dwordx4 v7, s[36:39], s57 offen offset:2048  lds
    v_mfma_f32_16x16x32_bf16 v[140:143], a[120:123], a[40:43], v[140:143]
    s_cmp_eq_u32 s64, s98
    s_cselect_b32 s99, s75, 1073741824
    v_mfma_f32_16x16x32_bf16 v[140:143], a[124:127], a[72:75], v[140:143]
    v_mfma_f32_16x16x32_bf16 v[136:139], a[116:119], a[72:75], v[136:139]
    v_mfma_f32_16x16x32_bf16 v[136:139], a[112:115], a[40:43], v[136:139]
    buffer_store_byte v22, v21, s[88:91], s99 offen sc1
    v_mfma_f32_16x16x32_bf16 v[144:147], a[112:115], a[36:39], v[144:147]
    v_mfma_f32_16x16x32_bf16 v[144:147], a[116:119], a[68:71], v[144:147]
    v_mfma_f32_16x16x32_bf16 v[148:151], a[124:127], a[68:71], v[148:151]
    v_mfma_f32_16x16x32_bf16 v[148:151], a[120:123], a[36:39], v[148:151]
    buffer_load_dwordx4 v8, s[36:39], s57 offen offset:3072  lds
    v_mfma_f32_16x16x32_bf16 v[156:159], a[120:123], a[32:35], v[156:159]
    s_add_u32 s57, s57, 262144
    v_mfma_f32_16x16x32_bf16 v[156:159], a[124:127], a[64:67], v[156:159]
    s_sub_u32 s64, s64, 1
    v_mfma_f32_16x16x32_bf16 v[152:155], a[116:119], a[64:67], v[152:155]
    s_cmp_lg_u32 s64, 0
    v_mfma_f32_16x16x32_bf16 v[152:155], a[112:115], a[32:35], v[152:155]
    s_waitcnt vmcnt(18) lgkmcnt(0)
    s_barrier
    v_mfma_f32_16x16x32_bf16 v[160:163], a[128:131], a[32:35], v[160:163]
    ds_read_b128 a[96:99], v11 offset:0
    v_mfma_f32_16x16x32_bf16 v[160:163], a[132:135], a[64:67], v[160:163]
    v_mfma_f32_16x16x32_bf16 v[164:167], a[140:143], a[64:67], v[164:167]
    s_mov_b32 m0, s60
    ds_read_b64_tr_b16 a[192:193], v13 offset:49152
    v_mfma_f32_16x16x32_bf16 v[164:167], a[136:139], a[32:35], v[164:167]
    buffer_load_dwordx4 v1, s[32:35], s56 offen offset:0  lds
    v_mfma_f32_16x16x32_bf16 v[172:175], a[136:139], a[36:39], v[172:175]
    ds_read_b64_tr_b16 a[194:195], v13 offset:50176
    v_mfma_f32_16x16x32_bf16 v[172:175], a[140:143], a[68:71], v[172:175]
    v_mfma_f32_16x16x32_bf16 v[168:171], a[132:135], a[68:71], v[168:171]
    ds_read_b128 a[100:103], v12 offset:0
    v_mfma_f32_16x16x32_bf16 v[168:171], a[128:131], a[36:39], v[168:171]
    buffer_load_dword a248, v16, s[44:47], s76 offen
    v_mfma_f32_16x16x32_bf16 v[176:179], a[128:131], a[40:43], v[176:179]
    s_add_u32 s76, s76, 384
    ds_read_b64_tr_b16 a[196:197], v14 offset:49152
    v_mfma_f32_16x16x32_bf16 v[176:179], a[132:135], a[72:75], v[176:179]
    v_mfma_f32_16x16x32_bf16 v[180:183], a[140:143], a[72:75], v[180:183]
    ds_read_b64_tr_b16 a[198:199], v14 offset:50176
    v_mfma_f32_16x16x32_bf16 v[180:183], a[136:139], a[40:43], v[180:183]
    buffer_load_dwordx4 v2, s[32:35], s56 offen offset:1024  lds
    v_mfma_f32_16x16x32_bf16 v[188:191], a[136:139], a[44:47], v[188:191]
    ds_read_b128 a[104:107], v11 offset:2048
    v_mfma_f32_16x16x32_bf16 v[188:191], a[140:143], a[76:79], v[188:191]
    v_mfma_f32_16x16x32_bf16 v[184:187], a[132:135], a[76:79], v[184:187]
    ds_read_b64_tr_b16 a[200:201], v13 offset:49408
    v_mfma_f32_16x16x32_bf16 v[184:187], a[128:131], a[44:47], v[184:187]
    v_mfma_f32_16x16x32_bf16 v[192:195], a[128:131], a[48:51], v[192:195]
    ds_read_b64_tr_b16 a[202:203], v13 offset:50432
    v_mfma_f32_16x16x32_bf16 v[192:195], a[132:135], a[80:83], v[192:195]
    v_mfma_f32_16x16x32_bf16 v[196:199], a[140:143], a[80:83], v[196:199]
    ds_read_b128 a[108:111], v12 offset:2048
    v_mfma_f32_16x16x32_bf16 v[196:199], a[136:139], a[48:51], v[196:199]
    buffer_load_dwordx4 v3, s[32:35], s56 offen offset:2048  lds
    v_mfma_f32_16x16x32_bf16 v[204:207], a[136:139], a[52:55], v[204:207]
    ds_read_b64_tr_b16 a[204:205], v14 offset:49408
    v_mfma_f32_16x16x32_bf16 v[204:207], a[140:143], a[84:87], v[204:207]
    v_mfma_f32_16x16x32_bf16 v[200:203], a[132:135], a[84:87], v[200:203]
    ds_read_b64_tr_b16 a[206:207], v14 offset:50432
    v_mfma_f32_16x16x32_bf16 v[200:203], a[128:131], a[52:55], v[200:203]
    v_mfma_f32_16x16x32_bf16 v[208:211], a[128:131], a[56:59], v[208:211]
    ds_read_b128 a[112:115], v11 offset:4096
    v_mfma_f32_16x16x32_bf16 v[208:211], a[132:135], a[88:91], v[208:211]
    v_mfma_f32_16x16x32_bf16 v[212:215], a[140:143], a[88:91], v[212:215]
    ds_read_b64_tr_b16 a[208:209], v13 offset:49664
    v_mfma_f32_16x16x32_bf16 v[212:215], a[136:139], a[56:59], v[212:215]
    buffer_load_dwordx4 v4, s[32:35], s56 offen offset:3072  lds
    v_mfma_f32_16x16x32_bf16 v[220:223], a[136:139], a[60:63], v[220:223]
    ds_read_b64_tr_b16 a[210:211], v13 offset:50688
    v_mfma_f32_16x16x32_bf16 v[220:223], a[140:143], a[92:95], v[220:223]
    v_mfma_f32_16x16x32_bf16 v[216:219], a[132:135], a[92:95], v[216:219]
    ds_read_b128 a[116:119], v12 offset:4096
    v_mfma_f32_16x16x32_bf16 v[216:219], a[128:131], a[60:63], v[216:219]
    v_mfma_f32_16x16x32_bf16 v[224:227], a[144:147], a[60:63], v[224:227]
    ds_read_b64_tr_b16 a[212:213], v14 offset:49664
    v_mfma_f32_16x16x32_bf16 v[224:227], a[148:151], a[92:95], v[224:227]
    v_mfma_f32_16x16x32_bf16 v[228:231], a[156:159], a[92:95], v[228:231]
    s_add_u32 m0, s63, 32768
    ds_read_b64_tr_b16 a[214:215], v14 offset:50688
    v_mfma_f32_16x16x32_bf16 v[228:231], a[152:155], a[60:63], v[228:231]
    buffer_load_dwordx4 v5, s[36:39], s57 offen offset:0  lds
    v_mfma_f32_16x16x32_bf16 v[236:239], a[152:155], a[56:59], v[236:239]
    ds_read_b128 a[120:123], v11 offset:6144
    v_mfma_f32_16x16x32_bf16 v[236:239], a[156:159], a[88:91], v[236:239]
    v_mfma_f32_16x16x32_bf16 v[232:235], a[148:151], a[88:91], v[232:235]
    ds_read_b64_tr_b16 a[216:217], v13 offset:49920
    v_mfma_f32_16x16x32_bf16 v[232:235], a[144:147], a[56:59], v[232:235]
    buffer_load_dword a251, v19, s[52:55], s78 offen
    v_mfma_f32_16x16x32_bf16 v[240:243], a[144:147], a[52:55], v[240:243]
    s_add_u32 s78, s78, 2688
    ds_read_b64_tr_b16 a[218:219], v13 offset:50944
    v_mfma_f32_16x16x32_bf16 v[240:243], a[148:151], a[84:87], v[240:243]
    v_mfma_f32_16x16x32_bf16 v[244:247], a[156:159], a[84:87], v[244:247]
    ds_read_b128 a[124:127], v12 offset:6144
    v_mfma_f32_16x16x32_bf16 v[244:247], a[152:155], a[52:55], v[244:247]
    buffer_load_dwordx4 v6, s[36:39], s57 offen offset:1024  lds
    v_mfma_f32_16x16x32_bf16 v[252:255], a[152:155], a[48:51], v[252:255]
    ds_read_b64_tr_b16 a[220:221], v14 offset:49920
    v_mfma_f32_16x16x32_bf16 v[252:255], a[156:159], a[80:83], v[252:255]
    v_mfma_f32_16x16x32_bf16 v[248:251], a[148:151], a[80:83], v[248:251]
    ds_read_b64_tr_b16 a[222:223], v14 offset:50944
    v_mfma_f32_16x16x32_bf16 v[248:251], a[144:147], a[48:51], v[248:251]
    v_mfma_f32_16x16x32_bf16 a[0:3], a[144:147], a[44:47], a[0:3]
    v_mfma_f32_16x16x32_bf16 a[0:3], a[148:151], a[76:79], a[0:3]
    v_mfma_f32_16x16x32_bf16 a[4:7], a[156:159], a[76:79], a[4:7]
    v_mfma_f32_16x16x32_bf16 a[4:7], a[152:155], a[44:47], a[4:7]
    buffer_load_dwordx4 v7, s[36:39], s57 offen offset:2048  lds
    v_mfma_f32_16x16x32_bf16 a[12:15], a[152:155], a[40:43], a[12:15]
    v_mfma_f32_16x16x32_bf16 a[12:15], a[156:159], a[72:75], a[12:15]
    v_mfma_f32_16x16x32_bf16 a[8:11], a[148:151], a[72:75], a[8:11]
    v_mfma_f32_16x16x32_bf16 a[8:11], a[144:147], a[40:43], a[8:11]
    v_mfma_f32_16x16x32_bf16 a[16:19], a[144:147], a[36:39], a[16:19]
    v_mfma_f32_16x16x32_bf16 a[16:19], a[148:151], a[68:71], a[16:19]
    v_mfma_f32_16x16x32_bf16 a[20:23], a[156:159], a[68:71], a[20:23]
    v_mfma_f32_16x16x32_bf16 a[20:23], a[152:155], a[36:39], a[20:23]
    buffer_load_dwordx4 v8, s[36:39], s57 offen offset:3072  lds
    v_mfma_f32_16x16x32_bf16 a[28:31], a[152:155], a[32:35], a[28:31]
    s_add_u32 s57, s57, 262144
    v_mfma_f32_16x16x32_bf16 a[28:31], a[156:159], a[64:67], a[28:31]
    s_mov_b32 s67, s60
    s_mov_b32 s60, s61
    s_mov_b32 s61, s62
    v_mfma_f32_16x16x32_bf16 a[24:27], a[148:151], a[64:67], a[24:27]
    s_mov_b32 s62, s67
    v_mfma_f32_16x16x32_bf16 a[24:27], a[144:147], a[32:35], a[24:27]
    s_waitcnt vmcnt(18) lgkmcnt(0)
    s_barrier
    v_mfma_f32_16x16x32_bf16 v[32:35], a[96:99], a[160:163], v[32:35]
    ds_read_b128 a[128:131], v11 offset:8192
    v_mfma_f32_16x16x32_bf16 v[32:35], a[100:103], a[192:195], v[32:35]
    s_add_u32 s66, s56, 2097152
    v_mfma_f32_16x16x32_bf16 v[36:39], a[108:111], a[192:195], v[36:39]
    s_add_u32 m0, s62, 16384
    ds_read_b64_tr_b16 a[32:33], v13 offset:0
    v_mfma_f32_16x16x32_bf16 v[36:39], a[104:107], a[160:163], v[36:39]
    buffer_load_dwordx4 v1, s[32:35], s66 offen offset:0  lds
    v_mfma_f32_16x16x32_bf16 v[44:47], a[104:107], a[164:167], v[44:47]
    ds_read_b64_tr_b16 a[34:35], v13 offset:1024
    v_mfma_f32_16x16x32_bf16 v[44:47], a[108:111], a[196:199], v[44:47]
    v_mfma_f32_16x16x32_bf16 v[40:43], a[100:103], a[196:199], v[40:43]
    ds_read_b128 a[132:135], v12 offset:8192
    v_mfma_f32_16x16x32_bf16 v[40:43], a[96:99], a[164:167], v[40:43]
    buffer_load_dword a250, v18, s[48:51], s77 offen
    v_mfma_f32_16x16x32_bf16 v[48:51], a[96:99], a[168:171], v[48:51]
    s_add_u32 s77, s77, 768
    ds_read_b64_tr_b16 a[36:37], v14 offset:0
    v_mfma_f32_16x16x32_bf16 v[48:51], a[100:103], a[200:203], v[48:51]
    v_mfma_f32_16x16x32_bf16 v[52:55], a[108:111], a[200:203], v[52:55]
    ds_read_b64_tr_b16 a[38:39], v14 offset:1024
    v_mfma_f32_16x16x32_bf16 v[52:55], a[104:107], a[168:171], v[52:55]
    buffer_load_dwordx4 v2, s[32:35], s66 offen offset:1024  lds
    v_mfma_f32_16x16x32_bf16 v[60:63], a[104:107], a[172:175], v[60:63]
    ds_read_b128 a[136:139], v11 offset:10240
    v_mfma_f32_16x16x32_bf16 v[60:63], a[108:111], a[204:207], v[60:63]
    v_mfma_f32_16x16x32_bf16 v[56:59], a[100:103], a[204:207], v[56:59]
    ds_read_b64_tr_b16 a[40:41], v13 offset:256
    v_mfma_f32_16x16x32_bf16 v[56:59], a[96:99], a[172:175], v[56:59]
    v_mfma_f32_16x16x32_bf16 v[64:67], a[96:99], a[176:179], v[64:67]
    ds_read_b64_tr_b16 a[42:43], v13 offset:1280
    v_mfma_f32_16x16x32_bf16 v[64:67], a[100:103], a[208:211], v[64:67]
    v_mfma_f32_16x16x32_bf16 v[68:71], a[108:111], a[208:211], v[68:71]
    ds_read_b128 a[140:143], v12 offset:10240
    v_mfma_f32_16x16x32_bf16 v[68:71], a[104:107], a[176:179], v[68:71]
    buffer_load_dwordx4 v3, s[32:35], s66 offen offset:2048  lds
    v_mfma_f32_16x16x32_bf16 v[76:79], a[104:107], a[180:183], v[76:79]
    ds_read_b64_tr_b16 a[44:45], v14 offset:256
    v_mfma_f32_16x16x32_bf16 v[76:79], a[108:111], a[212:215], v[76:79]
    v_mfma_f32_16x16x32_bf16 v[72:75], a[100:103], a[212:215], v[72:75]
    ds_read_b64_tr_b16 a[46:47], v14 offset:1280
    v_mfma_f32_16x16x32_bf16 v[72:75], a[96:99], a[180:183], v[72:75]
    v_mfma_f32_16x16x32_bf16 v[80:83], a[96:99], a[184:187], v[80:83]
    ds_read_b128 a[144:147], v11 offset:12288
    v_mfma_f32_16x16x32_bf16 v[80:83], a[100:103], a[216:219], v[80:83]
    v_mfma_f32_16x16x32_bf16 v[84:87], a[108:111], a[216:219], v[84:87]
    ds_read_b64_tr_b16 a[48:49], v13 offset:512
    v_mfma_f32_16x16x32_bf16 v[84:87], a[104:107], a[184:187], v[84:87]
    buffer_load_dwordx4 v4, s[32:35], s66 offen offset:3072  lds
    v_mfma_f32_16x16x32_bf16 v[92:95], a[104:107], a[188:191], v[92:95]
    s_add_u32 s56, s56, 128
    ds_read_b64_tr_b16 a[50:51], v13 offset:1536
    v_mfma_f32_16x16x32_bf16 v[92:95], a[108:111], a[220:223], v[92:95]
    v_mfma_f32_16x16x32_bf16 v[88:91], a[100:103], a[220:223], v[88:91]
    ds_read_b128 a[148:151], v12 offset:12288
    v_mfma_f32_16x16x32_bf16 v[88:91], a[96:99], a[188:191], v[88:91]
    v_mfma_f32_16x16x32_bf16 v[96:99], a[112:115], a[188:191], v[96:99]
    ds_read_b64_tr_b16 a[52:53], v14 offset:512
    v_mfma_f32_16x16x32_bf16 v[96:99], a[116:119], a[220:223], v[96:99]
    v_mfma_f32_16x16x32_bf16 v[100:103], a[124:127], a[220:223], v[100:103]
    s_add_u32 m0, s63, 49152
    ds_read_b64_tr_b16 a[54:55], v14 offset:1536
    v_mfma_f32_16x16x32_bf16 v[100:103], a[120:123], a[188:191], v[100:103]
    buffer_load_dwordx4 v5, s[36:39], s57 offen offset:0  lds
    v_mfma_f32_16x16x32_bf16 v[108:111], a[120:123], a[184:187], v[108:111]
    ds_read_b128 a[152:155], v11 offset:14336
    v_mfma_f32_16x16x32_bf16 v[108:111], a[124:127], a[216:219], v[108:111]
    v_mfma_f32_16x16x32_bf16 v[104:107], a[116:119], a[216:219], v[104:107]
    ds_read_b64_tr_b16 a[56:57], v13 offset:768
    v_mfma_f32_16x16x32_bf16 v[104:107], a[112:115], a[184:187], v[104:107]
    v_mfma_f32_16x16x32_bf16 v[112:115], a[112:115], a[180:183], v[112:115]
    ds_read_b64_tr_b16 a[58:59], v13 offset:1792
    v_mfma_f32_16x16x32_bf16 v[112:115], a[116:119], a[212:215], v[112:115]
    v_mfma_f32_16x16x32_bf16 v[116:119], a[124:127], a[212:215], v[116:119]
    ds_read_b128 a[156:159], v12 offset:14336
    v_mfma_f32_16x16x32_bf16 v[116:119], a[120:123], a[180:183], v[116:119]
    buffer_load_dwordx4 v6, s[36:39], s57 offen offset:1024  lds
    v_mfma_f32_16x16x32_bf16 v[124:127], a[120:123], a[176:179], v[124:127]
    ds_read_b64_tr_b16 a[60:61], v14 offset:768
    v_mfma_f32_16x16x32_bf16 v[124:127], a[124:127], a[208:211], v[124:127]
    v_mfma_f32_16x16x32_bf16 v[120:123], a[116:119], a[208:211], v[120:123]
    ds_read_b64_tr_b16 a[62:63], v14 offset:1792
    v_mfma_f32_16x16x32_bf16 v[120:123], a[112:115], a[176:179], v[120:123]
    v_mfma_f32_16x16x32_bf16 v[128:131], a[112:115], a[172:175], v[128:131]
    v_add_u32 v11, s61, v9
    v_add_u32 v12, s61, v10
    v_mfma_f32_16x16x32_bf16 v[128:131], a[116:119], a[204:207], v[128:131]
    v_mfma_f32_16x16x32_bf16 v[132:135], a[124:127], a[204:207], v[132:135]
    v_mfma_f32_16x16x32_bf16 v[132:135], a[120:123], a[172:175], v[132:135]
    buffer_load_dwordx4 v7, s[36:39], s57 offen offset:2048  lds
    v_mfma_f32_16x16x32_bf16 v[140:143], a[120:123], a[168:171], v[140:143]
    s_cmp_eq_u32 s64, s98
    s_cselect_b32 s99, s75, 1073741824
    v_mfma_f32_16x16x32_bf16 v[140:143], a[124:127], a[200:203], v[140:143]
    v_mfma_f32_16x16x32_bf16 v[136:139], a[116:119], a[200:203], v[136:139]
    v_mfma_f32_16x16x32_bf16 v[136:139], a[112:115], a[168:171], v[136:139]
    buffer_store_byte v22, v21, s[88:91], s99 offen sc1
    v_mfma_f32_16x16x32_bf16 v[144:147], a[112:115], a[164:167], v[144:147]
    v_mfma_f32_16x16x32_bf16 v[144:147], a[116:119], a[196:199], v[144:147]
    v_mfma_f32_16x16x32_bf16 v[148:151], a[124:127], a[196:199], v[148:151]
    v_mfma_f32_16x16x32_bf16 v[148:151], a[120:123], a[164:167], v[148:151]
    buffer_load_dwordx4 v8, s[36:39], s57 offen offset:3072  lds
    v_mfma_f32_16x16x32_bf16 v[156:159], a[120:123], a[160:163], v[156:159]
    s_add_u32 s57, s57, 262144
    v_mfma_f32_16x16x32_bf16 v[156:159], a[124:127], a[192:195], v[156:159]
    s_sub_u32 s64, s64, 1
    v_mfma_f32_16x16x32_bf16 v[152:155], a[116:119], a[192:195], v[152:155]
    s_cmp_lg_u32 s64, 0
    v_mfma_f32_16x16x32_bf16 v[152:155], a[112:115], a[160:163], v[152:155]
    s_cbranch_scc1 F_vloop
F_vloop_x:
    s_waitcnt vmcnt(20) lgkmcnt(0)
    s_barrier
    v_mfma_f32_16x16x32_bf16 v[160:163], a[128:131], a[160:163], v[160:163]
    ds_read_b128 a[96:99], v11 offset:0
    v_mfma_f32_16x16x32_bf16 v[160:163], a[132:135], a[192:195], v[160:163]
    v_mfma_f32_16x16x32_bf16 v[164:167], a[140:143], a[192:195], v[164:167]
    s_mov_b32 m0, s60
    ds_read_b64_tr_b16 a[64:65], v13 offset:16384
    v_mfma_f32_16x16x32_bf16 v[164:167], a[136:139], a[160:163], v[164:167]
    buffer_load_dwordx4 v24, s[44:47], s58 offen offset:0  lds
    v_mfma_f32_16x16x32_bf16 v[172:175], a[136:139], a[164:167], v[172:175]
    v_lshlrev_b32 v4, 2, v30
    ds_read_b64_tr_b16 a[66:67], v13 offset:17408
    v_mfma_f32_16x16x32_bf16 v[172:175], a[140:143], a[196:199], v[172:175]
    v_and_b32 v16, 15, v30
    v_mul_u32_u24 v16, 896, v16
    v_mfma_f32_16x16x32_bf16 v[168:171], a[132:135], a[196:199], v[168:171]
    v_and_or_b32 v16, v30, 48, v16
    ds_read_b128 a[100:103], v12 offset:0
    v_mfma_f32_16x16x32_bf16 v[168:171], a[128:131], a[164:167], v[168:171]
    buffer_load_dword v1, v4, s[88:91], 0 offen sc1
    v_mfma_f32_16x16x32_bf16 v[176:179], a[128:131], a[168:171], v[176:179]
    ds_read_b64_tr_b16 a[68:69], v14 offset:16384
    v_mfma_f32_16x16x32_bf16 v[176:179], a[132:135], a[200:203], v[176:179]
    buffer_load_dwordx4 a[224:227], v16, s[52:55], s3 offen offset:0
    v_mfma_f32_16x16x32_bf16 v[180:183], a[140:143], a[200:203], v[180:183]
    ds_read_b64_tr_b16 a[70:71], v14 offset:17408
    v_mfma_f32_16x16x32_bf16 v[180:183], a[136:139], a[168:171], v[180:183]
    buffer_load_dwordx4 v25, s[44:47], s58 offen offset:1024  lds
    v_mfma_f32_16x16x32_bf16 v[188:191], a[136:139], a[172:175], v[188:191]
    ds_read_b128 a[104:107], v11 offset:2048
    v_mfma_f32_16x16x32_bf16 v[188:191], a[140:143], a[204:207], v[188:191]
    buffer_load_dwordx4 a[228:231], v16, s[52:55], s3 offen offset:64
    v_mfma_f32_16x16x32_bf16 v[184:187], a[132:135], a[204:207], v[184:187]
    ds_read_b64_tr_b16 a[72:73], v13 offset:16640
    v_mfma_f32_16x16x32_bf16 v[184:187], a[128:131], a[172:175], v[184:187]
    s_add_u32 s3, s3, 14336
    v_mfma_f32_16x16x32_bf16 v[192:195], a[128:131], a[176:179], v[192:195]
    ds_read_b64_tr_b16 a[74:75], v13 offset:17664
    v_mfma_f32_16x16x32_bf16 v[192:195], a[132:135], a[208:211], v[192:195]
    buffer_load_dwordx4 a[232:235], v16, s[52:55], s3 offen offset:0
    v_mfma_f32_16x16x32_bf16 v[196:199], a[140:143], a[208:211], v[196:199]
    ds_read_b128 a[108:111], v12 offset:2048
    v_mfma_f32_16x16x32_bf16 v[196:199], a[136:139], a[176:179], v[196:199]
    buffer_load_dwordx4 v26, s[44:47], s58 offen offset:2048  lds
    v_mfma_f32_16x16x32_bf16 v[204:207], a[136:139], a[180:183], v[204:207]
    ds_read_b64_tr_b16 a[76:77], v14 offset:16640
    v_mfma_f32_16x16x32_bf16 v[204:207], a[140:143], a[212:215], v[204:207]
    buffer_load_dwordx4 a[236:239], v16, s[52:55], s3 offen offset:64
    v_mfma_f32_16x16x32_bf16 v[200:203], a[132:135], a[212:215], v[200:203]
    ds_read_b64_tr_b16 a[78:79], v14 offset:17664
    v_mfma_f32_16x16x32_bf16 v[200:203], a[128:131], a[180:183], v[200:203]
    s_add_u32 s3, s3, 14336
    v_mfma_f32_16x16x32_bf16 v[208:211], a[128:131], a[184:187], v[208:211]
    ds_read_b128 a[112:115], v11 offset:4096
    v_mfma_f32_16x16x32_bf16 v[208:211], a[132:135], a[216:219], v[208:211]
    v_mfma_f32_16x16x32_bf16 v[212:215], a[140:143], a[216:219], v[212:215]
    ds_read_b64_tr_b16 a[80:81], v13 offset:16896
    v_mfma_f32_16x16x32_bf16 v[212:215], a[136:139], a[184:187], v[212:215]
    buffer_load_dwordx4 v27, s[44:47], s58 offen offset:3072  lds
    v_mfma_f32_16x16x32_bf16 v[220:223], a[136:139], a[188:191], v[220:223]
    ds_read_b64_tr_b16 a[82:83], v13 offset:17920
    v_mfma_f32_16x16x32_bf16 v[220:223], a[140:143], a[220:223], v[220:223]
    v_mfma_f32_16x16x32_bf16 v[216:219], a[132:135], a[220:223], v[216:219]
    ds_read_b128 a[116:119], v12 offset:4096
    v_mfma_f32_16x16x32_bf16 v[216:219], a[128:131], a[188:191], v[216:219]
    v_mfma_f32_16x16x32_bf16 v[224:227], a[144:147], a[188:191], v[224:227]
    ds_read_b64_tr_b16 a[84:85], v14 offset:16896
    v_mfma_f32_16x16x32_bf16 v[224:227], a[148:151], a[220:223], v[224:227]
    v_mfma_f32_16x16x32_bf16 v[228:231], a[156:159], a[220:223], v[228:231]
    s_add_u32 m0, s63, 0
    ds_read_b64_tr_b16 a[86:87], v14 offset:17920
    v_mfma_f32_16x16x32_bf16 v[228:231], a[152:155], a[188:191], v[228:231]
    buffer_load_dwordx4 v5, s[48:51], s59 offen offset:0  lds
    v_mfma_f32_16x16x32_bf16 v[236:239], a[152:155], a[184:187], v[236:239]
    ds_read_b128 a[120:123], v11 offset:6144
    v_mfma_f32_16x16x32_bf16 v[236:239], a[156:159], a[216:219], v[236:239]
    v_mfma_f32_16x16x32_bf16 v[232:235], a[148:151], a[216:219], v[232:235]
    ds_read_b64_tr_b16 a[88:89], v13 offset:17152
    v_mfma_f32_16x16x32_bf16 v[232:235], a[144:147], a[184:187], v[232:235]
    v_mfma_f32_16x16x32_bf16 v[240:243], a[144:147], a[180:183], v[240:243]
    ds_read_b64_tr_b16 a[90:91], v13 offset:18176
    v_mfma_f32_16x16x32_bf16 v[240:243], a[148:151], a[212:215], v[240:243]
    v_mfma_f32_16x16x32_bf16 v[244:247], a[156:159], a[212:215], v[244:247]
    ds_read_b128 a[124:127], v12 offset:6144
    v_mfma_f32_16x16x32_bf16 v[244:247], a[152:155], a[180:183], v[244:247]
    buffer_load_dwordx4 v6, s[48:51], s59 offen offset:1024  lds
    v_mfma_f32_16x16x32_bf16 v[252:255], a[152:155], a[176:179], v[252:255]
    ds_read_b64_tr_b16 a[92:93], v14 offset:17152
    v_mfma_f32_16x16x32_bf16 v[252:255], a[156:159], a[208:211], v[252:255]
    v_mfma_f32_16x16x32_bf16 v[248:251], a[148:151], a[208:211], v[248:251]
    ds_read_b64_tr_b16 a[94:95], v14 offset:18176
    v_mfma_f32_16x16x32_bf16 v[248:251], a[144:147], a[176:179], v[248:251]
    v_mfma_f32_16x16x32_bf16 a[0:3], a[144:147], a[172:175], a[0:3]
    v_mfma_f32_16x16x32_bf16 a[0:3], a[148:151], a[204:207], a[0:3]
    v_mfma_f32_16x16x32_bf16 a[4:7], a[156:159], a[204:207], a[4:7]
    v_mfma_f32_16x16x32_bf16 a[4:7], a[152:155], a[172:175], a[4:7]
    buffer_load_dwordx4 v7, s[48:51], s59 offen offset:2048  lds
    v_mfma_f32_16x16x32_bf16 a[12:15], a[152:155], a[168:171], a[12:15]
    v_mfma_f32_16x16x32_bf16 a[12:15], a[156:159], a[200:203], a[12:15]
    v_mfma_f32_16x16x32_bf16 a[8:11], a[148:151], a[200:203], a[8:11]
    v_mfma_f32_16x16x32_bf16 a[8:11], a[144:147], a[168:171], a[8:11]
    v_mfma_f32_16x16x32_bf16 a[16:19], a[144:147], a[164:167], a[16:19]
    v_mfma_f32_16x16x32_bf16 a[16:19], a[148:151], a[196:199], a[16:19]
    v_mfma_f32_16x16x32_bf16 a[20:23], a[156:159], a[196:199], a[20:23]
    v_mfma_f32_16x16x32_bf16 a[20:23], a[152:155], a[164:167], a[20:23]
    buffer_load_dwordx4 v8, s[48:51], s59 offen offset:3072  lds
    v_mfma_f32_16x16x32_bf16 a[28:31], a[152:155], a[160:163], a[28:31]
    s_add_u32 s59, s59, 262144
    v_mfma_f32_16x16x32_bf16 a[28:31], a[156:159], a[192:195], a[28:31]
    s_mov_b32 s67, s60
    s_mov_b32 s60, s61
    s_mov_b32 s61, s62
    v_mfma_f32_16x16x32_bf16 a[24:27], a[148:151], a[192:195], a[24:27]
    s_mov_b32 s62, s67
    v_mfma_f32_16x16x32_bf16 a[24:27], a[144:147], a[160:163], a[24:27]
    s_waitcnt vmcnt(23) lgkmcnt(0)
    s_barrier
    v_mfma_f32_16x16x32_bf16 v[32:35], a[96:99], a[32:35], v[32:35]
    ds_read_b128 a[128:131], v11 offset:8192
    v_mfma_f32_16x16x32_bf16 v[32:35], a[100:103], a[64:67], v[32:35]
    s_add_u32 s66, s58, s69
    v_mfma_f32_16x16x32_bf16 v[36:39], a[108:111], a[64:67], v[36:39]
    s_add_u32 m0, s62, 16384
    ds_read_b64_tr_b16 a[160:161], v13 offset:32768
    v_mfma_f32_16x16x32_bf16 v[36:39], a[104:107], a[32:35], v[36:39]
    buffer_load_dwordx4 v24, s[44:47], s66 offen offset:0  lds
    v_mfma_f32_16x16x32_bf16 v[44:47], a[104:107], a[36:39], v[44:47]
    ds_read_b64_tr_b16 a[162:163], v13 offset:33792
    v_mfma_f32_16x16x32_bf16 v[44:47], a[108:111], a[68:71], v[44:47]
    v_mfma_f32_16x16x32_bf16 v[40:43], a[100:103], a[68:71], v[40:43]
    ds_read_b128 a[132:135], v12 offset:8192
    v_mfma_f32_16x16x32_bf16 v[40:43], a[96:99], a[36:39], v[40:43]
    v_mfma_f32_16x16x32_bf16 v[48:51], a[96:99], a[40:43], v[48:51]
    ds_read_b64_tr_b16 a[164:165], v14 offset:32768
    v_mfma_f32_16x16x32_bf16 v[48:51], a[100:103], a[72:75], v[48:51]
    v_mfma_f32_16x16x32_bf16 v[52:55], a[108:111], a[72:75], v[52:55]
    ds_read_b64_tr_b16 a[166:167], v14 offset:33792
    v_mfma_f32_16x16x32_bf16 v[52:55], a[104:107], a[40:43], v[52:55]
    buffer_load_dwordx4 v25, s[44:47], s66 offen offset:1024  lds
    v_mfma_f32_16x16x32_bf16 v[60:63], a[104:107], a[44:47], v[60:63]
    ds_read_b128 a[136:139], v11 offset:10240
    v_mfma_f32_16x16x32_bf16 v[60:63], a[108:111], a[76:79], v[60:63]
    v_mfma_f32_16x16x32_bf16 v[56:59], a[100:103], a[76:79], v[56:59]
    ds_read_b64_tr_b16 a[168:169], v13 offset:33024
    v_mfma_f32_16x16x32_bf16 v[56:59], a[96:99], a[44:47], v[56:59]
    v_mfma_f32_16x16x32_bf16 v[64:67], a[96:99], a[48:51], v[64:67]
    ds_read_b64_tr_b16 a[170:171], v13 offset:34048
    v_mfma_f32_16x16x32_bf16 v[64:67], a[100:103], a[80:83], v[64:67]
    v_mfma_f32_16x16x32_bf16 v[68:71], a[108:111], a[80:83], v[68:71]
    ds_read_b128 a[140:143], v12 offset:10240
    v_mfma_f32_16x16x32_bf16 v[68:71], a[104:107], a[48:51], v[68:71]
    buffer_load_dwordx4 v26, s[44:47], s66 offen offset:2048  lds
    v_mfma_f32_16x16x32_bf16 v[76:79], a[104:107], a[52:55], v[76:79]
    ds_read_b64_tr_b16 a[172:173], v14 offset:33024
    v_mfma_f32_16x16x32_bf16 v[76:79], a[108:111], a[84:87], v[76:79]
    v_mfma_f32_16x16x32_bf16 v[72:75], a[100:103], a[84:87], v[72:75]
    ds_read_b64_tr_b16 a[174:175], v14 offset:34048
    v_mfma_f32_16x16x32_bf16 v[72:75], a[96:99], a[52:55], v[72:75]
    v_mfma_f32_16x16x32_bf16 v[80:83], a[96:99], a[56:59], v[80:83]
    ds_read_b128 a[144:147], v11 offset:12288
    v_mfma_f32_16x16x32_bf16 v[80:83], a[100:103], a[88:91], v[80:83]
    v_mfma_f32_16x16x32_bf16 v[84:87], a[108:111], a[88:91], v[84:87]
    ds_read_b64_tr_b16 a[176:177], v13 offset:33280
    v_mfma_f32_16x16x32_bf16 v[84:87], a[104:107], a[56:59], v[84:87]
    buffer_load_dwordx4 v27, s[44:47], s66 offen offset:3072  lds
    v_mfma_f32_16x16x32_bf16 v[92:95], a[104:107], a[60:63], v[92:95]
    s_add_u32 s58, s58, 128
    ds_read_b64_tr_b16 a[178:179], v13 offset:34304
    v_mfma_f32_16x16x32_bf16 v[92:95], a[108:111], a[92:95], v[92:95]
    v_mfma_f32_16x16x32_bf16 v[88:91], a[100:103], a[92:95], v[88:91]
    ds_read_b128 a[148:151], v12 offset:12288
    v_mfma_f32_16x16x32_bf16 v[88:91], a[96:99], a[60:63], v[88:91]
    v_mfma_f32_16x16x32_bf16 v[96:99], a[112:115], a[60:63], v[96:99]
    ds_read_b64_tr_b16 a[180:181], v14 offset:33280
    v_mfma_f32_16x16x32_bf16 v[96:99], a[116:119], a[92:95], v[96:99]
    v_mfma_f32_16x16x32_bf16 v[100:103], a[124:127], a[92:95], v[100:103]
    s_add_u32 m0, s63, 16384
    ds_read_b64_tr_b16 a[182:183], v14 offset:34304
    v_mfma_f32_16x16x32_bf16 v[100:103], a[120:123], a[60:63], v[100:103]
    buffer_load_dwordx4 v5, s[48:51], s59 offen offset:0  lds
    v_mfma_f32_16x16x32_bf16 v[108:111], a[120:123], a[56:59], v[108:111]
    ds_read_b128 a[152:155], v11 offset:14336
    v_mfma_f32_16x16x32_bf16 v[108:111], a[124:127], a[88:91], v[108:111]
    v_mfma_f32_16x16x32_bf16 v[104:107], a[116:119], a[88:91], v[104:107]
    ds_read_b64_tr_b16 a[184:185], v13 offset:33536
    v_mfma_f32_16x16x32_bf16 v[104:107], a[112:115], a[56:59], v[104:107]
    v_mfma_f32_16x16x32_bf16 v[112:115], a[112:115], a[52:55], v[112:115]
    ds_read_b64_tr_b16 a[186:187], v13 offset:34560
    v_mfma_f32_16x16x32_bf16 v[112:115], a[116:119], a[84:87], v[112:115]
    v_mfma_f32_16x16x32_bf16 v[116:119], a[124:127], a[84:87], v[116:119]
    ds_read_b128 a[156:159], v12 offset:14336
    v_mfma_f32_16x16x32_bf16 v[116:119], a[120:123], a[52:55], v[116:119]
    buffer_load_dwordx4 v6, s[48:51], s59 offen offset:1024  lds
    v_mfma_f32_16x16x32_bf16 v[124:127], a[120:123], a[48:51], v[124:127]
    ds_read_b64_tr_b16 a[188:189], v14 offset:33536
    v_mfma_f32_16x16x32_bf16 v[124:127], a[124:127], a[80:83], v[124:127]
    v_mfma_f32_16x16x32_bf16 v[120:123], a[116:119], a[80:83], v[120:123]
    ds_read_b64_tr_b16 a[190:191], v14 offset:34560
    v_mfma_f32_16x16x32_bf16 v[120:123], a[112:115], a[48:51], v[120:123]
    v_mfma_f32_16x16x32_bf16 v[128:131], a[112:115], a[44:47], v[128:131]
    v_add_u32 v11, s61, v9
    v_add_u32 v12, s61, v10
    v_mfma_f32_16x16x32_bf16 v[128:131], a[116:119], a[76:79], v[128:131]
    v_mfma_f32_16x16x32_bf16 v[132:135], a[124:127], a[76:79], v[132:135]
    v_mfma_f32_16x16x32_bf16 v[132:135], a[120:123], a[44:47], v[132:135]
    buffer_load_dwordx4 v7, s[48:51], s59 offen offset:2048  lds
    v_mfma_f32_16x16x32_bf16 v[140:143], a[120:123], a[40:43], v[140:143]
    v_mfma_f32_16x16x32_bf16 v[140:143], a[124:127], a[72:75], v[140:143]
    v_mfma_f32_16x16x32_bf16 v[136:139], a[116:119], a[72:75], v[136:139]
    v_mfma_f32_16x16x32_bf16 v[136:139], a[112:115], a[40:43], v[136:139]
    v_mfma_f32_16x16x32_bf16 v[144:147], a[112:115], a[36:39], v[144:147]
    v_mfma_f32_16x16x32_bf16 v[144:147], a[116:119], a[68:71], v[144:147]
    v_mfma_f32_16x16x32_bf16 v[148:151], a[124:127], a[68:71], v[148:151]
    v_mfma_f32_16x16x32_bf16 v[148:151], a[120:123], a[36:39], v[148:151]
    buffer_load_dwordx4 v8, s[48:51], s59 offen offset:3072  lds
    v_mfma_f32_16x16x32_bf16 v[156:159], a[120:123], a[32:35], v[156:159]
    s_add_u32 s59, s59, 262144
    v_mfma_f32_16x16x32_bf16 v[156:159], a[124:127], a[64:67], v[156:159]
    v_mfma_f32_16x16x32_bf16 v[152:155], a[116:119], a[64:67], v[152:155]
    v_mfma_f32_16x16x32_bf16 v[152:155], a[112:115], a[32:35], v[152:155]
    s_waitcnt vmcnt(13) lgkmcnt(0)
    s_barrier
    v_cmp_gt_u32 vcc, 16843009, v1
    s_nop 0
    s_cmp_lg_u64 vcc, 0
    s_cbranch_scc1 F_spin1
F_spin1r:
    v_mfma_f32_16x16x32_bf16 v[160:163], a[128:131], a[32:35], v[160:163]
    ds_read_b128 a[96:99], v11 offset:0
    v_mfma_f32_16x16x32_bf16 v[16:19], a[224:227], a[240:243], 0
    v_mfma_f32_16x16x32_bf16 v[20:23], a[232:235], a[240:243], 0
    s_mov_b32 m0, s60
    ds_read_b64_tr_b16 a[192:193], v13 offset:49152
    v_mfma_f32_16x16x32_bf16 v[160:163], a[132:135], a[64:67], v[160:163]
    buffer_load_dwordx4 v24, s[44:47], s58 offen offset:0  lds
    v_mfma_f32_16x16x32_bf16 v[164:167], a[140:143], a[64:67], v[164:167]
    ds_read_b64_tr_b16 a[194:195], v13 offset:50176
    v_mfma_f32_16x16x32_bf16 v[164:167], a[136:139], a[32:35], v[164:167]
    v_mfma_f32_16x16x32_bf16 v[172:175], a[136:139], a[36:39], v[172:175]
    ds_read_b128 a[100:103], v12 offset:0
    v_mfma_f32_16x16x32_bf16 v[172:175], a[140:143], a[68:71], v[172:175]
    v_mfma_f32_16x16x32_bf16 v[168:171], a[132:135], a[68:71], v[168:171]
    v_cvt_pk_bf16_f32 v16, v16, v17
    ds_read_b64_tr_b16 a[196:197], v14 offset:49152
    v_mfma_f32_16x16x32_bf16 v[168:171], a[128:131], a[36:39], v[168:171]
    v_cvt_pk_bf16_f32 v17, v18, v19
    v_cvt_pk_bf16_f32 v18, v20, v21
    v_mfma_f32_16x16x32_bf16 v[176:179], a[128:131], a[40:43], v[176:179]
    v_cvt_pk_bf16_f32 v19, v22, v23
    ds_read_b64_tr_b16 a[198:199], v14 offset:50176
    v_mfma_f32_16x16x32_bf16 v[176:179], a[132:135], a[72:75], v[176:179]
    buffer_load_dwordx4 v25, s[44:47], s58 offen offset:1024  lds
    v_mfma_f32_16x16x32_bf16 v[180:183], a[140:143], a[72:75], v[180:183]
    buffer_store_dwordx4 v[16:19], v15, s[40:43], s74 offen offset:0 sc1
    v_mfma_f32_16x16x32_bf16 v[180:183], a[136:139], a[40:43], v[180:183]
    ds_read_b128 a[104:107], v11 offset:2048
    v_mfma_f32_16x16x32_bf16 v[188:191], a[136:139], a[44:47], v[188:191]
    ds_read_b64_tr_b16 a[200:201], v13 offset:49408
    v_mfma_f32_16x16x32_bf16 v[188:191], a[140:143], a[76:79], v[188:191]
    v_mfma_f32_16x16x32_bf16 v[16:19], a[224:227], a[244:247], 0
    ds_read_b64_tr_b16 a[202:203], v13 offset:50432
    v_mfma_f32_16x16x32_bf16 v[20:23], a[232:235], a[244:247], 0
    v_mfma_f32_16x16x32_bf16 v[184:187], a[132:135], a[76:79], v[184:187]
    ds_read_b128 a[108:111], v12 offset:2048
    v_mfma_f32_16x16x32_bf16 v[184:187], a[128:131], a[44:47], v[184:187]
    buffer_load_dwordx4 v26, s[44:47], s58 offen offset:2048  lds
    v_mfma_f32_16x16x32_bf16 v[192:195], a[128:131], a[48:51], v[192:195]
    ds_read_b64_tr_b16 a[204:205], v14 offset:49408
    v_mfma_f32_16x16x32_bf16 v[192:195], a[132:135], a[80:83], v[192:195]
    v_mfma_f32_16x16x32_bf16 v[196:199], a[140:143], a[80:83], v[196:199]
    ds_read_b64_tr_b16 a[206:207], v14 offset:50432
    v_mfma_f32_16x16x32_bf16 v[196:199], a[136:139], a[48:51], v[196:199]
    v_cvt_pk_bf16_f32 v16, v16, v17
    v_cvt_pk_bf16_f32 v17, v18, v19
    v_mfma_f32_16x16x32_bf16 v[204:207], a[136:139], a[52:55], v[204:207]
    v_cvt_pk_bf16_f32 v18, v20, v21
    ds_read_b128 a[112:115], v11 offset:4096
    v_mfma_f32_16x16x32_bf16 v[204:207], a[140:143], a[84:87], v[204:207]
    v_cvt_pk_bf16_f32 v19, v22, v23
    v_mfma_f32_16x16x32_bf16 v[200:203], a[132:135], a[84:87], v[200:203]
    buffer_store_dwordx4 v[16:19], v15, s[40:43], s74 offen offset:1024 sc1
    v_mfma_f32_16x16x32_bf16 v[200:203], a[128:131], a[52:55], v[200:203]
    buffer_load_dwordx4 v27, s[44:47], s58 offen offset:3072  lds
    v_mfma_f32_16x16x32_bf16 v[208:211], a[128:131], a[56:59], v[208:211]
    ds_read_b64_tr_b16 a[208:209], v13 offset:49664
    ds_read_b64_tr_b16 a[210:211], v13 offset:50688
    v_mfma_f32_16x16x32_bf16 v[208:211], a[132:135], a[88:91], v[208:211]
    v_mfma_f32_16x16x32_bf16 v[212:215], a[140:143], a[88:91], v[212:215]
    ds_read_b128 a[116:119], v12 offset:4096
    v_mfma_f32_16x16x32_bf16 v[16:19], a[228:231], a[240:243], 0
    v_mfma_f32_16x16x32_bf16 v[20:23], a[236:239], a[240:243], 0
    ds_read_b64_tr_b16 a[212:213], v14 offset:49664
    v_mfma_f32_16x16x32_bf16 v[212:215], a[136:139], a[56:59], v[212:215]
    v_mfma_f32_16x16x32_bf16 v[220:223], a[136:139], a[60:63], v[220:223]
    s_add_u32 m0, s63, 32768
    ds_read_b64_tr_b16 a[214:215], v14 offset:50688
    v_mfma_f32_16x16x32_bf16 v[220:223], a[140:143], a[92:95], v[220:223]
    buffer_load_dwordx4 v5, s[48:51], s59 offen offset:0  lds
    v_mfma_f32_16x16x32_bf16 v[216:219], a[132:135], a[92:95], v[216:219]
    ds_read_b128 a[120:123], v11 offset:6144
    v_mfma_f32_16x16x32_bf16 v[216:219], a[128:131], a[60:63], v[216:219]
    v_mfma_f32_16x16x32_bf16 v[224:227], a[144:147], a[60:63], v[224:227]
    v_cvt_pk_bf16_f32 v16, v16, v17
    ds_read_b64_tr_b16 a[216:217], v13 offset:49920
    v_mfma_f32_16x16x32_bf16 v[224:227], a[148:151], a[92:95], v[224:227]
    v_cvt_pk_bf16_f32 v17, v18, v19
    v_cvt_pk_bf16_f32 v18, v20, v21
    v_mfma_f32_16x16x32_bf16 v[228:231], a[156:159], a[92:95], v[228:231]
    v_cvt_pk_bf16_f32 v19, v22, v23
    ds_read_b64_tr_b16 a[218:219], v13 offset:50944
    v_mfma_f32_16x16x32_bf16 v[228:231], a[152:155], a[60:63], v[228:231]
    buffer_store_dwordx4 v[16:19], v15, s[40:43], s74 offen offset:2048 sc1
    v_mfma_f32_16x16x32_bf16 v[236:239], a[152:155], a[56:59], v[236:239]
    ds_read_b128 a[124:127], v12 offset:6144
    v_mfma_f32_16x16x32_bf16 v[236:239], a[156:159], a[88:91], v[236:239]
    buffer_load_dwordx4 v6, s[48:51], s59 offen offset:1024  lds
    v_mfma_f32_16x16x32_bf16 v[232:235], a[148:151], a[88:91], v[232:235]
    ds_read_b64_tr_b16 a[220:221], v14 offset:49920
    v_mfma_f32_16x16x32_bf16 v[232:235], a[144:147], a[56:59], v[232:235]
    v_mfma_f32_16x16x32_bf16 v[16:19], a[228:231], a[244:247], 0
    ds_read_b64_tr_b16 a[222:223], v14 offset:50944
    v_mfma_f32_16x16x32_bf16 v[20:23], a[236:239], a[244:247], 0
    v_mfma_f32_16x16x32_bf16 v[240:243], a[144:147], a[52:55], v[240:243]
    v_mfma_f32_16x16x32_bf16 v[240:243], a[148:151], a[84:87], v[240:243]
    v_mfma_f32_16x16x32_bf16 v[244:247], a[156:159], a[84:87], v[244:247]
    v_mfma_f32_16x16x32_bf16 v[244:247], a[152:155], a[52:55], v[244:247]
    buffer_load_dwordx4 v7, s[48:51], s59 offen offset:2048  lds
    v_mfma_f32_16x16x32_bf16 v[252:255], a[152:155], a[48:51], v[252:255]
    v_mfma_f32_16x16x32_bf16 v[252:255], a[156:159], a[80:83], v[252:255]
    v_cvt_pk_bf16_f32 v16, v16, v17
    v_cvt_pk_bf16_f32 v17, v18, v19
    v_mfma_f32_16x16x32_bf16 v[248:251], a[148:151], a[80:83], v[248:251]
    v_cvt_pk_bf16_f32 v18, v20, v21
    v_cvt_pk_bf16_f32 v19, v22, v23
    v_mfma_f32_16x16x32_bf16 v[248:251], a[144:147], a[48:51], v[248:251]
    buffer_store_dwordx4 v[16:19], v15, s[40:43], s74 offen offset:3072 sc1
    v_mfma_f32_16x16x32_bf16 a[0:3], a[144:147], a[44:47], a[0:3]
    s_lshl_b32 s56, s26, 11
    s_add_u32 s75, s56, 82837504
    s_lshl_b32 s56, s28, 3
    v_mfma_f32_16x16x32_bf16 a[0:3], a[148:151], a[76:79], a[0:3]
    s_add_u32 s56, s56, s27
    s_lshl_b32 s56, s56, 7
    s_add_u32 s56, s56, s75
    v_mfma_f32_16x16x32_bf16 a[4:7], a[156:159], a[76:79], a[4:7]
    s_cmp_eq_u32 s29, 0
    s_cselect_b32 s56, s56, 1073741824
    v_mov_b32 v2, 1
    v_bfe_u32 v3, v15, 2, 7
    v_mfma_f32_16x16x32_bf16 a[4:7], a[152:155], a[44:47], a[4:7]
    buffer_load_dwordx4 v8, s[48:51], s59 offen offset:3072  lds
    v_mfma_f32_16x16x32_bf16 a[12:15], a[152:155], a[40:43], a[12:15]
    s_add_u32 s59, s59, 262144
    v_lshlrev_b32 v4, 3, v15
    v_and_b32 v4, 2047, v4
    v_mfma_f32_16x16x32_bf16 a[12:15], a[156:159], a[72:75], a[12:15]
    s_mov_b32 s67, s60
    s_mov_b32 s60, s61
    s_mov_b32 s61, s62
    v_mfma_f32_16x16x32_bf16 a[8:11], a[148:151], a[72:75], a[8:11]
    s_mov_b32 s62, s67
    v_mfma_f32_16x16x32_bf16 a[8:11], a[144:147], a[40:43], a[8:11]
    v_mfma_f32_16x16x32_bf16 a[16:19], a[144:147], a[36:39], a[16:19]
    v_mfma_f32_16x16x32_bf16 a[16:19], a[148:151], a[68:71], a[16:19]
    v_mfma_f32_16x16x32_bf16 a[20:23], a[156:159], a[68:71], a[20:23]
    v_mfma_f32_16x16x32_bf16 a[20:23], a[152:155], a[36:39], a[20:23]
    v_mfma_f32_16x16x32_bf16 a[28:31], a[152:155], a[32:35], a[28:31]
    v_mfma_f32_16x16x32_bf16 a[28:31], a[156:159], a[64:67], a[28:31]
    v_mfma_f32_16x16x32_bf16 a[24:27], a[148:151], a[64:67], a[24:27]
    v_mfma_f32_16x16x32_bf16 a[24:27], a[144:147], a[32:35], a[24:27]
    s_waitcnt vmcnt(20) lgkmcnt(0)
    s_barrier
    v_mfma_f32_16x16x32_bf16 v[32:35], a[96:99], a[160:163], v[32:35]
    ds_read_b128 a[128:131], v11 offset:8192
    v_mfma_f32_16x16x32_bf16 v[32:35], a[100:103], a[192:195], v[32:35]
    s_add_u32 s66, s58, s69
    v_mfma_f32_16x16x32_bf16 v[36:39], a[108:111], a[192:195], v[36:39]
    s_add_u32 m0, s62, 16384
    ds_read_b128 a[132:135], v12 offset:8192
    v_mfma_f32_16x16x32_bf16 v[36:39], a[104:107], a[160:163], v[36:39]
    buffer_load_dwordx4 v24, s[44:47], s66 offen offset:0  lds
    v_mfma_f32_16x16x32_bf16 v[44:47], a[104:107], a[164:167], v[44:47]
    ds_read_b128 a[136:139], v11 offset:10240
    v_mfma_f32_16x16x32_bf16 v[44:47], a[108:111], a[196:199], v[44:47]
    v_mfma_f32_16x16x32_bf16 v[40:43], a[100:103], a[196:199], v[40:43]
    ds_read_b128 a[140:143], v12 offset:10240
    v_mfma_f32_16x16x32_bf16 v[40:43], a[96:99], a[164:167], v[40:43]
    v_mfma_f32_16x16x32_bf16 v[48:51], a[96:99], a[168:171], v[48:51]
    ds_read_b128 a[144:147], v11 offset:12288
    v_mfma_f32_16x16x32_bf16 v[48:51], a[100:103], a[200:203], v[48:51]
    v_cvt_pk_bf16_f32 v32, v32, v33
    v_cvt_pk_bf16_f32 v33, v34, v35
    v_mfma_f32_16x16x32_bf16 v[52:55], a[108:111], a[200:203], v[52:55]
    v_cvt_pk_bf16_f32 v34, v36, v37
    ds_read_b128 a[148:151], v12 offset:12288
    v_mfma_f32_16x16x32_bf16 v[52:55], a[104:107], a[168:171], v[52:55]
    buffer_load_dwordx4 v25, s[44:47], s66 offen offset:1024  lds
    v_mfma_f32_16x16x32_bf16 v[60:63], a[104:107], a[172:175], v[60:63]
    v_cvt_pk_bf16_f32 v35, v38, v39
    ds_read_b128 a[152:155], v11 offset:14336
    v_mfma_f32_16x16x32_bf16 v[60:63], a[108:111], a[204:207], v[60:63]
    v_cvt_pk_bf16_f32 v36, v40, v41
    v_cvt_pk_bf16_f32 v37, v42, v43
    v_mfma_f32_16x16x32_bf16 v[56:59], a[100:103], a[204:207], v[56:59]
    v_cvt_pk_bf16_f32 v38, v44, v45
    ds_read_b128 a[156:159], v12 offset:14336
    v_mfma_f32_16x16x32_bf16 v[56:59], a[96:99], a[172:175], v[56:59]
    v_cvt_pk_bf16_f32 v39, v46, v47
    v_mfma_f32_16x16x32_bf16 v[64:67], a[96:99], a[176:179], v[64:67]
    v_add_u32 v11, s61, v9
    v_add_u32 v12, s61, v10
    v_mfma_f32_16x16x32_bf16 v[64:67], a[100:103], a[208:211], v[64:67]
    v_cvt_pk_bf16_f32 v40, v48, v49
    v_cvt_pk_bf16_f32 v41, v50, v51
    v_mfma_f32_16x16x32_bf16 v[68:71], a[108:111], a[208:211], v[68:71]
    v_cvt_pk_bf16_f32 v42, v52, v53
    v_cvt_pk_bf16_f32 v43, v54, v55
    v_mfma_f32_16x16x32_bf16 v[68:71], a[104:107], a[176:179], v[68:71]
    buffer_load_dwordx4 v26, s[44:47], s66 offen offset:2048  lds
    v_mfma_f32_16x16x32_bf16 v[76:79], a[104:107], a[180:183], v[76:79]
    v_mfma_f32_16x16x32_bf16 v[76:79], a[108:111], a[212:215], v[76:79]
    v_cvt_pk_bf16_f32 v44, v56, v57
    v_cvt_pk_bf16_f32 v45, v58, v59
    v_mfma_f32_16x16x32_bf16 v[72:75], a[100:103], a[212:215], v[72:75]
    v_cvt_pk_bf16_f32 v46, v60, v61
    v_cvt_pk_bf16_f32 v47, v62, v63
    s_add_u32 s74, s65, 0
    v_mfma_f32_16x16x32_bf16 v[72:75], a[96:99], a[180:183], v[72:75]
    buffer_store_dwordx4 v[32:35], v15, s[40:43], s74 offen offset:0 sc1
    v_mfma_f32_16x16x32_bf16 v[80:83], a[96:99], a[184:187], v[80:83]
    v_mfma_f32_16x16x32_bf16 v[80:83], a[100:103], a[216:219], v[80:83]
    v_cvt_pk_bf16_f32 v48, v64, v65
    v_cvt_pk_bf16_f32 v49, v66, v67
    v_mfma_f32_16x16x32_bf16 v[84:87], a[108:111], a[216:219], v[84:87]
    v_cvt_pk_bf16_f32 v50, v68, v69
    v_cvt_pk_bf16_f32 v51, v70, v71
    v_mfma_f32_16x16x32_bf16 v[84:87], a[104:107], a[184:187], v[84:87]
    buffer_load_dwordx4 v27, s[44:47], s66 offen offset:3072  lds
    v_mfma_f32_16x16x32_bf16 v[92:95], a[104:107], a[188:191], v[92:95]
    s_add_u32 s58, s58, 128
    v_mfma_f32_16x16x32_bf16 v[92:95], a[108:111], a[220:223], v[92:95]
    v_cvt_pk_bf16_f32 v52, v72, v73
    v_cvt_pk_bf16_f32 v53, v74, v75
    v_mfma_f32_16x16x32_bf16 v[88:91], a[100:103], a[220:223], v[88:91]
    v_cvt_pk_bf16_f32 v54, v76, v77
    v_cvt_pk_bf16_f32 v55, v78, v79
    v_mfma_f32_16x16x32_bf16 v[88:91], a[96:99], a[188:191], v[88:91]
    v_mfma_f32_16x16x32_bf16 v[96:99], a[112:115], a[188:191], v[96:99]
    v_mfma_f32_16x16x32_bf16 v[96:99], a[116:119], a[220:223], v[96:99]
    v_cvt_pk_bf16_f32 v56, v80, v81
    v_cvt_pk_bf16_f32 v57, v82, v83
    v_mfma_f32_16x16x32_bf16 v[100:103], a[124:127], a[220:223], v[100:103]
    s_add_u32 m0, s63, 49152
    v_cvt_pk_bf16_f32 v58, v84, v85
    v_cvt_pk_bf16_f32 v59, v86, v87
    v_mfma_f32_16x16x32_bf16 v[100:103], a[120:123], a[188:191], v[100:103]
    buffer_load_dwordx4 v5, s[48:51], s59 offen offset:0  lds
    v_mfma_f32_16x16x32_bf16 v[108:111], a[120:123], a[184:187], v[108:111]
    v_mfma_f32_16x16x32_bf16 v[108:111], a[124:127], a[216:219], v[108:111]
    v_cvt_pk_bf16_f32 v60, v88, v89
    v_cvt_pk_bf16_f32 v61, v90, v91
    v_mfma_f32_16x16x32_bf16 v[104:107], a[116:119], a[216:219], v[104:107]
    v_cvt_pk_bf16_f32 v62, v92, v93
    v_cvt_pk_bf16_f32 v63, v94, v95
    v_mfma_f32_16x16x32_bf16 v[104:107], a[112:115], a[184:187], v[104:107]
    v_mfma_f32_16x16x32_bf16 v[112:115], a[112:115], a[180:183], v[112:115]
    v_mfma_f32_16x16x32_bf16 v[112:115], a[116:119], a[212:215], v[112:115]
    v_cvt_pk_bf16_f32 v64, v96, v97
    v_cvt_pk_bf16_f32 v65, v98, v99
    v_mfma_f32_16x16x32_bf16 v[116:119], a[124:127], a[212:215], v[116:119]
    v_cvt_pk_bf16_f32 v66, v100, v101
    v_cvt_pk_bf16_f32 v67, v102, v103
    v_mfma_f32_16x16x32_bf16 v[116:119], a[120:123], a[180:183], v[116:119]
    buffer_load_dwordx4 v6, s[48:51], s59 offen offset:1024  lds
    v_mfma_f32_16x16x32_bf16 v[124:127], a[120:123], a[176:179], v[124:127]
    v_mfma_f32_16x16x32_bf16 v[124:127], a[124:127], a[208:211], v[124:127]
    v_cvt_pk_bf16_f32 v68, v104, v105
    v_cvt_pk_bf16_f32 v69, v106, v107
    v_mfma_f32_16x16x32_bf16 v[120:123], a[116:119], a[208:211], v[120:123]
    v_cvt_pk_bf16_f32 v70, v108, v109
    v_cvt_pk_bf16_f32 v71, v110, v111
    v_mfma_f32_16x16x32_bf16 v[120:123], a[112:115], a[176:179], v[120:123]
    v_mfma_f32_16x16x32_bf16 v[128:131], a[112:115], a[172:175], v[128:131]
    v_mfma_f32_16x16x32_bf16 v[128:131], a[116:119], a[204:207], v[128:131]
    v_cvt_pk_bf16_f32 v72, v112, v113
    v_cvt_pk_bf16_f32 v73, v114, v115
    v_mfma_f32_16x16x32_bf16 v[132:135], a[124:127], a[204:207], v[132:135]
    v_cvt_pk_bf16_f32 v74, v116, v117
    v_cvt_pk_bf16_f32 v75, v118, v119
    v_mfma_f32_16x16x32_bf16 v[132:135], a[120:123], a[172:175], v[132:135]
    buffer_load_dwordx4 v7, s[48:51], s59 offen offset:2048  lds
    v_mfma_f32_16x16x32_bf16 v[140:143], a[120:123], a[168:171], v[140:143]
    v_mfma_f32_16x16x32_bf16 v[140:143], a[124:127], a[200:203], v[140:143]
    v_cvt_pk_bf16_f32 v76, v120, v121
    v_cvt_pk_bf16_f32 v77, v122, v123
    v_mfma_f32_16x16x32_bf16 v[136:139], a[116:119], a[200:203], v[136:139]
    v_cvt_pk_bf16_f32 v78, v124, v125
    v_cvt_pk_bf16_f32 v79, v126, v127
    v_mfma_f32_16x16x32_bf16 v[136:139], a[112:115], a[168:171], v[136:139]
    buffer_store_dwordx4 v[36:39], v15, s[40:43], s74 offen offset:1024 sc1
    v_mfma_f32_16x16x32_bf16 v[144:147], a[112:115], a[164:167], v[144:147]
    v_mfma_f32_16x16x32_bf16 v[144:147], a[116:119], a[196:199], v[144:147]
    v_cvt_pk_bf16_f32 v80, v128, v129
    v_cvt_pk_bf16_f32 v81, v130, v131
    v_mfma_f32_16x16x32_bf16 v[148:151], a[124:127], a[196:199], v[148:151]
    v_cvt_pk_bf16_f32 v82, v132, v133
    v_cvt_pk_bf16_f32 v83, v134, v135
    v_mfma_f32_16x16x32_bf16 v[148:151], a[120:123], a[164:167], v[148:151]
    buffer_load_dwordx4 v8, s[48:51], s59 offen offset:3072  lds
    v_mfma_f32_16x16x32_bf16 v[156:159], a[120:123], a[160:163], v[156:159]
    s_add_u32 s59, s59, 262144
    v_mfma_f32_16x16x32_bf16 v[156:159], a[124:127], a[192:195], v[156:159]
    v_cvt_pk_bf16_f32 v84, v136, v137
    v_cvt_pk_bf16_f32 v85, v138, v139
    v_mfma_f32_16x16x32_bf16 v[152:155], a[116:119], a[192:195], v[152:155]
    v_cvt_pk_bf16_f32 v86, v140, v141
    v_cvt_pk_bf16_f32 v87, v142, v143
    v_mfma_f32_16x16x32_bf16 v[152:155], a[112:115], a[160:163], v[152:155]
    s_waitcnt vmcnt(22) lgkmcnt(0)
    s_barrier
    s_lshr_b32 s66, s29, 1
    s_lshl_b32 s66, s66, 14
    s_lshl_b32 s67, s29, 12
    s_sub_u32 s66, s67, s66
    v_add_u32 v9, s66, v9
    v_add_u32 v10, s66, v10
    v_add_u32 v11, s66, v11
    v_and_b32 v13, 0x1fff, v13
    v_and_b32 v14, 0x1fff, v14
    v_mfma_f32_16x16x32_bf16 v[160:163], a[128:131], a[160:163], v[160:163]
    ds_read_b64_tr_b16 a[32:33], v13 offset:0
    v_mfma_f32_16x16x32_bf16 v[160:163], a[132:135], a[192:195], v[160:163]
    ds_read_b64_tr_b16 a[34:35], v13 offset:1024
    v_mfma_f32_16x16x32_bf16 v[164:167], a[140:143], a[192:195], v[164:167]
    s_mov_b32 m0, s60
    ds_read_b64_tr_b16 a[36:37], v14 offset:0
    v_mfma_f32_16x16x32_bf16 v[164:167], a[136:139], a[160:163], v[164:167]
    buffer_load_dwordx4 v24, s[44:47], s58 offen offset:0  lds
    v_mfma_f32_16x16x32_bf16 v[172:175], a[136:139], a[164:167], v[172:175]
    v_cvt_pk_bf16_f32 v88, v144, v145
    ds_read_b64_tr_b16 a[38:39], v14 offset:1024
    v_mfma_f32_16x16x32_bf16 v[172:175], a[140:143], a[196:199], v[172:175]
    v_cvt_pk_bf16_f32 v89, v146, v147
    ds_read_b64_tr_b16 a[40:41], v13 offset:256
    v_mfma_f32_16x16x32_bf16 v[168:171], a[132:135], a[196:199], v[168:171]
    v_cvt_pk_bf16_f32 v90, v148, v149
    ds_read_b64_tr_b16 a[42:43], v13 offset:1280
    v_mfma_f32_16x16x32_bf16 v[168:171], a[128:131], a[164:167], v[168:171]
    v_cvt_pk_bf16_f32 v91, v150, v151
    ds_read_b64_tr_b16 a[44:45], v14 offset:256
    v_mfma_f32_16x16x32_bf16 v[176:179], a[128:131], a[168:171], v[176:179]
    v_cvt_pk_bf16_f32 v92, v152, v153
    ds_read_b64_tr_b16 a[46:47], v14 offset:1280
    v_mfma_f32_16x16x32_bf16 v[176:179], a[132:135], a[200:203], v[176:179]
    v_cvt_pk_bf16_f32 v93, v154, v155
    ds_read_b64_tr_b16 a[48:49], v13 offset:512
    v_mfma_f32_16x16x32_bf16 v[180:183], a[140:143], a[200:203], v[180:183]
    v_cvt_pk_bf16_f32 v94, v156, v157
    ds_read_b64_tr_b16 a[50:51], v13 offset:1536
    v_mfma_f32_16x16x32_bf16 v[180:183], a[136:139], a[168:171], v[180:183]
    buffer_load_dwordx4 v25, s[44:47], s58 offen offset:1024  lds
    v_mfma_f32_16x16x32_bf16 v[188:191], a[136:139], a[172:175], v[188:191]
    v_cvt_pk_bf16_f32 v95, v158, v159
    ds_read_b64_tr_b16 a[52:53], v14 offset:512
    v_mfma_f32_16x16x32_bf16 v[188:191], a[140:143], a[204:207], v[188:191]
    v_cvt_pk_bf16_f32 v96, v160, v161
    ds_read_b64_tr_b16 a[54:55], v14 offset:1536
    v_mfma_f32_16x16x32_bf16 v[184:187], a[132:135], a[204:207], v[184:187]
    v_cvt_pk_bf16_f32 v97, v162, v163
    ds_read_b64_tr_b16 a[56:57], v13 offset:768
    v_mfma_f32_16x16x32_bf16 v[184:187], a[128:131], a[172:175], v[184:187]
    v_cvt_pk_bf16_f32 v98, v164, v165
    ds_read_b64_tr_b16 a[58:59], v13 offset:1792
    v_mfma_f32_16x16x32_bf16 v[192:195], a[128:131], a[176:179], v[192:195]
    v_cvt_pk_bf16_f32 v99, v166, v167
    ds_read_b64_tr_b16 a[60:61], v14 offset:768
    v_mfma_f32_16x16x32_bf16 v[192:195], a[132:135], a[208:211], v[192:195]
    v_cvt_pk_bf16_f32 v100, v168, v169
    ds_read_b64_tr_b16 a[62:63], v14 offset:1792
    v_mfma_f32_16x16x32_bf16 v[196:199], a[140:143], a[208:211], v[196:199]
    v_cvt_pk_bf16_f32 v101, v170, v171
    ds_read_b64_tr_b16 a[64:65], v13 offset:8192
    v_mfma_f32_16x16x32_bf16 v[196:199], a[136:139], a[176:179], v[196:199]
    buffer_load_dwordx4 v26, s[44:47], s58 offen offset:2048  lds
    v_mfma_f32_16x16x32_bf16 v[204:207], a[136:139], a[180:183], v[204:207]
    v_cvt_pk_bf16_f32 v102, v172, v173
    ds_read_b64_tr_b16 a[66:67], v13 offset:9216
    v_mfma_f32_16x16x32_bf16 v[204:207], a[140:143], a[212:215], v[204:207]
    v_cvt_pk_bf16_f32 v103, v174, v175
    ds_read_b64_tr_b16 a[68:69], v14 offset:8192
    v_mfma_f32_16x16x32_bf16 v[200:203], a[132:135], a[212:215], v[200:203]
    v_cvt_pk_bf16_f32 v104, v176, v177
    ds_read_b64_tr_b16 a[70:71], v14 offset:9216
    v_mfma_f32_16x16x32_bf16 v[200:203], a[128:131], a[180:183], v[200:203]
    v_cvt_pk_bf16_f32 v105, v178, v179
    ds_read_b64_tr_b16 a[72:73], v13 offset:8448
    v_mfma_f32_16x16x32_bf16 v[208:211], a[128:131], a[184:187], v[208:211]
    v_cvt_pk_bf16_f32 v106, v180, v181
    ds_read_b64_tr_b16 a[74:75], v13 offset:9472
    v_mfma_f32_16x16x32_bf16 v[208:211], a[132:135], a[216:219], v[208:211]
    v_cvt_pk_bf16_f32 v107, v182, v183
    ds_read_b64_tr_b16 a[76:77], v14 offset:8448
    v_mfma_f32_16x16x32_bf16 v[212:215], a[140:143], a[216:219], v[212:215]
    v_cvt_pk_bf16_f32 v108, v184, v185
    ds_read_b64_tr_b16 a[78:79], v14 offset:9472
    v_mfma_f32_16x16x32_bf16 v[212:215], a[136:139], a[184:187], v[212:215]
    buffer_load_dwordx4 v27, s[44:47], s58 offen offset:3072  lds
    v_mfma_f32_16x16x32_bf16 v[220:223], a[136:139], a[188:191], v[220:223]
    v_cvt_pk_bf16_f32 v109, v186, v187
    ds_read_b64_tr_b16 a[80:81], v13 offset:8704
    v_mfma_f32_16x16x32_bf16 v[220:223], a[140:143], a[220:223], v[220:223]
    v_cvt_pk_bf16_f32 v110, v188, v189
    ds_read_b64_tr_b16 a[82:83], v13 offset:9728
    v_mfma_f32_16x16x32_bf16 v[216:219], a[132:135], a[220:223], v[216:219]
    v_cvt_pk_bf16_f32 v111, v190, v191
    ds_read_b64_tr_b16 a[84:85], v14 offset:8704
    v_mfma_f32_16x16x32_bf16 v[216:219], a[128:131], a[188:191], v[216:219]
    buffer_store_dwordx4 v[40:43], v15, s[40:43], s74 offen offset:2048 sc1
    v_mfma_f32_16x16x32_bf16 v[224:227], a[144:147], a[188:191], v[224:227]
    v_cvt_pk_bf16_f32 v112, v192, v193
    ds_read_b64_tr_b16 a[86:87], v14 offset:9728
    v_mfma_f32_16x16x32_bf16 v[224:227], a[148:151], a[220:223], v[224:227]
    v_cvt_pk_bf16_f32 v113, v194, v195
    ds_read_b64_tr_b16 a[88:89], v13 offset:8960
    v_mfma_f32_16x16x32_bf16 v[228:231], a[156:159], a[220:223], v[228:231]
    v_cvt_pk_bf16_f32 v114, v196, v197
    ds_read_b64_tr_b16 a[90:91], v13 offset:9984
    v_mfma_f32_16x16x32_bf16 v[228:231], a[152:155], a[188:191], v[228:231]
    v_cvt_pk_bf16_f32 v115, v198, v199
    ds_read_b64_tr_b16 a[92:93], v14 offset:8960
    v_mfma_f32_16x16x32_bf16 v[236:239], a[152:155], a[184:187], v[236:239]
    v_cvt_pk_bf16_f32 v116, v200, v201
    ds_read_b64_tr_b16 a[94:95], v14 offset:9984
    v_mfma_f32_16x16x32_bf16 v[236:239], a[156:159], a[216:219], v[236:239]
    v_cvt_pk_bf16_f32 v117, v202, v203
    ds_read_b128 a[96:99], v11 offset:0
    v_mfma_f32_16x16x32_bf16 v[232:235], a[148:151], a[216:219], v[232:235]
    v_cvt_pk_bf16_f32 v118, v204, v205
    ds_read_b128 a[100:103], v11 offset:2048
    v_mfma_f32_16x16x32_bf16 v[232:235], a[144:147], a[184:187], v[232:235]
    v_cvt_pk_bf16_f32 v119, v206, v207
    ds_read_b128 a[104:107], v11 offset:16384
    v_mfma_f32_16x16x32_bf16 v[240:243], a[144:147], a[180:183], v[240:243]
    v_cvt_pk_bf16_f32 v120, v208, v209
    ds_read_b128 a[108:111], v11 offset:18432
    v_mfma_f32_16x16x32_bf16 v[240:243], a[148:151], a[212:215], v[240:243]
    v_cvt_pk_bf16_f32 v121, v210, v211
    v_add_u32 v12, s61, v10
    v_mfma_f32_16x16x32_bf16 v[244:247], a[156:159], a[212:215], v[244:247]
    v_cvt_pk_bf16_f32 v122, v212, v213
    v_cvt_pk_bf16_f32 v123, v214, v215
    v_mfma_f32_16x16x32_bf16 v[244:247], a[152:155], a[180:183], v[244:247]
    v_cvt_pk_bf16_f32 v124, v216, v217
    v_cvt_pk_bf16_f32 v125, v218, v219
    v_mfma_f32_16x16x32_bf16 v[252:255], a[152:155], a[176:179], v[252:255]
    v_cvt_pk_bf16_f32 v126, v220, v221
    v_cvt_pk_bf16_f32 v127, v222, v223
    v_mfma_f32_16x16x32_bf16 v[252:255], a[156:159], a[208:211], v[252:255]
    v_cvt_pk_bf16_f32 v128, v224, v225
    v_cvt_pk_bf16_f32 v129, v226, v227
    v_mfma_f32_16x16x32_bf16 v[248:251], a[148:151], a[208:211], v[248:251]
    v_cvt_pk_bf16_f32 v130, v228, v229
    v_cvt_pk_bf16_f32 v131, v230, v231
    v_mfma_f32_16x16x32_bf16 v[248:251], a[144:147], a[176:179], v[248:251]
    v_cvt_pk_bf16_f32 v132, v232, v233
    v_cvt_pk_bf16_f32 v133, v234, v235
    v_mfma_f32_16x16x32_bf16 a[0:3], a[144:147], a[172:175], a[0:3]
    v_cvt_pk_bf16_f32 v134, v236, v237
    v_cvt_pk_bf16_f32 v135, v238, v239
    v_mfma_f32_16x16x32_bf16 a[0:3], a[148:151], a[204:207], a[0:3]
    v_cvt_pk_bf16_f32 v136, v240, v241
    v_cvt_pk_bf16_f32 v137, v242, v243
    v_mfma_f32_16x16x32_bf16 a[4:7], a[156:159], a[204:207], a[4:7]
    v_cvt_pk_bf16_f32 v138, v244, v245
    v_cvt_pk_bf16_f32 v139, v246, v247
    v_mfma_f32_16x16x32_bf16 a[4:7], a[152:155], a[172:175], a[4:7]
    v_mfma_f32_16x16x32_bf16 a[12:15], a[152:155], a[168:171], a[12:15]
    v_mfma_f32_16x16x32_bf16 a[12:15], a[156:159], a[200:203], a[12:15]
    v_cvt_pk_bf16_f32 v140, v248, v249
    v_cvt_pk_bf16_f32 v141, v250, v251
    v_mfma_f32_16x16x32_bf16 a[8:11], a[148:151], a[200:203], a[8:11]
    v_cvt_pk_bf16_f32 v142, v252, v253
    v_cvt_pk_bf16_f32 v143, v254, v255
    v_mfma_f32_16x16x32_bf16 a[8:11], a[144:147], a[168:171], a[8:11]
    buffer_store_dwordx4 v[44:47], v15, s[40:43], s74 offen offset:3072 sc1
    v_mfma_f32_16x16x32_bf16 a[16:19], a[144:147], a[164:167], a[16:19]
    v_mfma_f32_16x16x32_bf16 a[16:19], a[148:151], a[196:199], a[16:19]
    v_accvgpr_read_b32 v16, a0
    v_accvgpr_read_b32 v17, a1
    v_mfma_f32_16x16x32_bf16 a[20:23], a[156:159], a[196:199], a[20:23]
    v_accvgpr_read_b32 v18, a2
    v_accvgpr_read_b32 v19, a3
    v_mfma_f32_16x16x32_bf16 a[20:23], a[152:155], a[164:167], a[20:23]
    v_accvgpr_read_b32 v20, a4
    v_accvgpr_read_b32 v21, a5
    v_mfma_f32_16x16x32_bf16 a[28:31], a[152:155], a[160:163], a[28:31]
    v_accvgpr_read_b32 v22, a6
    v_accvgpr_read_b32 v23, a7
    v_mfma_f32_16x16x32_bf16 a[28:31], a[156:159], a[192:195], a[28:31]
    s_mov_b32 s67, s60
    v_cvt_pk_bf16_f32 v144, v16, v17
    s_mov_b32 s60, s61
    v_mfma_f32_16x16x32_bf16 a[24:27], a[148:151], a[192:195], a[24:27]
    s_mov_b32 s61, s62
    v_cvt_pk_bf16_f32 v145, v18, v19
    s_mov_b32 s62, s67
    v_mfma_f32_16x16x32_bf16 a[24:27], a[144:147], a[160:163], a[24:27]
    v_cvt_pk_bf16_f32 v146, v20, v21
    v_cvt_pk_bf16_f32 v147, v22, v23
    s_waitcnt vmcnt(16) lgkmcnt(0)
    s_barrier
    v_mfma_f32_16x16x32_bf16 a[144:147], a[32:35], a[96:99], 0
    ds_read_b64_tr_b16 a[128:129], v13 offset:16384
    v_mfma_f32_16x16x32_bf16 a[152:155], a[32:35], a[100:103], 0
    s_add_u32 s66, s58, s69
    ds_read_b64_tr_b16 a[130:131], v13 offset:17408
    v_mfma_f32_16x16x32_bf16 a[160:163], a[32:35], a[104:107], 0
    s_add_u32 m0, s62, 16384
    ds_read_b64_tr_b16 a[132:133], v14 offset:16384
    v_mfma_f32_16x16x32_bf16 a[168:171], a[32:35], a[108:111], 0
    buffer_load_dwordx4 v24, s[44:47], s66 offen offset:0  lds
    v_mfma_f32_16x16x32_bf16 a[172:175], a[36:39], a[108:111], 0
    v_accvgpr_read_b32 v16, a8
    ds_read_b64_tr_b16 a[134:135], v14 offset:17408
    v_mfma_f32_16x16x32_bf16 a[164:167], a[36:39], a[104:107], 0
    v_accvgpr_read_b32 v17, a9
    ds_read_b64_tr_b16 a[136:137], v13 offset:16640
    v_mfma_f32_16x16x32_bf16 a[156:159], a[36:39], a[100:103], 0
    v_accvgpr_read_b32 v18, a10
    ds_read_b64_tr_b16 a[138:139], v13 offset:17664
    v_mfma_f32_16x16x32_bf16 a[148:151], a[36:39], a[96:99], 0
    v_accvgpr_read_b32 v19, a11
    ds_read_b64_tr_b16 a[140:141], v14 offset:16640
    v_mfma_f32_16x16x32_bf16 a[176:179], a[40:43], a[96:99], 0
    v_accvgpr_read_b32 v20, a12
    ds_read_b64_tr_b16 a[142:143], v14 offset:17664
    v_mfma_f32_16x16x32_bf16 a[184:187], a[40:43], a[100:103], 0
    v_accvgpr_read_b32 v21, a13
    ds_read_b64_tr_b16 a[32:33], v13 offset:16896
    v_mfma_f32_16x16x32_bf16 a[192:195], a[40:43], a[104:107], 0
    v_accvgpr_read_b32 v22, a14
    ds_read_b64_tr_b16 a[34:35], v13 offset:17920
    v_mfma_f32_16x16x32_bf16 a[200:203], a[40:43], a[108:111], 0
    buffer_load_dwordx4 v25, s[44:47], s66 offen offset:1024  lds
    v_mfma_f32_16x16x32_bf16 a[204:207], a[44:47], a[108:111], 0
    v_accvgpr_read_b32 v23, a15
    ds_read_b128 a[112:115], v12 offset:0
    v_mfma_f32_16x16x32_bf16 a[196:199], a[44:47], a[104:107], 0
    v_cvt_pk_bf16_f32 v148, v16, v17
    ds_read_b64_tr_b16 a[36:37], v14 offset:16896
    v_mfma_f32_16x16x32_bf16 a[188:191], a[44:47], a[100:103], 0
    v_cvt_pk_bf16_f32 v149, v18, v19
    ds_read_b64_tr_b16 a[38:39], v14 offset:17920
    v_mfma_f32_16x16x32_bf16 a[180:183], a[44:47], a[96:99], 0
    v_cvt_pk_bf16_f32 v150, v20, v21
    ds_read_b128 a[116:119], v12 offset:2048
    v_mfma_f32_16x16x32_bf16 a[208:211], a[48:51], a[96:99], 0
    v_cvt_pk_bf16_f32 v151, v22, v23
    ds_read_b64_tr_b16 a[40:41], v13 offset:17152
    v_mfma_f32_16x16x32_bf16 a[216:219], a[48:51], a[100:103], 0
    v_accvgpr_read_b32 v16, a16
    ds_read_b64_tr_b16 a[42:43], v13 offset:18176
    v_mfma_f32_16x16x32_bf16 a[224:227], a[48:51], a[104:107], 0
    v_accvgpr_read_b32 v17, a17
    ds_read_b128 a[120:123], v12 offset:16384
    v_mfma_f32_16x16x32_bf16 a[232:235], a[48:51], a[108:111], 0
    buffer_load_dwordx4 v26, s[44:47], s66 offen offset:2048  lds
    v_mfma_f32_16x16x32_bf16 a[236:239], a[52:55], a[108:111], 0
    v_accvgpr_read_b32 v18, a18
    ds_read_b64_tr_b16 a[44:45], v14 offset:17152
    v_mfma_f32_16x16x32_bf16 a[228:231], a[52:55], a[104:107], 0
    v_accvgpr_read_b32 v19, a19
    ds_read_b64_tr_b16 a[46:47], v14 offset:18176
    v_mfma_f32_16x16x32_bf16 a[220:223], a[52:55], a[100:103], 0
    v_accvgpr_read_b32 v20, a20
    ds_read_b128 a[124:127], v12 offset:18432
    v_mfma_f32_16x16x32_bf16 a[212:215], a[52:55], a[96:99], 0
    v_accvgpr_read_b32 v21, a21
    ds_read_b64_tr_b16 a[48:49], v13 offset:24576
    v_mfma_f32_16x16x32_bf16 v[32:35], a[56:59], a[96:99], 0
    v_accvgpr_read_b32 v22, a22
    ds_read_b64_tr_b16 a[50:51], v13 offset:25600
    v_mfma_f32_16x16x32_bf16 v[40:43], a[56:59], a[100:103], 0
    v_accvgpr_read_b32 v23, a23
    ds_read_b64_tr_b16 a[52:53], v14 offset:24576
    v_mfma_f32_16x16x32_bf16 a[240:243], a[56:59], a[104:107], 0
    v_cvt_pk_bf16_f32 v152, v16, v17
    ds_read_b64_tr_b16 a[54:55], v14 offset:25600
    v_mfma_f32_16x16x32_bf16 a[248:251], a[56:59], a[108:111], 0
    buffer_load_dwordx4 v27, s[44:47], s66 offen offset:3072  lds
    v_mfma_f32_16x16x32_bf16 a[252:255], a[60:63], a[108:111], 0
    s_add_u32 s58, s58, 128
    v_cvt_pk_bf16_f32 v153, v18, v19
    ds_read_b64_tr_b16 a[56:57], v13 offset:24832
    v_mfma_f32_16x16x32_bf16 a[244:247], a[60:63], a[104:107], 0
    v_cvt_pk_bf16_f32 v154, v20, v21
    ds_read_b64_tr_b16 a[58:59], v13 offset:25856
    v_mfma_f32_16x16x32_bf16 v[44:47], a[60:63], a[100:103], 0
    v_cvt_pk_bf16_f32 v155, v22, v23
    v_accvgpr_read_b32 v16, a24
    v_mfma_f32_16x16x32_bf16 v[36:39], a[60:63], a[96:99], 0
    v_accvgpr_read_b32 v17, a25
    v_accvgpr_read_b32 v18, a26
    v_mfma_f32_16x16x32_bf16 v[160:163], a[64:67], a[96:99], 0
    v_accvgpr_read_b32 v19, a27
    ds_read_b64_tr_b16 a[60:61], v14 offset:24832
    v_mfma_f32_16x16x32_bf16 v[168:171], a[64:67], a[100:103], 0
    v_accvgpr_read_b32 v20, a28
    ds_read_b64_tr_b16 a[62:63], v14 offset:25856
    v_mfma_f32_16x16x32_bf16 v[176:179], a[64:67], a[104:107], 0
    s_add_u32 m0, s63, 0
    v_accvgpr_read_b32 v21, a29
    v_accvgpr_read_b32 v22, a30
    v_mfma_f32_16x16x32_bf16 v[184:187], a[64:67], a[108:111], 0
    buffer_load_dwordx4 v5, s[48:51], s59 offen offset:0  lds
    v_mfma_f32_16x16x32_bf16 v[188:191], a[68:71], a[108:111], 0
    v_accvgpr_read_b32 v23, a31
    ds_read_b64_tr_b16 a[64:65], v13 offset:25088
    v_mfma_f32_16x16x32_bf16 v[180:183], a[68:71], a[104:107], 0
    v_cvt_pk_bf16_f32 v156, v16, v17
    ds_read_b64_tr_b16 a[66:67], v13 offset:26112
    v_mfma_f32_16x16x32_bf16 v[172:175], a[68:71], a[100:103], 0
    v_cvt_pk_bf16_f32 v157, v18, v19
    v_cvt_pk_bf16_f32 v158, v20, v21
    v_mfma_f32_16x16x32_bf16 v[164:167], a[68:71], a[96:99], 0
    v_cvt_pk_bf16_f32 v159, v22, v23
    v_mfma_f32_16x16x32_bf16 v[192:195], a[72:75], a[96:99], 0
    ds_read_b64_tr_b16 a[68:69], v14 offset:25088
    v_mfma_f32_16x16x32_bf16 v[200:203], a[72:75], a[100:103], 0
    ds_read_b64_tr_b16 a[70:71], v14 offset:26112
    v_mfma_f32_16x16x32_bf16 v[208:211], a[72:75], a[104:107], 0
    v_mfma_f32_16x16x32_bf16 v[216:219], a[72:75], a[108:111], 0
    buffer_load_dwordx4 v6, s[48:51], s59 offen offset:1024  lds
    v_mfma_f32_16x16x32_bf16 v[220:223], a[76:79], a[108:111], 0
    ds_read_b64_tr_b16 a[72:73], v13 offset:25344
    v_mfma_f32_16x16x32_bf16 v[212:215], a[76:79], a[104:107], 0
    ds_read_b64_tr_b16 a[74:75], v13 offset:26368
    v_mfma_f32_16x16x32_bf16 v[204:207], a[76:79], a[100:103], 0
    v_mfma_f32_16x16x32_bf16 v[196:199], a[76:79], a[96:99], 0
    v_mfma_f32_16x16x32_bf16 v[224:227], a[80:83], a[96:99], 0
    ds_read_b64_tr_b16 a[76:77], v14 offset:25344
    v_mfma_f32_16x16x32_bf16 v[232:235], a[80:83], a[100:103], 0
    ds_read_b64_tr_b16 a[78:79], v14 offset:26368
    v_mfma_f32_16x16x32_bf16 v[240:243], a[80:83], a[104:107], 0
    v_xor_b32 v13, 0x8000, v13
    v_xor_b32 v14, 0x8000, v14
    v_mfma_f32_16x16x32_bf16 v[248:251], a[80:83], a[108:111], 0
    buffer_load_dwordx4 v7, s[48:51], s59 offen offset:2048  lds
    v_mfma_f32_16x16x32_bf16 v[252:255], a[84:87], a[108:111], 0
    v_add_u32 v11, s61, v9
    v_mfma_f32_16x16x32_bf16 v[244:247], a[84:87], a[104:107], 0
    v_mfma_f32_16x16x32_bf16 v[236:239], a[84:87], a[100:103], 0
    v_mfma_f32_16x16x32_bf16 v[228:231], a[84:87], a[96:99], 0
    v_mfma_f32_16x16x32_bf16 a[0:3], a[88:91], a[96:99], 0
    v_mfma_f32_16x16x32_bf16 a[8:11], a[88:91], a[100:103], 0
    v_mfma_f32_16x16x32_bf16 a[16:19], a[88:91], a[104:107], 0
    v_mfma_f32_16x16x32_bf16 a[24:27], a[88:91], a[108:111], 0
    buffer_load_dwordx4 v8, s[48:51], s59 offen offset:3072  lds
    v_mfma_f32_16x16x32_bf16 a[28:31], a[92:95], a[108:111], 0
    s_add_u32 s59, s59, 262144
    v_mfma_f32_16x16x32_bf16 a[20:23], a[92:95], a[104:107], 0
    v_mfma_f32_16x16x32_bf16 a[12:15], a[92:95], a[100:103], 0
    v_mfma_f32_16x16x32_bf16 a[4:7], a[92:95], a[96:99], 0
    s_waitcnt vmcnt(14) lgkmcnt(0)
    s_barrier
    v_mfma_f32_16x16x32_bf16 a[144:147], a[128:131], a[112:115], a[144:147]
    ds_read_b64_tr_b16 a[80:81], v13 offset:0
    v_mfma_f32_16x16x32_bf16 a[152:155], a[128:131], a[116:119], a[152:155]
    ds_read_b64_tr_b16 a[82:83], v13 offset:1024
    v_mfma_f32_16x16x32_bf16 a[160:163], a[128:131], a[120:123], a[160:163]
    s_mov_b32 m0, s60
    ds_read_b64_tr_b16 a[84:85], v14 offset:0
    v_mfma_f32_16x16x32_bf16 a[168:171], a[128:131], a[124:127], a[168:171]
    buffer_load_dwordx4 v24, s[44:47], s58 offen offset:0  lds
    v_mfma_f32_16x16x32_bf16 a[172:175], a[132:135], a[124:127], a[172:175]
    ds_read_b64_tr_b16 a[86:87], v14 offset:1024
    ds_read_b64_tr_b16 a[88:89], v13 offset:256
    v_mfma_f32_16x16x32_bf16 a[164:167], a[132:135], a[120:123], a[164:167]
    ds_read_b64_tr_b16 a[90:91], v13 offset:1280
    v_mfma_f32_16x16x32_bf16 a[156:159], a[132:135], a[116:119], a[156:159]
    s_add_u32 s74, s65, 4096
    ds_read_b64_tr_b16 a[92:93], v14 offset:256
    v_mfma_f32_16x16x32_bf16 a[148:151], a[132:135], a[112:115], a[148:151]
    buffer_store_dwordx4 v[48:51], v15, s[40:43], s74 offen offset:0 sc1
    v_mfma_f32_16x16x32_bf16 a[176:179], a[136:139], a[112:115], a[176:179]
    ds_read_b64_tr_b16 a[94:95], v14 offset:1280
    ds_read_b64_tr_b16 a[128:129], v13 offset:512
    v_mfma_f32_16x16x32_bf16 a[184:187], a[136:139], a[116:119], a[184:187]
    ds_read_b64_tr_b16 a[130:131], v13 offset:1536
    v_mfma_f32_16x16x32_bf16 a[192:195], a[136:139], a[120:123], a[192:195]
    ds_read_b128 a[96:99], v11 offset:0
    v_mfma_f32_16x16x32_bf16 a[200:203], a[136:139], a[124:127], a[200:203]
    buffer_load_dwordx4 v25, s[44:47], s58 offen offset:1024  lds
    v_mfma_f32_16x16x32_bf16 a[204:207], a[140:143], a[124:127], a[204:207]
    ds_read_b64_tr_b16 a[132:133], v14 offset:512
    ds_read_b64_tr_b16 a[134:135], v14 offset:1536
    v_mfma_f32_16x16x32_bf16 a[196:199], a[140:143], a[120:123], a[196:199]
    ds_read_b128 a[100:103], v11 offset:2048
    v_mfma_f32_16x16x32_bf16 a[188:191], a[140:143], a[116:119], a[188:191]
    ds_read_b64_tr_b16 a[136:137], v13 offset:768
    v_mfma_f32_16x16x32_bf16 a[180:183], a[140:143], a[112:115], a[180:183]
    ds_read_b64_tr_b16 a[138:139], v13 offset:1792
    v_mfma_f32_16x16x32_bf16 a[208:211], a[32:35], a[112:115], a[208:211]
    ds_read_b128 a[104:107], v11 offset:16384
    v_mfma_f32_16x16x32_bf16 a[216:219], a[32:35], a[116:119], a[216:219]
    ds_read_b64_tr_b16 a[140:141], v14 offset:768
    v_mfma_f32_16x16x32_bf16 a[224:227], a[32:35], a[120:123], a[224:227]
    ds_read_b64_tr_b16 a[142:143], v14 offset:1792
    v_mfma_f32_16x16x32_bf16 a[232:235], a[32:35], a[124:127], a[232:235]
    buffer_load_dwordx4 v26, s[44:47], s58 offen offset:2048  lds
    v_mfma_f32_16x16x32_bf16 a[236:239], a[36:39], a[124:127], a[236:239]
    ds_read_b128 a[108:111], v11 offset:18432
    ds_read_b64_tr_b16 a[32:33], v13 offset:8192
    v_mfma_f32_16x16x32_bf16 a[228:231], a[36:39], a[120:123], a[228:231]
    ds_read_b64_tr_b16 a[34:35], v13 offset:9216
    v_mfma_f32_16x16x32_bf16 a[220:223], a[36:39], a[116:119], a[220:223]
    buffer_store_dwordx4 v[52:55], v15, s[40:43], s74 offen offset:1024 sc1
    v_mfma_f32_16x16x32_bf16 a[212:215], a[36:39], a[112:115], a[212:215]
    v_mfma_f32_16x16x32_bf16 v[32:35], a[40:43], a[112:115], v[32:35]
    ds_read_b64_tr_b16 a[36:37], v14 offset:8192
    v_mfma_f32_16x16x32_bf16 v[40:43], a[40:43], a[116:119], v[40:43]
    ds_read_b64_tr_b16 a[38:39], v14 offset:9216
    v_mfma_f32_16x16x32_bf16 a[240:243], a[40:43], a[120:123], a[240:243]
    v_mfma_f32_16x16x32_bf16 a[248:251], a[40:43], a[124:127], a[248:251]
    buffer_load_dwordx4 v27, s[44:47], s58 offen offset:3072  lds
    v_mfma_f32_16x16x32_bf16 a[252:255], a[44:47], a[124:127], a[252:255]
    ds_read_b64_tr_b16 a[40:41], v13 offset:8448
    v_mfma_f32_16x16x32_bf16 a[244:247], a[44:47], a[120:123], a[244:247]
    ds_read_b64_tr_b16 a[42:43], v13 offset:9472
    v_mfma_f32_16x16x32_bf16 v[44:47], a[44:47], a[116:119], v[44:47]
    v_mfma_f32_16x16x32_bf16 v[36:39], a[44:47], a[112:115], v[36:39]
    v_mfma_f32_16x16x32_bf16 v[160:163], a[48:51], a[112:115], v[160:163]
    ds_read_b64_tr_b16 a[44:45], v14 offset:8448
    v_mfma_f32_16x16x32_bf16 v[168:171], a[48:51], a[116:119], v[168:171]
    ds_read_b64_tr_b16 a[46:47], v14 offset:9472
    v_mfma_f32_16x16x32_bf16 v[176:179], a[48:51], a[120:123], v[176:179]
    s_add_u32 m0, s63, 16384
    v_mfma_f32_16x16x32_bf16 v[184:187], a[48:51], a[124:127], v[184:187]
    buffer_load_dwordx4 v5, s[48:51], s59 offen offset:0  lds
    v_mfma_f32_16x16x32_bf16 v[188:191], a[52:55], a[124:127], v[188:191]
    ds_read_b64_tr_b16 a[48:49], v13 offset:8704
    v_mfma_f32_16x16x32_bf16 v[180:183], a[52:55], a[120:123], v[180:183]
    ds_read_b64_tr_b16 a[50:51], v13 offset:9728
    v_mfma_f32_16x16x32_bf16 v[172:175], a[52:55], a[116:119], v[172:175]
    buffer_store_dwordx4 v[56:59], v15, s[40:43], s74 offen offset:2048 sc1
    v_mfma_f32_16x16x32_bf16 v[164:167], a[52:55], a[112:115], v[164:167]
    v_mfma_f32_16x16x32_bf16 v[192:195], a[56:59], a[112:115], v[192:195]
    ds_read_b64_tr_b16 a[52:53], v14 offset:8704
    v_mfma_f32_16x16x32_bf16 v[200:203], a[56:59], a[116:119], v[200:203]
    ds_read_b64_tr_b16 a[54:55], v14 offset:9728
    v_mfma_f32_16x16x32_bf16 v[208:211], a[56:59], a[120:123], v[208:211]
    v_mfma_f32_16x16x32_bf16 v[216:219], a[56:59], a[124:127], v[216:219]
    buffer_load_dwordx4 v6, s[48:51], s59 offen offset:1024  lds
    v_mfma_f32_16x16x32_bf16 v[220:223], a[60:63], a[124:127], v[220:223]
    ds_read_b64_tr_b16 a[56:57], v13 offset:8960
    v_mfma_f32_16x16x32_bf16 v[212:215], a[60:63], a[120:123], v[212:215]
    ds_read_b64_tr_b16 a[58:59], v13 offset:9984
    v_mfma_f32_16x16x32_bf16 v[204:207], a[60:63], a[116:119], v[204:207]
    v_mfma_f32_16x16x32_bf16 v[196:199], a[60:63], a[112:115], v[196:199]
    v_mfma_f32_16x16x32_bf16 v[224:227], a[64:67], a[112:115], v[224:227]
    ds_read_b64_tr_b16 a[60:61], v14 offset:8960
    v_mfma_f32_16x16x32_bf16 v[232:235], a[64:67], a[116:119], v[232:235]
    ds_read_b64_tr_b16 a[62:63], v14 offset:9984
    v_mfma_f32_16x16x32_bf16 v[240:243], a[64:67], a[120:123], v[240:243]
    v_add_u32 v12, s61, v10
    v_mfma_f32_16x16x32_bf16 v[248:251], a[64:67], a[124:127], v[248:251]
    buffer_load_dwordx4 v7, s[48:51], s59 offen offset:2048  lds
    v_mfma_f32_16x16x32_bf16 v[252:255], a[68:71], a[124:127], v[252:255]
    v_mfma_f32_16x16x32_bf16 v[244:247], a[68:71], a[120:123], v[244:247]
    v_mfma_f32_16x16x32_bf16 v[236:239], a[68:71], a[116:119], v[236:239]
    v_mfma_f32_16x16x32_bf16 v[228:231], a[68:71], a[112:115], v[228:231]
    v_mfma_f32_16x16x32_bf16 a[0:3], a[72:75], a[112:115], a[0:3]
    v_mfma_f32_16x16x32_bf16 a[8:11], a[72:75], a[116:119], a[8:11]
    v_mfma_f32_16x16x32_bf16 a[16:19], a[72:75], a[120:123], a[16:19]
    v_mfma_f32_16x16x32_bf16 a[24:27], a[72:75], a[124:127], a[24:27]
    buffer_load_dwordx4 v8, s[48:51], s59 offen offset:3072  lds
    v_mfma_f32_16x16x32_bf16 a[28:31], a[76:79], a[124:127], a[28:31]
    s_add_u32 s59, s59, 262144
    v_mfma_f32_16x16x32_bf16 a[20:23], a[76:79], a[120:123], a[20:23]
    s_xor_b32 s63, s63, 0x8000
    s_mov_b32 s67, s60
    s_mov_b32 s60, s61
    v_mfma_f32_16x16x32_bf16 a[12:15], a[76:79], a[116:119], a[12:15]
    s_mov_b32 s61, s62
    s_mov_b32 s62, s67
    v_mfma_f32_16x16x32_bf16 a[4:7], a[76:79], a[112:115], a[4:7]
    s_waitcnt vmcnt(21) lgkmcnt(0)
    s_barrier
    v_mfma_f32_16x16x32_bf16 a[144:147], a[80:83], a[96:99], a[144:147]
    ds_read_b64_tr_b16 a[64:65], v13 offset:16384
    v_mfma_f32_16x16x32_bf16 a[152:155], a[80:83], a[100:103], a[152:155]
    s_add_u32 s66, s58, s69
    ds_read_b64_tr_b16 a[66:67], v13 offset:17408
    v_mfma_f32_16x16x32_bf16 a[160:163], a[80:83], a[104:107], a[160:163]
    s_add_u32 m0, s62, 16384
    ds_read_b64_tr_b16 a[68:69], v14 offset:16384
    v_mfma_f32_16x16x32_bf16 a[168:171], a[80:83], a[108:111], a[168:171]
    buffer_load_dwordx4 v24, s[44:47], s66 offen offset:0  lds
    v_mfma_f32_16x16x32_bf16 a[172:175], a[84:87], a[108:111], a[172:175]
    ds_read_b64_tr_b16 a[70:71], v14 offset:17408
    ds_read_b64_tr_b16 a[72:73], v13 offset:16640
    v_mfma_f32_16x16x32_bf16 a[164:167], a[84:87], a[104:107], a[164:167]
    ds_read_b64_tr_b16 a[74:75], v13 offset:17664
    v_mfma_f32_16x16x32_bf16 a[156:159], a[84:87], a[100:103], a[156:159]
    buffer_store_dwordx4 v[60:63], v15, s[40:43], s74 offen offset:3072 sc1
    v_mfma_f32_16x16x32_bf16 a[148:151], a[84:87], a[96:99], a[148:151]
    ds_read_b64_tr_b16 a[76:77], v14 offset:16640
    ds_read_b64_tr_b16 a[78:79], v14 offset:17664
    v_mfma_f32_16x16x32_bf16 a[176:179], a[88:91], a[96:99], a[176:179]
    ds_read_b64_tr_b16 a[80:81], v13 offset:16896
    v_mfma_f32_16x16x32_bf16 a[184:187], a[88:91], a[100:103], a[184:187]
    ds_read_b64_tr_b16 a[82:83], v13 offset:17920
    v_mfma_f32_16x16x32_bf16 a[192:195], a[88:91], a[104:107], a[192:195]
    ds_read_b128 a[112:115], v12 offset:0
    v_mfma_f32_16x16x32_bf16 a[200:203], a[88:91], a[108:111], a[200:203]
    buffer_load_dwordx4 v25, s[44:47], s66 offen offset:1024  lds
    v_mfma_f32_16x16x32_bf16 a[204:207], a[92:95], a[108:111], a[204:207]
    ds_read_b64_tr_b16 a[84:85], v14 offset:16896
    ds_read_b64_tr_b16 a[86:87], v14 offset:17920
    v_mfma_f32_16x16x32_bf16 a[196:199], a[92:95], a[104:107], a[196:199]
    ds_read_b128 a[116:119], v12 offset:2048
    v_mfma_f32_16x16x32_bf16 a[188:191], a[92:95], a[100:103], a[188:191]
    ds_read_b64_tr_b16 a[88:89], v13 offset:17152
    v_mfma_f32_16x16x32_bf16 a[180:183], a[92:95], a[96:99], a[180:183]
    ds_read_b64_tr_b16 a[90:91], v13 offset:18176
    v_mfma_f32_16x16x32_bf16 a[208:211], a[128:131], a[96:99], a[208:211]
    ds_read_b128 a[120:123], v12 offset:16384
    v_mfma_f32_16x16x32_bf16 a[216:219], a[128:131], a[100:103], a[216:219]
    ds_read_b64_tr_b16 a[92:93], v14 offset:17152
    v_mfma_f32_16x16x32_bf16 a[224:227], a[128:131], a[104:107], a[224:227]
    ds_read_b64_tr_b16 a[94:95], v14 offset:18176
    v_mfma_f32_16x16x32_bf16 a[232:235], a[128:131], a[108:111], a[232:235]
    buffer_load_dwordx4 v26, s[44:47], s66 offen offset:2048  lds
    v_mfma_f32_16x16x32_bf16 a[236:239], a[132:135], a[108:111], a[236:239]
    ds_read_b128 a[124:127], v12 offset:18432
    ds_read_b64_tr_b16 a[128:129], v13 offset:24576
    v_mfma_f32_16x16x32_bf16 a[228:231], a[132:135], a[104:107], a[228:231]
    ds_read_b64_tr_b16 a[130:131], v13 offset:25600
    v_mfma_f32_16x16x32_bf16 a[220:223], a[132:135], a[100:103], a[220:223]
    s_add_u32 s74, s65, 266240
    buffer_store_dwordx4 v[64:67], v15, s[40:43], s74 offen offset:3072 sc1
    v_mfma_f32_16x16x32_bf16 a[212:215], a[132:135], a[96:99], a[212:215]
    v_mfma_f32_16x16x32_bf16 v[32:35], a[136:139], a[96:99], v[32:35]
    ds_read_b64_tr_b16 a[132:133], v14 offset:24576
    v_mfma_f32_16x16x32_bf16 v[40:43], a[136:139], a[100:103], v[40:43]
    ds_read_b64_tr_b16 a[134:135], v14 offset:25600
    v_mfma_f32_16x16x32_bf16 a[240:243], a[136:139], a[104:107], a[240:243]
    v_mfma_f32_16x16x32_bf16 a[248:251], a[136:139], a[108:111], a[248:251]
    buffer_load_dwordx4 v27, s[44:47], s66 offen offset:3072  lds
    v_mfma_f32_16x16x32_bf16 a[252:255], a[140:143], a[108:111], a[252:255]
    s_add_u32 s58, s58, 128
    ds_read_b64_tr_b16 a[136:137], v13 offset:24832
    v_mfma_f32_16x16x32_bf16 a[244:247], a[140:143], a[104:107], a[244:247]
    ds_read_b64_tr_b16 a[138:139], v13 offset:25856
    v_mfma_f32_16x16x32_bf16 v[44:47], a[140:143], a[100:103], v[44:47]
    v_mfma_f32_16x16x32_bf16 v[36:39], a[140:143], a[96:99], v[36:39]
    v_mfma_f32_16x16x32_bf16 v[160:163], a[32:35], a[96:99], v[160:163]
    ds_read_b64_tr_b16 a[140:141], v14 offset:24832
    v_mfma_f32_16x16x32_bf16 v[168:171], a[32:35], a[100:103], v[168:171]
    ds_read_b64_tr_b16 a[142:143], v14 offset:25856
    v_mfma_f32_16x16x32_bf16 v[176:179], a[32:35], a[104:107], v[176:179]
    s_add_u32 m0, s63, 0
    v_mfma_f32_16x16x32_bf16 v[184:187], a[32:35], a[108:111], v[184:187]
    buffer_load_dwordx4 v5, s[48:51], s59 offen offset:0  lds
    v_mfma_f32_16x16x32_bf16 v[188:191], a[36:39], a[108:111], v[188:191]
    ds_read_b64_tr_b16 a[32:33], v13 offset:25088
    v_mfma_f32_16x16x32_bf16 v[180:183], a[36:39], a[104:107], v[180:183]
    ds_read_b64_tr_b16 a[34:35], v13 offset:26112
    v_mfma_f32_16x16x32_bf16 v[172:175], a[36:39], a[100:103], v[172:175]
    buffer_store_dwordx4 v[68:71], v15, s[40:43], s74 offen offset:2048 sc1
    v_mfma_f32_16x16x32_bf16 v[164:167], a[36:39], a[96:99], v[164:167]
    v_mfma_f32_16x16x32_bf16 v[192:195], a[40:43], a[96:99], v[192:195]
    ds_read_b64_tr_b16 a[36:37], v14 offset:25088
    v_mfma_f32_16x16x32_bf16 v[200:203], a[40:43], a[100:103], v[200:203]
    ds_read_b64_tr_b16 a[38:39], v14 offset:26112
    v_mfma_f32_16x16x32_bf16 v[208:211], a[40:43], a[104:107], v[208:211]
    v_mfma_f32_16x16x32_bf16 v[216:219], a[40:43], a[108:111], v[216:219]
    buffer_load_dwordx4 v6, s[48:51], s59 offen offset:1024  lds
    v_mfma_f32_16x16x32_bf16 v[220:223], a[44:47], a[108:111], v[220:223]
    ds_read_b64_tr_b16 a[40:41], v13 offset:25344
    v_mfma_f32_16x16x32_bf16 v[212:215], a[44:47], a[104:107], v[212:215]
    ds_read_b64_tr_b16 a[42:43], v13 offset:26368
    v_mfma_f32_16x16x32_bf16 v[204:207], a[44:47], a[100:103], v[204:207]
    v_mfma_f32_16x16x32_bf16 v[196:199], a[44:47], a[96:99], v[196:199]
    v_mfma_f32_16x16x32_bf16 v[224:227], a[48:51], a[96:99], v[224:227]
    ds_read_b64_tr_b16 a[44:45], v14 offset:25344
    v_mfma_f32_16x16x32_bf16 v[232:235], a[48:51], a[100:103], v[232:235]
    ds_read_b64_tr_b16 a[46:47], v14 offset:26368
    v_mfma_f32_16x16x32_bf16 v[240:243], a[48:51], a[104:107], v[240:243]
    v_xor_b32 v13, 0x8000, v13
    v_xor_b32 v14, 0x8000, v14
    v_mfma_f32_16x16x32_bf16 v[248:251], a[48:51], a[108:111], v[248:251]
    buffer_load_dwordx4 v7, s[48:51], s59 offen offset:2048  lds
    v_mfma_f32_16x16x32_bf16 v[252:255], a[52:55], a[108:111], v[252:255]
    v_add_u32 v11, s61, v9
    v_mfma_f32_16x16x32_bf16 v[244:247], a[52:55], a[104:107], v[244:247]
    v_mfma_f32_16x16x32_bf16 v[236:239], a[52:55], a[100:103], v[236:239]
    v_mfma_f32_16x16x32_bf16 v[228:231], a[52:55], a[96:99], v[228:231]
    v_mfma_f32_16x16x32_bf16 a[0:3], a[56:59], a[96:99], a[0:3]
    v_mfma_f32_16x16x32_bf16 a[8:11], a[56:59], a[100:103], a[8:11]
    v_mfma_f32_16x16x32_bf16 a[16:19], a[56:59], a[104:107], a[16:19]
    v_mfma_f32_16x16x32_bf16 a[24:27], a[56:59], a[108:111], a[24:27]
    buffer_load_dwordx4 v8, s[48:51], s59 offen offset:3072  lds
    v_mfma_f32_16x16x32_bf16 a[28:31], a[60:63], a[108:111], a[28:31]
    s_add_u32 s59, s59, 262144
    v_mfma_f32_16x16x32_bf16 a[20:23], a[60:63], a[104:107], a[20:23]
    v_mfma_f32_16x16x32_bf16 a[12:15], a[60:63], a[100:103], a[12:15]
    v_mfma_f32_16x16x32_bf16 a[4:7], a[60:63], a[96:99], a[4:7]
    s_waitcnt vmcnt(22) lgkmcnt(0)
    s_barrier
    v_mfma_f32_16x16x32_bf16 a[144:147], a[64:67], a[112:115], a[144:147]
    ds_read_b64_tr_b16 a[48:49], v13 offset:0
    v_mfma_f32_16x16x32_bf16 a[152:155], a[64:67], a[116:119], a[152:155]
    ds_read_b64_tr_b16 a[50:51], v13 offset:1024
    v_mfma_f32_16x16x32_bf16 a[160:163], a[64:67], a[120:123], a[160:163]
    s_mov_b32 m0, s60
    ds_read_b64_tr_b16 a[52:53], v14 offset:0
    v_mfma_f32_16x16x32_bf16 a[168:171], a[64:67], a[124:127], a[168:171]
    buffer_load_dwordx4 v24, s[44:47], s58 offen offset:0  lds
    v_mfma_f32_16x16x32_bf16 a[172:175], a[68:71], a[124:127], a[172:175]
    ds_read_b64_tr_b16 a[54:55], v14 offset:1024
    ds_read_b64_tr_b16 a[56:57], v13 offset:256
    v_mfma_f32_16x16x32_bf16 a[164:167], a[68:71], a[120:123], a[164:167]
    ds_read_b64_tr_b16 a[58:59], v13 offset:1280
    v_mfma_f32_16x16x32_bf16 a[156:159], a[68:71], a[116:119], a[156:159]
    buffer_store_dwordx4 v[72:75], v15, s[40:43], s74 offen offset:1024 sc1
    v_mfma_f32_16x16x32_bf16 a[148:151], a[68:71], a[112:115], a[148:151]
    ds_read_b64_tr_b16 a[60:61], v14 offset:256
    ds_read_b64_tr_b16 a[62:63], v14 offset:1280
    v_mfma_f32_16x16x32_bf16 a[176:179], a[72:75], a[112:115], a[176:179]
    ds_read_b64_tr_b16 a[64:65], v13 offset:512
    v_mfma_f32_16x16x32_bf16 a[184:187], a[72:75], a[116:119], a[184:187]
    ds_read_b64_tr_b16 a[66:67], v13 offset:1536
    v_mfma_f32_16x16x32_bf16 a[192:195], a[72:75], a[120:123], a[192:195]
    ds_read_b128 a[96:99], v11 offset:0
    v_mfma_f32_16x16x32_bf16 a[200:203], a[72:75], a[124:127], a[200:203]
    buffer_load_dwordx4 v25, s[44:47], s58 offen offset:1024  lds
    v_mfma_f32_16x16x32_bf16 a[204:207], a[76:79], a[124:127], a[204:207]
    ds_read_b64_tr_b16 a[68:69], v14 offset:512
    ds_read_b64_tr_b16 a[70:71], v14 offset:1536
    v_mfma_f32_16x16x32_bf16 a[196:199], a[76:79], a[120:123], a[196:199]
    ds_read_b128 a[100:103], v11 offset:2048
    v_mfma_f32_16x16x32_bf16 a[188:191], a[76:79], a[116:119], a[188:191]
    ds_read_b64_tr_b16 a[72:73], v13 offset:768
    v_mfma_f32_16x16x32_bf16 a[180:183], a[76:79], a[112:115], a[180:183]
    ds_read_b64_tr_b16 a[74:75], v13 offset:1792
    v_mfma_f32_16x16x32_bf16 a[208:211], a[80:83], a[112:115], a[208:211]
    ds_read_b128 a[104:107], v11 offset:16384
    v_mfma_f32_16x16x32_bf16 a[216:219], a[80:83], a[116:119], a[216:219]
    ds_read_b64_tr_b16 a[76:77], v14 offset:768
    v_mfma_f32_16x16x32_bf16 a[224:227], a[80:83], a[120:123], a[224:227]
    ds_read_b64_tr_b16 a[78:79], v14 offset:1792
    v_mfma_f32_16x16x32_bf16 a[232:235], a[80:83], a[124:127], a[232:235]
    buffer_load_dwordx4 v26, s[44:47], s58 offen offset:2048  lds
    v_mfma_f32_16x16x32_bf16 a[236:239], a[84:87], a[124:127], a[236:239]
    ds_read_b128 a[108:111], v11 offset:18432
    ds_read_b64_tr_b16 a[80:81], v13 offset:8192
    v_mfma_f32_16x16x32_bf16 a[228:231], a[84:87], a[120:123], a[228:231]
    ds_read_b64_tr_b16 a[82:83], v13 offset:9216
    v_mfma_f32_16x16x32_bf16 a[220:223], a[84:87], a[116:119], a[220:223]
    v_mfma_f32_16x16x32_bf16 a[212:215], a[84:87], a[112:115], a[212:215]
    v_mfma_f32_16x16x32_bf16 v[32:35], a[88:91], a[112:115], v[32:35]
    ds_read_b64_tr_b16 a[84:85], v14 offset:8192
    v_mfma_f32_16x16x32_bf16 v[40:43], a[88:91], a[116:119], v[40:43]
    ds_read_b64_tr_b16 a[86:87], v14 offset:9216
    v_mfma_f32_16x16x32_bf16 a[240:243], a[88:91], a[120:123], a[240:243]
    v_mfma_f32_16x16x32_bf16 a[248:251], a[88:91], a[124:127], a[248:251]
    buffer_load_dwordx4 v27, s[44:47], s58 offen offset:3072  lds
    v_mfma_f32_16x16x32_bf16 a[252:255], a[92:95], a[124:127], a[252:255]
    ds_read_b64_tr_b16 a[88:89], v13 offset:8448
    v_mfma_f32_16x16x32_bf16 a[244:247], a[92:95], a[120:123], a[244:247]
    ds_read_b64_tr_b16 a[90:91], v13 offset:9472
    v_mfma_f32_16x16x32_bf16 v[44:47], a[92:95], a[116:119], v[44:47]
    buffer_store_dwordx4 v[76:79], v15, s[40:43], s74 offen offset:0 sc1
    v_mfma_f32_16x16x32_bf16 v[36:39], a[92:95], a[112:115], v[36:39]
    v_mfma_f32_16x16x32_bf16 v[160:163], a[128:131], a[112:115], v[160:163]
    ds_read_b64_tr_b16 a[92:93], v14 offset:8448
    v_mfma_f32_16x16x32_bf16 v[168:171], a[128:131], a[116:119], v[168:171]
    ds_read_b64_tr_b16 a[94:95], v14 offset:9472
    v_mfma_f32_16x16x32_bf16 v[176:179], a[128:131], a[120:123], v[176:179]
    s_add_u32 m0, s63, 16384
    v_mfma_f32_16x16x32_bf16 v[184:187], a[128:131], a[124:127], v[184:187]
    buffer_load_dwordx4 v5, s[48:51], s59 offen offset:0  lds
    v_mfma_f32_16x16x32_bf16 v[188:191], a[132:135], a[124:127], v[188:191]
    ds_read_b64_tr_b16 a[128:129], v13 offset:8704
    v_mfma_f32_16x16x32_bf16 v[180:183], a[132:135], a[120:123], v[180:183]
    ds_read_b64_tr_b16 a[130:131], v13 offset:9728
    v_mfma_f32_16x16x32_bf16 v[172:175], a[132:135], a[116:119], v[172:175]
    v_mfma_f32_16x16x32_bf16 v[164:167], a[132:135], a[112:115], v[164:167]
    v_mfma_f32_16x16x32_bf16 v[192:195], a[136:139], a[112:115], v[192:195]
    ds_read_b64_tr_b16 a[132:133], v14 offset:8704
    v_mfma_f32_16x16x32_bf16 v[200:203], a[136:139], a[116:119], v[200:203]
    ds_read_b64_tr_b16 a[134:135], v14 offset:9728
    v_mfma_f32_16x16x32_bf16 v[208:211], a[136:139], a[120:123], v[208:211]
    v_mfma_f32_16x16x32_bf16 v[216:219], a[136:139], a[124:127], v[216:219]
    buffer_load_dwordx4 v6, s[48:51], s59 offen offset:1024  lds
    v_mfma_f32_16x16x32_bf16 v[220:223], a[140:143], a[124:127], v[220:223]
    ds_read_b64_tr_b16 a[136:137], v13 offset:8960
    v_mfma_f32_16x16x32_bf16 v[212:215], a[140:143], a[120:123], v[212:215]
    ds_read_b64_tr_b16 a[138:139], v13 offset:9984
    v_mfma_f32_16x16x32_bf16 v[204:207], a[140:143], a[116:119], v[204:207]
    v_mfma_f32_16x16x32_bf16 v[196:199], a[140:143], a[112:115], v[196:199]
    v_mfma_f32_16x16x32_bf16 v[224:227], a[32:35], a[112:115], v[224:227]
    ds_read_b64_tr_b16 a[140:141], v14 offset:8960
    v_mfma_f32_16x16x32_bf16 v[232:235], a[32:35], a[116:119], v[232:235]
    ds_read_b64_tr_b16 a[142:143], v14 offset:9984
    v_mfma_f32_16x16x32_bf16 v[240:243], a[32:35], a[120:123], v[240:243]
    v_add_u32 v12, s61, v10
    v_mfma_f32_16x16x32_bf16 v[248:251], a[32:35], a[124:127], v[248:251]
    buffer_load_dwordx4 v7, s[48:51], s59 offen offset:2048  lds
    v_mfma_f32_16x16x32_bf16 v[252:255], a[36:39], a[124:127], v[252:255]
    v_mfma_f32_16x16x32_bf16 v[244:247], a[36:39], a[120:123], v[244:247]
    v_mfma_f32_16x16x32_bf16 v[236:239], a[36:39], a[116:119], v[236:239]
    v_mfma_f32_16x16x32_bf16 v[228:231], a[36:39], a[112:115], v[228:231]
    v_mfma_f32_16x16x32_bf16 a[0:3], a[40:43], a[112:115], a[0:3]
    v_mfma_f32_16x16x32_bf16 a[8:11], a[40:43], a[116:119], a[8:11]
    v_mfma_f32_16x16x32_bf16 a[16:19], a[40:43], a[120:123], a[16:19]
    v_mfma_f32_16x16x32_bf16 a[24:27], a[40:43], a[124:127], a[24:27]
    buffer_load_dwordx4 v8, s[48:51], s59 offen offset:3072  lds
    v_mfma_f32_16x16x32_bf16 a[28:31], a[44:47], a[124:127], a[28:31]
    s_add_u32 s59, s59, 262144
    v_mfma_f32_16x16x32_bf16 a[20:23], a[44:47], a[120:123], a[20:23]
    s_xor_b32 s63, s63, 0x8000
    s_mov_b32 s67, s60
    s_mov_b32 s60, s61
    v_mfma_f32_16x16x32_bf16 a[12:15], a[44:47], a[116:119], a[12:15]
    s_mov_b32 s61, s62
    s_mov_b32 s62, s67
    v_mfma_f32_16x16x32_bf16 a[4:7], a[44:47], a[112:115], a[4:7]
    s_waitcnt vmcnt(21) lgkmcnt(0)
    s_barrier
    v_mfma_f32_16x16x32_bf16 a[144:147], a[48:51], a[96:99], a[144:147]
    ds_read_b64_tr_b16 a[32:33], v13 offset:16384
    v_mfma_f32_16x16x32_bf16 a[152:155], a[48:51], a[100:103], a[152:155]
    s_add_u32 s66, s58, s69
    ds_read_b64_tr_b16 a[34:35], v13 offset:17408
    v_mfma_f32_16x16x32_bf16 a[160:163], a[48:51], a[104:107], a[160:163]
    s_add_u32 m0, s62, 16384
    ds_read_b64_tr_b16 a[36:37], v14 offset:16384
    v_mfma_f32_16x16x32_bf16 a[168:171], a[48:51], a[108:111], a[168:171]
    buffer_load_dwordx4 v24, s[44:47], s66 offen offset:0  lds
    v_mfma_f32_16x16x32_bf16 a[172:175], a[52:55], a[108:111], a[172:175]
    ds_read_b64_tr_b16 a[38:39], v14 offset:17408
    ds_read_b64_tr_b16 a[40:41], v13 offset:16640
    v_mfma_f32_16x16x32_bf16 a[164:167], a[52:55], a[104:107], a[164:167]
    ds_read_b64_tr_b16 a[42:43], v13 offset:17664
    v_mfma_f32_16x16x32_bf16 a[156:159], a[52:55], a[100:103], a[156:159]
    s_add_u32 s74, s65, 262144
    ds_read_b64_tr_b16 a[44:45], v14 offset:16640
    v_mfma_f32_16x16x32_bf16 a[148:151], a[52:55], a[96:99], a[148:151]
    buffer_store_dwordx4 v[80:83], v15, s[40:43], s74 offen offset:3072 sc1
    v_mfma_f32_16x16x32_bf16 a[176:179], a[56:59], a[96:99], a[176:179]
    ds_read_b64_tr_b16 a[46:47], v14 offset:17664
    ds_read_b64_tr_b16 a[48:49], v13 offset:16896
    v_mfma_f32_16x16x32_bf16 a[184:187], a[56:59], a[100:103], a[184:187]
    ds_read_b64_tr_b16 a[50:51], v13 offset:17920
    v_mfma_f32_16x16x32_bf16 a[192:195], a[56:59], a[104:107], a[192:195]
    ds_read_b128 a[112:115], v12 offset:0
    v_mfma_f32_16x16x32_bf16 a[200:203], a[56:59], a[108:111], a[200:203]
    buffer_load_dwordx4 v25, s[44:47], s66 offen offset:1024  lds
    v_mfma_f32_16x16x32_bf16 a[204:207], a[60:63], a[108:111], a[204:207]
    ds_read_b64_tr_b16 a[52:53], v14 offset:16896
    ds_read_b64_tr_b16 a[54:55], v14 offset:17920
    v_mfma_f32_16x16x32_bf16 a[196:199], a[60:63], a[104:107], a[196:199]
    ds_read_b128 a[116:119], v12 offset:2048
    v_mfma_f32_16x16x32_bf16 a[188:191], a[60:63], a[100:103], a[188:191]
    ds_read_b64_tr_b16 a[56:57], v13 offset:17152
    v_mfma_f32_16x16x32_bf16 a[180:183], a[60:63], a[96:99], a[180:183]
    ds_read_b64_tr_b16 a[58:59], v13 offset:18176
    v_mfma_f32_16x16x32_bf16 a[208:211], a[64:67], a[96:99], a[208:211]
    ds_read_b128 a[120:123], v12 offset:16384
    v_mfma_f32_16x16x32_bf16 a[216:219], a[64:67], a[100:103], a[216:219]
    ds_read_b64_tr_b16 a[60:61], v14 offset:17152
    v_mfma_f32_16x16x32_bf16 a[224:227], a[64:67], a[104:107], a[224:227]
    ds_read_b64_tr_b16 a[62:63], v14 offset:18176
    v_mfma_f32_16x16x32_bf16 a[232:235], a[64:67], a[108:111], a[232:235]
    buffer_load_dwordx4 v26, s[44:47], s66 offen offset:2048  lds
    v_mfma_f32_16x16x32_bf16 a[236:239], a[68:71], a[108:111], a[236:239]
    ds_read_b128 a[124:127], v12 offset:18432
    ds_read_b64_tr_b16 a[64:65], v13 offset:24576
    v_mfma_f32_16x16x32_bf16 a[228:231], a[68:71], a[104:107], a[228:231]
    ds_read_b64_tr_b16 a[66:67], v13 offset:25600
    v_mfma_f32_16x16x32_bf16 a[220:223], a[68:71], a[100:103], a[220:223]
    buffer_store_dwordx4 v[84:87], v15, s[40:43], s74 offen offset:2048 sc1
    v_mfma_f32_16x16x32_bf16 a[212:215], a[68:71], a[96:99], a[212:215]
    v_mfma_f32_16x16x32_bf16 v[32:35], a[72:75], a[96:99], v[32:35]
    ds_read_b64_tr_b16 a[68:69], v14 offset:24576
    v_mfma_f32_16x16x32_bf16 v[40:43], a[72:75], a[100:103], v[40:43]
    ds_read_b64_tr_b16 a[70:71], v14 offset:25600
    v_mfma_f32_16x16x32_bf16 a[240:243], a[72:75], a[104:107], a[240:243]
    v_mfma_f32_16x16x32_bf16 a[248:251], a[72:75], a[108:111], a[248:251]
    buffer_load_dwordx4 v27, s[44:47], s66 offen offset:3072  lds
    v_mfma_f32_16x16x32_bf16 a[252:255], a[76:79], a[108:111], a[252:255]
    s_add_u32 s58, s58, 128
    ds_read_b64_tr_b16 a[72:73], v13 offset:24832
    v_mfma_f32_16x16x32_bf16 a[244:247], a[76:79], a[104:107], a[244:247]
    ds_read_b64_tr_b16 a[74:75], v13 offset:25856
    v_mfma_f32_16x16x32_bf16 v[44:47], a[76:79], a[100:103], v[44:47]
    v_mfma_f32_16x16x32_bf16 v[36:39], a[76:79], a[96:99], v[36:39]
    v_mfma_f32_16x16x32_bf16 v[160:163], a[80:83], a[96:99], v[160:163]
    ds_read_b64_tr_b16 a[76:77], v14 offset:24832
    v_mfma_f32_16x16x32_bf16 v[168:171], a[80:83], a[100:103], v[168:171]
    ds_read_b64_tr_b16 a[78:79], v14 offset:25856
    v_mfma_f32_16x16x32_bf16 v[176:179], a[80:83], a[104:107], v[176:179]
    s_add_u32 m0, s63, 0
    v_mfma_f32_16x16x32_bf16 v[184:187], a[80:83], a[108:111], v[184:187]
    buffer_load_dwordx4 v5, s[48:51], s59 offen offset:0  lds
    v_mfma_f32_16x16x32_bf16 v[188:191], a[84:87], a[108:111], v[188:191]
    ds_read_b64_tr_b16 a[80:81], v13 offset:25088
    v_mfma_f32_16x16x32_bf16 v[180:183], a[84:87], a[104:107], v[180:183]
    ds_read_b64_tr_b16 a[82:83], v13 offset:26112
    v_mfma_f32_16x16x32_bf16 v[172:175], a[84:87], a[100:103], v[172:175]
    buffer_store_dwordx4 v[88:91], v15, s[40:43], s74 offen offset:1024 sc1
    v_mfma_f32_16x16x32_bf16 v[164:167], a[84:87], a[96:99], v[164:167]
    v_mfma_f32_16x16x32_bf16 v[192:195], a[88:91], a[96:99], v[192:195]
    ds_read_b64_tr_b16 a[84:85], v14 offset:25088
    v_mfma_f32_16x16x32_bf16 v[200:203], a[88:91], a[100:103], v[200:203]
    ds_read_b64_tr_b16 a[86:87], v14 offset:26112
    v_mfma_f32_16x16x32_bf16 v[208:211], a[88:91], a[104:107], v[208:211]
    v_mfma_f32_16x16x32_bf16 v[216:219], a[88:91], a[108:111], v[216:219]
    buffer_load_dwordx4 v6, s[48:51], s59 offen offset:1024  lds
    v_mfma_f32_16x16x32_bf16 v[220:223], a[92:95], a[108:111], v[220:223]
    ds_read_b64_tr_b16 a[88:89], v13 offset:25344
    v_mfma_f32_16x16x32_bf16 v[212:215], a[92:95], a[104:107], v[212:215]
    ds_read_b64_tr_b16 a[90:91], v13 offset:26368
    v_mfma_f32_16x16x32_bf16 v[204:207], a[92:95], a[100:103], v[204:207]
    v_mfma_f32_16x16x32_bf16 v[196:199], a[92:95], a[96:99], v[196:199]
    v_mfma_f32_16x16x32_bf16 v[224:227], a[128:131], a[96:99], v[224:227]
    ds_read_b64_tr_b16 a[92:93], v14 offset:25344
    v_mfma_f32_16x16x32_bf16 v[232:235], a[128:131], a[100:103], v[232:235]
    ds_read_b64_tr_b16 a[94:95], v14 offset:26368
    v_mfma_f32_16x16x32_bf16 v[240:243], a[128:131], a[104:107], v[240:243]
    v_xor_b32 v13, 0x8000, v13
    v_xor_b32 v14, 0x8000, v14
    v_mfma_f32_16x16x32_bf16 v[248:251], a[128:131], a[108:111], v[248:251]
    buffer_load_dwordx4 v7, s[48:51], s59 offen offset:2048  lds
    v_mfma_f32_16x16x32_bf16 v[252:255], a[132:135], a[108:111], v[252:255]
    v_add_u32 v11, s61, v9
    v_mfma_f32_16x16x32_bf16 v[244:247], a[132:135], a[104:107], v[244:247]
    v_mfma_f32_16x16x32_bf16 v[236:239], a[132:135], a[100:103], v[236:239]
    v_mfma_f32_16x16x32_bf16 v[228:231], a[132:135], a[96:99], v[228:231]
    v_mfma_f32_16x16x32_bf16 a[0:3], a[136:139], a[96:99], a[0:3]
    v_mfma_f32_16x16x32_bf16 a[8:11], a[136:139], a[100:103], a[8:11]
    v_mfma_f32_16x16x32_bf16 a[16:19], a[136:139], a[104:107], a[16:19]
    v_mfma_f32_16x16x32_bf16 a[24:27], a[136:139], a[108:111], a[24:27]
    buffer_load_dwordx4 v8, s[48:51], s59 offen offset:3072  lds
    v_mfma_f32_16x16x32_bf16 a[28:31], a[140:143], a[108:111], a[28:31]
    s_add_u32 s59, s59, 262144
    v_mfma_f32_16x16x32_bf16 a[20:23], a[140:143], a[104:107], a[20:23]
    v_mfma_f32_16x16x32_bf16 a[12:15], a[140:143], a[100:103], a[12:15]
    v_mfma_f32_16x16x32_bf16 a[4:7], a[140:143], a[96:99], a[4:7]
    s_waitcnt vmcnt(21) lgkmcnt(0)
    s_barrier
    v_mfma_f32_16x16x32_bf16 a[144:147], a[32:35], a[112:115], a[144:147]
    buffer_store_dword v2, v3, s[40:43], s56 offen sc1
    v_mfma_f32_16x16x32_bf16 a[152:155], a[32:35], a[116:119], a[152:155]
    ds_read_b64_tr_b16 a[128:129], v13 offset:0
    ds_read_b64_tr_b16 a[130:131], v13 offset:1024
    v_mfma_f32_16x16x32_bf16 a[160:163], a[32:35], a[120:123], a[160:163]
    s_mov_b32 m0, s60
    v_mov_b32 v2, 2
    ds_read_b64_tr_b16 a[132:133], v14 offset:0
    v_mfma_f32_16x16x32_bf16 a[168:171], a[32:35], a[124:127], a[168:171]
    buffer_load_dwordx4 v24, s[44:47], s58 offen offset:0  lds
    v_mfma_f32_16x16x32_bf16 a[172:175], a[36:39], a[124:127], a[172:175]
    ds_read_b64_tr_b16 a[134:135], v14 offset:1024
    ds_read_b64_tr_b16 a[136:137], v13 offset:256
    v_mfma_f32_16x16x32_bf16 a[164:167], a[36:39], a[120:123], a[164:167]
    ds_read_b64_tr_b16 a[138:139], v13 offset:1280
    v_mfma_f32_16x16x32_bf16 a[156:159], a[36:39], a[116:119], a[156:159]
    buffer_store_dwordx4 v[92:95], v15, s[40:43], s74 offen offset:0 sc1
    v_mfma_f32_16x16x32_bf16 a[148:151], a[36:39], a[112:115], a[148:151]
    ds_read_b64_tr_b16 a[140:141], v14 offset:256
    ds_read_b64_tr_b16 a[142:143], v14 offset:1280
    v_mfma_f32_16x16x32_bf16 a[176:179], a[40:43], a[112:115], a[176:179]
    ds_read_b64_tr_b16 a[32:33], v13 offset:512
    v_mfma_f32_16x16x32_bf16 a[184:187], a[40:43], a[116:119], a[184:187]
    ds_read_b64_tr_b16 a[34:35], v13 offset:1536
    v_mfma_f32_16x16x32_bf16 a[192:195], a[40:43], a[120:123], a[192:195]
    ds_read_b128 a[96:99], v11 offset:0
    v_mfma_f32_16x16x32_bf16 a[200:203], a[40:43], a[124:127], a[200:203]
    buffer_load_dwordx4 v25, s[44:47], s58 offen offset:1024  lds
    v_mfma_f32_16x16x32_bf16 a[204:207], a[44:47], a[124:127], a[204:207]
    ds_read_b64_tr_b16 a[36:37], v14 offset:512
    ds_read_b64_tr_b16 a[38:39], v14 offset:1536
    v_mfma_f32_16x16x32_bf16 a[196:199], a[44:47], a[120:123], a[196:199]
    ds_read_b128 a[100:103], v11 offset:2048
    v_mfma_f32_16x16x32_bf16 a[188:191], a[44:47], a[116:119], a[188:191]
    ds_read_b64_tr_b16 a[40:41], v13 offset:768
    v_mfma_f32_16x16x32_bf16 a[180:183], a[44:47], a[112:115], a[180:183]
    ds_read_b64_tr_b16 a[42:43], v13 offset:1792
    v_mfma_f32_16x16x32_bf16 a[208:211], a[48:51], a[112:115], a[208:211]
    ds_read_b128 a[104:107], v11 offset:16384
    v_mfma_f32_16x16x32_bf16 a[216:219], a[48:51], a[116:119], a[216:219]
    ds_read_b64_tr_b16 a[44:45], v14 offset:768
    v_mfma_f32_16x16x32_bf16 a[224:227], a[48:51], a[120:123], a[224:227]
    ds_read_b64_tr_b16 a[46:47], v14 offset:1792
    v_mfma_f32_16x16x32_bf16 a[232:235], a[48:51], a[124:127], a[232:235]
    buffer_load_dwordx4 v26, s[44:47], s58 offen offset:2048  lds
    v_mfma_f32_16x16x32_bf16 a[236:239], a[52:55], a[124:127], a[236:239]
    ds_read_b128 a[108:111], v11 offset:18432
    ds_read_b64_tr_b16 a[48:49], v13 offset:8192
    v_mfma_f32_16x16x32_bf16 a[228:231], a[52:55], a[120:123], a[228:231]
    ds_read_b64_tr_b16 a[50:51], v13 offset:9216
    v_mfma_f32_16x16x32_bf16 a[220:223], a[52:55], a[116:119], a[220:223]
    v_mfma_f32_16x16x32_bf16 a[212:215], a[52:55], a[112:115], a[212:215]
    v_mfma_f32_16x16x32_bf16 v[32:35], a[56:59], a[112:115], v[32:35]
    ds_read_b64_tr_b16 a[52:53], v14 offset:8192
    v_mfma_f32_16x16x32_bf16 v[40:43], a[56:59], a[116:119], v[40:43]
    ds_read_b64_tr_b16 a[54:55], v14 offset:9216
    v_mfma_f32_16x16x32_bf16 a[240:243], a[56:59], a[120:123], a[240:243]
    v_mfma_f32_16x16x32_bf16 a[248:251], a[56:59], a[124:127], a[248:251]
    buffer_load_dwordx4 v27, s[44:47], s58 offen offset:3072  lds
    v_mfma_f32_16x16x32_bf16 a[252:255], a[60:63], a[124:127], a[252:255]
    ds_read_b64_tr_b16 a[56:57], v13 offset:8448
    v_mfma_f32_16x16x32_bf16 a[244:247], a[60:63], a[120:123], a[244:247]
    ds_read_b64_tr_b16 a[58:59], v13 offset:9472
    v_mfma_f32_16x16x32_bf16 v[44:47], a[60:63], a[116:119], v[44:47]
    s_add_u32 s74, s65, 524288
    buffer_store_dwordx4 v[96:99], v15, s[40:43], s74 offen offset:0 sc1
    v_mfma_f32_16x16x32_bf16 v[36:39], a[60:63], a[112:115], v[36:39]
    v_mfma_f32_16x16x32_bf16 v[160:163], a[64:67], a[112:115], v[160:163]
    ds_read_b64_tr_b16 a[60:61], v14 offset:8448
    v_mfma_f32_16x16x32_bf16 v[168:171], a[64:67], a[116:119], v[168:171]
    ds_read_b64_tr_b16 a[62:63], v14 offset:9472
    v_mfma_f32_16x16x32_bf16 v[176:179], a[64:67], a[120:123], v[176:179]
    s_add_u32 m0, s63, 16384
    v_mfma_f32_16x16x32_bf16 v[184:187], a[64:67], a[124:127], v[184:187]
    buffer_load_dwordx4 v5, s[48:51], s59 offen offset:0  lds
    v_mfma_f32_16x16x32_bf16 v[188:191], a[68:71], a[124:127], v[188:191]
    ds_read_b64_tr_b16 a[64:65], v13 offset:8704
    v_mfma_f32_16x16x32_bf16 v[180:183], a[68:71], a[120:123], v[180:183]
    ds_read_b64_tr_b16 a[66:67], v13 offset:9728
    v_mfma_f32_16x16x32_bf16 v[172:175], a[68:71], a[116:119], v[172:175]
    v_mfma_f32_16x16x32_bf16 v[164:167], a[68:71], a[112:115], v[164:167]
    v_mfma_f32_16x16x32_bf16 v[192:195], a[72:75], a[112:115], v[192:195]
    ds_read_b64_tr_b16 a[68:69], v14 offset:8704
    v_mfma_f32_16x16x32_bf16 v[200:203], a[72:75], a[116:119], v[200:203]
    ds_read_b64_tr_b16 a[70:71], v14 offset:9728
    v_mfma_f32_16x16x32_bf16 v[208:211], a[72:75], a[120:123], v[208:211]
    v_mfma_f32_16x16x32_bf16 v[216:219], a[72:75], a[124:127], v[216:219]
    buffer_load_dwordx4 v6, s[48:51], s59 offen offset:1024  lds
    v_mfma_f32_16x16x32_bf16 v[220:223], a[76:79], a[124:127], v[220:223]
    ds_read_b64_tr_b16 a[72:73], v13 offset:8960
    v_mfma_f32_16x16x32_bf16 v[212:215], a[76:79], a[120:123], v[212:215]
    ds_read_b64_tr_b16 a[74:75], v13 offset:9984
    v_mfma_f32_16x16x32_bf16 v[204:207], a[76:79], a[116:119], v[204:207]
    v_mfma_f32_16x16x32_bf16 v[196:199], a[76:79], a[112:115], v[196:199]
    v_mfma_f32_16x16x32_bf16 v[224:227], a[80:83], a[112:115], v[224:227]
    ds_read_b64_tr_b16 a[76:77], v14 offset:8960
    v_mfma_f32_16x16x32_bf16 v[232:235], a[80:83], a[116:119], v[232:235]
    ds_read_b64_tr_b16 a[78:79], v14 offset:9984
    v_mfma_f32_16x16x32_bf16 v[240:243], a[80:83], a[120:123], v[240:243]
    v_add_u32 v12, s61, v10
    v_mfma_f32_16x16x32_bf16 v[248:251], a[80:83], a[124:127], v[248:251]
    buffer_load_dwordx4 v7, s[48:51], s59 offen offset:2048  lds
    v_mfma_f32_16x16x32_bf16 v[252:255], a[84:87], a[124:127], v[252:255]
    v_mfma_f32_16x16x32_bf16 v[244:247], a[84:87], a[120:123], v[244:247]
    v_mfma_f32_16x16x32_bf16 v[236:239], a[84:87], a[116:119], v[236:239]
    v_mfma_f32_16x16x32_bf16 v[228:231], a[84:87], a[112:115], v[228:231]
    v_mfma_f32_16x16x32_bf16 a[0:3], a[88:91], a[112:115], a[0:3]
    v_mfma_f32_16x16x32_bf16 a[8:11], a[88:91], a[116:119], a[8:11]
    v_mfma_f32_16x16x32_bf16 a[16:19], a[88:91], a[120:123], a[16:19]
    v_mfma_f32_16x16x32_bf16 a[24:27], a[88:91], a[124:127], a[24:27]
    buffer_load_dwordx4 v8, s[48:51], s59 offen offset:3072  lds
    v_mfma_f32_16x16x32_bf16 a[28:31], a[92:95], a[124:127], a[28:31]
    s_add_u32 s59, s59, 262144
    v_mfma_f32_16x16x32_bf16 a[20:23], a[92:95], a[120:123], a[20:23]
    s_xor_b32 s63, s63, 0x8000
    s_mov_b32 s67, s60
    s_mov_b32 s60, s61
    v_mfma_f32_16x16x32_bf16 a[12:15], a[92:95], a[116:119], a[12:15]
    s_mov_b32 s61, s62
    s_mov_b32 s62, s67
    v_mfma_f32_16x16x32_bf16 a[4:7], a[92:95], a[112:115], a[4:7]
    s_waitcnt vmcnt(22) lgkmcnt(0)
    s_barrier
    v_mfma_f32_16x16x32_bf16 a[144:147], a[128:131], a[96:99], a[144:147]
    ds_read_b64_tr_b16 a[80:81], v13 offset:16384
    v_mfma_f32_16x16x32_bf16 a[152:155], a[128:131], a[100:103], a[152:155]
    s_add_u32 s66, s58, s69
    ds_read_b64_tr_b16 a[82:83], v13 offset:17408
    v_mfma_f32_16x16x32_bf16 a[160:163], a[128:131], a[104:107], a[160:163]
    s_add_u32 m0, s62, 16384
    ds_read_b64_tr_b16 a[84:85], v14 offset:16384
    v_mfma_f32_16x16x32_bf16 a[168:171], a[128:131], a[108:111], a[168:171]
    buffer_load_dwordx4 v24, s[44:47], s66 offen offset:0  lds
    v_mfma_f32_16x16x32_bf16 a[172:175], a[132:135], a[108:111], a[172:175]
    ds_read_b64_tr_b16 a[86:87], v14 offset:17408
    ds_read_b64_tr_b16 a[88:89], v13 offset:16640
    v_mfma_f32_16x16x32_bf16 a[164:167], a[132:135], a[104:107], a[164:167]
    ds_read_b64_tr_b16 a[90:91], v13 offset:17664
    v_mfma_f32_16x16x32_bf16 a[156:159], a[132:135], a[100:103], a[156:159]
    buffer_store_dwordx4 v[100:103], v15, s[40:43], s74 offen offset:1024 sc1
    v_mfma_f32_16x16x32_bf16 a[148:151], a[132:135], a[96:99], a[148:151]
    ds_read_b64_tr_b16 a[92:93], v14 offset:16640
    ds_read_b64_tr_b16 a[94:95], v14 offset:17664
    v_mfma_f32_16x16x32_bf16 a[176:179], a[136:139], a[96:99], a[176:179]
    ds_read_b64_tr_b16 a[128:129], v13 offset:16896
    v_mfma_f32_16x16x32_bf16 a[184:187], a[136:139], a[100:103], a[184:187]
    ds_read_b64_tr_b16 a[130:131], v13 offset:17920
    v_mfma_f32_16x16x32_bf16 a[192:195], a[136:139], a[104:107], a[192:195]
    ds_read_b128 a[112:115], v12 offset:0
    v_mfma_f32_16x16x32_bf16 a[200:203], a[136:139], a[108:111], a[200:203]
    buffer_load_dwordx4 v25, s[44:47], s66 offen offset:1024  lds
    v_mfma_f32_16x16x32_bf16 a[204:207], a[140:143], a[108:111], a[204:207]
    ds_read_b64_tr_b16 a[132:133], v14 offset:16896
    ds_read_b64_tr_b16 a[134:135], v14 offset:17920
    v_mfma_f32_16x16x32_bf16 a[196:199], a[140:143], a[104:107], a[196:199]
    ds_read_b128 a[116:119], v12 offset:2048
    v_mfma_f32_16x16x32_bf16 a[188:191], a[140:143], a[100:103], a[188:191]
    ds_read_b64_tr_b16 a[136:137], v13 offset:17152
    v_mfma_f32_16x16x32_bf16 a[180:183], a[140:143], a[96:99], a[180:183]
    ds_read_b64_tr_b16 a[138:139], v13 offset:18176
    v_mfma_f32_16x16x32_bf16 a[208:211], a[32:35], a[96:99], a[208:211]
    ds_read_b128 a[120:123], v12 offset:16384
    v_mfma_f32_16x16x32_bf16 a[216:219], a[32:35], a[100:103], a[216:219]
    ds_read_b64_tr_b16 a[140:141], v14 offset:17152
    v_mfma_f32_16x16x32_bf16 a[224:227], a[32:35], a[104:107], a[224:227]
    ds_read_b64_tr_b16 a[142:143], v14 offset:18176
    v_mfma_f32_16x16x32_bf16 a[232:235], a[32:35], a[108:111], a[232:235]
    buffer_load_dwordx4 v26, s[44:47], s66 offen offset:2048  lds
    v_mfma_f32_16x16x32_bf16 a[236:239], a[36:39], a[108:111], a[236:239]
    ds_read_b128 a[124:127], v12 offset:18432
    ds_read_b64_tr_b16 a[32:33], v13 offset:24576
    v_mfma_f32_16x16x32_bf16 a[228:231], a[36:39], a[104:107], a[228:231]
    ds_read_b64_tr_b16 a[34:35], v13 offset:25600
    v_mfma_f32_16x16x32_bf16 a[220:223], a[36:39], a[100:103], a[220:223]
    buffer_store_dwordx4 v[104:107], v15, s[40:43], s74 offen offset:2048 sc1
    v_mfma_f32_16x16x32_bf16 a[212:215], a[36:39], a[96:99], a[212:215]
    v_mfma_f32_16x16x32_bf16 v[32:35], a[40:43], a[96:99], v[32:35]
    ds_read_b64_tr_b16 a[36:37], v14 offset:24576
    v_mfma_f32_16x16x32_bf16 v[40:43], a[40:43], a[100:103], v[40:43]
    ds_read_b64_tr_b16 a[38:39], v14 offset:25600
    v_mfma_f32_16x16x32_bf16 a[240:243], a[40:43], a[104:107], a[240:243]
    v_mfma_f32_16x16x32_bf16 a[248:251], a[40:43], a[108:111], a[248:251]
    buffer_load_dwordx4 v27, s[44:47], s66 offen offset:3072  lds
    v_mfma_f32_16x16x32_bf16 a[252:255], a[44:47], a[108:111], a[252:255]
    s_add_u32 s58, s58, 128
    ds_read_b64_tr_b16 a[40:41], v13 offset:24832
    v_mfma_f32_16x16x32_bf16 a[244:247], a[44:47], a[104:107], a[244:247]
    ds_read_b64_tr_b16 a[42:43], v13 offset:25856
    v_mfma_f32_16x16x32_bf16 v[44:47], a[44:47], a[100:103], v[44:47]
    v_mfma_f32_16x16x32_bf16 v[36:39], a[44:47], a[96:99], v[36:39]
    v_mfma_f32_16x16x32_bf16 v[160:163], a[48:51], a[96:99], v[160:163]
    ds_read_b64_tr_b16 a[44:45], v14 offset:24832
    v_mfma_f32_16x16x32_bf16 v[168:171], a[48:51], a[100:103], v[168:171]
    ds_read_b64_tr_b16 a[46:47], v14 offset:25856
    v_mfma_f32_16x16x32_bf16 v[176:179], a[48:51], a[104:107], v[176:179]
    s_add_u32 m0, s63, 0
    v_mfma_f32_16x16x32_bf16 v[184:187], a[48:51], a[108:111], v[184:187]
    buffer_load_dwordx4 v5, s[48:51], s59 offen offset:0  lds
    v_mfma_f32_16x16x32_bf16 v[188:191], a[52:55], a[108:111], v[188:191]
    ds_read_b64_tr_b16 a[48:49], v13 offset:25088
    v_mfma_f32_16x16x32_bf16 v[180:183], a[52:55], a[104:107], v[180:183]
    ds_read_b64_tr_b16 a[50:51], v13 offset:26112
    v_mfma_f32_16x16x32_bf16 v[172:175], a[52:55], a[100:103], v[172:175]
    buffer_store_dwordx4 v[108:111], v15, s[40:43], s74 offen offset:3072 sc1
    v_mfma_f32_16x16x32_bf16 v[164:167], a[52:55], a[96:99], v[164:167]
    v_mfma_f32_16x16x32_bf16 v[192:195], a[56:59], a[96:99], v[192:195]
    ds_read_b64_tr_b16 a[52:53], v14 offset:25088
    v_mfma_f32_16x16x32_bf16 v[200:203], a[56:59], a[100:103], v[200:203]
    ds_read_b64_tr_b16 a[54:55], v14 offset:26112
    v_mfma_f32_16x16x32_bf16 v[208:211], a[56:59], a[104:107], v[208:211]
    v_mfma_f32_16x16x32_bf16 v[216:219], a[56:59], a[108:111], v[216:219]
    buffer_load_dwordx4 v6, s[48:51], s59 offen offset:1024  lds
    v_mfma_f32_16x16x32_bf16 v[220:223], a[60:63], a[108:111], v[220:223]
    ds_read_b64_tr_b16 a[56:57], v13 offset:25344
    v_mfma_f32_16x16x32_bf16 v[212:215], a[60:63], a[104:107], v[212:215]
    ds_read_b64_tr_b16 a[58:59], v13 offset:26368
    v_mfma_f32_16x16x32_bf16 v[204:207], a[60:63], a[100:103], v[204:207]
    v_mfma_f32_16x16x32_bf16 v[196:199], a[60:63], a[96:99], v[196:199]
    v_mfma_f32_16x16x32_bf16 v[224:227], a[64:67], a[96:99], v[224:227]
    ds_read_b64_tr_b16 a[60:61], v14 offset:25344
    v_mfma_f32_16x16x32_bf16 v[232:235], a[64:67], a[100:103], v[232:235]
    ds_read_b64_tr_b16 a[62:63], v14 offset:26368
    v_mfma_f32_16x16x32_bf16 v[240:243], a[64:67], a[104:107], v[240:243]
    v_xor_b32 v13, 0x8000, v13
    v_xor_b32 v14, 0x8000, v14
    v_mfma_f32_16x16x32_bf16 v[248:251], a[64:67], a[108:111], v[248:251]
    buffer_load_dwordx4 v7, s[48:51], s59 offen offset:2048  lds
    v_mfma_f32_16x16x32_bf16 v[252:255], a[68:71], a[108:111], v[252:255]
    v_add_u32 v11, s61, v9
    v_mfma_f32_16x16x32_bf16 v[244:247], a[68:71], a[104:107], v[244:247]
    v_mfma_f32_16x16x32_bf16 v[236:239], a[68:71], a[100:103], v[236:239]
    v_mfma_f32_16x16x32_bf16 v[228:231], a[68:71], a[96:99], v[228:231]
    v_mfma_f32_16x16x32_bf16 a[0:3], a[72:75], a[96:99], a[0:3]
    v_mfma_f32_16x16x32_bf16 a[8:11], a[72:75], a[100:103], a[8:11]
    v_mfma_f32_16x16x32_bf16 a[16:19], a[72:75], a[104:107], a[16:19]
    v_mfma_f32_16x16x32_bf16 a[24:27], a[72:75], a[108:111], a[24:27]
    buffer_load_dwordx4 v8, s[48:51], s59 offen offset:3072  lds
    v_mfma_f32_16x16x32_bf16 a[28:31], a[76:79], a[108:111], a[28:31]
    s_add_u32 s59, s59, 262144
    v_mfma_f32_16x16x32_bf16 a[20:23], a[76:79], a[104:107], a[20:23]
    v_mfma_f32_16x16x32_bf16 a[12:15], a[76:79], a[100:103], a[12:15]
    v_mfma_f32_16x16x32_bf16 a[4:7], a[76:79], a[96:99], a[4:7]
    s_waitcnt vmcnt(22) lgkmcnt(0)
    s_barrier
    v_mfma_f32_16x16x32_bf16 a[144:147], a[80:83], a[112:115], a[144:147]
    ds_read_b64_tr_b16 a[64:65], v13 offset:0
    v_mfma_f32_16x16x32_bf16 a[152:155], a[80:83], a[116:119], a[152:155]
    ds_read_b64_tr_b16 a[66:67], v13 offset:1024
    v_mfma_f32_16x16x32_bf16 a[160:163], a[80:83], a[120:123], a[160:163]
    s_mov_b32 m0, s60
    ds_read_b64_tr_b16 a[68:69], v14 offset:0
    v_mfma_f32_16x16x32_bf16 a[168:171], a[80:83], a[124:127], a[168:171]
    buffer_load_dwordx4 v24, s[44:47], s58 offen offset:0  lds
    v_mfma_f32_16x16x32_bf16 a[172:175], a[84:87], a[124:127], a[172:175]
    ds_read_b64_tr_b16 a[70:71], v14 offset:1024
    ds_read_b64_tr_b16 a[72:73], v13 offset:256
    v_mfma_f32_16x16x32_bf16 a[164:167], a[84:87], a[120:123], a[164:167]
    ds_read_b64_tr_b16 a[74:75], v13 offset:1280
    v_mfma_f32_16x16x32_bf16 a[156:159], a[84:87], a[116:119], a[156:159]
    s_add_u32 s74, s65, 528384
    ds_read_b64_tr_b16 a[76:77], v14 offset:256
    v_mfma_f32_16x16x32_bf16 a[148:151], a[84:87], a[112:115], a[148:151]
    buffer_store_dwordx4 v[112:115], v15, s[40:43], s74 offen offset:0 sc1
    v_mfma_f32_16x16x32_bf16 a[176:179], a[88:91], a[112:115], a[176:179]
    ds_read_b64_tr_b16 a[78:79], v14 offset:1280
    ds_read_b64_tr_b16 a[80:81], v13 offset:512
    v_mfma_f32_16x16x32_bf16 a[184:187], a[88:91], a[116:119], a[184:187]
    ds_read_b64_tr_b16 a[82:83], v13 offset:1536
    v_mfma_f32_16x16x32_bf16 a[192:195], a[88:91], a[120:123], a[192:195]
    ds_read_b128 a[96:99], v11 offset:0
    v_mfma_f32_16x16x32_bf16 a[200:203], a[88:91], a[124:127], a[200:203]
    buffer_load_dwordx4 v25, s[44:47], s58 offen offset:1024  lds
    v_mfma_f32_16x16x32_bf16 a[204:207], a[92:95], a[124:127], a[204:207]
    ds_read_b64_tr_b16 a[84:85], v14 offset:512
    ds_read_b64_tr_b16 a[86:87], v14 offset:1536
    v_mfma_f32_16x16x32_bf16 a[196:199], a[92:95], a[120:123], a[196:199]
    ds_read_b128 a[100:103], v11 offset:2048
    v_mfma_f32_16x16x32_bf16 a[188:191], a[92:95], a[116:119], a[188:191]
    ds_read_b64_tr_b16 a[88:89], v13 offset:768
    v_mfma_f32_16x16x32_bf16 a[180:183], a[92:95], a[112:115], a[180:183]
    ds_read_b64_tr_b16 a[90:91], v13 offset:1792
    v_mfma_f32_16x16x32_bf16 a[208:211], a[128:131], a[112:115], a[208:211]
    ds_read_b128 a[104:107], v11 offset:16384
    v_mfma_f32_16x16x32_bf16 a[216:219], a[128:131], a[116:119], a[216:219]
    ds_read_b64_tr_b16 a[92:93], v14 offset:768
    v_mfma_f32_16x16x32_bf16 a[224:227], a[128:131], a[120:123], a[224:227]
    ds_read_b64_tr_b16 a[94:95], v14 offset:1792
    v_mfma_f32_16x16x32_bf16 a[232:235], a[128:131], a[124:127], a[232:235]
    buffer_load_dwordx4 v26, s[44:47], s58 offen offset:2048  lds
    v_mfma_f32_16x16x32_bf16 a[236:239], a[132:135], a[124:127], a[236:239]
    ds_read_b128 a[108:111], v11 offset:18432
    ds_read_b64_tr_b16 a[128:129], v13 offset:8192
    v_mfma_f32_16x16x32_bf16 a[228:231], a[132:135], a[120:123], a[228:231]
    ds_read_b64_tr_b16 a[130:131], v13 offset:9216
    v_mfma_f32_16x16x32_bf16 a[220:223], a[132:135], a[116:119], a[220:223]
    v_mfma_f32_16x16x32_bf16 a[212:215], a[132:135], a[112:115], a[212:215]
    v_mfma_f32_16x16x32_bf16 v[32:35], a[136:139], a[112:115], v[32:35]
    ds_read_b64_tr_b16 a[132:133], v14 offset:8192
    v_mfma_f32_16x16x32_bf16 v[40:43], a[136:139], a[116:119], v[40:43]
    ds_read_b64_tr_b16 a[134:135], v14 offset:9216
    v_mfma_f32_16x16x32_bf16 a[240:243], a[136:139], a[120:123], a[240:243]
    v_mfma_f32_16x16x32_bf16 a[248:251], a[136:139], a[124:127], a[248:251]
    buffer_load_dwordx4 v27, s[44:47], s58 offen offset:3072  lds
    v_mfma_f32_16x16x32_bf16 a[252:255], a[140:143], a[124:127], a[252:255]
    ds_read_b64_tr_b16 a[136:137], v13 offset:8448
    v_mfma_f32_16x16x32_bf16 a[244:247], a[140:143], a[120:123], a[244:247]
    ds_read_b64_tr_b16 a[138:139], v13 offset:9472
    v_mfma_f32_16x16x32_bf16 v[44:47], a[140:143], a[116:119], v[44:47]
    buffer_store_dwordx4 v[116:119], v15, s[40:43], s74 offen offset:1024 sc1
    v_mfma_f32_16x16x32_bf16 v[36:39], a[140:143], a[112:115], v[36:39]
    v_mfma_f32_16x16x32_bf16 v[160:163], a[32:35], a[112:115], v[160:163]
    ds_read_b64_tr_b16 a[140:141], v14 offset:8448
    v_mfma_f32_16x16x32_bf16 v[168:171], a[32:35], a[116:119], v[168:171]
    ds_read_b64_tr_b16 a[142:143], v14 offset:9472
    v_mfma_f32_16x16x32_bf16 v[176:179], a[32:35], a[120:123], v[176:179]
    s_add_u32 m0, s63, 16384
    v_mfma_f32_16x16x32_bf16 v[184:187], a[32:35], a[124:127], v[184:187]
    buffer_load_dwordx4 v5, s[48:51], s59 offen offset:0  lds
    v_mfma_f32_16x16x32_bf16 v[188:191], a[36:39], a[124:127], v[188:191]
    ds_read_b64_tr_b16 a[32:33], v13 offset:8704
    v_mfma_f32_16x16x32_bf16 v[180:183], a[36:39], a[120:123], v[180:183]
    ds_read_b64_tr_b16 a[34:35], v13 offset:9728
    v_mfma_f32_16x16x32_bf16 v[172:175], a[36:39], a[116:119], v[172:175]
    v_mfma_f32_16x16x32_bf16 v[164:167], a[36:39], a[112:115], v[164:167]
    v_mfma_f32_16x16x32_bf16 v[192:195], a[40:43], a[112:115], v[192:195]
    ds_read_b64_tr_b16 a[36:37], v14 offset:8704
    v_mfma_f32_16x16x32_bf16 v[200:203], a[40:43], a[116:119], v[200:203]
    ds_read_b64_tr_b16 a[38:39], v14 offset:9728
    v_mfma_f32_16x16x32_bf16 v[208:211], a[40:43], a[120:123], v[208:211]
    v_mfma_f32_16x16x32_bf16 v[216:219], a[40:43], a[124:127], v[216:219]
    buffer_load_dwordx4 v6, s[48:51], s59 offen offset:1024  lds
    v_mfma_f32_16x16x32_bf16 v[220:223], a[44:47], a[124:127], v[220:223]
    ds_read_b64_tr_b16 a[40:41], v13 offset:8960
    v_mfma_f32_16x16x32_bf16 v[212:215], a[44:47], a[120:123], v[212:215]
    ds_read_b64_tr_b16 a[42:43], v13 offset:9984
    v_mfma_f32_16x16x32_bf16 v[204:207], a[44:47], a[116:119], v[204:207]
    v_mfma_f32_16x16x32_bf16 v[196:199], a[44:47], a[112:115], v[196:199]
    v_mfma_f32_16x16x32_bf16 v[224:227], a[48:51], a[112:115], v[224:227]
    ds_read_b64_tr_b16 a[44:45], v14 offset:8960
    v_mfma_f32_16x16x32_bf16 v[232:235], a[48:51], a[116:119], v[232:235]
    ds_read_b64_tr_b16 a[46:47], v14 offset:9984
    v_mfma_f32_16x16x32_bf16 v[240:243], a[48:51], a[120:123], v[240:243]
    v_add_u32 v12, s61, v10
    v_mfma_f32_16x16x32_bf16 v[248:251], a[48:51], a[124:127], v[248:251]
    buffer_load_dwordx4 v7, s[48:51], s59 offen offset:2048  lds
    v_mfma_f32_16x16x32_bf16 v[252:255], a[52:55], a[124:127], v[252:255]
    v_mfma_f32_16x16x32_bf16 v[244:247], a[52:55], a[120:123], v[244:247]
    v_mfma_f32_16x16x32_bf16 v[236:239], a[52:55], a[116:119], v[236:239]
    v_mfma_f32_16x16x32_bf16 v[228:231], a[52:55], a[112:115], v[228:231]
    v_mfma_f32_16x16x32_bf16 a[0:3], a[56:59], a[112:115], a[0:3]
    v_mfma_f32_16x16x32_bf16 a[8:11], a[56:59], a[116:119], a[8:11]
    v_mfma_f32_16x16x32_bf16 a[16:19], a[56:59], a[120:123], a[16:19]
    v_mfma_f32_16x16x32_bf16 a[24:27], a[56:59], a[124:127], a[24:27]
    buffer_load_dwordx4 v8, s[48:51], s59 offen offset:3072  lds
    v_mfma_f32_16x16x32_bf16 a[28:31], a[60:63], a[124:127], a[28:31]
    s_add_u32 s59, s59, 262144
    v_mfma_f32_16x16x32_bf16 a[20:23], a[60:63], a[120:123], a[20:23]
    s_xor_b32 s63, s63, 0x8000
    s_mov_b32 s67, s60
    s_mov_b32 s60, s61
    v_mfma_f32_16x16x32_bf16 a[12:15], a[60:63], a[116:119], a[12:15]
    s_mov_b32 s61, s62
    s_mov_b32 s62, s67
    v_mfma_f32_16x16x32_bf16 a[4:7], a[60:63], a[112:115], a[4:7]
    s_waitcnt vmcnt(21) lgkmcnt(0)
    s_barrier
    v_mfma_f32_16x16x32_bf16 a[144:147], a[64:67], a[96:99], a[144:147]
    ds_read_b64_tr_b16 a[48:49], v13 offset:16384
    v_mfma_f32_16x16x32_bf16 a[152:155], a[64:67], a[100:103], a[152:155]
    s_add_u32 s66, s58, s69
    ds_read_b64_tr_b16 a[50:51], v13 offset:17408
    v_mfma_f32_16x16x32_bf16 a[160:163], a[64:67], a[104:107], a[160:163]
    s_add_u32 m0, s62, 16384
    ds_read_b64_tr_b16 a[52:53], v14 offset:16384
    v_mfma_f32_16x16x32_bf16 a[168:171], a[64:67], a[108:111], a[168:171]
    buffer_load_dwordx4 v24, s[44:47], s66 offen offset:0  lds
    v_mfma_f32_16x16x32_bf16 a[172:175], a[68:71], a[108:111], a[172:175]
    ds_read_b64_tr_b16 a[54:55], v14 offset:17408
    ds_read_b64_tr_b16 a[56:57], v13 offset:16640
    v_mfma_f32_16x16x32_bf16 a[164:167], a[68:71], a[104:107], a[164:167]
    ds_read_b64_tr_b16 a[58:59], v13 offset:17664
    v_mfma_f32_16x16x32_bf16 a[156:159], a[68:71], a[100:103], a[156:159]
    buffer_store_dwordx4 v[120:123], v15, s[40:43], s74 offen offset:2048 sc1
    v_mfma_f32_16x16x32_bf16 a[148:151], a[68:71], a[96:99], a[148:151]
    ds_read_b64_tr_b16 a[60:61], v14 offset:16640
    ds_read_b64_tr_b16 a[62:63], v14 offset:17664
    v_mfma_f32_16x16x32_bf16 a[176:179], a[72:75], a[96:99], a[176:179]
    ds_read_b64_tr_b16 a[64:65], v13 offset:16896
    v_mfma_f32_16x16x32_bf16 a[184:187], a[72:75], a[100:103], a[184:187]
    ds_read_b64_tr_b16 a[66:67], v13 offset:17920
    v_mfma_f32_16x16x32_bf16 a[192:195], a[72:75], a[104:107], a[192:195]
    ds_read_b128 a[112:115], v12 offset:0
    v_mfma_f32_16x16x32_bf16 a[200:203], a[72:75], a[108:111], a[200:203]
    buffer_load_dwordx4 v25, s[44:47], s66 offen offset:1024  lds
    v_mfma_f32_16x16x32_bf16 a[204:207], a[76:79], a[108:111], a[204:207]
    ds_read_b64_tr_b16 a[68:69], v14 offset:16896
    ds_read_b64_tr_b16 a[70:71], v14 offset:17920
    v_mfma_f32_16x16x32_bf16 a[196:199], a[76:79], a[104:107], a[196:199]
    ds_read_b128 a[116:119], v12 offset:2048
    v_mfma_f32_16x16x32_bf16 a[188:191], a[76:79], a[100:103], a[188:191]
    ds_read_b64_tr_b16 a[72:73], v13 offset:17152
    v_mfma_f32_16x16x32_bf16 a[180:183], a[76:79], a[96:99], a[180:183]
    ds_read_b64_tr_b16 a[74:75], v13 offset:18176
    v_mfma_f32_16x16x32_bf16 a[208:211], a[80:83], a[96:99], a[208:211]
    ds_read_b128 a[120:123], v12 offset:16384
    v_mfma_f32_16x16x32_bf16 a[216:219], a[80:83], a[100:103], a[216:219]
    ds_read_b64_tr_b16 a[76:77], v14 offset:17152
    v_mfma_f32_16x16x32_bf16 a[224:227], a[80:83], a[104:107], a[224:227]
    ds_read_b64_tr_b16 a[78:79], v14 offset:18176
    v_mfma_f32_16x16x32_bf16 a[232:235], a[80:83], a[108:111], a[232:235]
    buffer_load_dwordx4 v26, s[44:47], s66 offen offset:2048  lds
    v_mfma_f32_16x16x32_bf16 a[236:239], a[84:87], a[108:111], a[236:239]
    ds_read_b128 a[124:127], v12 offset:18432
    ds_read_b64_tr_b16 a[80:81], v13 offset:24576
    v_mfma_f32_16x16x32_bf16 a[228:231], a[84:87], a[104:107], a[228:231]
    ds_read_b64_tr_b16 a[82:83], v13 offset:25600
    v_mfma_f32_16x16x32_bf16 a[220:223], a[84:87], a[100:103], a[220:223]
    buffer_store_dwordx4 v[124:127], v15, s[40:43], s74 offen offset:3072 sc1
    v_mfma_f32_16x16x32_bf16 a[212:215], a[84:87], a[96:99], a[212:215]
    v_mfma_f32_16x16x32_bf16 v[32:35], a[88:91], a[96:99], v[32:35]
    ds_read_b64_tr_b16 a[84:85], v14 offset:24576
    v_mfma_f32_16x16x32_bf16 v[40:43], a[88:91], a[100:103], v[40:43]
    ds_read_b64_tr_b16 a[86:87], v14 offset:25600
    v_mfma_f32_16x16x32_bf16 a[240:243], a[88:91], a[104:107], a[240:243]
    v_mfma_f32_16x16x32_bf16 a[248:251], a[88:91], a[108:111], a[248:251]
    buffer_load_dwordx4 v27, s[44:47], s66 offen offset:3072  lds
    v_mfma_f32_16x16x32_bf16 a[252:255], a[92:95], a[108:111], a[252:255]
    s_add_u32 s58, s58, 128
    ds_read_b64_tr_b16 a[88:89], v13 offset:24832
    v_mfma_f32_16x16x32_bf16 a[244:247], a[92:95], a[104:107], a[244:247]
    ds_read_b64_tr_b16 a[90:91], v13 offset:25856
    v_mfma_f32_16x16x32_bf16 v[44:47], a[92:95], a[100:103], v[44:47]
    v_mfma_f32_16x16x32_bf16 v[36:39], a[92:95], a[96:99], v[36:39]
    v_mfma_f32_16x16x32_bf16 v[160:163], a[128:131], a[96:99], v[160:163]
    ds_read_b64_tr_b16 a[92:93], v14 offset:24832
    v_mfma_f32_16x16x32_bf16 v[168:171], a[128:131], a[100:103], v[168:171]
    ds_read_b64_tr_b16 a[94:95], v14 offset:25856
    v_mfma_f32_16x16x32_bf16 v[176:179], a[128:131], a[104:107], v[176:179]
    s_add_u32 m0, s63, 0
    v_mfma_f32_16x16x32_bf16 v[184:187], a[128:131], a[108:111], v[184:187]
    buffer_load_dwordx4 v5, s[48:51], s59 offen offset:0  lds
    v_mfma_f32_16x16x32_bf16 v[188:191], a[132:135], a[108:111], v[188:191]
    ds_read_b64_tr_b16 a[128:129], v13 offset:25088
    v_mfma_f32_16x16x32_bf16 v[180:183], a[132:135], a[104:107], v[180:183]
    ds_read_b64_tr_b16 a[130:131], v13 offset:26112
    v_mfma_f32_16x16x32_bf16 v[172:175], a[132:135], a[100:103], v[172:175]
    s_add_u32 s74, s65, 790528
    buffer_store_dwordx4 v[128:131], v15, s[40:43], s74 offen offset:3072 sc1
    v_mfma_f32_16x16x32_bf16 v[164:167], a[132:135], a[96:99], v[164:167]
    v_mfma_f32_16x16x32_bf16 v[192:195], a[136:139], a[96:99], v[192:195]
    ds_read_b64_tr_b16 a[132:133], v14 offset:25088
    v_mfma_f32_16x16x32_bf16 v[200:203], a[136:139], a[100:103], v[200:203]
    ds_read_b64_tr_b16 a[134:135], v14 offset:26112
    v_mfma_f32_16x16x32_bf16 v[208:211], a[136:139], a[104:107], v[208:211]
    v_mfma_f32_16x16x32_bf16 v[216:219], a[136:139], a[108:111], v[216:219]
    buffer_load_dwordx4 v6, s[48:51], s59 offen offset:1024  lds
    v_mfma_f32_16x16x32_bf16 v[220:223], a[140:143], a[108:111], v[220:223]
    ds_read_b64_tr_b16 a[136:137], v13 offset:25344
    v_mfma_f32_16x16x32_bf16 v[212:215], a[140:143], a[104:107], v[212:215]
    ds_read_b64_tr_b16 a[138:139], v13 offset:26368
    v_mfma_f32_16x16x32_bf16 v[204:207], a[140:143], a[100:103], v[204:207]
    v_mfma_f32_16x16x32_bf16 v[196:199], a[140:143], a[96:99], v[196:199]
    v_mfma_f32_16x16x32_bf16 v[224:227], a[32:35], a[96:99], v[224:227]
    ds_read_b64_tr_b16 a[140:141], v14 offset:25344
    v_mfma_f32_16x16x32_bf16 v[232:235], a[32:35], a[100:103], v[232:235]
    ds_read_b64_tr_b16 a[142:143], v14 offset:26368
    v_mfma_f32_16x16x32_bf16 v[240:243], a[32:35], a[104:107], v[240:243]
    v_xor_b32 v13, 0x8000, v13
    v_xor_b32 v14, 0x8000, v14
    v_mfma_f32_16x16x32_bf16 v[248:251], a[32:35], a[108:111], v[248:251]
    buffer_load_dwordx4 v7, s[48:51], s59 offen offset:2048  lds
    v_mfma_f32_16x16x32_bf16 v[252:255], a[36:39], a[108:111], v[252:255]
    v_add_u32 v11, s61, v9
    v_mfma_f32_16x16x32_bf16 v[244:247], a[36:39], a[104:107], v[244:247]
    v_mfma_f32_16x16x32_bf16 v[236:239], a[36:39], a[100:103], v[236:239]
    v_mfma_f32_16x16x32_bf16 v[228:231], a[36:39], a[96:99], v[228:231]
    v_mfma_f32_16x16x32_bf16 a[0:3], a[40:43], a[96:99], a[0:3]
    v_mfma_f32_16x16x32_bf16 a[8:11], a[40:43], a[100:103], a[8:11]
    v_mfma_f32_16x16x32_bf16 a[16:19], a[40:43], a[104:107], a[16:19]
    v_mfma_f32_16x16x32_bf16 a[24:27], a[40:43], a[108:111], a[24:27]
    buffer_load_dwordx4 v8, s[48:51], s59 offen offset:3072  lds
    v_mfma_f32_16x16x32_bf16 a[28:31], a[44:47], a[108:111], a[28:31]
    s_add_u32 s59, s59, 262144
    v_mfma_f32_16x16x32_bf16 a[20:23], a[44:47], a[104:107], a[20:23]
    v_mfma_f32_16x16x32_bf16 a[12:15], a[44:47], a[100:103], a[12:15]
    v_mfma_f32_16x16x32_bf16 a[4:7], a[44:47], a[96:99], a[4:7]
    s_waitcnt vmcnt(21) lgkmcnt(0)
    s_barrier
    v_mfma_f32_16x16x32_bf16 a[144:147], a[48:51], a[112:115], a[144:147]
    ds_read_b64_tr_b16 a[32:33], v13 offset:0
    v_mfma_f32_16x16x32_bf16 a[152:155], a[48:51], a[116:119], a[152:155]
    ds_read_b64_tr_b16 a[34:35], v13 offset:1024
    v_mfma_f32_16x16x32_bf16 a[160:163], a[48:51], a[120:123], a[160:163]
    ds_read_b64_tr_b16 a[36:37], v14 offset:0
    v_mfma_f32_16x16x32_bf16 a[168:171], a[48:51], a[124:127], a[168:171]
    ds_read_b64_tr_b16 a[38:39], v14 offset:1024
    v_mfma_f32_16x16x32_bf16 a[172:175], a[52:55], a[124:127], a[172:175]
    ds_read_b64_tr_b16 a[40:41], v13 offset:256
    v_mfma_f32_16x16x32_bf16 a[164:167], a[52:55], a[120:123], a[164:167]
    ds_read_b64_tr_b16 a[42:43], v13 offset:1280
    v_mfma_f32_16x16x32_bf16 a[156:159], a[52:55], a[116:119], a[156:159]
    buffer_store_dwordx4 v[132:135], v15, s[40:43], s74 offen offset:2048 sc1
    v_mfma_f32_16x16x32_bf16 a[148:151], a[52:55], a[112:115], a[148:151]
    ds_read_b64_tr_b16 a[44:45], v14 offset:256
    ds_read_b64_tr_b16 a[46:47], v14 offset:1280
    v_mfma_f32_16x16x32_bf16 a[176:179], a[56:59], a[112:115], a[176:179]
    ds_read_b64_tr_b16 a[48:49], v13 offset:512
    v_mfma_f32_16x16x32_bf16 a[184:187], a[56:59], a[116:119], a[184:187]
    ds_read_b64_tr_b16 a[50:51], v13 offset:1536
    v_mfma_f32_16x16x32_bf16 a[192:195], a[56:59], a[120:123], a[192:195]
    ds_read_b128 a[96:99], v11 offset:0
    v_mfma_f32_16x16x32_bf16 a[200:203], a[56:59], a[124:127], a[200:203]
    ds_read_b64_tr_b16 a[52:53], v14 offset:512
    v_mfma_f32_16x16x32_bf16 a[204:207], a[60:63], a[124:127], a[204:207]
    ds_read_b64_tr_b16 a[54:55], v14 offset:1536
    v_mfma_f32_16x16x32_bf16 a[196:199], a[60:63], a[120:123], a[196:199]
    ds_read_b128 a[100:103], v11 offset:2048
    v_mfma_f32_16x16x32_bf16 a[188:191], a[60:63], a[116:119], a[188:191]
    ds_read_b64_tr_b16 a[56:57], v13 offset:768
    v_mfma_f32_16x16x32_bf16 a[180:183], a[60:63], a[112:115], a[180:183]
    ds_read_b64_tr_b16 a[58:59], v13 offset:1792
    v_mfma_f32_16x16x32_bf16 a[208:211], a[64:67], a[112:115], a[208:211]
    ds_read_b128 a[104:107], v11 offset:16384
    v_mfma_f32_16x16x32_bf16 a[216:219], a[64:67], a[116:119], a[216:219]
    ds_read_b64_tr_b16 a[60:61], v14 offset:768
    v_mfma_f32_16x16x32_bf16 a[224:227], a[64:67], a[120:123], a[224:227]
    ds_read_b64_tr_b16 a[62:63], v14 offset:1792
    v_mfma_f32_16x16x32_bf16 a[232:235], a[64:67], a[124:127], a[232:235]
    ds_read_b128 a[108:111], v11 offset:18432
    v_mfma_f32_16x16x32_bf16 a[236:239], a[68:71], a[124:127], a[236:239]
    ds_read_b64_tr_b16 a[64:65], v13 offset:8192
    v_mfma_f32_16x16x32_bf16 a[228:231], a[68:71], a[120:123], a[228:231]
    ds_read_b64_tr_b16 a[66:67], v13 offset:9216
    v_mfma_f32_16x16x32_bf16 a[220:223], a[68:71], a[116:119], a[220:223]
    v_mfma_f32_16x16x32_bf16 a[212:215], a[68:71], a[112:115], a[212:215]
    v_mfma_f32_16x16x32_bf16 v[32:35], a[72:75], a[112:115], v[32:35]
    ds_read_b64_tr_b16 a[68:69], v14 offset:8192
    v_mfma_f32_16x16x32_bf16 v[40:43], a[72:75], a[116:119], v[40:43]
    ds_read_b64_tr_b16 a[70:71], v14 offset:9216
    v_mfma_f32_16x16x32_bf16 a[240:243], a[72:75], a[120:123], a[240:243]
    v_mfma_f32_16x16x32_bf16 a[248:251], a[72:75], a[124:127], a[248:251]
    v_mfma_f32_16x16x32_bf16 a[252:255], a[76:79], a[124:127], a[252:255]
    ds_read_b64_tr_b16 a[72:73], v13 offset:8448
    v_mfma_f32_16x16x32_bf16 a[244:247], a[76:79], a[120:123], a[244:247]
    ds_read_b64_tr_b16 a[74:75], v13 offset:9472
    v_mfma_f32_16x16x32_bf16 v[44:47], a[76:79], a[116:119], v[44:47]
    buffer_store_dwordx4 v[136:139], v15, s[40:43], s74 offen offset:1024 sc1
    v_mfma_f32_16x16x32_bf16 v[36:39], a[76:79], a[112:115], v[36:39]
    v_mfma_f32_16x16x32_bf16 v[160:163], a[80:83], a[112:115], v[160:163]
    ds_read_b64_tr_b16 a[76:77], v14 offset:8448
    v_mfma_f32_16x16x32_bf16 v[168:171], a[80:83], a[116:119], v[168:171]
    ds_read_b64_tr_b16 a[78:79], v14 offset:9472
    v_mfma_f32_16x16x32_bf16 v[176:179], a[80:83], a[120:123], v[176:179]
    s_add_u32 m0, s63, 16384
    v_mfma_f32_16x16x32_bf16 v[184:187], a[80:83], a[124:127], v[184:187]
    buffer_load_dwordx4 v5, s[48:51], s59 offen offset:0  lds
    v_mfma_f32_16x16x32_bf16 v[188:191], a[84:87], a[124:127], v[188:191]
    ds_read_b64_tr_b16 a[80:81], v13 offset:8704
    v_mfma_f32_16x16x32_bf16 v[180:183], a[84:87], a[120:123], v[180:183]
    ds_read_b64_tr_b16 a[82:83], v13 offset:9728
    v_mfma_f32_16x16x32_bf16 v[172:175], a[84:87], a[116:119], v[172:175]
    v_mfma_f32_16x16x32_bf16 v[164:167], a[84:87], a[112:115], v[164:167]
    v_mfma_f32_16x16x32_bf16 v[192:195], a[88:91], a[112:115], v[192:195]
    ds_read_b64_tr_b16 a[84:85], v14 offset:8704
    v_mfma_f32_16x16x32_bf16 v[200:203], a[88:91], a[116:119], v[200:203]
    ds_read_b64_tr_b16 a[86:87], v14 offset:9728
    v_mfma_f32_16x16x32_bf16 v[208:211], a[88:91], a[120:123], v[208:211]
    v_mfma_f32_16x16x32_bf16 v[216:219], a[88:91], a[124:127], v[216:219]
    buffer_load_dwordx4 v6, s[48:51], s59 offen offset:1024  lds
    v_mfma_f32_16x16x32_bf16 v[220:223], a[92:95], a[124:127], v[220:223]
    ds_read_b64_tr_b16 a[88:89], v13 offset:8960
    v_mfma_f32_16x16x32_bf16 v[212:215], a[92:95], a[120:123], v[212:215]
    ds_read_b64_tr_b16 a[90:91], v13 offset:9984
    v_mfma_f32_16x16x32_bf16 v[204:207], a[92:95], a[116:119], v[204:207]
    v_mfma_f32_16x16x32_bf16 v[196:199], a[92:95], a[112:115], v[196:199]
    v_mfma_f32_16x16x32_bf16 v[224:227], a[128:131], a[112:115], v[224:227]
    ds_read_b64_tr_b16 a[92:93], v14 offset:8960
    v_mfma_f32_16x16x32_bf16 v[232:235], a[128:131], a[116:119], v[232:235]
    ds_read_b64_tr_b16 a[94:95], v14 offset:9984
    v_mfma_f32_16x16x32_bf16 v[240:243], a[128:131], a[120:123], v[240:243]
    v_add_u32 v12, s61, v10
    v_mfma_f32_16x16x32_bf16 v[248:251], a[128:131], a[124:127], v[248:251]
    buffer_load_dwordx4 v7, s[48:51], s59 offen offset:2048  lds
    v_mfma_f32_16x16x32_bf16 v[252:255], a[132:135], a[124:127], v[252:255]
    v_mfma_f32_16x16x32_bf16 v[244:247], a[132:135], a[120:123], v[244:247]
    v_mfma_f32_16x16x32_bf16 v[236:239], a[132:135], a[116:119], v[236:239]
    v_mfma_f32_16x16x32_bf16 v[228:231], a[132:135], a[112:115], v[228:231]
    v_mfma_f32_16x16x32_bf16 a[0:3], a[136:139], a[112:115], a[0:3]
    v_mfma_f32_16x16x32_bf16 a[8:11], a[136:139], a[116:119], a[8:11]
    v_mfma_f32_16x16x32_bf16 a[16:19], a[136:139], a[120:123], a[16:19]
    v_mfma_f32_16x16x32_bf16 a[24:27], a[136:139], a[124:127], a[24:27]
    buffer_load_dwordx4 v8, s[48:51], s59 offen offset:3072  lds
    v_mfma_f32_16x16x32_bf16 a[28:31], a[140:143], a[124:127], a[28:31]
    s_add_u32 s59, s59, 262144
    v_mfma_f32_16x16x32_bf16 a[20:23], a[140:143], a[120:123], a[20:23]
    s_xor_b32 s63, s63, 0x8000
    s_mov_b32 s67, s60
    s_mov_b32 s60, s61
    v_mfma_f32_16x16x32_bf16 a[12:15], a[140:143], a[116:119], a[12:15]
    s_mov_b32 s61, s62
    s_mov_b32 s62, s67
    v_mfma_f32_16x16x32_bf16 a[4:7], a[140:143], a[112:115], a[4:7]
    s_waitcnt vmcnt(17) lgkmcnt(0)
    s_barrier
    v_mfma_f32_16x16x32_bf16 a[144:147], a[32:35], a[96:99], a[144:147]
    buffer_load_dword v16, v4, s[40:43], s75 offen sc1
    v_mfma_f32_16x16x32_bf16 a[152:155], a[32:35], a[100:103], a[152:155]
    ds_read_b64_tr_b16 a[128:129], v13 offset:16384
    ds_read_b64_tr_b16 a[130:131], v13 offset:17408
    v_mfma_f32_16x16x32_bf16 a[160:163], a[32:35], a[104:107], a[160:163]
    s_lshl_b32 s19, s26, 21
    ds_read_b64_tr_b16 a[132:133], v14 offset:16384
    s_lshl_b32 s20, s29, 13
    v_mfma_f32_16x16x32_bf16 a[168:171], a[32:35], a[108:111], a[168:171]
    s_mov_b32 s8, 1073741824
    ds_read_b64_tr_b16 a[134:135], v14 offset:17408
    s_mov_b32 s96, 0x71800000
    v_mfma_f32_16x16x32_bf16 a[172:175], a[36:39], a[108:111], a[172:175]
    s_sub_u32 s18, 15, s27
    ds_read_b64_tr_b16 a[136:137], v13 offset:16640
    s_lshl_b32 s66, s18, 2
    v_mfma_f32_16x16x32_bf16 a[164:167], a[36:39], a[104:107], a[164:167]
    s_lshl_b32 s67, s27, 1
    ds_read_b64_tr_b16 a[138:139], v13 offset:17664
    s_lshr_b32 s67, 0, s67
    v_mfma_f32_16x16x32_bf16 a[156:159], a[36:39], a[100:103], a[156:159]
    s_and_b32 s67, s67, 3
    buffer_store_dwordx4 v[140:143], v15, s[40:43], s74 offen offset:0 sc1
    s_add_u32 s67, s67, 32
    v_mfma_f32_16x16x32_bf16 a[148:151], a[36:39], a[96:99], a[148:151]
    s_lshl_b32 s21, s26, 3
    ds_read_b64_tr_b16 a[140:141], v14 offset:16640
    s_add_u32 s21, s21, s27
    v_mfma_f32_16x16x32_bf16 a[176:179], a[40:43], a[96:99], a[176:179]
    s_lshl_b32 s21, s21, 2
    ds_read_b64_tr_b16 a[142:143], v14 offset:17664
    s_add_u32 s21, s21, s29
    v_mfma_f32_16x16x32_bf16 a[184:187], a[40:43], a[100:103], a[184:187]
    s_lshl_b32 s76, s21, 7
    ds_read_b64_tr_b16 a[32:33], v13 offset:16896
    s_add_u32 s97, s66, 4
    v_mfma_f32_16x16x32_bf16 a[192:195], a[40:43], a[104:107], a[192:195]
    s_sub_u32 s97, s97, s67
    ds_read_b64_tr_b16 a[34:35], v13 offset:17920
    s_mov_b32 s78, s67
    v_mfma_f32_16x16x32_bf16 a[200:203], a[40:43], a[108:111], a[200:203]
    s_mov_b32 s11, 1
    ds_read_b128 a[112:115], v12 offset:0
    s_mov_b32 s12, 1
    v_mfma_f32_16x16x32_bf16 a[204:207], a[44:47], a[108:111], a[204:207]
    s_mov_b32 s17, 1
    ds_read_b64_tr_b16 a[36:37], v14 offset:16896
    s_lshl_b32 s7, s27, 2
    v_mfma_f32_16x16x32_bf16 a[196:199], a[44:47], a[104:107], a[196:199]
    s_add_u32 s7, s7, 4
    ds_read_b64_tr_b16 a[38:39], v14 offset:17920
    s_add_u32 s6, s19, s20
    v_mfma_f32_16x16x32_bf16 a[188:191], a[44:47], a[100:103], a[188:191]
    s_add_u32 s6, s6, 16384
    ds_read_b128 a[116:119], v12 offset:2048
    s_lshr_b32 s66, s29, 1
    v_mfma_f32_16x16x32_bf16 a[180:183], a[44:47], a[96:99], a[180:183]
    s_lshl_b32 s66, s66, 15
    ds_read_b64_tr_b16 a[40:41], v13 offset:17152
    s_sub_u32 s6, s6, s66
    v_mfma_f32_16x16x32_bf16 a[208:211], a[48:51], a[96:99], a[208:211]
    s_add_u32 s76, s76, 82968576
    ds_read_b64_tr_b16 a[42:43], v13 offset:18176
    s_lshr_b32 s66, s29, 1
    v_mfma_f32_16x16x32_bf16 a[216:219], a[48:51], a[100:103], a[216:219]
    s_sub_u32 s5, s97, s66
    ds_read_b128 a[120:123], v12 offset:16384
    s_lshl_b32 s4, s78, 15
    v_mfma_f32_16x16x32_bf16 a[224:227], a[48:51], a[104:107], a[224:227]
    s_add_u32 s4, s4, s19
    ds_read_b64_tr_b16 a[44:45], v14 offset:17152
    s_lshl_b32 s66, s28, 3
    v_mfma_f32_16x16x32_bf16 a[232:235], a[48:51], a[108:111], a[232:235]
    s_add_u32 s66, s66, s27
    ds_read_b64_tr_b16 a[46:47], v14 offset:18176
    s_xor_b32 s66, s66, 7
    v_mfma_f32_16x16x32_bf16 a[236:239], a[52:55], a[108:111], a[236:239]
    s_lshl_b32 s66, s66, 1
    ds_read_b128 a[124:127], v12 offset:18432
    s_lshr_b32 s46, s2, 7
    v_mfma_f32_16x16x32_bf16 a[228:231], a[52:55], a[104:107], a[228:231]
    s_add_u32 s66, s66, s46
    ds_read_b64_tr_b16 a[48:49], v13 offset:24576
    s_lshr_b32 s47, s66, 2
    v_mfma_f32_16x16x32_bf16 a[220:223], a[52:55], a[100:103], a[220:223]
    s_and_b32 s66, s66, 3
    s_add_u32 s74, s65, 786432
    ds_read_b64_tr_b16 a[50:51], v13 offset:25600
    v_mfma_f32_16x16x32_bf16 a[212:215], a[52:55], a[96:99], a[212:215]
    s_and_b32 s46, s2, 7
    buffer_store_dwordx4 v[144:147], v15, s[40:43], s74 offen offset:3072 sc1
    s_lshl_b32 s46, s46, 2
    v_mfma_f32_16x16x32_bf16 v[32:35], a[56:59], a[96:99], v[32:35]
    s_add_u32 s46, s46, s66
    ds_read_b64_tr_b16 a[52:53], v14 offset:24576
    s_lshl_b32 s66, s47, 2
    v_mfma_f32_16x16x32_bf16 v[40:43], a[56:59], a[100:103], v[40:43]
    s_add_u32 s66, s66, s29
    ds_read_b64_tr_b16 a[54:55], v14 offset:25600
    s_lshl_b32 s45, s66, 17
    v_mfma_f32_16x16x32_bf16 a[240:243], a[56:59], a[104:107], a[240:243]
    s_add_u32 s45, s45, 41943040
    s_lshl_b32 s44, s66, 10
    s_add_u32 s44, s44, 82837504
    v_mfma_f32_16x16x32_bf16 a[248:251], a[56:59], a[108:111], a[248:251]
    s_xor_b32 s22, s46, s47
    s_and_b32 s22, s22, 0
    s_cmp_eq_u32 s47, 7
    s_cselect_b32 s22, 0, s22
    v_mfma_f32_16x16x32_bf16 a[252:255], a[60:63], a[108:111], a[252:255]
    s_lshl_b32 s22, s22, 16
    ds_read_b64_tr_b16 a[56:57], v13 offset:24832
    s_add_u32 s45, s45, s22
    v_mfma_f32_16x16x32_bf16 a[244:247], a[60:63], a[104:107], a[244:247]
    s_lshr_b32 s66, s2, 3
    ds_read_b64_tr_b16 a[58:59], v13 offset:25856
    s_lshl_b32 s66, s66, 2
    v_mfma_f32_16x16x32_bf16 v[44:47], a[60:63], a[100:103], v[44:47]
    s_add_u32 s66, s66, s29
    s_lshl_b32 s66, s66, 10
    v_and_b32 v20, 0x380, v15
    v_mfma_f32_16x16x32_bf16 v[36:39], a[60:63], a[96:99], v[36:39]
    v_add_u32 v20, s66, v20
    v_mfma_f32_16x16x32_bf16 v[160:163], a[64:67], a[96:99], v[160:163]
    global_load_dword v21, v20, s[30:31]
    v_mfma_f32_16x16x32_bf16 v[168:171], a[64:67], a[100:103], v[168:171]
    ds_read_b64_tr_b16 a[60:61], v14 offset:24832
    ds_read_b64_tr_b16 a[62:63], v14 offset:25856
    v_mfma_f32_16x16x32_bf16 v[176:179], a[64:67], a[104:107], v[176:179]
    v_mfma_f32_16x16x32_bf16 v[184:187], a[64:67], a[108:111], v[184:187]
    v_mfma_f32_16x16x32_bf16 v[188:191], a[68:71], a[108:111], v[188:191]
    ds_read_b64_tr_b16 a[64:65], v13 offset:25088
    v_mfma_f32_16x16x32_bf16 v[180:183], a[68:71], a[104:107], v[180:183]
    ds_read_b64_tr_b16 a[66:67], v13 offset:26112
    v_mfma_f32_16x16x32_bf16 v[172:175], a[68:71], a[100:103], v[172:175]
    buffer_store_dwordx4 v[148:151], v15, s[40:43], s74 offen offset:2048 sc1
    v_mfma_f32_16x16x32_bf16 v[164:167], a[68:71], a[96:99], v[164:167]
    v_mfma_f32_16x16x32_bf16 v[192:195], a[72:75], a[96:99], v[192:195]
    ds_read_b64_tr_b16 a[68:69], v14 offset:25088
    v_mfma_f32_16x16x32_bf16 v[200:203], a[72:75], a[100:103], v[200:203]
    ds_read_b64_tr_b16 a[70:71], v14 offset:26112
    v_mfma_f32_16x16x32_bf16 v[208:211], a[72:75], a[104:107], v[208:211]
    v_mfma_f32_16x16x32_bf16 v[216:219], a[72:75], a[108:111], v[216:219]
    v_mfma_f32_16x16x32_bf16 v[220:223], a[76:79], a[108:111], v[220:223]
    ds_read_b64_tr_b16 a[72:73], v13 offset:25344
    v_mfma_f32_16x16x32_bf16 v[212:215], a[76:79], a[104:107], v[212:215]
    ds_read_b64_tr_b16 a[74:75], v13 offset:26368
    v_mfma_f32_16x16x32_bf16 v[204:207], a[76:79], a[100:103], v[204:207]
    v_mfma_f32_16x16x32_bf16 v[196:199], a[76:79], a[96:99], v[196:199]
    v_mfma_f32_16x16x32_bf16 v[224:227], a[80:83], a[96:99], v[224:227]
    ds_read_b64_tr_b16 a[76:77], v14 offset:25344
    v_mfma_f32_16x16x32_bf16 v[232:235], a[80:83], a[100:103], v[232:235]
    ds_read_b64_tr_b16 a[78:79], v14 offset:26368
    v_mfma_f32_16x16x32_bf16 v[240:243], a[80:83], a[104:107], v[240:243]
    v_xor_b32 v13, 0x8000, v13
    v_xor_b32 v14, 0x8000, v14
    v_mfma_f32_16x16x32_bf16 v[248:251], a[80:83], a[108:111], v[248:251]
    v_add_u32 v11, s61, v9
    v_mfma_f32_16x16x32_bf16 v[252:255], a[84:87], a[108:111], v[252:255]
    v_mfma_f32_16x16x32_bf16 v[244:247], a[84:87], a[104:107], v[244:247]
    v_mfma_f32_16x16x32_bf16 v[236:239], a[84:87], a[100:103], v[236:239]
    v_mfma_f32_16x16x32_bf16 v[228:231], a[84:87], a[96:99], v[228:231]
    v_mfma_f32_16x16x32_bf16 a[0:3], a[88:91], a[96:99], a[0:3]
    v_mfma_f32_16x16x32_bf16 a[8:11], a[88:91], a[100:103], a[8:11]
    v_mfma_f32_16x16x32_bf16 a[16:19], a[88:91], a[104:107], a[16:19]
    v_mfma_f32_16x16x32_bf16 a[24:27], a[88:91], a[108:111], a[24:27]
    v_mfma_f32_16x16x32_bf16 a[28:31], a[92:95], a[108:111], a[28:31]
    v_mfma_f32_16x16x32_bf16 a[20:23], a[92:95], a[104:107], a[20:23]
    v_mfma_f32_16x16x32_bf16 a[12:15], a[92:95], a[100:103], a[12:15]
    v_mfma_f32_16x16x32_bf16 a[4:7], a[92:95], a[96:99], a[4:7]
    s_waitcnt vmcnt(4) lgkmcnt(0)
    s_barrier
    v_cmp_gt_u32 vcc, 1, v16
    s_nop 0
    s_cmp_lg_u64 vcc, 0
    s_cbranch_scc1 F_spin2
F_spin2r:
    v_mfma_f32_16x16x32_bf16 a[144:147], a[128:131], a[112:115], a[144:147]
    s_lshr_b32 s66, s20, 1
    ds_read_b64_tr_b16 a[80:81], v13 offset:0
    s_add_u32 s67, s4, s66
    v_mfma_f32_16x16x32_bf16 a[152:155], a[128:131], a[116:119], a[152:155]
    s_add_u32 m0, s66, 131072
    ds_read_b64_tr_b16 a[82:83], v13 offset:1024
    v_mfma_f32_16x16x32_bf16 a[160:163], a[128:131], a[120:123], a[160:163]
    buffer_load_dwordx4 v15, s[40:43], s67 offen offset:0 sc1 lds
    v_mfma_f32_16x16x32_bf16 a[168:171], a[128:131], a[124:127], a[168:171]
    ds_read_b64_tr_b16 a[84:85], v14 offset:0
    ds_read_b64_tr_b16 a[86:87], v14 offset:1024
    v_mfma_f32_16x16x32_bf16 a[172:175], a[132:135], a[124:127], a[172:175]
    ds_read_b64_tr_b16 a[88:89], v13 offset:256
    v_mfma_f32_16x16x32_bf16 a[164:167], a[132:135], a[120:123], a[164:167]
    ds_read_b64_tr_b16 a[90:91], v13 offset:1280
    v_mfma_f32_16x16x32_bf16 a[156:159], a[132:135], a[116:119], a[156:159]
    buffer_store_dwordx4 v[152:155], v15, s[40:43], s74 offen offset:1024 sc1
    v_mfma_f32_16x16x32_bf16 a[148:151], a[132:135], a[112:115], a[148:151]
    buffer_load_dwordx4 v15, s[40:43], s67 offen offset:1024 sc1 lds
    v_mfma_f32_16x16x32_bf16 a[176:179], a[136:139], a[112:115], a[176:179]
    ds_read_b64_tr_b16 a[92:93], v14 offset:256
    ds_read_b64_tr_b16 a[94:95], v14 offset:1280
    v_mfma_f32_16x16x32_bf16 a[184:187], a[136:139], a[116:119], a[184:187]
    ds_read_b64_tr_b16 a[128:129], v13 offset:512
    ds_read_b64_tr_b16 a[130:131], v13 offset:1536
    v_mfma_f32_16x16x32_bf16 a[192:195], a[136:139], a[120:123], a[192:195]
    ds_read_b128 a[96:99], v11 offset:0
    v_mfma_f32_16x16x32_bf16 a[200:203], a[136:139], a[124:127], a[200:203]
    ds_read_b64_tr_b16 a[132:133], v14 offset:512
    v_mfma_f32_16x16x32_bf16 a[204:207], a[140:143], a[124:127], a[204:207]
    buffer_load_dwordx4 v15, s[40:43], s67 offen offset:2048 sc1 lds
    v_mfma_f32_16x16x32_bf16 a[196:199], a[140:143], a[120:123], a[196:199]
    ds_read_b64_tr_b16 a[134:135], v14 offset:1536
    ds_read_b128 a[100:103], v11 offset:2048
    v_mfma_f32_16x16x32_bf16 a[188:191], a[140:143], a[116:119], a[188:191]
    ds_read_b64_tr_b16 a[136:137], v13 offset:768
    v_mfma_f32_16x16x32_bf16 a[180:183], a[140:143], a[112:115], a[180:183]
    ds_read_b64_tr_b16 a[138:139], v13 offset:1792
    v_mfma_f32_16x16x32_bf16 a[208:211], a[32:35], a[112:115], a[208:211]
    ds_read_b128 a[104:107], v11 offset:16384
    v_mfma_f32_16x16x32_bf16 a[216:219], a[32:35], a[116:119], a[216:219]
    buffer_load_dwordx4 v15, s[40:43], s67 offen offset:3072 sc1 lds
    v_mfma_f32_16x16x32_bf16 a[224:227], a[32:35], a[120:123], a[224:227]
    ds_read_b64_tr_b16 a[140:141], v14 offset:768
    ds_read_b64_tr_b16 a[142:143], v14 offset:1792
    v_mfma_f32_16x16x32_bf16 a[232:235], a[32:35], a[124:127], a[232:235]
    ds_read_b128 a[108:111], v11 offset:18432
    v_mfma_f32_16x16x32_bf16 a[236:239], a[36:39], a[124:127], a[236:239]
    s_add_u32 s4, s4, s20
    ds_read_b64_tr_b16 a[32:33], v13 offset:8192
    s_add_u32 s4, s4, 16384
    v_mfma_f32_16x16x32_bf16 a[228:231], a[36:39], a[120:123], a[228:231]
    s_add_u32 s10, s20, 32768
    ds_read_b64_tr_b16 a[34:35], v13 offset:9216
    s_mov_b32 m0, s10
    v_mfma_f32_16x16x32_bf16 a[220:223], a[36:39], a[116:119], a[220:223]
    buffer_load_dwordx4 v15, s[40:43], s4 offen offset:0 sc1 lds
    v_mfma_f32_16x16x32_bf16 a[212:215], a[36:39], a[112:115], a[212:215]
    v_mfma_f32_16x16x32_bf16 v[32:35], a[40:43], a[112:115], v[32:35]
    ds_read_b64_tr_b16 a[36:37], v14 offset:8192
    v_mfma_f32_16x16x32_bf16 v[40:43], a[40:43], a[116:119], v[40:43]
    ds_read_b64_tr_b16 a[38:39], v14 offset:9216
    v_mfma_f32_16x16x32_bf16 a[240:243], a[40:43], a[120:123], a[240:243]
    v_mfma_f32_16x16x32_bf16 a[248:251], a[40:43], a[124:127], a[248:251]
    buffer_load_dwordx4 v15, s[40:43], s4 offen offset:1024 sc1 lds
    v_mfma_f32_16x16x32_bf16 a[252:255], a[44:47], a[124:127], a[252:255]
    ds_read_b64_tr_b16 a[40:41], v13 offset:8448
    v_mfma_f32_16x16x32_bf16 a[244:247], a[44:47], a[120:123], a[244:247]
    ds_read_b64_tr_b16 a[42:43], v13 offset:9472
    v_mfma_f32_16x16x32_bf16 v[44:47], a[44:47], a[116:119], v[44:47]
    buffer_store_dwordx4 v[156:159], v15, s[40:43], s74 offen offset:0 sc1
    v_mfma_f32_16x16x32_bf16 v[36:39], a[44:47], a[112:115], v[36:39]
    v_mfma_f32_16x16x32_bf16 v[160:163], a[48:51], a[112:115], v[160:163]
    buffer_load_dwordx4 v15, s[40:43], s4 offen offset:2048 sc1 lds
    v_mfma_f32_16x16x32_bf16 v[168:171], a[48:51], a[116:119], v[168:171]
    ds_read_b64_tr_b16 a[44:45], v14 offset:8448
    ds_read_b64_tr_b16 a[46:47], v14 offset:9472
    v_mfma_f32_16x16x32_bf16 v[176:179], a[48:51], a[120:123], v[176:179]
    v_mfma_f32_16x16x32_bf16 v[184:187], a[48:51], a[124:127], v[184:187]
    v_mfma_f32_16x16x32_bf16 v[188:191], a[52:55], a[124:127], v[188:191]
    ds_read_b64_tr_b16 a[48:49], v13 offset:8704
    v_mfma_f32_16x16x32_bf16 v[180:183], a[52:55], a[120:123], v[180:183]
    buffer_load_dwordx4 v15, s[40:43], s4 offen offset:3072 sc1 lds
    v_mfma_f32_16x16x32_bf16 v[172:175], a[52:55], a[116:119], v[172:175]
    ds_read_b64_tr_b16 a[50:51], v13 offset:9728
    v_mfma_f32_16x16x32_bf16 v[164:167], a[52:55], a[112:115], v[164:167]
    v_mfma_f32_16x16x32_bf16 v[192:195], a[56:59], a[112:115], v[192:195]
    s_add_u32 s67, s4, 4096
    ds_read_b64_tr_b16 a[52:53], v14 offset:8704
    s_add_u32 m0, s10, 4096
    v_mfma_f32_16x16x32_bf16 v[200:203], a[56:59], a[116:119], v[200:203]
    ds_read_b64_tr_b16 a[54:55], v14 offset:9728
    v_mfma_f32_16x16x32_bf16 v[208:211], a[56:59], a[120:123], v[208:211]
    buffer_load_dwordx4 v15, s[40:43], s67 offen offset:0 sc1 lds
    v_mfma_f32_16x16x32_bf16 v[216:219], a[56:59], a[124:127], v[216:219]
    v_mfma_f32_16x16x32_bf16 v[220:223], a[60:63], a[124:127], v[220:223]
    ds_read_b64_tr_b16 a[56:57], v13 offset:8960
    v_mfma_f32_16x16x32_bf16 v[212:215], a[60:63], a[120:123], v[212:215]
    ds_read_b64_tr_b16 a[58:59], v13 offset:9984
    v_mfma_f32_16x16x32_bf16 v[204:207], a[60:63], a[116:119], v[204:207]
    v_mfma_f32_16x16x32_bf16 v[196:199], a[60:63], a[112:115], v[196:199]
    buffer_load_dwordx4 v15, s[40:43], s67 offen offset:1024 sc1 lds
    v_mfma_f32_16x16x32_bf16 v[224:227], a[64:67], a[112:115], v[224:227]
    ds_read_b64_tr_b16 a[60:61], v14 offset:8960
    v_mfma_f32_16x16x32_bf16 v[232:235], a[64:67], a[116:119], v[232:235]
    ds_read_b64_tr_b16 a[62:63], v14 offset:9984
    v_mfma_f32_16x16x32_bf16 v[240:243], a[64:67], a[120:123], v[240:243]
    v_add_u32 v12, s61, v10
    v_mfma_f32_16x16x32_bf16 v[248:251], a[64:67], a[124:127], v[248:251]
    v_mfma_f32_16x16x32_bf16 v[252:255], a[68:71], a[124:127], v[252:255]
    buffer_load_dwordx4 v15, s[40:43], s67 offen offset:2048 sc1 lds
    v_mfma_f32_16x16x32_bf16 v[244:247], a[68:71], a[120:123], v[244:247]
    v_mfma_f32_16x16x32_bf16 v[236:239], a[68:71], a[116:119], v[236:239]
    v_mfma_f32_16x16x32_bf16 v[228:231], a[68:71], a[112:115], v[228:231]
    v_mfma_f32_16x16x32_bf16 a[0:3], a[72:75], a[112:115], a[0:3]
    v_mfma_f32_16x16x32_bf16 a[8:11], a[72:75], a[116:119], a[8:11]
    buffer_load_dwordx4 v15, s[40:43], s67 offen offset:3072 sc1 lds
    v_mfma_f32_16x16x32_bf16 a[16:19], a[72:75], a[120:123], a[16:19]
    v_mfma_f32_16x16x32_bf16 a[24:27], a[72:75], a[124:127], a[24:27]
    v_mfma_f32_16x16x32_bf16 a[28:31], a[76:79], a[124:127], a[28:31]
    s_add_u32 s4, s4, 32768
    s_sub_u32 s5, s5, 1
    s_cmp_eq_u32 s5, 0
    s_cselect_b32 s4, s6, s4
    s_cselect_b32 s5, s7, s5
    s_cselect_b32 s6, s8, s6
    v_mfma_f32_16x16x32_bf16 a[20:23], a[76:79], a[120:123], a[20:23]
    v_mfma_f32_16x16x32_bf16 a[12:15], a[76:79], a[116:119], a[12:15]
    v_mfma_f32_16x16x32_bf16 a[4:7], a[76:79], a[112:115], a[4:7]
    s_waitcnt vmcnt(19) lgkmcnt(0)
    s_barrier
    v_mfma_f32_16x16x32_bf16 a[144:147], a[80:83], a[96:99], a[144:147]
    ds_read_b64_tr_b16 a[64:65], v13 offset:16384
    v_mfma_f32_16x16x32_bf16 a[152:155], a[80:83], a[100:103], a[152:155]
    s_add_u32 s10, s20, 65536
    ds_read_b64_tr_b16 a[66:67], v13 offset:17408
    s_mov_b32 m0, s10
    v_mfma_f32_16x16x32_bf16 a[160:163], a[80:83], a[104:107], a[160:163]
    ds_read_b64_tr_b16 a[68:69], v14 offset:16384
    v_mfma_f32_16x16x32_bf16 a[168:171], a[80:83], a[108:111], a[168:171]
    buffer_load_dwordx4 v15, s[40:43], s4 offen offset:0 sc1 lds
    v_mfma_f32_16x16x32_bf16 a[172:175], a[84:87], a[108:111], a[172:175]
    ds_read_b64_tr_b16 a[70:71], v14 offset:17408
    ds_read_b64_tr_b16 a[72:73], v13 offset:16640
    v_mfma_f32_16x16x32_bf16 a[164:167], a[84:87], a[104:107], a[164:167]
    ds_read_b64_tr_b16 a[74:75], v13 offset:17664
    v_mfma_f32_16x16x32_bf16 a[156:159], a[84:87], a[100:103], a[156:159]
    ds_read_b64_tr_b16 a[76:77], v14 offset:16640
    v_mfma_f32_16x16x32_bf16 a[148:151], a[84:87], a[96:99], a[148:151]
    ds_read_b64_tr_b16 a[78:79], v14 offset:17664
    v_mfma_f32_16x16x32_bf16 a[176:179], a[88:91], a[96:99], a[176:179]
    ds_read_b64_tr_b16 a[80:81], v13 offset:16896
    v_mfma_f32_16x16x32_bf16 a[184:187], a[88:91], a[100:103], a[184:187]
    ds_read_b64_tr_b16 a[82:83], v13 offset:17920
    v_mfma_f32_16x16x32_bf16 a[192:195], a[88:91], a[104:107], a[192:195]
    buffer_load_dwordx4 v15, s[40:43], s4 offen offset:1024 sc1 lds
    v_mfma_f32_16x16x32_bf16 a[200:203], a[88:91], a[108:111], a[200:203]
    ds_read_b128 a[112:115], v12 offset:0
    ds_read_b64_tr_b16 a[84:85], v14 offset:16896
    v_mfma_f32_16x16x32_bf16 a[204:207], a[92:95], a[108:111], a[204:207]
    ds_read_b64_tr_b16 a[86:87], v14 offset:17920
    v_mfma_f32_16x16x32_bf16 a[196:199], a[92:95], a[104:107], a[196:199]
    ds_read_b128 a[116:119], v12 offset:2048
    v_mfma_f32_16x16x32_bf16 a[188:191], a[92:95], a[100:103], a[188:191]
    ds_read_b64_tr_b16 a[88:89], v13 offset:17152
    v_mfma_f32_16x16x32_bf16 a[180:183], a[92:95], a[96:99], a[180:183]
    ds_read_b64_tr_b16 a[90:91], v13 offset:18176
    v_mfma_f32_16x16x32_bf16 a[208:211], a[128:131], a[96:99], a[208:211]
    ds_read_b128 a[120:123], v12 offset:16384
    v_mfma_f32_16x16x32_bf16 a[216:219], a[128:131], a[100:103], a[216:219]
    buffer_load_dwordx4 v15, s[40:43], s4 offen offset:2048 sc1 lds
    v_mfma_f32_16x16x32_bf16 a[224:227], a[128:131], a[104:107], a[224:227]
    ds_read_b64_tr_b16 a[92:93], v14 offset:17152
    ds_read_b64_tr_b16 a[94:95], v14 offset:18176
    v_mfma_f32_16x16x32_bf16 a[232:235], a[128:131], a[108:111], a[232:235]
    ds_read_b128 a[124:127], v12 offset:18432
    v_mfma_f32_16x16x32_bf16 a[236:239], a[132:135], a[108:111], a[236:239]
    ds_read_b64_tr_b16 a[128:129], v13 offset:24576
    v_mfma_f32_16x16x32_bf16 a[228:231], a[132:135], a[104:107], a[228:231]
    ds_read_b64_tr_b16 a[130:131], v13 offset:25600
    v_mfma_f32_16x16x32_bf16 a[220:223], a[132:135], a[100:103], a[220:223]
    v_mfma_f32_16x16x32_bf16 a[212:215], a[132:135], a[96:99], a[212:215]
    v_mfma_f32_16x16x32_bf16 v[32:35], a[136:139], a[96:99], v[32:35]
    buffer_load_dwordx4 v15, s[40:43], s4 offen offset:3072 sc1 lds
    v_mfma_f32_16x16x32_bf16 v[40:43], a[136:139], a[100:103], v[40:43]
    ds_read_b64_tr_b16 a[132:133], v14 offset:24576
    ds_read_b64_tr_b16 a[134:135], v14 offset:25600
    v_mfma_f32_16x16x32_bf16 a[240:243], a[136:139], a[104:107], a[240:243]
    v_mfma_f32_16x16x32_bf16 a[248:251], a[136:139], a[108:111], a[248:251]
    v_mfma_f32_16x16x32_bf16 a[252:255], a[140:143], a[108:111], a[252:255]
    ds_read_b64_tr_b16 a[136:137], v13 offset:24832
    v_mfma_f32_16x16x32_bf16 a[244:247], a[140:143], a[104:107], a[244:247]
    s_add_u32 s67, s4, 4096
    ds_read_b64_tr_b16 a[138:139], v13 offset:25856
    s_add_u32 m0, s10, 4096
    v_mfma_f32_16x16x32_bf16 v[44:47], a[140:143], a[100:103], v[44:47]
    v_mfma_f32_16x16x32_bf16 v[36:39], a[140:143], a[96:99], v[36:39]
    buffer_load_dwordx4 v15, s[40:43], s67 offen offset:0 sc1 lds
    v_mfma_f32_16x16x32_bf16 v[160:163], a[32:35], a[96:99], v[160:163]
    ds_read_b64_tr_b16 a[140:141], v14 offset:24832
    v_mfma_f32_16x16x32_bf16 v[168:171], a[32:35], a[100:103], v[168:171]
    ds_read_b64_tr_b16 a[142:143], v14 offset:25856
    v_mfma_f32_16x16x32_bf16 v[176:179], a[32:35], a[104:107], v[176:179]
    v_mfma_f32_16x16x32_bf16 v[184:187], a[32:35], a[108:111], v[184:187]
    v_mfma_f32_16x16x32_bf16 v[188:191], a[36:39], a[108:111], v[188:191]
    ds_read_b64_tr_b16 a[32:33], v13 offset:25088
    v_mfma_f32_16x16x32_bf16 v[180:183], a[36:39], a[104:107], v[180:183]
    ds_read_b64_tr_b16 a[34:35], v13 offset:26112
    v_mfma_f32_16x16x32_bf16 v[172:175], a[36:39], a[100:103], v[172:175]
    buffer_load_dwordx4 v15, s[40:43], s67 offen offset:1024 sc1 lds
    v_mfma_f32_16x16x32_bf16 v[164:167], a[36:39], a[96:99], v[164:167]
    v_mfma_f32_16x16x32_bf16 v[192:195], a[40:43], a[96:99], v[192:195]
    ds_read_b64_tr_b16 a[36:37], v14 offset:25088
    v_mfma_f32_16x16x32_bf16 v[200:203], a[40:43], a[100:103], v[200:203]
    ds_read_b64_tr_b16 a[38:39], v14 offset:26112
    v_mfma_f32_16x16x32_bf16 v[208:211], a[40:43], a[104:107], v[208:211]
    v_mfma_f32_16x16x32_bf16 v[216:219], a[40:43], a[108:111], v[216:219]
    v_mfma_f32_16x16x32_bf16 v[220:223], a[44:47], a[108:111], v[220:223]
    ds_read_b64_tr_b16 a[40:41], v13 offset:25344
    v_mfma_f32_16x16x32_bf16 v[212:215], a[44:47], a[104:107], v[212:215]
    buffer_load_dwordx4 v15, s[40:43], s67 offen offset:2048 sc1 lds
    v_mfma_f32_16x16x32_bf16 v[204:207], a[44:47], a[100:103], v[204:207]
    ds_read_b64_tr_b16 a[42:43], v13 offset:26368
    v_mfma_f32_16x16x32_bf16 v[196:199], a[44:47], a[96:99], v[196:199]
    v_mfma_f32_16x16x32_bf16 v[224:227], a[48:51], a[96:99], v[224:227]
    ds_read_b64_tr_b16 a[44:45], v14 offset:25344
    v_mfma_f32_16x16x32_bf16 v[232:235], a[48:51], a[100:103], v[232:235]
    ds_read_b64_tr_b16 a[46:47], v14 offset:26368
    v_mfma_f32_16x16x32_bf16 v[240:243], a[48:51], a[104:107], v[240:243]
    v_xor_b32 v13, 0x8000, v13
    v_xor_b32 v14, 0x8000, v14
    v_mfma_f32_16x16x32_bf16 v[248:251], a[48:51], a[108:111], v[248:251]
    v_add_u32 v11, s61, v9
    v_mfma_f32_16x16x32_bf16 v[252:255], a[52:55], a[108:111], v[252:255]
    buffer_load_dwordx4 v15, s[40:43], s67 offen offset:3072 sc1 lds
    v_mfma_f32_16x16x32_bf16 v[244:247], a[52:55], a[104:107], v[244:247]
    v_mfma_f32_16x16x32_bf16 v[236:239], a[52:55], a[100:103], v[236:239]
    v_mfma_f32_16x16x32_bf16 v[228:231], a[52:55], a[96:99], v[228:231]
    v_mfma_f32_16x16x32_bf16 a[0:3], a[56:59], a[96:99], a[0:3]
    v_mfma_f32_16x16x32_bf16 a[8:11], a[56:59], a[100:103], a[8:11]
    s_add_u32 s4, s4, 32768
    s_sub_u32 s5, s5, 1
    s_cmp_eq_u32 s5, 0
    s_cselect_b32 s4, s6, s4
    s_cselect_b32 s5, s7, s5
    s_cselect_b32 s6, s8, s6
    v_mfma_f32_16x16x32_bf16 a[16:19], a[56:59], a[104:107], a[16:19]
    v_mfma_f32_16x16x32_bf16 a[24:27], a[56:59], a[108:111], a[24:27]
    v_mfma_f32_16x16x32_bf16 a[28:31], a[60:63], a[108:111], a[28:31]
    v_mfma_f32_16x16x32_bf16 a[20:23], a[60:63], a[104:107], a[20:23]
    v_mfma_f32_16x16x32_bf16 a[12:15], a[60:63], a[100:103], a[12:15]
    v_mfma_f32_16x16x32_bf16 a[4:7], a[60:63], a[96:99], a[4:7]
    s_waitcnt vmcnt(8) lgkmcnt(0)
    s_barrier
    s_lshl_b32 s65, s21, 14
    s_add_u32 s65, s65, 33554432
    v_add_u32 v1, 114688, v15
    v_mfma_f32_16x16x32_bf16 v[32:35], a[88:91], a[112:115], v[32:35]
    buffer_store_dword v2, v3, s[40:43], s56 offen sc1
    v_mfma_f32_16x16x32_bf16 v[40:43], a[88:91], a[116:119], v[40:43]
    v_lshlrev_b32 v6, 3, v15
    v_and_b32 v6, 1023, v6
    v_mfma_f32_16x16x32_bf16 v[44:47], a[92:95], a[116:119], v[44:47]
    buffer_load_dword v5, v6, s[40:43], s44 offen sc1
    v_mfma_f32_16x16x32_bf16 v[36:39], a[92:95], a[112:115], v[36:39]
    v_mfma_f32_16x16x32_bf16 v[160:163], a[128:131], a[112:115], v[160:163]
    v_mfma_f32_16x16x32_bf16 v[168:171], a[128:131], a[116:119], v[168:171]
    v_mfma_f32_16x16x32_bf16 v[172:175], a[132:135], a[116:119], v[172:175]
    v_mfma_f32_16x16x32_bf16 v[164:167], a[132:135], a[112:115], v[164:167]
    v_mfma_f32_16x16x32_bf16 v[192:195], a[136:139], a[112:115], v[192:195]
    v_cvt_pk_bf16_f32 v32, v32, v33
    v_cvt_pk_bf16_f32 v33, v34, v35
    v_mfma_f32_16x16x32_bf16 v[200:203], a[136:139], a[116:119], v[200:203]
    v_cvt_pk_bf16_f32 v34, v36, v37
    v_cvt_pk_bf16_f32 v35, v38, v39
    s_add_u32 s74, s65, 0
    v_mfma_f32_16x16x32_bf16 v[204:207], a[140:143], a[116:119], v[204:207]
    buffer_store_dwordx4 v[32:35], v15, s[40:43], s74 offen offset:3072 sc1
    v_mfma_f32_16x16x32_bf16 v[196:199], a[140:143], a[112:115], v[196:199]
    v_cvt_pk_bf16_f32 v40, v40, v41
    v_cvt_pk_bf16_f32 v41, v42, v43
    v_mfma_f32_16x16x32_bf16 v[224:227], a[32:35], a[112:115], v[224:227]
    v_cvt_pk_bf16_f32 v42, v44, v45
    v_cvt_pk_bf16_f32 v43, v46, v47
    s_add_u32 s74, s65, 8192
    v_mfma_f32_16x16x32_bf16 v[232:235], a[32:35], a[116:119], v[232:235]
    buffer_store_dwordx4 v[40:43], v15, s[40:43], s74 offen offset:3072 sc1
    v_mfma_f32_16x16x32_bf16 v[236:239], a[36:39], a[116:119], v[236:239]
    v_cvt_pk_bf16_f32 v160, v160, v161
    v_cvt_pk_bf16_f32 v161, v162, v163
    v_mfma_f32_16x16x32_bf16 v[228:231], a[36:39], a[112:115], v[228:231]
    v_cvt_pk_bf16_f32 v162, v164, v165
    v_cvt_pk_bf16_f32 v163, v166, v167
    s_add_u32 s74, s65, 4096
    v_mfma_f32_16x16x32_bf16 a[0:3], a[40:43], a[112:115], a[0:3]
    buffer_store_dwordx4 v[160:163], v15, s[40:43], s74 offen offset:0 sc1
    v_mfma_f32_16x16x32_bf16 a[8:11], a[40:43], a[116:119], a[8:11]
    v_cvt_pk_bf16_f32 v168, v168, v169
    v_cvt_pk_bf16_f32 v169, v170, v171
    v_mfma_f32_16x16x32_bf16 a[12:15], a[44:47], a[116:119], a[12:15]
    v_cvt_pk_bf16_f32 v170, v172, v173
    v_cvt_pk_bf16_f32 v171, v174, v175
    s_add_u32 s74, s65, 12288
    v_mfma_f32_16x16x32_bf16 a[4:7], a[44:47], a[112:115], a[4:7]
    buffer_store_dwordx4 v[168:171], v15, s[40:43], s74 offen offset:0 sc1
    v_mfma_f32_16x16x32_bf16 a[144:147], a[64:67], a[112:115], a[144:147]
    v_cvt_pk_bf16_f32 v192, v192, v193
    v_cvt_pk_bf16_f32 v193, v194, v195
    v_mfma_f32_16x16x32_bf16 a[152:155], a[64:67], a[116:119], a[152:155]
    v_cvt_pk_bf16_f32 v194, v196, v197
    v_cvt_pk_bf16_f32 v195, v198, v199
    s_add_u32 s74, s65, 4096
    v_mfma_f32_16x16x32_bf16 a[156:159], a[68:71], a[116:119], a[156:159]
    buffer_store_dwordx4 v[192:195], v15, s[40:43], s74 offen offset:1024 sc1
    v_mfma_f32_16x16x32_bf16 a[148:151], a[68:71], a[112:115], a[148:151]
    v_cvt_pk_bf16_f32 v200, v200, v201
    v_cvt_pk_bf16_f32 v201, v202, v203
    v_mfma_f32_16x16x32_bf16 a[176:179], a[72:75], a[112:115], a[176:179]
    v_cvt_pk_bf16_f32 v202, v204, v205
    v_cvt_pk_bf16_f32 v203, v206, v207
    s_add_u32 s74, s65, 12288
    v_mfma_f32_16x16x32_bf16 a[184:187], a[72:75], a[116:119], a[184:187]
    buffer_store_dwordx4 v[200:203], v15, s[40:43], s74 offen offset:1024 sc1
    v_mfma_f32_16x16x32_bf16 a[188:191], a[76:79], a[116:119], a[188:191]
    v_cvt_pk_bf16_f32 v224, v224, v225
    v_cvt_pk_bf16_f32 v225, v226, v227
    v_mfma_f32_16x16x32_bf16 a[180:183], a[76:79], a[112:115], a[180:183]
    v_cvt_pk_bf16_f32 v226, v228, v229
    v_cvt_pk_bf16_f32 v227, v230, v231
    s_add_u32 s74, s65, 4096
    v_mfma_f32_16x16x32_bf16 a[208:211], a[80:83], a[112:115], a[208:211]
    buffer_store_dwordx4 v[224:227], v15, s[40:43], s74 offen offset:2048 sc1
    v_mfma_f32_16x16x32_bf16 a[216:219], a[80:83], a[116:119], a[216:219]
    v_cvt_pk_bf16_f32 v232, v232, v233
    v_cvt_pk_bf16_f32 v233, v234, v235
    v_mfma_f32_16x16x32_bf16 a[220:223], a[84:87], a[116:119], a[220:223]
    v_cvt_pk_bf16_f32 v234, v236, v237
    v_cvt_pk_bf16_f32 v235, v238, v239
    s_add_u32 s74, s65, 12288
    v_mfma_f32_16x16x32_bf16 a[212:215], a[84:87], a[112:115], a[212:215]
    buffer_store_dwordx4 v[232:235], v15, s[40:43], s74 offen offset:2048 sc1
    v_mfma_f32_16x16x32_bf16 a[240:243], a[88:91], a[120:123], a[240:243]
    v_accvgpr_read_b32 v16, a0
    v_accvgpr_read_b32 v17, a1
    v_mfma_f32_16x16x32_bf16 a[248:251], a[88:91], a[124:127], a[248:251]
    v_accvgpr_read_b32 v18, a2
    v_accvgpr_read_b32 v19, a3
    v_mfma_f32_16x16x32_bf16 a[252:255], a[92:95], a[124:127], a[252:255]
    v_accvgpr_read_b32 v20, a4
    v_accvgpr_read_b32 v21, a5
    v_mfma_f32_16x16x32_bf16 a[244:247], a[92:95], a[120:123], a[244:247]
    v_accvgpr_read_b32 v22, a6
    v_accvgpr_read_b32 v23, a7
    v_mfma_f32_16x16x32_bf16 v[176:179], a[128:131], a[120:123], v[176:179]
    v_cvt_pk_bf16_f32 v128, v16, v17
    v_cvt_pk_bf16_f32 v129, v18, v19
    v_mfma_f32_16x16x32_bf16 v[184:187], a[128:131], a[124:127], v[184:187]
    v_cvt_pk_bf16_f32 v130, v20, v21
    v_cvt_pk_bf16_f32 v131, v22, v23
    s_add_u32 s74, s65, 4096
    v_mfma_f32_16x16x32_bf16 v[188:191], a[132:135], a[124:127], v[188:191]
    buffer_store_dwordx4 v[128:131], v15, s[40:43], s74 offen offset:3072 sc1
    v_mfma_f32_16x16x32_bf16 v[180:183], a[132:135], a[120:123], v[180:183]
    v_accvgpr_read_b32 v16, a8
    v_accvgpr_read_b32 v17, a9
    v_mfma_f32_16x16x32_bf16 v[208:211], a[136:139], a[120:123], v[208:211]
    v_accvgpr_read_b32 v18, a10
    v_accvgpr_read_b32 v19, a11
    v_mfma_f32_16x16x32_bf16 v[216:219], a[136:139], a[124:127], v[216:219]
    v_accvgpr_read_b32 v20, a12
    v_accvgpr_read_b32 v21, a13
    v_mfma_f32_16x16x32_bf16 v[220:223], a[140:143], a[124:127], v[220:223]
    v_accvgpr_read_b32 v22, a14
    v_accvgpr_read_b32 v23, a15
    v_mfma_f32_16x16x32_bf16 v[212:215], a[140:143], a[120:123], v[212:215]
    v_cvt_pk_bf16_f32 v132, v16, v17
    v_cvt_pk_bf16_f32 v133, v18, v19
    v_mfma_f32_16x16x32_bf16 v[240:243], a[32:35], a[120:123], v[240:243]
    v_cvt_pk_bf16_f32 v134, v20, v21
    v_cvt_pk_bf16_f32 v135, v22, v23
    s_add_u32 s74, s65, 12288
    v_mfma_f32_16x16x32_bf16 v[248:251], a[32:35], a[124:127], v[248:251]
    buffer_store_dwordx4 v[132:135], v15, s[40:43], s74 offen offset:3072 sc1
    v_mfma_f32_16x16x32_bf16 v[252:255], a[36:39], a[124:127], v[252:255]
    v_accvgpr_read_b32 v16, a144
    v_accvgpr_read_b32 v17, a145
    v_mfma_f32_16x16x32_bf16 v[244:247], a[36:39], a[120:123], v[244:247]
    v_accvgpr_read_b32 v18, a146
    v_accvgpr_read_b32 v19, a147
    v_mfma_f32_16x16x32_bf16 a[16:19], a[40:43], a[120:123], a[16:19]
    v_accvgpr_read_b32 v20, a148
    v_accvgpr_read_b32 v21, a149
    v_mfma_f32_16x16x32_bf16 a[24:27], a[40:43], a[124:127], a[24:27]
    v_accvgpr_read_b32 v22, a150
    v_accvgpr_read_b32 v23, a151
    v_mfma_f32_16x16x32_bf16 a[28:31], a[44:47], a[124:127], a[28:31]
    v_cvt_pk_bf16_f32 v136, v16, v17
    v_cvt_pk_bf16_f32 v137, v18, v19
    v_mfma_f32_16x16x32_bf16 a[20:23], a[44:47], a[120:123], a[20:23]
    v_cvt_pk_bf16_f32 v138, v20, v21
    v_cvt_pk_bf16_f32 v139, v22, v23
    s_add_u32 s74, s65, 0
    v_mfma_f32_16x16x32_bf16 a[160:163], a[64:67], a[120:123], a[160:163]
    buffer_store_dwordx4 v[136:139], v15, s[40:43], s74 offen offset:0 sc1
    v_mfma_f32_16x16x32_bf16 a[168:171], a[64:67], a[124:127], a[168:171]
    v_accvgpr_read_b32 v16, a152
    v_accvgpr_read_b32 v17, a153
    v_mfma_f32_16x16x32_bf16 a[172:175], a[68:71], a[124:127], a[172:175]
    v_accvgpr_read_b32 v18, a154
    v_accvgpr_read_b32 v19, a155
    v_mfma_f32_16x16x32_bf16 a[164:167], a[68:71], a[120:123], a[164:167]
    v_accvgpr_read_b32 v20, a156
    v_accvgpr_read_b32 v21, a157
    v_mfma_f32_16x16x32_bf16 a[192:195], a[72:75], a[120:123], a[192:195]
    v_accvgpr_read_b32 v22, a158
    v_accvgpr_read_b32 v23, a159
    v_mfma_f32_16x16x32_bf16 a[200:203], a[72:75], a[124:127], a[200:203]
    v_cvt_pk_bf16_f32 v140, v16, v17
    v_cvt_pk_bf16_f32 v141, v18, v19
    v_mfma_f32_16x16x32_bf16 a[204:207], a[76:79], a[124:127], a[204:207]
    v_cvt_pk_bf16_f32 v142, v20, v21
    v_cvt_pk_bf16_f32 v143, v22, v23
    s_add_u32 s74, s65, 8192
    v_mfma_f32_16x16x32_bf16 a[196:199], a[76:79], a[120:123], a[196:199]
    buffer_store_dwordx4 v[140:143], v15, s[40:43], s74 offen offset:0 sc1
    v_mfma_f32_16x16x32_bf16 a[224:227], a[80:83], a[120:123], a[224:227]
    v_accvgpr_read_b32 v16, a176
    v_accvgpr_read_b32 v17, a177
    v_mfma_f32_16x16x32_bf16 a[232:235], a[80:83], a[124:127], a[232:235]
    v_accvgpr_read_b32 v18, a178
    v_accvgpr_read_b32 v19, a179
    v_mfma_f32_16x16x32_bf16 a[236:239], a[84:87], a[124:127], a[236:239]
    v_accvgpr_read_b32 v20, a180
    v_accvgpr_read_b32 v21, a181
    v_mfma_f32_16x16x32_bf16 a[228:231], a[84:87], a[120:123], a[228:231]
    v_accvgpr_read_b32 v22, a182
    v_accvgpr_read_b32 v23, a183
    v_cvt_pk_bf16_f32 v144, v16, v17
    v_cvt_pk_bf16_f32 v145, v18, v19
    v_cvt_pk_bf16_f32 v146, v20, v21
    v_cvt_pk_bf16_f32 v147, v22, v23
    s_add_u32 s74, s65, 0
    buffer_store_dwordx4 v[144:147], v15, s[40:43], s74 offen offset:1024 sc1
    v_accvgpr_read_b32 v16, a184
    v_accvgpr_read_b32 v17, a185
    v_accvgpr_read_b32 v18, a186
    v_accvgpr_read_b32 v19, a187
    v_accvgpr_read_b32 v20, a188
    v_accvgpr_read_b32 v21, a189
    v_accvgpr_read_b32 v22, a190
    v_accvgpr_read_b32 v23, a191
    v_cvt_pk_bf16_f32 v148, v16, v17
    v_cvt_pk_bf16_f32 v149, v18, v19
    v_cvt_pk_bf16_f32 v150, v20, v21
    v_cvt_pk_bf16_f32 v151, v22, v23
    s_add_u32 s74, s65, 8192
    buffer_store_dwordx4 v[148:151], v15, s[40:43], s74 offen offset:1024 sc1
    v_accvgpr_read_b32 v16, a208
    v_accvgpr_read_b32 v17, a209
    v_accvgpr_read_b32 v18, a210
    v_accvgpr_read_b32 v19, a211
    v_accvgpr_read_b32 v20, a212
    v_accvgpr_read_b32 v21, a213
    v_accvgpr_read_b32 v22, a214
    v_accvgpr_read_b32 v23, a215
    v_cvt_pk_bf16_f32 v152, v16, v17
    v_cvt_pk_bf16_f32 v153, v18, v19
    v_cvt_pk_bf16_f32 v154, v20, v21
    v_cvt_pk_bf16_f32 v155, v22, v23
    s_add_u32 s74, s65, 0
    buffer_store_dwordx4 v[152:155], v15, s[40:43], s74 offen offset:2048 sc1
    v_accvgpr_read_b32 v16, a216
    v_accvgpr_read_b32 v17, a217
    v_accvgpr_read_b32 v18, a218
    v_accvgpr_read_b32 v19, a219
    v_accvgpr_read_b32 v20, a220
    v_accvgpr_read_b32 v21, a221
    v_accvgpr_read_b32 v22, a222
    v_accvgpr_read_b32 v23, a223
    v_cvt_pk_bf16_f32 v156, v16, v17
    v_cvt_pk_bf16_f32 v157, v18, v19
    v_cvt_pk_bf16_f32 v158, v20, v21
    v_cvt_pk_bf16_f32 v159, v22, v23
    s_add_u32 s74, s65, 8192
    buffer_store_dwordx4 v[156:159], v15, s[40:43], s74 offen offset:2048 sc1
    ds_read_b128 a[64:67], v1 offset:16384
    ds_read_b128 a[68:71], v1 offset:17408
    ds_read_b128 a[72:75], v1 offset:18432
    ds_read_b128 a[76:79], v1 offset:19456
    ds_read_b128 a[80:83], v1 offset:20480
    ds_read_b128 a[84:87], v1 offset:21504
    ds_read_b128 a[88:91], v1 offset:22528
    ds_read_b128 a[92:95], v1 offset:23552
    ds_read_b128 a[96:99], v1 offset:24576
    ds_read_b128 a[100:103], v1 offset:25600
    ds_read_b128 a[104:107], v1 offset:26624
    ds_read_b128 a[108:111], v1 offset:27648
    ds_read_b128 a[112:115], v1 offset:28672
    ds_read_b128 a[116:119], v1 offset:29696
    ds_read_b128 a[120:123], v1 offset:30720
    ds_read_b128 a[124:127], v1 offset:31744
    v_accvgpr_read_b32 v16, a240
    v_accvgpr_read_b32 v17, a241
    v_accvgpr_read_b32 v18, a242
    v_accvgpr_read_b32 v19, a243
    v_accvgpr_read_b32 v20, a244
    v_accvgpr_read_b32 v21, a245
    v_accvgpr_read_b32 v22, a246
    v_accvgpr_read_b32 v23, a247
    v_cvt_pk_bf16_f32 v76, v16, v17
    v_cvt_pk_bf16_f32 v77, v18, v19
    v_cvt_pk_bf16_f32 v78, v20, v21
    v_cvt_pk_bf16_f32 v79, v22, v23
    v_accvgpr_read_b32 v16, a248
    v_accvgpr_read_b32 v17, a249
    v_accvgpr_read_b32 v18, a250
    v_accvgpr_read_b32 v19, a251
    v_accvgpr_read_b32 v20, a252
    v_accvgpr_read_b32 v21, a253
    v_accvgpr_read_b32 v22, a254
    s_add_u32 s10, s20, 98304
    v_accvgpr_read_b32 v23, a255
    s_mov_b32 m0, s10
    v_cvt_pk_bf16_f32 v108, v16, v17
    buffer_load_dwordx4 v15, s[40:43], s4 offen offset:0 sc1 lds
    v_cvt_pk_bf16_f32 v109, v18, v19
    v_cvt_pk_bf16_f32 v110, v20, v21
    v_cvt_pk_bf16_f32 v111, v22, v23
    v_cvt_pk_bf16_f32 v80, v176, v177
    v_cvt_pk_bf16_f32 v81, v178, v179
    v_cvt_pk_bf16_f32 v82, v180, v181
    v_cvt_pk_bf16_f32 v83, v182, v183
    v_cvt_pk_bf16_f32 v112, v184, v185
    v_cvt_pk_bf16_f32 v113, v186, v187
    v_cvt_pk_bf16_f32 v114, v188, v189
    v_cvt_pk_bf16_f32 v115, v190, v191
    v_cvt_pk_bf16_f32 v84, v208, v209
    v_cvt_pk_bf16_f32 v85, v210, v211
    v_cvt_pk_bf16_f32 v86, v212, v213
    v_cvt_pk_bf16_f32 v87, v214, v215
    v_cvt_pk_bf16_f32 v116, v216, v217
    v_cvt_pk_bf16_f32 v117, v218, v219
    v_cvt_pk_bf16_f32 v118, v220, v221
    v_cvt_pk_bf16_f32 v119, v222, v223
    v_cvt_pk_bf16_f32 v88, v240, v241
    buffer_load_dwordx4 v15, s[40:43], s4 offen offset:1024 sc1 lds
    v_cvt_pk_bf16_f32 v89, v242, v243
    v_cvt_pk_bf16_f32 v90, v244, v245
    v_cvt_pk_bf16_f32 v91, v246, v247
    v_cvt_pk_bf16_f32 v120, v248, v249
    v_cvt_pk_bf16_f32 v121, v250, v251
    v_cvt_pk_bf16_f32 v122, v252, v253
    v_cvt_pk_bf16_f32 v123, v254, v255
    v_accvgpr_read_b32 v16, a16
    v_accvgpr_read_b32 v17, a17
    v_accvgpr_read_b32 v18, a18
    v_accvgpr_read_b32 v19, a19
    v_accvgpr_read_b32 v20, a20
    v_accvgpr_read_b32 v21, a21
    v_accvgpr_read_b32 v22, a22
    v_accvgpr_read_b32 v23, a23
    v_cvt_pk_bf16_f32 v92, v16, v17
    v_cvt_pk_bf16_f32 v93, v18, v19
    v_cvt_pk_bf16_f32 v94, v20, v21
    v_cvt_pk_bf16_f32 v95, v22, v23
    v_accvgpr_read_b32 v16, a24
    buffer_load_dwordx4 v15, s[40:43], s4 offen offset:2048 sc1 lds
    v_accvgpr_read_b32 v17, a25
    v_accvgpr_read_b32 v18, a26
    v_accvgpr_read_b32 v19, a27
    v_accvgpr_read_b32 v20, a28
    v_accvgpr_read_b32 v21, a29
    v_accvgpr_read_b32 v22, a30
    v_accvgpr_read_b32 v23, a31
    v_cvt_pk_bf16_f32 v124, v16, v17
    v_cvt_pk_bf16_f32 v125, v18, v19
    v_cvt_pk_bf16_f32 v126, v20, v21
    v_cvt_pk_bf16_f32 v127, v22, v23
    v_accvgpr_read_b32 v16, a160
    v_accvgpr_read_b32 v17, a161
    v_accvgpr_read_b32 v18, a162
    v_accvgpr_read_b32 v19, a163
    v_accvgpr_read_b32 v20, a164
    v_accvgpr_read_b32 v21, a165
    v_accvgpr_read_b32 v22, a166
    v_accvgpr_read_b32 v23, a167
    v_cvt_pk_bf16_f32 v64, v16, v17
    buffer_load_dwordx4 v15, s[40:43], s4 offen offset:3072 sc1 lds
    v_cvt_pk_bf16_f32 v65, v18, v19
    v_cvt_pk_bf16_f32 v66, v20, v21
    v_cvt_pk_bf16_f32 v67, v22, v23
    v_accvgpr_read_b32 v16, a168
    v_accvgpr_read_b32 v17, a169
    v_accvgpr_read_b32 v18, a170
    v_accvgpr_read_b32 v19, a171
    v_accvgpr_read_b32 v20, a172
    v_accvgpr_read_b32 v21, a173
    v_accvgpr_read_b32 v22, a174
    v_accvgpr_read_b32 v23, a175
    v_cvt_pk_bf16_f32 v96, v16, v17
    v_cvt_pk_bf16_f32 v97, v18, v19
    v_cvt_pk_bf16_f32 v98, v20, v21
    v_cvt_pk_bf16_f32 v99, v22, v23
    v_accvgpr_read_b32 v16, a192
    v_accvgpr_read_b32 v17, a193
    v_accvgpr_read_b32 v18, a194
    s_add_u32 s67, s4, 4096
    v_accvgpr_read_b32 v19, a195
    s_add_u32 m0, s10, 4096
    v_accvgpr_read_b32 v20, a196
    buffer_load_dwordx4 v15, s[40:43], s67 offen offset:0 sc1 lds
    v_accvgpr_read_b32 v21, a197
    v_accvgpr_read_b32 v22, a198
    v_accvgpr_read_b32 v23, a199
    v_cvt_pk_bf16_f32 v68, v16, v17
    v_cvt_pk_bf16_f32 v69, v18, v19
    v_cvt_pk_bf16_f32 v70, v20, v21
    v_cvt_pk_bf16_f32 v71, v22, v23
    v_accvgpr_read_b32 v16, a200
    v_accvgpr_read_b32 v17, a201
    v_accvgpr_read_b32 v18, a202
    v_accvgpr_read_b32 v19, a203
    v_accvgpr_read_b32 v20, a204
    v_accvgpr_read_b32 v21, a205
    v_accvgpr_read_b32 v22, a206
    v_accvgpr_read_b32 v23, a207
    v_cvt_pk_bf16_f32 v100, v16, v17
    v_cvt_pk_bf16_f32 v101, v18, v19
    v_cvt_pk_bf16_f32 v102, v20, v21
    v_cvt_pk_bf16_f32 v103, v22, v23
    v_accvgpr_read_b32 v16, a224
    buffer_load_dwordx4 v15, s[40:43], s67 offen offset:1024 sc1 lds
    v_accvgpr_read_b32 v17, a225
    v_accvgpr_read_b32 v18, a226
    v_accvgpr_read_b32 v19, a227
    v_accvgpr_read_b32 v20, a228
    v_accvgpr_read_b32 v21, a229
    v_accvgpr_read_b32 v22, a230
    v_accvgpr_read_b32 v23, a231
    v_cvt_pk_bf16_f32 v72, v16, v17
    v_cvt_pk_bf16_f32 v73, v18, v19
    v_cvt_pk_bf16_f32 v74, v20, v21
    v_cvt_pk_bf16_f32 v75, v22, v23
    v_accvgpr_read_b32 v16, a232
    v_accvgpr_read_b32 v17, a233
    v_accvgpr_read_b32 v18, a234
    v_accvgpr_read_b32 v19, a235
    v_accvgpr_read_b32 v20, a236
    v_accvgpr_read_b32 v21, a237
    v_accvgpr_read_b32 v22, a238
    v_accvgpr_read_b32 v23, a239
    v_cvt_pk_bf16_f32 v104, v16, v17
    buffer_load_dwordx4 v15, s[40:43], s67 offen offset:2048 sc1 lds
    v_cvt_pk_bf16_f32 v105, v18, v19
    v_cvt_pk_bf16_f32 v106, v20, v21
    v_cvt_pk_bf16_f32 v107, v22, v23
    v_accvgpr_write_b32 a0, v136
    v_accvgpr_write_b32 a1, v137
    v_accvgpr_write_b32 a2, v138
    v_accvgpr_write_b32 a3, v139
    v_accvgpr_write_b32 a32, v140
    v_accvgpr_write_b32 a33, v141
    v_accvgpr_write_b32 a34, v142
    v_accvgpr_write_b32 a35, v143
    v_accvgpr_write_b32 a4, v144
    v_accvgpr_write_b32 a5, v145
    v_accvgpr_write_b32 a6, v146
    v_accvgpr_write_b32 a7, v147
    v_accvgpr_write_b32 a36, v148
    v_accvgpr_write_b32 a37, v149
    v_accvgpr_write_b32 a38, v150
    v_accvgpr_write_b32 a39, v151
    v_accvgpr_write_b32 a8, v152
    buffer_load_dwordx4 v15, s[40:43], s67 offen offset:3072 sc1 lds
    v_accvgpr_write_b32 a9, v153
    v_accvgpr_write_b32 a10, v154
    v_accvgpr_write_b32 a11, v155
    v_accvgpr_write_b32 a40, v156
    v_accvgpr_write_b32 a41, v157
    v_accvgpr_write_b32 a42, v158
    v_accvgpr_write_b32 a43, v159
    v_accvgpr_write_b32 a12, v32
    v_accvgpr_write_b32 a13, v33
    v_accvgpr_write_b32 a14, v34
    v_accvgpr_write_b32 a15, v35
    v_accvgpr_write_b32 a44, v40
    v_accvgpr_write_b32 a45, v41
    v_accvgpr_write_b32 a46, v42
    v_accvgpr_write_b32 a47, v43
    v_accvgpr_write_b32 a16, v160
    v_accvgpr_write_b32 a17, v161
    v_accvgpr_write_b32 a18, v162
    s_add_u32 s4, s4, 32768
    v_accvgpr_write_b32 a19, v163
    s_sub_u32 s5, s5, 1
    v_accvgpr_write_b32 a48, v168
    s_cmp_eq_u32 s5, 0
    s_cselect_b32 s4, s6, s4
    s_cselect_b32 s5, s7, s5
    s_cselect_b32 s6, s8, s6
    v_accvgpr_write_b32 a49, v169
    s_mov_b32 s10, s20
    v_accvgpr_write_b32 a50, v170
    s_mov_b32 s9, 32768
    v_accvgpr_write_b32 a51, v171
    v_accvgpr_write_b32 a20, v192
    v_accvgpr_write_b32 a21, v193
    v_accvgpr_write_b32 a22, v194
    v_accvgpr_write_b32 a23, v195
    v_accvgpr_write_b32 a52, v200
    v_accvgpr_write_b32 a53, v201
    v_accvgpr_write_b32 a54, v202
    v_accvgpr_write_b32 a55, v203
    v_accvgpr_write_b32 a24, v224
    v_accvgpr_write_b32 a25, v225
    v_accvgpr_write_b32 a26, v226
    v_accvgpr_write_b32 a27, v227
    v_accvgpr_write_b32 a56, v232
    v_accvgpr_write_b32 a57, v233
    v_accvgpr_write_b32 a58, v234
    v_accvgpr_write_b32 a59, v235
    v_accvgpr_write_b32 a28, v128
    v_accvgpr_write_b32 a29, v129
    v_accvgpr_write_b32 a30, v130
    v_accvgpr_write_b32 a31, v131
    v_accvgpr_write_b32 a60, v132
    v_accvgpr_write_b32 a61, v133
    v_accvgpr_write_b32 a62, v134
    v_accvgpr_write_b32 a63, v135
    s_waitcnt vmcnt(24)
    v_cmp_gt_u32 vcc, 1, v5
    s_nop 0
    s_cmp_lg_u64 vcc, 0
    s_cbranch_scc1 F_spin3
F_spin3r:
    v_lshrrev_b32 v2, 2, v15
    v_bfe_u32 v3, v15, 2, 7
    v_mov_b32 v4, 0xff800000
    v_and_b32 v8, 0x30, v15
    v_cmp_eq_u32 vcc, 0, v8
    v_mov_b32 v9, 0x3f803f80
    s_nop 0
    v_cndmask_b32 v8, 0, v9, vcc
    v_mov_b32 v9, v8
    v_mov_b32 v10, v8
    v_mov_b32 v11, v8
    v_bfe_u32 v12, v15, 4, 4
    v_lshrrev_b32 v13, 8, v15
    v_lshlrev_b32 v13, 2, v13
    v_cmp_gt_u32 s[88:89], v13, v12
    v_add_u32 v13, 1, v13
    v_cmp_gt_u32 s[90:91], v13, v12
    v_add_u32 v13, 1, v13
    v_cmp_gt_u32 s[92:93], v13, v12
    v_add_u32 v13, 1, v13
    v_cmp_gt_u32 s[94:95], v13, v12
    v_add_u32 v13, 1, v13
    s_mov_b32 s52, 49152
    s_mov_b32 s49, 32768
    s_mov_b32 s48, 0
    s_add_u32 s51, s28, 1
    s_mul_i32 s53, s29, s11
    s_add_u32 s53, s53, s51
    s_add_u32 s53, s53, 1
    s_mov_b32 s13, 2
    s_mov_b32 s98, 1
    v_lshlrev_b32 v6, 3, v15
    v_and_b32 v6, 2047, v6
    s_sub_u32 s16, 3, s29
    s_mul_i32 s16, s16, s11
    s_sub_u32 s64, s97, s16
    s_mov_b32 s77, s64
    s_cmp_eq_u32 s17, 0
    s_cselect_b32 s44, s45, s8
    s_waitcnt vmcnt(8)
    buffer_store_dword v4, v3, s[40:43], s76 offen sc1
    s_branch F_att
F_spin1:
    s_mov_b32 s99, 0x200000
F_spin1a:
    s_sleep 4
    buffer_load_dword v1, v4, s[88:91], 0 offen sc1
    s_waitcnt vmcnt(0)
    s_sub_u32 s99, s99, 1
    s_cbranch_scc1 F_spin1r
    v_cmp_gt_u32 vcc, 16843009, v1
    s_nop 0
    s_cmp_lg_u64 vcc, 0
    s_cbranch_scc1 F_spin1a
    s_branch F_spin1r
F_spin2:
    s_mov_b32 s99, 0x200000
F_spin2a:
    s_sleep 4
    buffer_load_dword v16, v4, s[40:43], s75 offen sc1
    s_waitcnt vmcnt(0)
    s_sub_u32 s99, s99, 1
    s_cbranch_scc1 F_spin2r
    v_cmp_gt_u32 vcc, 1, v16
    s_nop 0
    s_cmp_lg_u64 vcc, 0
    s_cbranch_scc1 F_spin2a
    s_branch F_spin2r
F_spin3:
    s_mov_b32 s99, 0x200000
F_spin3a:
    s_sleep 4
    buffer_load_dword v5, v6, s[40:43], s44 offen sc1
    s_waitcnt vmcnt(0)
    s_sub_u32 s99, s99, 1
    s_cbranch_scc1 F_spin3r
    v_cmp_gt_u32 vcc, 1, v5
    s_nop 0
    s_cmp_lg_u64 vcc, 0
    s_cbranch_scc1 F_spin3a
    s_branch F_spin3r
F_kb:
    s_and_b32 s14, s2, 1
    s_lshl_b32 s14, s14, 3
    s_add_u32 s14, s14, s27
    s_and_b32 s15, s2, 6
    s_lshr_b32 s66, s2, 7
    s_add_u32 s15, s15, s66
    s_mul_i32 s58, s15, 229376
    s_mul_i32 s59, s14, 56
    s_mov_b32 s68, 0x3db8aa3b
    s_mov_b32 s69, s68
    s_lshl_b32 s65, s26, 21
    s_lshl_b32 s66, s27, 15
    s_add_u32 s65, s65, s66
    s_lshr_b32 s66, s29, 1
    s_lshl_b32 s66, s66, 20
    s_add_u32 s65, s65, s66
    s_and_b32 s66, s29, 1
    s_lshl_b32 s66, s66, 12
    s_add_u32 s65, s65, s66
    v_lshrrev_b32 v20, 2, v30
    v_mul_u32_u24 v20, 2688, v20
    s_mul_i32 s66, s29, 896
    s_cmp_eq_u32 s29, 3
    s_cselect_b32 s66, 1073741824, s66
    v_add_u32 v20, s66, v20
    v_lshrrev_b32 v21, 5, v30
    v_lshlrev_b32 v21, 1, v21
    v_and_b32 v22, 3, v30
    v_xor_b32 v21, v21, v22
    v_lshl_add_u32 v28, v21, 4, v20
    v_add_u32 v29, 41984, v28
    s_lshr_b32 s66, s2, 7
    s_lshl_b32 s66, s66, 6
    s_and_b32 s67, s2, 63
    s_add_u32 s66, s66, s67
    s_lshl_b32 s66, s66, 2
    s_add_u32 s66, s66, s29
    s_mul_i32 s76, s66, 3584
    s_mul_i32 s77, s66, 2432
    s_mov_b32 s78, s3
    v_bfe_u32 v20, v30, 1, 3
    v_lshrrev_b32 v21, 4, v30
    v_lshlrev_b32 v21, 2, v21
    v_sub_u32 v20, v20, v21
    v_and_b32 v21, 1, v30
    v_lshlrev_b32 v21, 4, v21
    v_mov_b32 v22, 0x3f80
    v_lshlrev_b32 v21, v21, v22
    v_cmp_eq_i32 vcc, 0, v20
    s_nop 1
    v_cndmask_b32 v22, 0, v21, vcc
    v_accvgpr_write_b32 a240, v22
    v_cmp_eq_i32 vcc, 1, v20
    s_nop 1
    v_cndmask_b32 v22, 0, v21, vcc
    v_accvgpr_write_b32 a241, v22
    v_cmp_eq_i32 vcc, 2, v20
    s_nop 1
    v_cndmask_b32 v22, 0, v21, vcc
    v_accvgpr_write_b32 a242, v22
    v_cmp_eq_i32 vcc, 3, v20
    s_nop 1
    v_cndmask_b32 v22, 0, v21, vcc
    v_accvgpr_write_b32 a243, v22
    v_cmp_eq_i32 vcc, -8, v20
    s_nop 1
    v_cndmask_b32 v22, 0, v21, vcc
    v_accvgpr_write_b32 a244, v22
    v_cmp_eq_i32 vcc, -7, v20
    s_nop 1
    v_cndmask_b32 v22, 0, v21, vcc
    v_accvgpr_write_b32 a245, v22
    v_cmp_eq_i32 vcc, -6, v20
    s_nop 1
    v_cndmask_b32 v22, 0, v21, vcc
    v_accvgpr_write_b32 a246, v22
    v_cmp_eq_i32 vcc, -5, v20
    s_nop 1
    v_cndmask_b32 v22, 0, v21, vcc
    v_accvgpr_write_b32 a247, v22
    s_nop 1
    v_min_u32 v16, 2, v30
    v_lshlrev_b32 v16, 7, v16
    v_min_u32 v18, 1, v30
    v_lshlrev_b32 v18, 7, v18
    v_min_u32 v19, 2, v30
    v_mul_u32_u24 v19, 896, v19
    s_lshr_b32 s66, s2, 7
    s_lshl_b32 s66, s66, 3
    s_add_u32 s66, s66, s27
    s_lshl_b32 s66, s66, 2
    s_add_u32 s66, s66, s29
    s_lshl_b32 s66, s66, 9
    s_add_u32 s66, s66, F_kloop_x-F_pc
    v_min_u32 v20, 3, v30
    v_lshlrev_b32 v20, 7, v20
    v_add_u32 v20, s66, v20
    v_lshlrev_b32 v21, 8, v30
    v_mov_b32 v22, 1
    s_lshl_b32 s75, s29, 8
    s_add_u32 s75, s75, s2
    s_add_u32 s98, s27, 5
    s_add_u32 s66, s56, 2097152
    s_add_u32 m0, s60, 16384
    s_nop 0
    buffer_load_dwordx4 v1, s[32:35], s66 offen offset:0 lds
    buffer_load_dwordx4 v2, s[32:35], s66 offen offset:1024 lds
    buffer_load_dwordx4 v3, s[32:35], s66 offen offset:2048 lds
    buffer_load_dwordx4 v4, s[32:35], s66 offen offset:3072 lds
    s_add_u32 s56, s56, 128
    s_add_u32 m0, s63, 16384
    s_nop 0
    buffer_load_dwordx4 v5, s[36:39], s57 offen offset:0 lds
    buffer_load_dwordx4 v6, s[36:39], s57 offen offset:1024 lds
    buffer_load_dwordx4 v7, s[36:39], s57 offen offset:2048 lds
    buffer_load_dwordx4 v8, s[36:39], s57 offen offset:3072 lds
    s_add_u32 s57, s57, 262144
    s_add_u32 m0, s63, 32768
    s_nop 0
    buffer_load_dwordx4 v5, s[36:39], s57 offen offset:0 lds
    buffer_load_dwordx4 v6, s[36:39], s57 offen offset:1024 lds
    buffer_load_dwordx4 v7, s[36:39], s57 offen offset:2048 lds
    buffer_load_dwordx4 v8, s[36:39], s57 offen offset:3072 lds
    s_add_u32 s57, s57, 262144
    s_add_u32 s66, s56, 0
    s_add_u32 m0, s61, 0
    s_nop 0
    buffer_load_dwordx4 v1, s[32:35], s66 offen offset:0 lds
    buffer_load_dwordx4 v2, s[32:35], s66 offen offset:1024 lds
    buffer_load_dwordx4 v3, s[32:35], s66 offen offset:2048 lds
    buffer_load_dwordx4 v4, s[32:35], s66 offen offset:3072 lds
    s_lshl_b32 s66, s2, 2
    s_add_u32 s66, s66, s29
    s_lshl_b32 s66, s66, 12
    v_lshlrev_b32 v23, 2, v15
    v_and_b32 v23, 2559, v23
    buffer_load_dword a248, v23, s[32:35], s66 offen
    s_lshl_b32 s67, s27, 2
    s_add_u32 s67, s67, s29
    s_mul_i32 s67, s67, 32768
    s_lshl_b32 s99, s26, 9
    s_add_u32 s67, s67, s99
    s_add_u32 s67, s67, 786432
    v_lshrrev_b32 v23, 2, v30
    v_min_u32 v23, 3, v23
    v_lshlrev_b32 v23, 6, v23
    v_and_or_b32 v23, v30, 3, v23
    v_lshlrev_b32 v23, 7, v23
    buffer_load_dword a249, v23, s[36:39], s67 offen
    s_waitcnt vmcnt(10)
    s_barrier
    ds_read_b128 a[96:99], v11 offset:0
    ds_read_b64_tr_b16 a[32:33], v13 offset:0
    ds_read_b64_tr_b16 a[34:35], v13 offset:1024
    ds_read_b128 a[100:103], v12 offset:0
    ds_read_b64_tr_b16 a[36:37], v14 offset:0
    ds_read_b64_tr_b16 a[38:39], v14 offset:1024
    ds_read_b128 a[104:107], v11 offset:2048
    ds_read_b64_tr_b16 a[40:41], v13 offset:256
    ds_read_b64_tr_b16 a[42:43], v13 offset:1280
    ds_read_b128 a[108:111], v12 offset:2048
    ds_read_b64_tr_b16 a[44:45], v14 offset:256
    ds_read_b64_tr_b16 a[46:47], v14 offset:1280
    ds_read_b128 a[112:115], v11 offset:4096
    ds_read_b64_tr_b16 a[48:49], v13 offset:512
    ds_read_b64_tr_b16 a[50:51], v13 offset:1536
    ds_read_b128 a[116:119], v12 offset:4096
    ds_read_b64_tr_b16 a[52:53], v14 offset:512
    ds_read_b64_tr_b16 a[54:55], v14 offset:1536
    ds_read_b128 a[120:123], v11 offset:6144
    ds_read_b64_tr_b16 a[56:57], v13 offset:768
    ds_read_b64_tr_b16 a[58:59], v13 offset:1792
    ds_read_b128 a[124:127], v12 offset:6144
    ds_read_b64_tr_b16 a[60:61], v14 offset:768
    ds_read_b64_tr_b16 a[62:63], v14 offset:1792
    ds_read_b64_tr_b16 a[64:65], v13 offset:16384
    ds_read_b64_tr_b16 a[66:67], v13 offset:17408
    ds_read_b64_tr_b16 a[68:69], v14 offset:16384
    ds_read_b64_tr_b16 a[70:71], v14 offset:17408
    ds_read_b64_tr_b16 a[72:73], v13 offset:16640
    ds_read_b64_tr_b16 a[74:75], v13 offset:17664
    ds_read_b64_tr_b16 a[76:77], v14 offset:16640
    ds_read_b64_tr_b16 a[78:79], v14 offset:17664
    ds_read_b64_tr_b16 a[80:81], v13 offset:16896
    ds_read_b64_tr_b16 a[82:83], v13 offset:17920
    ds_read_b64_tr_b16 a[84:85], v14 offset:16896
    ds_read_b64_tr_b16 a[86:87], v14 offset:17920
    ds_read_b64_tr_b16 a[88:89], v13 offset:17152
    ds_read_b64_tr_b16 a[90:91], v13 offset:18176
    ds_read_b64_tr_b16 a[92:93], v14 offset:17152
    ds_read_b64_tr_b16 a[94:95], v14 offset:18176
    s_waitcnt vmcnt(6) lgkmcnt(0)
    s_barrier
    v_mfma_f32_16x16x32_bf16 v[32:35], a[32:35], a[96:99], 0
    s_add_u32 s66, s56, 2097152
    ds_read_b128 a[128:131], v11 offset:8192
    s_add_u32 m0, s61, 16384
    v_mfma_f32_16x16x32_bf16 v[32:35], a[64:67], a[100:103], v[32:35]
    buffer_load_dwordx4 v1, s[32:35], s66 offen offset:0 lds
    v_mfma_f32_16x16x32_bf16 v[36:39], a[68:71], a[100:103], 0
    ds_read_b64_tr_b16 a[160:161], v13 offset:32768
    v_mfma_f32_16x16x32_bf16 v[36:39], a[36:39], a[96:99], v[36:39]
    v_mfma_f32_16x16x32_bf16 v[40:43], a[40:43], a[96:99], 0
    ds_read_b64_tr_b16 a[162:163], v13 offset:33792
    v_mfma_f32_16x16x32_bf16 v[40:43], a[72:75], a[100:103], v[40:43]
    v_mfma_f32_16x16x32_bf16 v[44:47], a[76:79], a[100:103], 0
    buffer_load_dwordx4 v2, s[32:35], s66 offen offset:1024 lds
    v_mfma_f32_16x16x32_bf16 v[44:47], a[44:47], a[96:99], v[44:47]
    ds_read_b128 a[132:135], v12 offset:8192
    v_mfma_f32_16x16x32_bf16 v[48:51], a[48:51], a[96:99], 0
    ds_read_b64_tr_b16 a[164:165], v14 offset:32768
    v_mfma_f32_16x16x32_bf16 v[48:51], a[80:83], a[100:103], v[48:51]
    v_mfma_f32_16x16x32_bf16 v[52:55], a[84:87], a[100:103], 0
    ds_read_b64_tr_b16 a[166:167], v14 offset:33792
    v_mfma_f32_16x16x32_bf16 v[52:55], a[52:55], a[96:99], v[52:55]
    buffer_load_dwordx4 v3, s[32:35], s66 offen offset:2048 lds
    v_mfma_f32_16x16x32_bf16 v[56:59], a[56:59], a[96:99], 0
    ds_read_b128 a[136:139], v11 offset:10240
    v_mfma_f32_16x16x32_bf16 v[56:59], a[88:91], a[100:103], v[56:59]
    v_mfma_f32_16x16x32_bf16 v[60:63], a[92:95], a[100:103], 0
    ds_read_b64_tr_b16 a[168:169], v13 offset:33024
    v_mfma_f32_16x16x32_bf16 v[60:63], a[60:63], a[96:99], v[60:63]
    v_mfma_f32_16x16x32_bf16 v[68:71], a[60:63], a[104:107], 0
    buffer_load_dwordx4 v4, s[32:35], s66 offen offset:3072 lds
    v_mfma_f32_16x16x32_bf16 v[68:71], a[92:95], a[108:111], v[68:71]
    ds_read_b64_tr_b16 a[170:171], v13 offset:34048
    v_mfma_f32_16x16x32_bf16 v[64:67], a[88:91], a[108:111], 0
    ds_read_b128 a[140:143], v12 offset:10240
    v_mfma_f32_16x16x32_bf16 v[64:67], a[56:59], a[104:107], v[64:67]
    s_add_u32 s56, s56, 128
    s_add_u32 m0, s63, 49152
    v_mfma_f32_16x16x32_bf16 v[76:79], a[52:55], a[104:107], 0
    ds_read_b64_tr_b16 a[172:173], v14 offset:33024
    v_mfma_f32_16x16x32_bf16 v[76:79], a[84:87], a[108:111], v[76:79]
    buffer_load_dwordx4 v5, s[36:39], s57 offen offset:0 lds
    v_mfma_f32_16x16x32_bf16 v[72:75], a[80:83], a[108:111], 0
    ds_read_b64_tr_b16 a[174:175], v14 offset:34048
    v_mfma_f32_16x16x32_bf16 v[72:75], a[48:51], a[104:107], v[72:75]
    v_mfma_f32_16x16x32_bf16 v[84:87], a[44:47], a[104:107], 0
    ds_read_b128 a[144:147], v11 offset:12288
    v_mfma_f32_16x16x32_bf16 v[84:87], a[76:79], a[108:111], v[84:87]
    v_mfma_f32_16x16x32_bf16 v[80:83], a[72:75], a[108:111], 0
    buffer_load_dwordx4 v6, s[36:39], s57 offen offset:1024 lds
    v_mfma_f32_16x16x32_bf16 v[80:83], a[40:43], a[104:107], v[80:83]
    ds_read_b64_tr_b16 a[176:177], v13 offset:33280
    v_mfma_f32_16x16x32_bf16 v[92:95], a[36:39], a[104:107], 0
    ds_read_b64_tr_b16 a[178:179], v13 offset:34304
    v_mfma_f32_16x16x32_bf16 v[92:95], a[68:71], a[108:111], v[92:95]
    v_mfma_f32_16x16x32_bf16 v[88:91], a[64:67], a[108:111], 0
    ds_read_b128 a[148:151], v12 offset:12288
    v_mfma_f32_16x16x32_bf16 v[88:91], a[32:35], a[104:107], v[88:91]
    buffer_load_dwordx4 v7, s[36:39], s57 offen offset:2048 lds
    v_mfma_f32_16x16x32_bf16 v[96:99], a[32:35], a[112:115], 0
    ds_read_b64_tr_b16 a[180:181], v14 offset:33280
    v_mfma_f32_16x16x32_bf16 v[96:99], a[64:67], a[116:119], v[96:99]
    v_mfma_f32_16x16x32_bf16 v[100:103], a[68:71], a[116:119], 0
    ds_read_b64_tr_b16 a[182:183], v14 offset:34304
    v_mfma_f32_16x16x32_bf16 v[100:103], a[36:39], a[112:115], v[100:103]
    v_mfma_f32_16x16x32_bf16 v[104:107], a[40:43], a[112:115], 0
    buffer_load_dwordx4 v8, s[36:39], s57 offen offset:3072 lds
    v_mfma_f32_16x16x32_bf16 v[104:107], a[72:75], a[116:119], v[104:107]
    ds_read_b128 a[152:155], v11 offset:14336
    v_mfma_f32_16x16x32_bf16 v[108:111], a[76:79], a[116:119], 0
    ds_read_b64_tr_b16 a[184:185], v13 offset:33536
    v_mfma_f32_16x16x32_bf16 v[108:111], a[44:47], a[112:115], v[108:111]
    s_add_u32 s57, s57, 262144
    s_add_u32 m0, s63, 0
    v_mfma_f32_16x16x32_bf16 v[112:115], a[48:51], a[112:115], 0
    ds_read_b64_tr_b16 a[186:187], v13 offset:34560
    v_mfma_f32_16x16x32_bf16 v[112:115], a[80:83], a[116:119], v[112:115]
    buffer_load_dwordx4 v5, s[36:39], s57 offen offset:0 lds
    v_mfma_f32_16x16x32_bf16 v[116:119], a[84:87], a[116:119], 0
    ds_read_b128 a[156:159], v12 offset:14336
    v_mfma_f32_16x16x32_bf16 v[116:119], a[52:55], a[112:115], v[116:119]
    v_mfma_f32_16x16x32_bf16 v[120:123], a[56:59], a[112:115], 0
    ds_read_b64_tr_b16 a[188:189], v14 offset:33536
    v_mfma_f32_16x16x32_bf16 v[120:123], a[88:91], a[116:119], v[120:123]
    v_mfma_f32_16x16x32_bf16 v[124:127], a[92:95], a[116:119], 0
    buffer_load_dwordx4 v6, s[36:39], s57 offen offset:1024 lds
    v_mfma_f32_16x16x32_bf16 v[124:127], a[60:63], a[112:115], v[124:127]
    ds_read_b64_tr_b16 a[190:191], v14 offset:34560
    v_mfma_f32_16x16x32_bf16 v[132:135], a[60:63], a[120:123], 0
    v_add_u32 v11, s61, v9
    v_add_u32 v12, s61, v10
    v_mfma_f32_16x16x32_bf16 v[132:135], a[92:95], a[124:127], v[132:135]
    v_mfma_f32_16x16x32_bf16 v[128:131], a[88:91], a[124:127], 0
    v_mfma_f32_16x16x32_bf16 v[128:131], a[56:59], a[120:123], v[128:131]
    buffer_load_dwordx4 v7, s[36:39], s57 offen offset:2048 lds
    v_mfma_f32_16x16x32_bf16 v[140:143], a[52:55], a[120:123], 0
    v_mfma_f32_16x16x32_bf16 v[140:143], a[84:87], a[124:127], v[140:143]
    v_mfma_f32_16x16x32_bf16 v[136:139], a[80:83], a[124:127], 0
    v_mfma_f32_16x16x32_bf16 v[136:139], a[48:51], a[120:123], v[136:139]
    v_mfma_f32_16x16x32_bf16 v[148:151], a[44:47], a[120:123], 0
    buffer_load_dwordx4 v8, s[36:39], s57 offen offset:3072 lds
    v_mfma_f32_16x16x32_bf16 v[148:151], a[76:79], a[124:127], v[148:151]
    v_mfma_f32_16x16x32_bf16 v[144:147], a[72:75], a[124:127], 0
    v_mfma_f32_16x16x32_bf16 v[144:147], a[40:43], a[120:123], v[144:147]
    s_add_u32 s57, s57, 262144
    v_mfma_f32_16x16x32_bf16 v[156:159], a[36:39], a[120:123], 0
    v_mfma_f32_16x16x32_bf16 v[156:159], a[68:71], a[124:127], v[156:159]
    v_mfma_f32_16x16x32_bf16 v[152:155], a[64:67], a[124:127], 0
    v_mfma_f32_16x16x32_bf16 v[152:155], a[32:35], a[120:123], v[152:155]
    s_waitcnt vmcnt(4) lgkmcnt(0)
    s_barrier
    v_mfma_f32_16x16x32_bf16 v[160:163], a[32:35], a[128:131], 0
    s_add_u32 s66, s56, 0
    ds_read_b128 a[96:99], v11 offset:0
    s_add_u32 m0, s62, 0
    v_mfma_f32_16x16x32_bf16 v[160:163], a[64:67], a[132:135], v[160:163]
    buffer_load_dwordx4 v1, s[32:35], s66 offen offset:0 lds
    v_mfma_f32_16x16x32_bf16 v[164:167], a[68:71], a[132:135], 0
    ds_read_b64_tr_b16 a[192:193], v13 offset:49152
    v_mfma_f32_16x16x32_bf16 v[164:167], a[36:39], a[128:131], v[164:167]
    v_mfma_f32_16x16x32_bf16 v[168:171], a[40:43], a[128:131], 0
    ds_read_b64_tr_b16 a[194:195], v13 offset:50176
    v_mfma_f32_16x16x32_bf16 v[168:171], a[72:75], a[132:135], v[168:171]
    v_mfma_f32_16x16x32_bf16 v[172:175], a[76:79], a[132:135], 0
    buffer_load_dwordx4 v2, s[32:35], s66 offen offset:1024 lds
    v_mfma_f32_16x16x32_bf16 v[172:175], a[44:47], a[128:131], v[172:175]
    ds_read_b128 a[100:103], v12 offset:0
    v_mfma_f32_16x16x32_bf16 v[176:179], a[48:51], a[128:131], 0
    ds_read_b64_tr_b16 a[196:197], v14 offset:49152
    v_mfma_f32_16x16x32_bf16 v[176:179], a[80:83], a[132:135], v[176:179]
    v_mfma_f32_16x16x32_bf16 v[180:183], a[84:87], a[132:135], 0
    ds_read_b64_tr_b16 a[198:199], v14 offset:50176
    v_mfma_f32_16x16x32_bf16 v[180:183], a[52:55], a[128:131], v[180:183]
    buffer_load_dwordx4 v3, s[32:35], s66 offen offset:2048 lds
    v_mfma_f32_16x16x32_bf16 v[184:187], a[56:59], a[128:131], 0
    ds_read_b128 a[104:107], v11 offset:2048
    v_mfma_f32_16x16x32_bf16 v[184:187], a[88:91], a[132:135], v[184:187]
    v_mfma_f32_16x16x32_bf16 v[188:191], a[92:95], a[132:135], 0
    ds_read_b64_tr_b16 a[200:201], v13 offset:49408
    v_mfma_f32_16x16x32_bf16 v[188:191], a[60:63], a[128:131], v[188:191]
    v_mfma_f32_16x16x32_bf16 v[196:199], a[60:63], a[136:139], 0
    buffer_load_dwordx4 v4, s[32:35], s66 offen offset:3072 lds
    v_mfma_f32_16x16x32_bf16 v[196:199], a[92:95], a[140:143], v[196:199]
    ds_read_b64_tr_b16 a[202:203], v13 offset:50432
    v_mfma_f32_16x16x32_bf16 v[192:195], a[88:91], a[140:143], 0
    ds_read_b128 a[108:111], v12 offset:2048
    v_mfma_f32_16x16x32_bf16 v[192:195], a[56:59], a[136:139], v[192:195]
    s_add_u32 s66, s56, 2097152
    s_add_u32 m0, s62, 16384
    v_mfma_f32_16x16x32_bf16 v[204:207], a[52:55], a[136:139], 0
    ds_read_b64_tr_b16 a[204:205], v14 offset:49408
    v_mfma_f32_16x16x32_bf16 v[204:207], a[84:87], a[140:143], v[204:207]
    buffer_load_dwordx4 v1, s[32:35], s66 offen offset:0 lds
    v_mfma_f32_16x16x32_bf16 v[200:203], a[80:83], a[140:143], 0
    ds_read_b64_tr_b16 a[206:207], v14 offset:50432
    v_mfma_f32_16x16x32_bf16 v[200:203], a[48:51], a[136:139], v[200:203]
    v_mfma_f32_16x16x32_bf16 v[212:215], a[44:47], a[136:139], 0
    ds_read_b128 a[112:115], v11 offset:4096
    v_mfma_f32_16x16x32_bf16 v[212:215], a[76:79], a[140:143], v[212:215]
    v_mfma_f32_16x16x32_bf16 v[208:211], a[72:75], a[140:143], 0
    buffer_load_dwordx4 v2, s[32:35], s66 offen offset:1024 lds
    v_mfma_f32_16x16x32_bf16 v[208:211], a[40:43], a[136:139], v[208:211]
    ds_read_b64_tr_b16 a[208:209], v13 offset:49664
    v_mfma_f32_16x16x32_bf16 v[220:223], a[36:39], a[136:139], 0
    ds_read_b64_tr_b16 a[210:211], v13 offset:50688
    v_mfma_f32_16x16x32_bf16 v[220:223], a[68:71], a[140:143], v[220:223]
    v_mfma_f32_16x16x32_bf16 v[216:219], a[64:67], a[140:143], 0
    ds_read_b128 a[116:119], v12 offset:4096
    v_mfma_f32_16x16x32_bf16 v[216:219], a[32:35], a[136:139], v[216:219]
    buffer_load_dwordx4 v3, s[32:35], s66 offen offset:2048 lds
    v_mfma_f32_16x16x32_bf16 v[224:227], a[32:35], a[144:147], 0
    ds_read_b64_tr_b16 a[212:213], v14 offset:49664
    v_mfma_f32_16x16x32_bf16 v[224:227], a[64:67], a[148:151], v[224:227]
    v_mfma_f32_16x16x32_bf16 v[228:231], a[68:71], a[148:151], 0
    ds_read_b64_tr_b16 a[214:215], v14 offset:50688
    v_mfma_f32_16x16x32_bf16 v[228:231], a[36:39], a[144:147], v[228:231]
    v_mfma_f32_16x16x32_bf16 v[232:235], a[40:43], a[144:147], 0
    buffer_load_dwordx4 v4, s[32:35], s66 offen offset:3072 lds
    v_mfma_f32_16x16x32_bf16 v[232:235], a[72:75], a[148:151], v[232:235]
    ds_read_b128 a[120:123], v11 offset:6144
    v_mfma_f32_16x16x32_bf16 v[236:239], a[76:79], a[148:151], 0
    ds_read_b64_tr_b16 a[216:217], v13 offset:49920
    v_mfma_f32_16x16x32_bf16 v[236:239], a[44:47], a[144:147], v[236:239]
    s_add_u32 s56, s56, 128
    s_add_u32 m0, s63, 16384
    v_mfma_f32_16x16x32_bf16 v[240:243], a[48:51], a[144:147], 0
    ds_read_b64_tr_b16 a[218:219], v13 offset:50944
    v_mfma_f32_16x16x32_bf16 v[240:243], a[80:83], a[148:151], v[240:243]
    buffer_load_dwordx4 v5, s[36:39], s57 offen offset:0 lds
    v_mfma_f32_16x16x32_bf16 v[244:247], a[84:87], a[148:151], 0
    ds_read_b128 a[124:127], v12 offset:6144
    v_mfma_f32_16x16x32_bf16 v[244:247], a[52:55], a[144:147], v[244:247]
    v_mfma_f32_16x16x32_bf16 v[248:251], a[56:59], a[144:147], 0
    ds_read_b64_tr_b16 a[220:221], v14 offset:49920
    v_mfma_f32_16x16x32_bf16 v[248:251], a[88:91], a[148:151], v[248:251]
    v_mfma_f32_16x16x32_bf16 v[252:255], a[92:95], a[148:151], 0
    buffer_load_dwordx4 v6, s[36:39], s57 offen offset:1024 lds
    v_mfma_f32_16x16x32_bf16 v[252:255], a[60:63], a[144:147], v[252:255]
    ds_read_b64_tr_b16 a[222:223], v14 offset:50944
    v_mfma_f32_16x16x32_bf16 a[4:7], a[60:63], a[152:155], 0
    v_mfma_f32_16x16x32_bf16 a[4:7], a[92:95], a[156:159], a[4:7]
    v_mfma_f32_16x16x32_bf16 a[0:3], a[88:91], a[156:159], 0
    v_mfma_f32_16x16x32_bf16 a[0:3], a[56:59], a[152:155], a[0:3]
    buffer_load_dwordx4 v7, s[36:39], s57 offen offset:2048 lds
    v_mfma_f32_16x16x32_bf16 a[12:15], a[52:55], a[152:155], 0
    v_mfma_f32_16x16x32_bf16 a[12:15], a[84:87], a[156:159], a[12:15]
    v_mfma_f32_16x16x32_bf16 a[8:11], a[80:83], a[156:159], 0
    v_mfma_f32_16x16x32_bf16 a[8:11], a[48:51], a[152:155], a[8:11]
    v_mfma_f32_16x16x32_bf16 a[20:23], a[44:47], a[152:155], 0
    buffer_load_dwordx4 v8, s[36:39], s57 offen offset:3072 lds
    v_mfma_f32_16x16x32_bf16 a[20:23], a[76:79], a[156:159], a[20:23]
    v_mfma_f32_16x16x32_bf16 a[16:19], a[72:75], a[156:159], 0
    v_mfma_f32_16x16x32_bf16 a[16:19], a[40:43], a[152:155], a[16:19]
    s_add_u32 s57, s57, 262144
    v_mfma_f32_16x16x32_bf16 a[28:31], a[36:39], a[152:155], 0
    v_mfma_f32_16x16x32_bf16 a[28:31], a[68:71], a[156:159], a[28:31]
    s_mov_b32 s67, s60
    s_mov_b32 s60, s61
    s_mov_b32 s61, s62
    v_mfma_f32_16x16x32_bf16 a[24:27], a[64:67], a[156:159], 0
    s_mov_b32 s62, s67
    v_mfma_f32_16x16x32_bf16 a[24:27], a[32:35], a[152:155], a[24:27]
    s_waitcnt vmcnt(12) lgkmcnt(0)
    s_barrier
    v_mfma_f32_16x16x32_bf16 v[32:35], a[160:163], a[96:99], v[32:35]
    s_add_u32 m0, s63, 32768
    ds_read_b128 a[128:131], v11 offset:8192
    v_mfma_f32_16x16x32_bf16 v[32:35], a[192:195], a[100:103], v[32:35]
    buffer_load_dwordx4 v5, s[36:39], s57 offen offset:0 lds
    v_mfma_f32_16x16x32_bf16 v[36:39], a[196:199], a[100:103], v[36:39]
    ds_read_b64_tr_b16 a[32:33], v13 offset:0
    v_mfma_f32_16x16x32_bf16 v[36:39], a[164:167], a[96:99], v[36:39]
    v_mfma_f32_16x16x32_bf16 v[40:43], a[168:171], a[96:99], v[40:43]
    ds_read_b64_tr_b16 a[34:35], v13 offset:1024
    v_mfma_f32_16x16x32_bf16 v[40:43], a[200:203], a[100:103], v[40:43]
    buffer_load_dwordx4 v6, s[36:39], s57 offen offset:1024 lds
    v_mfma_f32_16x16x32_bf16 v[44:47], a[204:207], a[100:103], v[44:47]
    ds_read_b128 a[132:135], v12 offset:8192
    v_mfma_f32_16x16x32_bf16 v[44:47], a[172:175], a[96:99], v[44:47]
    v_mfma_f32_16x16x32_bf16 v[48:51], a[176:179], a[96:99], v[48:51]
    ds_read_b64_tr_b16 a[36:37], v14 offset:0
    v_mfma_f32_16x16x32_bf16 v[48:51], a[208:211], a[100:103], v[48:51]
    buffer_load_dwordx4 v7, s[36:39], s57 offen offset:2048 lds
    v_mfma_f32_16x16x32_bf16 v[52:55], a[212:215], a[100:103], v[52:55]
    ds_read_b64_tr_b16 a[38:39], v14 offset:1024
    v_mfma_f32_16x16x32_bf16 v[52:55], a[180:183], a[96:99], v[52:55]
    v_mfma_f32_16x16x32_bf16 v[56:59], a[184:187], a[96:99], v[56:59]
    ds_read_b128 a[136:139], v11 offset:10240
    v_mfma_f32_16x16x32_bf16 v[56:59], a[216:219], a[100:103], v[56:59]
    buffer_load_dwordx4 v8, s[36:39], s57 offen offset:3072 lds
    v_mfma_f32_16x16x32_bf16 v[60:63], a[220:223], a[100:103], v[60:63]
    ds_read_b64_tr_b16 a[40:41], v13 offset:256
    v_mfma_f32_16x16x32_bf16 v[60:63], a[188:191], a[96:99], v[60:63]
    s_add_u32 s57, s57, 262144
    s_add_u32 s66, s56, 0
    s_add_u32 m0, s62, 0
    v_mfma_f32_16x16x32_bf16 v[68:71], a[188:191], a[104:107], v[68:71]
    ds_read_b64_tr_b16 a[42:43], v13 offset:1280
    v_mfma_f32_16x16x32_bf16 v[68:71], a[220:223], a[108:111], v[68:71]
    buffer_load_dwordx4 v1, s[32:35], s66 offen offset:0 lds
    v_mfma_f32_16x16x32_bf16 v[64:67], a[216:219], a[108:111], v[64:67]
    ds_read_b128 a[140:143], v12 offset:10240
    v_mfma_f32_16x16x32_bf16 v[64:67], a[184:187], a[104:107], v[64:67]
    v_mfma_f32_16x16x32_bf16 v[76:79], a[180:183], a[104:107], v[76:79]
    ds_read_b64_tr_b16 a[44:45], v14 offset:256
    v_mfma_f32_16x16x32_bf16 v[76:79], a[212:215], a[108:111], v[76:79]
    buffer_load_dwordx4 v2, s[32:35], s66 offen offset:1024 lds
    v_mfma_f32_16x16x32_bf16 v[72:75], a[208:211], a[108:111], v[72:75]
    ds_read_b64_tr_b16 a[46:47], v14 offset:1280
    v_mfma_f32_16x16x32_bf16 v[72:75], a[176:179], a[104:107], v[72:75]
    v_mfma_f32_16x16x32_bf16 v[84:87], a[172:175], a[104:107], v[84:87]
    ds_read_b128 a[144:147], v11 offset:12288
    v_mfma_f32_16x16x32_bf16 v[84:87], a[204:207], a[108:111], v[84:87]
    buffer_load_dwordx4 v3, s[32:35], s66 offen offset:2048 lds
    v_mfma_f32_16x16x32_bf16 v[80:83], a[200:203], a[108:111], v[80:83]
    ds_read_b64_tr_b16 a[48:49], v13 offset:512
    v_mfma_f32_16x16x32_bf16 v[80:83], a[168:171], a[104:107], v[80:83]
    v_mfma_f32_16x16x32_bf16 v[92:95], a[164:167], a[104:107], v[92:95]
    ds_read_b64_tr_b16 a[50:51], v13 offset:1536
    v_mfma_f32_16x16x32_bf16 v[92:95], a[196:199], a[108:111], v[92:95]
    buffer_load_dwordx4 v4, s[32:35], s66 offen offset:3072 lds
    v_mfma_f32_16x16x32_bf16 v[88:91], a[192:195], a[108:111], v[88:91]
    ds_read_b128 a[148:151], v12 offset:12288
    v_mfma_f32_16x16x32_bf16 v[88:91], a[160:163], a[104:107], v[88:91]
    s_add_u32 s66, s56, 2097152
    s_add_u32 m0, s62, 16384
    v_mfma_f32_16x16x32_bf16 v[96:99], a[160:163], a[112:115], v[96:99]
    ds_read_b64_tr_b16 a[52:53], v14 offset:512
    v_mfma_f32_16x16x32_bf16 v[96:99], a[192:195], a[116:119], v[96:99]
    buffer_load_dwordx4 v1, s[32:35], s66 offen offset:0 lds
    v_mfma_f32_16x16x32_bf16 v[100:103], a[196:199], a[116:119], v[100:103]
    ds_read_b64_tr_b16 a[54:55], v14 offset:1536
    v_mfma_f32_16x16x32_bf16 v[100:103], a[164:167], a[112:115], v[100:103]
    v_mfma_f32_16x16x32_bf16 v[104:107], a[168:171], a[112:115], v[104:107]
    ds_read_b128 a[152:155], v11 offset:14336
    v_mfma_f32_16x16x32_bf16 v[104:107], a[200:203], a[116:119], v[104:107]
    buffer_load_dwordx4 v2, s[32:35], s66 offen offset:1024 lds
    v_mfma_f32_16x16x32_bf16 v[108:111], a[204:207], a[116:119], v[108:111]
    ds_read_b64_tr_b16 a[56:57], v13 offset:768
    v_mfma_f32_16x16x32_bf16 v[108:111], a[172:175], a[112:115], v[108:111]
    v_mfma_f32_16x16x32_bf16 v[112:115], a[176:179], a[112:115], v[112:115]
    ds_read_b64_tr_b16 a[58:59], v13 offset:1792
    v_mfma_f32_16x16x32_bf16 v[112:115], a[208:211], a[116:119], v[112:115]
    buffer_load_dwordx4 v3, s[32:35], s66 offen offset:2048 lds
    v_mfma_f32_16x16x32_bf16 v[116:119], a[212:215], a[116:119], v[116:119]
    ds_read_b128 a[156:159], v12 offset:14336
    v_mfma_f32_16x16x32_bf16 v[116:119], a[180:183], a[112:115], v[116:119]
    v_mfma_f32_16x16x32_bf16 v[120:123], a[184:187], a[112:115], v[120:123]
    ds_read_b64_tr_b16 a[60:61], v14 offset:768
    v_mfma_f32_16x16x32_bf16 v[120:123], a[216:219], a[116:119], v[120:123]
    buffer_load_dwordx4 v4, s[32:35], s66 offen offset:3072 lds
    v_mfma_f32_16x16x32_bf16 v[124:127], a[220:223], a[116:119], v[124:127]
    ds_read_b64_tr_b16 a[62:63], v14 offset:1792
    v_mfma_f32_16x16x32_bf16 v[124:127], a[188:191], a[112:115], v[124:127]
    s_add_u32 s56, s56, 128
    s_add_u32 m0, s63, 49152
    v_mfma_f32_16x16x32_bf16 v[132:135], a[188:191], a[120:123], v[132:135]
    v_add_u32 v11, s61, v9
    v_add_u32 v12, s61, v10
    v_mfma_f32_16x16x32_bf16 v[132:135], a[220:223], a[124:127], v[132:135]
    buffer_load_dwordx4 v5, s[36:39], s57 offen offset:0 lds
    v_mfma_f32_16x16x32_bf16 v[128:131], a[216:219], a[124:127], v[128:131]
    v_mfma_f32_16x16x32_bf16 v[128:131], a[184:187], a[120:123], v[128:131]
    v_mfma_f32_16x16x32_bf16 v[140:143], a[180:183], a[120:123], v[140:143]
    v_mfma_f32_16x16x32_bf16 v[140:143], a[212:215], a[124:127], v[140:143]
    buffer_load_dwordx4 v6, s[36:39], s57 offen offset:1024 lds
    v_mfma_f32_16x16x32_bf16 v[136:139], a[208:211], a[124:127], v[136:139]
    v_mfma_f32_16x16x32_bf16 v[136:139], a[176:179], a[120:123], v[136:139]
    v_mfma_f32_16x16x32_bf16 v[148:151], a[172:175], a[120:123], v[148:151]
    v_mfma_f32_16x16x32_bf16 v[148:151], a[204:207], a[124:127], v[148:151]
    buffer_load_dwordx4 v7, s[36:39], s57 offen offset:2048 lds
    v_mfma_f32_16x16x32_bf16 v[144:147], a[200:203], a[124:127], v[144:147]
    v_mfma_f32_16x16x32_bf16 v[144:147], a[168:171], a[120:123], v[144:147]
    v_mfma_f32_16x16x32_bf16 v[156:159], a[164:167], a[120:123], v[156:159]
    v_mfma_f32_16x16x32_bf16 v[156:159], a[196:199], a[124:127], v[156:159]
    buffer_load_dwordx4 v8, s[36:39], s57 offen offset:3072 lds
    v_mfma_f32_16x16x32_bf16 v[152:155], a[192:195], a[124:127], v[152:155]
    v_mfma_f32_16x16x32_bf16 v[152:155], a[160:163], a[120:123], v[152:155]
    s_add_u32 s57, s57, 262144
    s_mov_b32 s64, 12
    .p2align 5
    s_nop 0
    s_nop 0
    s_nop 0
    s_nop 0
F_kloop:
    s_waitcnt vmcnt(16) lgkmcnt(0)
    s_barrier
    v_mfma_f32_16x16x32_bf16 v[160:163], a[160:163], a[128:131], v[160:163]
    ds_read_b128 a[96:99], v11 offset:0
    v_mfma_f32_16x16x32_bf16 v[160:163], a[192:195], a[132:135], v[160:163]
    v_mfma_f32_16x16x32_bf16 v[164:167], a[196:199], a[132:135], v[164:167]
    s_mov_b32 m0, s60
    ds_read_b64_tr_b16 a[64:65], v13 offset:16384
    v_mfma_f32_16x16x32_bf16 v[164:167], a[164:167], a[128:131], v[164:167]
    buffer_load_dwordx4 v1, s[32:35], s56 offen offset:0  lds
    v_mfma_f32_16x16x32_bf16 v[168:171], a[168:171], a[128:131], v[168:171]
    ds_read_b64_tr_b16 a[66:67], v13 offset:17408
    v_mfma_f32_16x16x32_bf16 v[168:171], a[200:203], a[132:135], v[168:171]
    v_mfma_f32_16x16x32_bf16 v[172:175], a[204:207], a[132:135], v[172:175]
    ds_read_b128 a[100:103], v12 offset:0
    v_mfma_f32_16x16x32_bf16 v[172:175], a[172:175], a[128:131], v[172:175]
    buffer_load_dword a248, v16, s[44:47], s76 offen
    v_mfma_f32_16x16x32_bf16 v[176:179], a[176:179], a[128:131], v[176:179]
    s_add_u32 s76, s76, 384
    ds_read_b64_tr_b16 a[68:69], v14 offset:16384
    v_mfma_f32_16x16x32_bf16 v[176:179], a[208:211], a[132:135], v[176:179]
    v_mfma_f32_16x16x32_bf16 v[180:183], a[212:215], a[132:135], v[180:183]
    ds_read_b64_tr_b16 a[70:71], v14 offset:17408
    v_mfma_f32_16x16x32_bf16 v[180:183], a[180:183], a[128:131], v[180:183]
    buffer_load_dwordx4 v2, s[32:35], s56 offen offset:1024  lds
    v_mfma_f32_16x16x32_bf16 v[184:187], a[184:187], a[128:131], v[184:187]
    ds_read_b128 a[104:107], v11 offset:2048
    v_mfma_f32_16x16x32_bf16 v[184:187], a[216:219], a[132:135], v[184:187]
    v_mfma_f32_16x16x32_bf16 v[188:191], a[220:223], a[132:135], v[188:191]
    ds_read_b64_tr_b16 a[72:73], v13 offset:16640
    v_mfma_f32_16x16x32_bf16 v[188:191], a[188:191], a[128:131], v[188:191]
    v_mfma_f32_16x16x32_bf16 v[196:199], a[188:191], a[136:139], v[196:199]
    ds_read_b64_tr_b16 a[74:75], v13 offset:17664
    v_mfma_f32_16x16x32_bf16 v[196:199], a[220:223], a[140:143], v[196:199]
    v_mfma_f32_16x16x32_bf16 v[192:195], a[216:219], a[140:143], v[192:195]
    ds_read_b128 a[108:111], v12 offset:2048
    v_mfma_f32_16x16x32_bf16 v[192:195], a[184:187], a[136:139], v[192:195]
    buffer_load_dwordx4 v3, s[32:35], s56 offen offset:2048  lds
    v_mfma_f32_16x16x32_bf16 v[204:207], a[180:183], a[136:139], v[204:207]
    ds_read_b64_tr_b16 a[76:77], v14 offset:16640
    v_mfma_f32_16x16x32_bf16 v[204:207], a[212:215], a[140:143], v[204:207]
    v_mfma_f32_16x16x32_bf16 v[200:203], a[208:211], a[140:143], v[200:203]
    ds_read_b64_tr_b16 a[78:79], v14 offset:17664
    v_mfma_f32_16x16x32_bf16 v[200:203], a[176:179], a[136:139], v[200:203]
    v_mfma_f32_16x16x32_bf16 v[212:215], a[172:175], a[136:139], v[212:215]
    ds_read_b128 a[112:115], v11 offset:4096
    v_mfma_f32_16x16x32_bf16 v[212:215], a[204:207], a[140:143], v[212:215]
    v_mfma_f32_16x16x32_bf16 v[208:211], a[200:203], a[140:143], v[208:211]
    ds_read_b64_tr_b16 a[80:81], v13 offset:16896
    v_mfma_f32_16x16x32_bf16 v[208:211], a[168:171], a[136:139], v[208:211]
    buffer_load_dwordx4 v4, s[32:35], s56 offen offset:3072  lds
    v_mfma_f32_16x16x32_bf16 v[220:223], a[164:167], a[136:139], v[220:223]
    ds_read_b64_tr_b16 a[82:83], v13 offset:17920
    v_mfma_f32_16x16x32_bf16 v[220:223], a[196:199], a[140:143], v[220:223]
    v_mfma_f32_16x16x32_bf16 v[216:219], a[192:195], a[140:143], v[216:219]
    ds_read_b128 a[116:119], v12 offset:4096
    v_mfma_f32_16x16x32_bf16 v[216:219], a[160:163], a[136:139], v[216:219]
    v_mfma_f32_16x16x32_bf16 v[224:227], a[160:163], a[144:147], v[224:227]
    ds_read_b64_tr_b16 a[84:85], v14 offset:16896
    v_mfma_f32_16x16x32_bf16 v[224:227], a[192:195], a[148:151], v[224:227]
    v_mfma_f32_16x16x32_bf16 v[228:231], a[196:199], a[148:151], v[228:231]
    s_add_u32 m0, s63, 0
    ds_read_b64_tr_b16 a[86:87], v14 offset:17920
    v_mfma_f32_16x16x32_bf16 v[228:231], a[164:167], a[144:147], v[228:231]
    buffer_load_dwordx4 v5, s[36:39], s57 offen offset:0  lds
    v_mfma_f32_16x16x32_bf16 v[232:235], a[168:171], a[144:147], v[232:235]
    ds_read_b128 a[120:123], v11 offset:6144
    v_mfma_f32_16x16x32_bf16 v[232:235], a[200:203], a[148:151], v[232:235]
    v_mfma_f32_16x16x32_bf16 v[236:239], a[204:207], a[148:151], v[236:239]
    ds_read_b64_tr_b16 a[88:89], v13 offset:17152
    v_mfma_f32_16x16x32_bf16 v[236:239], a[172:175], a[144:147], v[236:239]
    buffer_load_dword a251, v19, s[52:55], s78 offen
    v_mfma_f32_16x16x32_bf16 v[240:243], a[176:179], a[144:147], v[240:243]
    s_add_u32 s78, s78, 2688
    ds_read_b64_tr_b16 a[90:91], v13 offset:18176
    v_mfma_f32_16x16x32_bf16 v[240:243], a[208:211], a[148:151], v[240:243]
    v_mfma_f32_16x16x32_bf16 v[244:247], a[212:215], a[148:151], v[244:247]
    ds_read_b128 a[124:127], v12 offset:6144
    v_mfma_f32_16x16x32_bf16 v[244:247], a[180:183], a[144:147], v[244:247]
    buffer_load_dwordx4 v6, s[36:39], s57 offen offset:1024  lds
    v_mfma_f32_16x16x32_bf16 v[248:251], a[184:187], a[144:147], v[248:251]
    ds_read_b64_tr_b16 a[92:93], v14 offset:17152
    v_mfma_f32_16x16x32_bf16 v[248:251], a[216:219], a[148:151], v[248:251]
    v_mfma_f32_16x16x32_bf16 v[252:255], a[220:223], a[148:151], v[252:255]
    ds_read_b64_tr_b16 a[94:95], v14 offset:18176
    v_mfma_f32_16x16x32_bf16 v[252:255], a[188:191], a[144:147], v[252:255]
    v_mfma_f32_16x16x32_bf16 a[4:7], a[188:191], a[152:155], a[4:7]
    v_mfma_f32_16x16x32_bf16 a[4:7], a[220:223], a[156:159], a[4:7]
    v_mfma_f32_16x16x32_bf16 a[0:3], a[216:219], a[156:159], a[0:3]
    v_mfma_f32_16x16x32_bf16 a[0:3], a[184:187], a[152:155], a[0:3]
    buffer_load_dwordx4 v7, s[36:39], s57 offen offset:2048  lds
    v_mfma_f32_16x16x32_bf16 a[12:15], a[180:183], a[152:155], a[12:15]
    v_mfma_f32_16x16x32_bf16 a[12:15], a[212:215], a[156:159], a[12:15]
    v_mfma_f32_16x16x32_bf16 a[8:11], a[208:211], a[156:159], a[8:11]
    v_mfma_f32_16x16x32_bf16 a[8:11], a[176:179], a[152:155], a[8:11]
    v_mfma_f32_16x16x32_bf16 a[20:23], a[172:175], a[152:155], a[20:23]
    v_mfma_f32_16x16x32_bf16 a[20:23], a[204:207], a[156:159], a[20:23]
    v_mfma_f32_16x16x32_bf16 a[16:19], a[200:203], a[156:159], a[16:19]
    v_mfma_f32_16x16x32_bf16 a[16:19], a[168:171], a[152:155], a[16:19]
    buffer_load_dwordx4 v8, s[36:39], s57 offen offset:3072  lds
    v_mfma_f32_16x16x32_bf16 a[28:31], a[164:167], a[152:155], a[28:31]
    s_add_u32 s57, s57, 262144
    v_mfma_f32_16x16x32_bf16 a[28:31], a[196:199], a[156:159], a[28:31]
    s_mov_b32 s67, s60
    s_mov_b32 s60, s61
    s_mov_b32 s61, s62
    v_mfma_f32_16x16x32_bf16 a[24:27], a[192:195], a[156:159], a[24:27]
    s_mov_b32 s62, s67
    v_mfma_f32_16x16x32_bf16 a[24:27], a[160:163], a[152:155], a[24:27]
    s_waitcnt vmcnt(18) lgkmcnt(0)
    s_barrier
    v_mfma_f32_16x16x32_bf16 v[32:35], a[32:35], a[96:99], v[32:35]
    ds_read_b128 a[128:131], v11 offset:8192
    v_mfma_f32_16x16x32_bf16 v[32:35], a[64:67], a[100:103], v[32:35]
    s_add_u32 s66, s56, 2097152
    v_mfma_f32_16x16x32_bf16 v[36:39], a[68:71], a[100:103], v[36:39]
    s_add_u32 m0, s62, 16384
    ds_read_b64_tr_b16 a[160:161], v13 offset:32768
    v_mfma_f32_16x16x32_bf16 v[36:39], a[36:39], a[96:99], v[36:39]
    buffer_load_dwordx4 v1, s[32:35], s66 offen offset:0  lds
    v_mfma_f32_16x16x32_bf16 v[40:43], a[40:43], a[96:99], v[40:43]
    ds_read_b64_tr_b16 a[162:163], v13 offset:33792
    v_mfma_f32_16x16x32_bf16 v[40:43], a[72:75], a[100:103], v[40:43]
    v_mfma_f32_16x16x32_bf16 v[44:47], a[76:79], a[100:103], v[44:47]
    ds_read_b128 a[132:135], v12 offset:8192
    v_mfma_f32_16x16x32_bf16 v[44:47], a[44:47], a[96:99], v[44:47]
    buffer_load_dword a250, v18, s[48:51], s77 offen
    v_mfma_f32_16x16x32_bf16 v[48:51], a[48:51], a[96:99], v[48:51]
    s_add_u32 s77, s77, 256
    ds_read_b64_tr_b16 a[164:165], v14 offset:32768
    v_mfma_f32_16x16x32_bf16 v[48:51], a[80:83], a[100:103], v[48:51]
    v_mfma_f32_16x16x32_bf16 v[52:55], a[84:87], a[100:103], v[52:55]
    ds_read_b64_tr_b16 a[166:167], v14 offset:33792
    v_mfma_f32_16x16x32_bf16 v[52:55], a[52:55], a[96:99], v[52:55]
    buffer_load_dwordx4 v2, s[32:35], s66 offen offset:1024  lds
    v_mfma_f32_16x16x32_bf16 v[56:59], a[56:59], a[96:99], v[56:59]
    ds_read_b128 a[136:139], v11 offset:10240
    v_mfma_f32_16x16x32_bf16 v[56:59], a[88:91], a[100:103], v[56:59]
    v_mfma_f32_16x16x32_bf16 v[60:63], a[92:95], a[100:103], v[60:63]
    ds_read_b64_tr_b16 a[168:169], v13 offset:33024
    v_mfma_f32_16x16x32_bf16 v[60:63], a[60:63], a[96:99], v[60:63]
    v_mfma_f32_16x16x32_bf16 v[68:71], a[60:63], a[104:107], v[68:71]
    ds_read_b64_tr_b16 a[170:171], v13 offset:34048
    v_mfma_f32_16x16x32_bf16 v[68:71], a[92:95], a[108:111], v[68:71]
    v_mfma_f32_16x16x32_bf16 v[64:67], a[88:91], a[108:111], v[64:67]
    ds_read_b128 a[140:143], v12 offset:10240
    v_mfma_f32_16x16x32_bf16 v[64:67], a[56:59], a[104:107], v[64:67]
    buffer_load_dwordx4 v3, s[32:35], s66 offen offset:2048  lds
    v_mfma_f32_16x16x32_bf16 v[76:79], a[52:55], a[104:107], v[76:79]
    ds_read_b64_tr_b16 a[172:173], v14 offset:33024
    v_mfma_f32_16x16x32_bf16 v[76:79], a[84:87], a[108:111], v[76:79]
    v_mfma_f32_16x16x32_bf16 v[72:75], a[80:83], a[108:111], v[72:75]
    ds_read_b64_tr_b16 a[174:175], v14 offset:34048
    v_mfma_f32_16x16x32_bf16 v[72:75], a[48:51], a[104:107], v[72:75]
    v_mfma_f32_16x16x32_bf16 v[84:87], a[44:47], a[104:107], v[84:87]
    ds_read_b128 a[144:147], v11 offset:12288
    v_mfma_f32_16x16x32_bf16 v[84:87], a[76:79], a[108:111], v[84:87]
    v_mfma_f32_16x16x32_bf16 v[80:83], a[72:75], a[108:111], v[80:83]
    ds_read_b64_tr_b16 a[176:177], v13 offset:33280
    v_mfma_f32_16x16x32_bf16 v[80:83], a[40:43], a[104:107], v[80:83]
    buffer_load_dwordx4 v4, s[32:35], s66 offen offset:3072  lds
    v_mfma_f32_16x16x32_bf16 v[92:95], a[36:39], a[104:107], v[92:95]
    s_add_u32 s56, s56, 128
    ds_read_b64_tr_b16 a[178:179], v13 offset:34304
    v_mfma_f32_16x16x32_bf16 v[92:95], a[68:71], a[108:111], v[92:95]
    v_mfma_f32_16x16x32_bf16 v[88:91], a[64:67], a[108:111], v[88:91]
    ds_read_b128 a[148:151], v12 offset:12288
    v_mfma_f32_16x16x32_bf16 v[88:91], a[32:35], a[104:107], v[88:91]
    v_mfma_f32_16x16x32_bf16 v[96:99], a[32:35], a[112:115], v[96:99]
    ds_read_b64_tr_b16 a[180:181], v14 offset:33280
    v_mfma_f32_16x16x32_bf16 v[96:99], a[64:67], a[116:119], v[96:99]
    v_mfma_f32_16x16x32_bf16 v[100:103], a[68:71], a[116:119], v[100:103]
    s_add_u32 m0, s63, 16384
    ds_read_b64_tr_b16 a[182:183], v14 offset:34304
    v_mfma_f32_16x16x32_bf16 v[100:103], a[36:39], a[112:115], v[100:103]
    buffer_load_dwordx4 v5, s[36:39], s57 offen offset:0  lds
    v_mfma_f32_16x16x32_bf16 v[104:107], a[40:43], a[112:115], v[104:107]
    ds_read_b128 a[152:155], v11 offset:14336
    v_mfma_f32_16x16x32_bf16 v[104:107], a[72:75], a[116:119], v[104:107]
    v_mfma_f32_16x16x32_bf16 v[108:111], a[76:79], a[116:119], v[108:111]
    ds_read_b64_tr_b16 a[184:185], v13 offset:33536
    v_mfma_f32_16x16x32_bf16 v[108:111], a[44:47], a[112:115], v[108:111]
    global_load_dword a249, v20, s[30:31]
    v_mfma_f32_16x16x32_bf16 v[112:115], a[48:51], a[112:115], v[112:115]
    ds_read_b64_tr_b16 a[186:187], v13 offset:34560
    v_mfma_f32_16x16x32_bf16 v[112:115], a[80:83], a[116:119], v[112:115]
    v_mfma_f32_16x16x32_bf16 v[116:119], a[84:87], a[116:119], v[116:119]
    ds_read_b128 a[156:159], v12 offset:14336
    v_mfma_f32_16x16x32_bf16 v[116:119], a[52:55], a[112:115], v[116:119]
    buffer_load_dwordx4 v6, s[36:39], s57 offen offset:1024  lds
    v_mfma_f32_16x16x32_bf16 v[120:123], a[56:59], a[112:115], v[120:123]
    ds_read_b64_tr_b16 a[188:189], v14 offset:33536
    v_mfma_f32_16x16x32_bf16 v[120:123], a[88:91], a[116:119], v[120:123]
    v_mfma_f32_16x16x32_bf16 v[124:127], a[92:95], a[116:119], v[124:127]
    ds_read_b64_tr_b16 a[190:191], v14 offset:34560
    v_mfma_f32_16x16x32_bf16 v[124:127], a[60:63], a[112:115], v[124:127]
    v_mfma_f32_16x16x32_bf16 v[132:135], a[60:63], a[120:123], v[132:135]
    v_add_u32 v11, s61, v9
    v_add_u32 v12, s61, v10
    v_mfma_f32_16x16x32_bf16 v[132:135], a[92:95], a[124:127], v[132:135]
    v_mfma_f32_16x16x32_bf16 v[128:131], a[88:91], a[124:127], v[128:131]
    v_mfma_f32_16x16x32_bf16 v[128:131], a[56:59], a[120:123], v[128:131]
    buffer_load_dwordx4 v7, s[36:39], s57 offen offset:2048  lds
    v_mfma_f32_16x16x32_bf16 v[140:143], a[52:55], a[120:123], v[140:143]
    s_cmp_eq_u32 s64, s98
    s_cselect_b32 s99, s75, 1073741824
    v_mfma_f32_16x16x32_bf16 v[140:143], a[84:87], a[124:127], v[140:143]
    v_mfma_f32_16x16x32_bf16 v[136:139], a[80:83], a[124:127], v[136:139]
    v_mfma_f32_16x16x32_bf16 v[136:139], a[48:51], a[120:123], v[136:139]
    buffer_store_byte v22, v21, s[88:91], s99 offen sc1
    v_mfma_f32_16x16x32_bf16 v[148:151], a[44:47], a[120:123], v[148:151]
    v_mfma_f32_16x16x32_bf16 v[148:151], a[76:79], a[124:127], v[148:151]
    v_mfma_f32_16x16x32_bf16 v[144:147], a[72:75], a[124:127], v[144:147]
    v_mfma_f32_16x16x32_bf16 v[144:147], a[40:43], a[120:123], v[144:147]
    buffer_load_dwordx4 v8, s[36:39], s57 offen offset:3072  lds
    v_mfma_f32_16x16x32_bf16 v[156:159], a[36:39], a[120:123], v[156:159]
    s_add_u32 s57, s57, 262144
    v_mfma_f32_16x16x32_bf16 v[156:159], a[68:71], a[124:127], v[156:159]
    s_sub_u32 s64, s64, 1
    v_mfma_f32_16x16x32_bf16 v[152:155], a[64:67], a[124:127], v[152:155]
    s_cmp_lg_u32 s64, 0
    v_mfma_f32_16x16x32_bf16 v[152:155], a[32:35], a[120:123], v[152:155]
    s_waitcnt vmcnt(18) lgkmcnt(0)
    s_barrier
    v_mfma_f32_16x16x32_bf16 v[160:163], a[32:35], a[128:131], v[160:163]
    ds_read_b128 a[96:99], v11 offset:0
    v_mfma_f32_16x16x32_bf16 v[160:163], a[64:67], a[132:135], v[160:163]
    v_mfma_f32_16x16x32_bf16 v[164:167], a[68:71], a[132:135], v[164:167]
    s_mov_b32 m0, s60
    ds_read_b64_tr_b16 a[192:193], v13 offset:49152
    v_mfma_f32_16x16x32_bf16 v[164:167], a[36:39], a[128:131], v[164:167]
    buffer_load_dwordx4 v1, s[32:35], s56 offen offset:0  lds
    v_mfma_f32_16x16x32_bf16 v[168:171], a[40:43], a[128:131], v[168:171]
    ds_read_b64_tr_b16 a[194:195], v13 offset:50176
    v_mfma_f32_16x16x32_bf16 v[168:171], a[72:75], a[132:135], v[168:171]
    v_mfma_f32_16x16x32_bf16 v[172:175], a[76:79], a[132:135], v[172:175]
    ds_read_b128 a[100:103], v12 offset:0
    v_mfma_f32_16x16x32_bf16 v[172:175], a[44:47], a[128:131], v[172:175]
    buffer_load_dword a248, v16, s[44:47], s76 offen
    v_mfma_f32_16x16x32_bf16 v[176:179], a[48:51], a[128:131], v[176:179]
    s_add_u32 s76, s76, 384
    ds_read_b64_tr_b16 a[196:197], v14 offset:49152
    v_mfma_f32_16x16x32_bf16 v[176:179], a[80:83], a[132:135], v[176:179]
    v_mfma_f32_16x16x32_bf16 v[180:183], a[84:87], a[132:135], v[180:183]
    ds_read_b64_tr_b16 a[198:199], v14 offset:50176
    v_mfma_f32_16x16x32_bf16 v[180:183], a[52:55], a[128:131], v[180:183]
    buffer_load_dwordx4 v2, s[32:35], s56 offen offset:1024  lds
    v_mfma_f32_16x16x32_bf16 v[184:187], a[56:59], a[128:131], v[184:187]
    ds_read_b128 a[104:107], v11 offset:2048
    v_mfma_f32_16x16x32_bf16 v[184:187], a[88:91], a[132:135], v[184:187]
    v_mfma_f32_16x16x32_bf16 v[188:191], a[92:95], a[132:135], v[188:191]
    ds_read_b64_tr_b16 a[200:201], v13 offset:49408
    v_mfma_f32_16x16x32_bf16 v[188:191], a[60:63], a[128:131], v[188:191]
    v_mfma_f32_16x16x32_bf16 v[196:199], a[60:63], a[136:139], v[196:199]
    ds_read_b64_tr_b16 a[202:203], v13 offset:50432
    v_mfma_f32_16x16x32_bf16 v[196:199], a[92:95], a[140:143], v[196:199]
    v_mfma_f32_16x16x32_bf16 v[192:195], a[88:91], a[140:143], v[192:195]
    ds_read_b128 a[108:111], v12 offset:2048
    v_mfma_f32_16x16x32_bf16 v[192:195], a[56:59], a[136:139], v[192:195]
    buffer_load_dwordx4 v3, s[32:35], s56 offen offset:2048  lds
    v_mfma_f32_16x16x32_bf16 v[204:207], a[52:55], a[136:139], v[204:207]
    ds_read_b64_tr_b16 a[204:205], v14 offset:49408
    v_mfma_f32_16x16x32_bf16 v[204:207], a[84:87], a[140:143], v[204:207]
    v_mfma_f32_16x16x32_bf16 v[200:203], a[80:83], a[140:143], v[200:203]
    ds_read_b64_tr_b16 a[206:207], v14 offset:50432
    v_mfma_f32_16x16x32_bf16 v[200:203], a[48:51], a[136:139], v[200:203]
    v_mfma_f32_16x16x32_bf16 v[212:215], a[44:47], a[136:139], v[212:215]
    ds_read_b128 a[112:115], v11 offset:4096
    v_mfma_f32_16x16x32_bf16 v[212:215], a[76:79], a[140:143], v[212:215]
    v_mfma_f32_16x16x32_bf16 v[208:211], a[72:75], a[140:143], v[208:211]
    ds_read_b64_tr_b16 a[208:209], v13 offset:49664
    v_mfma_f32_16x16x32_bf16 v[208:211], a[40:43], a[136:139], v[208:211]
    buffer_load_dwordx4 v4, s[32:35], s56 offen offset:3072  lds
    v_mfma_f32_16x16x32_bf16 v[220:223], a[36:39], a[136:139], v[220:223]
    ds_read_b64_tr_b16 a[210:211], v13 offset:50688
    v_mfma_f32_16x16x32_bf16 v[220:223], a[68:71], a[140:143], v[220:223]
    v_mfma_f32_16x16x32_bf16 v[216:219], a[64:67], a[140:143], v[216:219]
    ds_read_b128 a[116:119], v12 offset:4096
    v_mfma_f32_16x16x32_bf16 v[216:219], a[32:35], a[136:139], v[216:219]
    v_mfma_f32_16x16x32_bf16 v[224:227], a[32:35], a[144:147], v[224:227]
    ds_read_b64_tr_b16 a[212:213], v14 offset:49664
    v_mfma_f32_16x16x32_bf16 v[224:227], a[64:67], a[148:151], v[224:227]
    v_mfma_f32_16x16x32_bf16 v[228:231], a[68:71], a[148:151], v[228:231]
    s_add_u32 m0, s63, 32768
    ds_read_b64_tr_b16 a[214:215], v14 offset:50688
    v_mfma_f32_16x16x32_bf16 v[228:231], a[36:39], a[144:147], v[228:231]
    buffer_load_dwordx4 v5, s[36:39], s57 offen offset:0  lds
    v_mfma_f32_16x16x32_bf16 v[232:235], a[40:43], a[144:147], v[232:235]
    ds_read_b128 a[120:123], v11 offset:6144
    v_mfma_f32_16x16x32_bf16 v[232:235], a[72:75], a[148:151], v[232:235]
    v_mfma_f32_16x16x32_bf16 v[236:239], a[76:79], a[148:151], v[236:239]
    ds_read_b64_tr_b16 a[216:217], v13 offset:49920
    v_mfma_f32_16x16x32_bf16 v[236:239], a[44:47], a[144:147], v[236:239]
    buffer_load_dword a251, v19, s[52:55], s78 offen
    v_mfma_f32_16x16x32_bf16 v[240:243], a[48:51], a[144:147], v[240:243]
    s_add_u32 s78, s78, 2688
    ds_read_b64_tr_b16 a[218:219], v13 offset:50944
    v_mfma_f32_16x16x32_bf16 v[240:243], a[80:83], a[148:151], v[240:243]
    v_mfma_f32_16x16x32_bf16 v[244:247], a[84:87], a[148:151], v[244:247]
    ds_read_b128 a[124:127], v12 offset:6144
    v_mfma_f32_16x16x32_bf16 v[244:247], a[52:55], a[144:147], v[244:247]
    buffer_load_dwordx4 v6, s[36:39], s57 offen offset:1024  lds
    v_mfma_f32_16x16x32_bf16 v[248:251], a[56:59], a[144:147], v[248:251]
    ds_read_b64_tr_b16 a[220:221], v14 offset:49920
    v_mfma_f32_16x16x32_bf16 v[248:251], a[88:91], a[148:151], v[248:251]
    v_mfma_f32_16x16x32_bf16 v[252:255], a[92:95], a[148:151], v[252:255]
    ds_read_b64_tr_b16 a[222:223], v14 offset:50944
    v_mfma_f32_16x16x32_bf16 v[252:255], a[60:63], a[144:147], v[252:255]
    v_mfma_f32_16x16x32_bf16 a[4:7], a[60:63], a[152:155], a[4:7]
    v_mfma_f32_16x16x32_bf16 a[4:7], a[92:95], a[156:159], a[4:7]
    v_mfma_f32_16x16x32_bf16 a[0:3], a[88:91], a[156:159], a[0:3]
    v_mfma_f32_16x16x32_bf16 a[0:3], a[56:59], a[152:155], a[0:3]
    buffer_load_dwordx4 v7, s[36:39], s57 offen offset:2048  lds
    v_mfma_f32_16x16x32_bf16 a[12:15], a[52:55], a[152:155], a[12:15]
    v_mfma_f32_16x16x32_bf16 a[12:15], a[84:87], a[156:159], a[12:15]
    v_mfma_f32_16x16x32_bf16 a[8:11], a[80:83], a[156:159], a[8:11]
    v_mfma_f32_16x16x32_bf16 a[8:11], a[48:51], a[152:155], a[8:11]
    v_mfma_f32_16x16x32_bf16 a[20:23], a[44:47], a[152:155], a[20:23]
    v_mfma_f32_16x16x32_bf16 a[20:23], a[76:79], a[156:159], a[20:23]
    v_mfma_f32_16x16x32_bf16 a[16:19], a[72:75], a[156:159], a[16:19]
    v_mfma_f32_16x16x32_bf16 a[16:19], a[40:43], a[152:155], a[16:19]
    buffer_load_dwordx4 v8, s[36:39], s57 offen offset:3072  lds
    v_mfma_f32_16x16x32_bf16 a[28:31], a[36:39], a[152:155], a[28:31]
    s_add_u32 s57, s57, 262144
    v_mfma_f32_16x16x32_bf16 a[28:31], a[68:71], a[156:159], a[28:31]
    s_mov_b32 s67, s60
    s_mov_b32 s60, s61
    s_mov_b32 s61, s62
    v_mfma_f32_16x16x32_bf16 a[24:27], a[64:67], a[156:159], a[24:27]
    s_mov_b32 s62, s67
    v_mfma_f32_16x16x32_bf16 a[24:27], a[32:35], a[152:155], a[24:27]
    s_waitcnt vmcnt(18) lgkmcnt(0)
    s_barrier
    v_mfma_f32_16x16x32_bf16 v[32:35], a[160:163], a[96:99], v[32:35]
    ds_read_b128 a[128:131], v11 offset:8192
    v_mfma_f32_16x16x32_bf16 v[32:35], a[192:195], a[100:103], v[32:35]
    s_add_u32 s66, s56, 2097152
    v_mfma_f32_16x16x32_bf16 v[36:39], a[196:199], a[100:103], v[36:39]
    s_add_u32 m0, s62, 16384
    ds_read_b64_tr_b16 a[32:33], v13 offset:0
    v_mfma_f32_16x16x32_bf16 v[36:39], a[164:167], a[96:99], v[36:39]
    buffer_load_dwordx4 v1, s[32:35], s66 offen offset:0  lds
    v_mfma_f32_16x16x32_bf16 v[40:43], a[168:171], a[96:99], v[40:43]
    ds_read_b64_tr_b16 a[34:35], v13 offset:1024
    v_mfma_f32_16x16x32_bf16 v[40:43], a[200:203], a[100:103], v[40:43]
    v_mfma_f32_16x16x32_bf16 v[44:47], a[204:207], a[100:103], v[44:47]
    ds_read_b128 a[132:135], v12 offset:8192
    v_mfma_f32_16x16x32_bf16 v[44:47], a[172:175], a[96:99], v[44:47]
    buffer_load_dword a250, v18, s[48:51], s77 offen
    v_mfma_f32_16x16x32_bf16 v[48:51], a[176:179], a[96:99], v[48:51]
    s_add_u32 s77, s77, 256
    ds_read_b64_tr_b16 a[36:37], v14 offset:0
    v_mfma_f32_16x16x32_bf16 v[48:51], a[208:211], a[100:103], v[48:51]
    v_mfma_f32_16x16x32_bf16 v[52:55], a[212:215], a[100:103], v[52:55]
    ds_read_b64_tr_b16 a[38:39], v14 offset:1024
    v_mfma_f32_16x16x32_bf16 v[52:55], a[180:183], a[96:99], v[52:55]
    buffer_load_dwordx4 v2, s[32:35], s66 offen offset:1024  lds
    v_mfma_f32_16x16x32_bf16 v[56:59], a[184:187], a[96:99], v[56:59]
    ds_read_b128 a[136:139], v11 offset:10240
    v_mfma_f32_16x16x32_bf16 v[56:59], a[216:219], a[100:103], v[56:59]
    v_mfma_f32_16x16x32_bf16 v[60:63], a[220:223], a[100:103], v[60:63]
    ds_read_b64_tr_b16 a[40:41], v13 offset:256
    v_mfma_f32_16x16x32_bf16 v[60:63], a[188:191], a[96:99], v[60:63]
    v_mfma_f32_16x16x32_bf16 v[68:71], a[188:191], a[104:107], v[68:71]
    ds_read_b64_tr_b16 a[42:43], v13 offset:1280
    v_mfma_f32_16x16x32_bf16 v[68:71], a[220:223], a[108:111], v[68:71]
    v_mfma_f32_16x16x32_bf16 v[64:67], a[216:219], a[108:111], v[64:67]
    ds_read_b128 a[140:143], v12 offset:10240
    v_mfma_f32_16x16x32_bf16 v[64:67], a[184:187], a[104:107], v[64:67]
    buffer_load_dwordx4 v3, s[32:35], s66 offen offset:2048  lds
    v_mfma_f32_16x16x32_bf16 v[76:79], a[180:183], a[104:107], v[76:79]
    ds_read_b64_tr_b16 a[44:45], v14 offset:256
    v_mfma_f32_16x16x32_bf16 v[76:79], a[212:215], a[108:111], v[76:79]
    v_mfma_f32_16x16x32_bf16 v[72:75], a[208:211], a[108:111], v[72:75]
    ds_read_b64_tr_b16 a[46:47], v14 offset:1280
    v_mfma_f32_16x16x32_bf16 v[72:75], a[176:179], a[104:107], v[72:75]
    v_mfma_f32_16x16x32_bf16 v[84:87], a[172:175], a[104:107], v[84:87]
    ds_read_b128 a[144:147], v11 offset:12288
    v_mfma_f32_16x16x32_bf16 v[84:87], a[204:207], a[108:111], v[84:87]
    v_mfma_f32_16x16x32_bf16 v[80:83], a[200:203], a[108:111], v[80:83]
    ds_read_b64_tr_b16 a[48:49], v13 offset:512
    v_mfma_f32_16x16x32_bf16 v[80:83], a[168:171], a[104:107], v[80:83]
    buffer_load_dwordx4 v4, s[32:35], s66 offen offset:3072  lds
    v_mfma_f32_16x16x32_bf16 v[92:95], a[164:167], a[104:107], v[92:95]
    s_add_u32 s56, s56, 128
    ds_read_b64_tr_b16 a[50:51], v13 offset:1536
    v_mfma_f32_16x16x32_bf16 v[92:95], a[196:199], a[108:111], v[92:95]
    v_mfma_f32_16x16x32_bf16 v[88:91], a[192:195], a[108:111], v[88:91]
    ds_read_b128 a[148:151], v12 offset:12288
    v_mfma_f32_16x16x32_bf16 v[88:91], a[160:163], a[104:107], v[88:91]
    v_mfma_f32_16x16x32_bf16 v[96:99], a[160:163], a[112:115], v[96:99]
    ds_read_b64_tr_b16 a[52:53], v14 offset:512
    v_mfma_f32_16x16x32_bf16 v[96:99], a[192:195], a[116:119], v[96:99]
    v_mfma_f32_16x16x32_bf16 v[100:103], a[196:199], a[116:119], v[100:103]
    s_add_u32 m0, s63, 49152
    ds_read_b64_tr_b16 a[54:55], v14 offset:1536
    v_mfma_f32_16x16x32_bf16 v[100:103], a[164:167], a[112:115], v[100:103]
    buffer_load_dwordx4 v5, s[36:39], s57 offen offset:0  lds
    v_mfma_f32_16x16x32_bf16 v[104:107], a[168:171], a[112:115], v[104:107]
    ds_read_b128 a[152:155], v11 offset:14336
    v_mfma_f32_16x16x32_bf16 v[104:107], a[200:203], a[116:119], v[104:107]
    v_mfma_f32_16x16x32_bf16 v[108:111], a[204:207], a[116:119], v[108:111]
    ds_read_b64_tr_b16 a[56:57], v13 offset:768
    v_mfma_f32_16x16x32_bf16 v[108:111], a[172:175], a[112:115], v[108:111]
    v_mfma_f32_16x16x32_bf16 v[112:115], a[176:179], a[112:115], v[112:115]
    ds_read_b64_tr_b16 a[58:59], v13 offset:1792
    v_mfma_f32_16x16x32_bf16 v[112:115], a[208:211], a[116:119], v[112:115]
    v_mfma_f32_16x16x32_bf16 v[116:119], a[212:215], a[116:119], v[116:119]
    ds_read_b128 a[156:159], v12 offset:14336
    v_mfma_f32_16x16x32_bf16 v[116:119], a[180:183], a[112:115], v[116:119]
    buffer_load_dwordx4 v6, s[36:39], s57 offen offset:1024  lds
    v_mfma_f32_16x16x32_bf16 v[120:123], a[184:187], a[112:115], v[120:123]
    ds_read_b64_tr_b16 a[60:61], v14 offset:768
    v_mfma_f32_16x16x32_bf16 v[120:123], a[216:219], a[116:119], v[120:123]
    v_mfma_f32_16x16x32_bf16 v[124:127], a[220:223], a[116:119], v[124:127]
    ds_read_b64_tr_b16 a[62:63], v14 offset:1792
    v_mfma_f32_16x16x32_bf16 v[124:127], a[188:191], a[112:115], v[124:127]
    v_mfma_f32_16x16x32_bf16 v[132:135], a[188:191], a[120:123], v[132:135]
    v_add_u32 v11, s61, v9
    v_add_u32 v12, s61, v10
    v_mfma_f32_16x16x32_bf16 v[132:135], a[220:223], a[124:127], v[132:135]
    v_mfma_f32_16x16x32_bf16 v[128:131], a[216:219], a[124:127], v[128:131]
    v_mfma_f32_16x16x32_bf16 v[128:131], a[184:187], a[120:123], v[128:131]
    buffer_load_dwordx4 v7, s[36:39], s57 offen offset:2048  lds
    v_mfma_f32_16x16x32_bf16 v[140:143], a[180:183], a[120:123], v[140:143]
    s_cmp_eq_u32 s64, s98
    s_cselect_b32 s99, s75, 1073741824
    v_mfma_f32_16x16x32_bf16 v[140:143], a[212:215], a[124:127], v[140:143]
    v_mfma_f32_16x16x32_bf16 v[136:139], a[208:211], a[124:127], v[136:139]
    v_mfma_f32_16x16x32_bf16 v[136:139], a[176:179], a[120:123], v[136:139]
    buffer_store_byte v22, v21, s[88:91], s99 offen sc1
    v_mfma_f32_16x16x32_bf16 v[148:151], a[172:175], a[120:123], v[148:151]
    v_mfma_f32_16x16x32_bf16 v[148:151], a[204:207], a[124:127], v[148:151]
    v_mfma_f32_16x16x32_bf16 v[144:147], a[200:203], a[124:127], v[144:147]
    v_mfma_f32_16x16x32_bf16 v[144:147], a[168:171], a[120:123], v[144:147]
    buffer_load_dwordx4 v8, s[36:39], s57 offen offset:3072  lds
    v_mfma_f32_16x16x32_bf16 v[156:159], a[164:167], a[120:123], v[156:159]
    s_add_u32 s57, s57, 262144
    v_mfma_f32_16x16x32_bf16 v[156:159], a[196:199], a[124:127], v[156:159]
    s_sub_u32 s64, s64, 1
    v_mfma_f32_16x16x32_bf16 v[152:155], a[192:195], a[124:127], v[152:155]
    s_cmp_lg_u32 s64, 0
    v_mfma_f32_16x16x32_bf16 v[152:155], a[160:163], a[120:123], v[152:155]
    s_cbranch_scc1 F_kloop
F_kloop_x:
    s_waitcnt vmcnt(20) lgkmcnt(0)
    s_barrier
    v_mfma_f32_16x16x32_bf16 v[160:163], a[160:163], a[128:131], v[160:163]
    ds_read_b128 a[96:99], v11 offset:0
    v_mfma_f32_16x16x32_bf16 v[160:163], a[192:195], a[132:135], v[160:163]
    v_mfma_f32_16x16x32_bf16 v[164:167], a[196:199], a[132:135], v[164:167]
    s_mov_b32 m0, s60
    ds_read_b64_tr_b16 a[64:65], v13 offset:16384
    v_mfma_f32_16x16x32_bf16 v[164:167], a[164:167], a[128:131], v[164:167]
    buffer_load_dwordx4 v24, s[44:47], s58 offen offset:0  lds
    v_mfma_f32_16x16x32_bf16 v[168:171], a[168:171], a[128:131], v[168:171]
    v_lshlrev_b32 v4, 2, v30
    ds_read_b64_tr_b16 a[66:67], v13 offset:17408
    v_mfma_f32_16x16x32_bf16 v[168:171], a[200:203], a[132:135], v[168:171]
    v_and_b32 v16, 15, v30
    v_mul_u32_u24 v16, 896, v16
    v_mfma_f32_16x16x32_bf16 v[172:175], a[204:207], a[132:135], v[172:175]
    v_and_or_b32 v16, v30, 48, v16
    ds_read_b128 a[100:103], v12 offset:0
    v_mfma_f32_16x16x32_bf16 v[172:175], a[172:175], a[128:131], v[172:175]
    buffer_load_dword v1, v4, s[88:91], 0 offen sc1
    v_mfma_f32_16x16x32_bf16 v[176:179], a[176:179], a[128:131], v[176:179]
    ds_read_b64_tr_b16 a[68:69], v14 offset:16384
    v_mfma_f32_16x16x32_bf16 v[176:179], a[208:211], a[132:135], v[176:179]
    buffer_load_dwordx4 a[224:227], v16, s[52:55], s3 offen offset:0
    v_mfma_f32_16x16x32_bf16 v[180:183], a[212:215], a[132:135], v[180:183]
    ds_read_b64_tr_b16 a[70:71], v14 offset:17408
    v_mfma_f32_16x16x32_bf16 v[180:183], a[180:183], a[128:131], v[180:183]
    buffer_load_dwordx4 v25, s[44:47], s58 offen offset:1024  lds
    v_mfma_f32_16x16x32_bf16 v[184:187], a[184:187], a[128:131], v[184:187]
    ds_read_b128 a[104:107], v11 offset:2048
    v_mfma_f32_16x16x32_bf16 v[184:187], a[216:219], a[132:135], v[184:187]
    buffer_load_dwordx4 a[228:231], v16, s[52:55], s3 offen offset:64
    v_mfma_f32_16x16x32_bf16 v[188:191], a[220:223], a[132:135], v[188:191]
    ds_read_b64_tr_b16 a[72:73], v13 offset:16640
    v_mfma_f32_16x16x32_bf16 v[188:191], a[188:191], a[128:131], v[188:191]
    s_add_u32 s3, s3, 14336
    v_mfma_f32_16x16x32_bf16 v[196:199], a[188:191], a[136:139], v[196:199]
    ds_read_b64_tr_b16 a[74:75], v13 offset:17664
    v_mfma_f32_16x16x32_bf16 v[196:199], a[220:223], a[140:143], v[196:199]
    buffer_load_dwordx4 a[232:235], v16, s[52:55], s3 offen offset:0
    v_mfma_f32_16x16x32_bf16 v[192:195], a[216:219], a[140:143], v[192:195]
    ds_read_b128 a[108:111], v12 offset:2048
    v_mfma_f32_16x16x32_bf16 v[192:195], a[184:187], a[136:139], v[192:195]
    buffer_load_dwordx4 v26, s[44:47], s58 offen offset:2048  lds
    v_mfma_f32_16x16x32_bf16 v[204:207], a[180:183], a[136:139], v[204:207]
    ds_read_b64_tr_b16 a[76:77], v14 offset:16640
    v_mfma_f32_16x16x32_bf16 v[204:207], a[212:215], a[140:143], v[204:207]
    buffer_load_dwordx4 a[236:239], v16, s[52:55], s3 offen offset:64
    v_mfma_f32_16x16x32_bf16 v[200:203], a[208:211], a[140:143], v[200:203]
    ds_read_b64_tr_b16 a[78:79], v14 offset:17664
    v_mfma_f32_16x16x32_bf16 v[200:203], a[176:179], a[136:139], v[200:203]
    s_add_u32 s3, s3, 14336
    v_mfma_f32_16x16x32_bf16 v[212:215], a[172:175], a[136:139], v[212:215]
    ds_read_b128 a[112:115], v11 offset:4096
    v_mfma_f32_16x16x32_bf16 v[212:215], a[204:207], a[140:143], v[212:215]
    v_mfma_f32_16x16x32_bf16 v[208:211], a[200:203], a[140:143], v[208:211]
    ds_read_b64_tr_b16 a[80:81], v13 offset:16896
    v_mfma_f32_16x16x32_bf16 v[208:211], a[168:171], a[136:139], v[208:211]
    buffer_load_dwordx4 v27, s[44:47], s58 offen offset:3072  lds
    v_mfma_f32_16x16x32_bf16 v[220:223], a[164:167], a[136:139], v[220:223]
    ds_read_b64_tr_b16 a[82:83], v13 offset:17920
    v_mfma_f32_16x16x32_bf16 v[220:223], a[196:199], a[140:143], v[220:223]
    v_mfma_f32_16x16x32_bf16 v[216:219], a[192:195], a[140:143], v[216:219]
    ds_read_b128 a[116:119], v12 offset:4096
    v_mfma_f32_16x16x32_bf16 v[216:219], a[160:163], a[136:139], v[216:219]
    v_mfma_f32_16x16x32_bf16 v[224:227], a[160:163], a[144:147], v[224:227]
    ds_read_b64_tr_b16 a[84:85], v14 offset:16896
    v_mfma_f32_16x16x32_bf16 v[224:227], a[192:195], a[148:151], v[224:227]
    v_mfma_f32_16x16x32_bf16 v[228:231], a[196:199], a[148:151], v[228:231]
    s_add_u32 m0, s63, 0
    ds_read_b64_tr_b16 a[86:87], v14 offset:17920
    v_mfma_f32_16x16x32_bf16 v[228:231], a[164:167], a[144:147], v[228:231]
    buffer_load_dwordx4 v28, s[48:51], s59 offen offset:0  lds
    v_mfma_f32_16x16x32_bf16 v[232:235], a[168:171], a[144:147], v[232:235]
    ds_read_b128 a[120:123], v11 offset:6144
    v_mfma_f32_16x16x32_bf16 v[232:235], a[200:203], a[148:151], v[232:235]
    v_mfma_f32_16x16x32_bf16 v[236:239], a[204:207], a[148:151], v[236:239]
    ds_read_b64_tr_b16 a[88:89], v13 offset:17152
    v_mfma_f32_16x16x32_bf16 v[236:239], a[172:175], a[144:147], v[236:239]
    v_mfma_f32_16x16x32_bf16 v[240:243], a[176:179], a[144:147], v[240:243]
    ds_read_b64_tr_b16 a[90:91], v13 offset:18176
    v_mfma_f32_16x16x32_bf16 v[240:243], a[208:211], a[148:151], v[240:243]
    v_mfma_f32_16x16x32_bf16 v[244:247], a[212:215], a[148:151], v[244:247]
    ds_read_b128 a[124:127], v12 offset:6144
    v_mfma_f32_16x16x32_bf16 v[244:247], a[180:183], a[144:147], v[244:247]
    buffer_load_dwordx4 v29, s[48:51], s59 offen offset:1024  lds
    v_mfma_f32_16x16x32_bf16 v[248:251], a[184:187], a[144:147], v[248:251]
    s_add_u32 s59, s59, 86016
    ds_read_b64_tr_b16 a[92:93], v14 offset:17152
    v_mfma_f32_16x16x32_bf16 v[248:251], a[216:219], a[148:151], v[248:251]
    v_mfma_f32_16x16x32_bf16 v[252:255], a[220:223], a[148:151], v[252:255]
    ds_read_b64_tr_b16 a[94:95], v14 offset:18176
    v_mfma_f32_16x16x32_bf16 v[252:255], a[188:191], a[144:147], v[252:255]
    v_mfma_f32_16x16x32_bf16 a[4:7], a[188:191], a[152:155], a[4:7]
    v_mfma_f32_16x16x32_bf16 a[4:7], a[220:223], a[156:159], a[4:7]
    v_mfma_f32_16x16x32_bf16 a[0:3], a[216:219], a[156:159], a[0:3]
    v_mfma_f32_16x16x32_bf16 a[0:3], a[184:187], a[152:155], a[0:3]
    v_mfma_f32_16x16x32_bf16 a[12:15], a[180:183], a[152:155], a[12:15]
    v_mfma_f32_16x16x32_bf16 a[12:15], a[212:215], a[156:159], a[12:15]
    v_mfma_f32_16x16x32_bf16 a[8:11], a[208:211], a[156:159], a[8:11]
    v_mfma_f32_16x16x32_bf16 a[8:11], a[176:179], a[152:155], a[8:11]
    v_mfma_f32_16x16x32_bf16 a[20:23], a[172:175], a[152:155], a[20:23]
    v_mfma_f32_16x16x32_bf16 a[20:23], a[204:207], a[156:159], a[20:23]
    v_mfma_f32_16x16x32_bf16 a[16:19], a[200:203], a[156:159], a[16:19]
    v_mfma_f32_16x16x32_bf16 a[16:19], a[168:171], a[152:155], a[16:19]
    v_mfma_f32_16x16x32_bf16 a[28:31], a[164:167], a[152:155], a[28:31]
    v_mfma_f32_16x16x32_bf16 a[28:31], a[196:199], a[156:159], a[28:31]
    s_mov_b32 s67, s60
    s_mov_b32 s60, s61
    s_mov_b32 s61, s62
    v_mfma_f32_16x16x32_bf16 a[24:27], a[192:195], a[156:159], a[24:27]
    s_mov_b32 s62, s67
    v_mfma_f32_16x16x32_bf16 a[24:27], a[160:163], a[152:155], a[24:27]
    s_waitcnt vmcnt(21) lgkmcnt(0)
    s_barrier
    v_mfma_f32_16x16x32_bf16 v[32:35], a[32:35], a[96:99], v[32:35]
    ds_read_b128 a[128:131], v11 offset:8192
    v_mfma_f32_16x16x32_bf16 v[32:35], a[64:67], a[100:103], v[32:35]
    s_add_u32 s66, s58, 114688
    v_mfma_f32_16x16x32_bf16 v[36:39], a[68:71], a[100:103], v[36:39]
    s_add_u32 m0, s62, 16384
    ds_read_b64_tr_b16 a[160:161], v13 offset:32768
    v_mfma_f32_16x16x32_bf16 v[36:39], a[36:39], a[96:99], v[36:39]
    buffer_load_dwordx4 v24, s[44:47], s66 offen offset:0  lds
    v_mfma_f32_16x16x32_bf16 v[40:43], a[40:43], a[96:99], v[40:43]
    ds_read_b64_tr_b16 a[162:163], v13 offset:33792
    v_mfma_f32_16x16x32_bf16 v[40:43], a[72:75], a[100:103], v[40:43]
    v_mfma_f32_16x16x32_bf16 v[44:47], a[76:79], a[100:103], v[44:47]
    ds_read_b128 a[132:135], v12 offset:8192
    v_mfma_f32_16x16x32_bf16 v[44:47], a[44:47], a[96:99], v[44:47]
    v_mfma_f32_16x16x32_bf16 v[48:51], a[48:51], a[96:99], v[48:51]
    ds_read_b64_tr_b16 a[164:165], v14 offset:32768
    v_mfma_f32_16x16x32_bf16 v[48:51], a[80:83], a[100:103], v[48:51]
    v_mfma_f32_16x16x32_bf16 v[52:55], a[84:87], a[100:103], v[52:55]
    ds_read_b64_tr_b16 a[166:167], v14 offset:33792
    v_mfma_f32_16x16x32_bf16 v[52:55], a[52:55], a[96:99], v[52:55]
    buffer_load_dwordx4 v25, s[44:47], s66 offen offset:1024  lds
    v_mfma_f32_16x16x32_bf16 v[56:59], a[56:59], a[96:99], v[56:59]
    ds_read_b128 a[136:139], v11 offset:10240
    v_mfma_f32_16x16x32_bf16 v[56:59], a[88:91], a[100:103], v[56:59]
    v_mfma_f32_16x16x32_bf16 v[60:63], a[92:95], a[100:103], v[60:63]
    ds_read_b64_tr_b16 a[168:169], v13 offset:33024
    v_mfma_f32_16x16x32_bf16 v[60:63], a[60:63], a[96:99], v[60:63]
    v_mfma_f32_16x16x32_bf16 v[68:71], a[60:63], a[104:107], v[68:71]
    ds_read_b64_tr_b16 a[170:171], v13 offset:34048
    v_mfma_f32_16x16x32_bf16 v[68:71], a[92:95], a[108:111], v[68:71]
    v_mfma_f32_16x16x32_bf16 v[64:67], a[88:91], a[108:111], v[64:67]
    ds_read_b128 a[140:143], v12 offset:10240
    v_mfma_f32_16x16x32_bf16 v[64:67], a[56:59], a[104:107], v[64:67]
    buffer_load_dwordx4 v26, s[44:47], s66 offen offset:2048  lds
    v_mfma_f32_16x16x32_bf16 v[76:79], a[52:55], a[104:107], v[76:79]
    ds_read_b64_tr_b16 a[172:173], v14 offset:33024
    v_mfma_f32_16x16x32_bf16 v[76:79], a[84:87], a[108:111], v[76:79]
    v_mfma_f32_16x16x32_bf16 v[72:75], a[80:83], a[108:111], v[72:75]
    ds_read_b64_tr_b16 a[174:175], v14 offset:34048
    v_mfma_f32_16x16x32_bf16 v[72:75], a[48:51], a[104:107], v[72:75]
    v_mfma_f32_16x16x32_bf16 v[84:87], a[44:47], a[104:107], v[84:87]
    ds_read_b128 a[144:147], v11 offset:12288
    v_mfma_f32_16x16x32_bf16 v[84:87], a[76:79], a[108:111], v[84:87]
    v_mfma_f32_16x16x32_bf16 v[80:83], a[72:75], a[108:111], v[80:83]
    ds_read_b64_tr_b16 a[176:177], v13 offset:33280
    v_mfma_f32_16x16x32_bf16 v[80:83], a[40:43], a[104:107], v[80:83]
    buffer_load_dwordx4 v27, s[44:47], s66 offen offset:3072  lds
    v_mfma_f32_16x16x32_bf16 v[92:95], a[36:39], a[104:107], v[92:95]
    s_add_u32 s58, s58, 128
    ds_read_b64_tr_b16 a[178:179], v13 offset:34304
    v_mfma_f32_16x16x32_bf16 v[92:95], a[68:71], a[108:111], v[92:95]
    v_mfma_f32_16x16x32_bf16 v[88:91], a[64:67], a[108:111], v[88:91]
    ds_read_b128 a[148:151], v12 offset:12288
    v_mfma_f32_16x16x32_bf16 v[88:91], a[32:35], a[104:107], v[88:91]
    v_mfma_f32_16x16x32_bf16 v[96:99], a[32:35], a[112:115], v[96:99]
    ds_read_b64_tr_b16 a[180:181], v14 offset:33280
    v_mfma_f32_16x16x32_bf16 v[96:99], a[64:67], a[116:119], v[96:99]
    v_mfma_f32_16x16x32_bf16 v[100:103], a[68:71], a[116:119], v[100:103]
    s_add_u32 m0, s63, 16384
    ds_read_b64_tr_b16 a[182:183], v14 offset:34304
    v_mfma_f32_16x16x32_bf16 v[100:103], a[36:39], a[112:115], v[100:103]
    buffer_load_dwordx4 v28, s[48:51], s59 offen offset:0  lds
    v_mfma_f32_16x16x32_bf16 v[104:107], a[40:43], a[112:115], v[104:107]
    ds_read_b128 a[152:155], v11 offset:14336
    v_mfma_f32_16x16x32_bf16 v[104:107], a[72:75], a[116:119], v[104:107]
    v_mfma_f32_16x16x32_bf16 v[108:111], a[76:79], a[116:119], v[108:111]
    ds_read_b64_tr_b16 a[184:185], v13 offset:33536
    v_mfma_f32_16x16x32_bf16 v[108:111], a[44:47], a[112:115], v[108:111]
    v_mfma_f32_16x16x32_bf16 v[112:115], a[48:51], a[112:115], v[112:115]
    ds_read_b64_tr_b16 a[186:187], v13 offset:34560
    v_mfma_f32_16x16x32_bf16 v[112:115], a[80:83], a[116:119], v[112:115]
    v_mfma_f32_16x16x32_bf16 v[116:119], a[84:87], a[116:119], v[116:119]
    ds_read_b128 a[156:159], v12 offset:14336
    v_mfma_f32_16x16x32_bf16 v[116:119], a[52:55], a[112:115], v[116:119]
    buffer_load_dwordx4 v29, s[48:51], s59 offen offset:1024  lds
    v_mfma_f32_16x16x32_bf16 v[120:123], a[56:59], a[112:115], v[120:123]
    s_add_u32 s59, s59, 86016
    ds_read_b64_tr_b16 a[188:189], v14 offset:33536
    v_mfma_f32_16x16x32_bf16 v[120:123], a[88:91], a[116:119], v[120:123]
    v_mfma_f32_16x16x32_bf16 v[124:127], a[92:95], a[116:119], v[124:127]
    ds_read_b64_tr_b16 a[190:191], v14 offset:34560
    v_mfma_f32_16x16x32_bf16 v[124:127], a[60:63], a[112:115], v[124:127]
    v_mfma_f32_16x16x32_bf16 v[132:135], a[60:63], a[120:123], v[132:135]
    v_add_u32 v11, s61, v9
    v_add_u32 v12, s61, v10
    v_mfma_f32_16x16x32_bf16 v[132:135], a[92:95], a[124:127], v[132:135]
    v_mfma_f32_16x16x32_bf16 v[128:131], a[88:91], a[124:127], v[128:131]
    v_mfma_f32_16x16x32_bf16 v[128:131], a[56:59], a[120:123], v[128:131]
    v_mfma_f32_16x16x32_bf16 v[140:143], a[52:55], a[120:123], v[140:143]
    v_mfma_f32_16x16x32_bf16 v[140:143], a[84:87], a[124:127], v[140:143]
    v_mfma_f32_16x16x32_bf16 v[136:139], a[80:83], a[124:127], v[136:139]
    v_mfma_f32_16x16x32_bf16 v[136:139], a[48:51], a[120:123], v[136:139]
    v_mfma_f32_16x16x32_bf16 v[148:151], a[44:47], a[120:123], v[148:151]
    v_mfma_f32_16x16x32_bf16 v[148:151], a[76:79], a[124:127], v[148:151]
    v_mfma_f32_16x16x32_bf16 v[144:147], a[72:75], a[124:127], v[144:147]
    v_mfma_f32_16x16x32_bf16 v[144:147], a[40:43], a[120:123], v[144:147]
    v_mfma_f32_16x16x32_bf16 v[156:159], a[36:39], a[120:123], v[156:159]
    v_mfma_f32_16x16x32_bf16 v[156:159], a[68:71], a[124:127], v[156:159]
    v_mfma_f32_16x16x32_bf16 v[152:155], a[64:67], a[124:127], v[152:155]
    v_mfma_f32_16x16x32_bf16 v[152:155], a[32:35], a[120:123], v[152:155]
    s_waitcnt vmcnt(9) lgkmcnt(0)
    s_barrier
    v_cmp_gt_u32 vcc, 16843009, v1
    s_nop 0
    s_cmp_lg_u64 vcc, 0
    s_cbranch_scc1 F_spin4
F_spin4r:
    v_mfma_f32_16x16x32_bf16 v[160:163], a[32:35], a[128:131], v[160:163]
    ds_read_b128 a[96:99], v11 offset:0
    v_mfma_f32_16x16x32_bf16 v[16:19], a[224:227], a[240:243], 0
    v_mfma_f32_16x16x32_bf16 v[20:23], a[232:235], a[240:243], 0
    s_mov_b32 m0, s60
    ds_read_b64_tr_b16 a[192:193], v13 offset:49152
    v_mfma_f32_16x16x32_bf16 v[160:163], a[64:67], a[132:135], v[160:163]
    buffer_load_dwordx4 v24, s[44:47], s58 offen offset:0  lds
    v_mfma_f32_16x16x32_bf16 v[164:167], a[68:71], a[132:135], v[164:167]
    ds_read_b64_tr_b16 a[194:195], v13 offset:50176
    v_mfma_f32_16x16x32_bf16 v[164:167], a[36:39], a[128:131], v[164:167]
    v_mfma_f32_16x16x32_bf16 v[168:171], a[40:43], a[128:131], v[168:171]
    ds_read_b128 a[100:103], v12 offset:0
    v_mfma_f32_16x16x32_bf16 v[168:171], a[72:75], a[132:135], v[168:171]
    v_mfma_f32_16x16x32_bf16 v[172:175], a[76:79], a[132:135], v[172:175]
    v_cvt_pk_bf16_f32 v16, v16, v17
    ds_read_b64_tr_b16 a[196:197], v14 offset:49152
    v_mfma_f32_16x16x32_bf16 v[172:175], a[44:47], a[128:131], v[172:175]
    v_cvt_pk_bf16_f32 v17, v18, v19
    v_cvt_pk_bf16_f32 v18, v20, v21
    v_mfma_f32_16x16x32_bf16 v[176:179], a[48:51], a[128:131], v[176:179]
    v_cvt_pk_bf16_f32 v19, v22, v23
    ds_read_b64_tr_b16 a[198:199], v14 offset:50176
    v_mfma_f32_16x16x32_bf16 v[176:179], a[80:83], a[132:135], v[176:179]
    buffer_load_dwordx4 v25, s[44:47], s58 offen offset:1024  lds
    v_mfma_f32_16x16x32_bf16 v[180:183], a[84:87], a[132:135], v[180:183]
    buffer_store_dwordx4 v[16:19], v15, s[40:43], s74 offen offset:0 sc1
    v_mfma_f32_16x16x32_bf16 v[180:183], a[52:55], a[128:131], v[180:183]
    ds_read_b128 a[104:107], v11 offset:2048
    v_mfma_f32_16x16x32_bf16 v[184:187], a[56:59], a[128:131], v[184:187]
    ds_read_b64_tr_b16 a[200:201], v13 offset:49408
    v_mfma_f32_16x16x32_bf16 v[184:187], a[88:91], a[132:135], v[184:187]
    v_mfma_f32_16x16x32_bf16 v[16:19], a[224:227], a[244:247], 0
    ds_read_b64_tr_b16 a[202:203], v13 offset:50432
    v_mfma_f32_16x16x32_bf16 v[20:23], a[232:235], a[244:247], 0
    v_mfma_f32_16x16x32_bf16 v[188:191], a[92:95], a[132:135], v[188:191]
    ds_read_b128 a[108:111], v12 offset:2048
    v_mfma_f32_16x16x32_bf16 v[188:191], a[60:63], a[128:131], v[188:191]
    buffer_load_dwordx4 v26, s[44:47], s58 offen offset:2048  lds
    v_mfma_f32_16x16x32_bf16 v[196:199], a[60:63], a[136:139], v[196:199]
    ds_read_b64_tr_b16 a[204:205], v14 offset:49408
    v_mfma_f32_16x16x32_bf16 v[196:199], a[92:95], a[140:143], v[196:199]
    v_mfma_f32_16x16x32_bf16 v[192:195], a[88:91], a[140:143], v[192:195]
    ds_read_b64_tr_b16 a[206:207], v14 offset:50432
    v_mfma_f32_16x16x32_bf16 v[192:195], a[56:59], a[136:139], v[192:195]
    v_cvt_pk_bf16_f32 v16, v16, v17
    v_cvt_pk_bf16_f32 v17, v18, v19
    v_mfma_f32_16x16x32_bf16 v[204:207], a[52:55], a[136:139], v[204:207]
    v_cvt_pk_bf16_f32 v18, v20, v21
    ds_read_b128 a[112:115], v11 offset:4096
    v_mfma_f32_16x16x32_bf16 v[204:207], a[84:87], a[140:143], v[204:207]
    v_cvt_pk_bf16_f32 v19, v22, v23
    v_mfma_f32_16x16x32_bf16 v[200:203], a[80:83], a[140:143], v[200:203]
    buffer_store_dwordx4 v[16:19], v15, s[40:43], s74 offen offset:1024 sc1
    v_mfma_f32_16x16x32_bf16 v[200:203], a[48:51], a[136:139], v[200:203]
    buffer_load_dwordx4 v27, s[44:47], s58 offen offset:3072  lds
    v_mfma_f32_16x16x32_bf16 v[212:215], a[44:47], a[136:139], v[212:215]
    ds_read_b64_tr_b16 a[208:209], v13 offset:49664
    ds_read_b64_tr_b16 a[210:211], v13 offset:50688
    v_mfma_f32_16x16x32_bf16 v[212:215], a[76:79], a[140:143], v[212:215]
    v_mfma_f32_16x16x32_bf16 v[208:211], a[72:75], a[140:143], v[208:211]
    ds_read_b128 a[116:119], v12 offset:4096
    v_mfma_f32_16x16x32_bf16 v[16:19], a[228:231], a[240:243], 0
    v_mfma_f32_16x16x32_bf16 v[20:23], a[236:239], a[240:243], 0
    ds_read_b64_tr_b16 a[212:213], v14 offset:49664
    v_mfma_f32_16x16x32_bf16 v[208:211], a[40:43], a[136:139], v[208:211]
    v_mfma_f32_16x16x32_bf16 v[220:223], a[36:39], a[136:139], v[220:223]
    s_add_u32 m0, s63, 32768
    ds_read_b64_tr_b16 a[214:215], v14 offset:50688
    v_mfma_f32_16x16x32_bf16 v[220:223], a[68:71], a[140:143], v[220:223]
    buffer_load_dwordx4 v28, s[48:51], s59 offen offset:0  lds
    v_mfma_f32_16x16x32_bf16 v[216:219], a[64:67], a[140:143], v[216:219]
    ds_read_b128 a[120:123], v11 offset:6144
    v_mfma_f32_16x16x32_bf16 v[216:219], a[32:35], a[136:139], v[216:219]
    v_mfma_f32_16x16x32_bf16 v[224:227], a[32:35], a[144:147], v[224:227]
    v_cvt_pk_bf16_f32 v16, v16, v17
    ds_read_b64_tr_b16 a[216:217], v13 offset:49920
    v_mfma_f32_16x16x32_bf16 v[224:227], a[64:67], a[148:151], v[224:227]
    v_cvt_pk_bf16_f32 v17, v18, v19
    v_cvt_pk_bf16_f32 v18, v20, v21
    v_mfma_f32_16x16x32_bf16 v[228:231], a[68:71], a[148:151], v[228:231]
    v_cvt_pk_bf16_f32 v19, v22, v23
    ds_read_b64_tr_b16 a[218:219], v13 offset:50944
    v_mfma_f32_16x16x32_bf16 v[228:231], a[36:39], a[144:147], v[228:231]
    buffer_store_dwordx4 v[16:19], v15, s[40:43], s74 offen offset:2048 sc1
    v_mfma_f32_16x16x32_bf16 v[232:235], a[40:43], a[144:147], v[232:235]
    ds_read_b128 a[124:127], v12 offset:6144
    v_mfma_f32_16x16x32_bf16 v[232:235], a[72:75], a[148:151], v[232:235]
    buffer_load_dwordx4 v29, s[48:51], s59 offen offset:1024  lds
    v_mfma_f32_16x16x32_bf16 v[236:239], a[76:79], a[148:151], v[236:239]
    s_add_u32 s59, s59, 86016
    ds_read_b64_tr_b16 a[220:221], v14 offset:49920
    v_mfma_f32_16x16x32_bf16 v[236:239], a[44:47], a[144:147], v[236:239]
    v_mfma_f32_16x16x32_bf16 v[16:19], a[228:231], a[244:247], 0
    ds_read_b64_tr_b16 a[222:223], v14 offset:50944
    v_mfma_f32_16x16x32_bf16 v[20:23], a[236:239], a[244:247], 0
    v_mfma_f32_16x16x32_bf16 v[240:243], a[48:51], a[144:147], v[240:243]
    v_mfma_f32_16x16x32_bf16 v[240:243], a[80:83], a[148:151], v[240:243]
    v_mfma_f32_16x16x32_bf16 v[244:247], a[84:87], a[148:151], v[244:247]
    v_mfma_f32_16x16x32_bf16 v[244:247], a[52:55], a[144:147], v[244:247]
    v_mfma_f32_16x16x32_bf16 v[248:251], a[56:59], a[144:147], v[248:251]
    v_mfma_f32_16x16x32_bf16 v[248:251], a[88:91], a[148:151], v[248:251]
    v_cvt_pk_bf16_f32 v16, v16, v17
    v_cvt_pk_bf16_f32 v17, v18, v19
    v_mfma_f32_16x16x32_bf16 v[252:255], a[92:95], a[148:151], v[252:255]
    v_cvt_pk_bf16_f32 v18, v20, v21
    v_cvt_pk_bf16_f32 v19, v22, v23
    v_mfma_f32_16x16x32_bf16 v[252:255], a[60:63], a[144:147], v[252:255]
    buffer_store_dwordx4 v[16:19], v15, s[40:43], s74 offen offset:3072 sc1
    v_mfma_f32_16x16x32_bf16 a[4:7], a[60:63], a[152:155], a[4:7]
    s_lshl_b32 s56, s26, 11
    s_add_u32 s75, s56, 82837504
    s_lshl_b32 s56, s28, 3
    v_mfma_f32_16x16x32_bf16 a[4:7], a[92:95], a[156:159], a[4:7]
    s_add_u32 s56, s56, s27
    s_lshl_b32 s56, s56, 7
    s_add_u32 s56, s56, s75
    v_mfma_f32_16x16x32_bf16 a[0:3], a[88:91], a[156:159], a[0:3]
    s_cmp_eq_u32 s29, 0
    s_cselect_b32 s56, s56, 1073741824
    v_mov_b32 v2, 1
    v_bfe_u32 v3, v15, 2, 7
    v_mfma_f32_16x16x32_bf16 a[0:3], a[56:59], a[152:155], a[0:3]
    v_lshlrev_b32 v4, 3, v15
    v_and_b32 v4, 2047, v4
    v_mfma_f32_16x16x32_bf16 a[12:15], a[52:55], a[152:155], a[12:15]
    v_mfma_f32_16x16x32_bf16 a[12:15], a[84:87], a[156:159], a[12:15]
    s_mov_b32 s67, s60
    s_mov_b32 s60, s61
    s_mov_b32 s61, s62
    v_mfma_f32_16x16x32_bf16 a[8:11], a[80:83], a[156:159], a[8:11]
    s_mov_b32 s62, s67
    v_mfma_f32_16x16x32_bf16 a[8:11], a[48:51], a[152:155], a[8:11]
    v_mfma_f32_16x16x32_bf16 a[20:23], a[44:47], a[152:155], a[20:23]
    v_mfma_f32_16x16x32_bf16 a[20:23], a[76:79], a[156:159], a[20:23]
    v_mfma_f32_16x16x32_bf16 a[16:19], a[72:75], a[156:159], a[16:19]
    v_mfma_f32_16x16x32_bf16 a[16:19], a[40:43], a[152:155], a[16:19]
    v_mfma_f32_16x16x32_bf16 a[28:31], a[36:39], a[152:155], a[28:31]
    v_mfma_f32_16x16x32_bf16 a[28:31], a[68:71], a[156:159], a[28:31]
    v_mfma_f32_16x16x32_bf16 a[24:27], a[64:67], a[156:159], a[24:27]
    v_mfma_f32_16x16x32_bf16 a[24:27], a[32:35], a[152:155], a[24:27]
    s_waitcnt vmcnt(16) lgkmcnt(0)
    s_barrier
    v_mfma_f32_16x16x32_bf16 v[32:35], a[160:163], a[96:99], v[32:35]
    ds_read_b128 a[128:131], v11 offset:8192
    v_mfma_f32_16x16x32_bf16 v[32:35], a[192:195], a[100:103], v[32:35]
    s_add_u32 s66, s58, 114688
    v_mfma_f32_16x16x32_bf16 v[36:39], a[196:199], a[100:103], v[36:39]
    s_add_u32 m0, s62, 16384
    ds_read_b128 a[132:135], v12 offset:8192
    v_mfma_f32_16x16x32_bf16 v[36:39], a[164:167], a[96:99], v[36:39]
    buffer_load_dwordx4 v24, s[44:47], s66 offen offset:0  lds
    v_mfma_f32_16x16x32_bf16 v[40:43], a[168:171], a[96:99], v[40:43]
    ds_read_b128 a[136:139], v11 offset:10240
    v_mfma_f32_16x16x32_bf16 v[40:43], a[200:203], a[100:103], v[40:43]
    v_mfma_f32_16x16x32_bf16 v[44:47], a[204:207], a[100:103], v[44:47]
    ds_read_b128 a[140:143], v12 offset:10240
    v_mfma_f32_16x16x32_bf16 v[44:47], a[172:175], a[96:99], v[44:47]
    s_mov_b32 s92, s20
    s_and_b32 s93, s21, 0xffff
    s_mov_b32 s94, 25088
    v_mfma_f32_16x16x32_bf16 v[48:51], a[176:179], a[96:99], v[48:51]
    s_mov_b32 s95, 0x20000
    ds_read_b128 a[144:147], v11 offset:12288
    v_and_b32 v20, 15, v30
    v_mfma_f32_16x16x32_bf16 v[48:51], a[208:211], a[100:103], v[48:51]
    v_lshrrev_b32 v21, 4, v30
    v_mul_f32 v32, s68, v32
    v_mfma_f32_16x16x32_bf16 v[52:55], a[212:215], a[100:103], v[52:55]
    v_cmp_eq_u32 s[70:71], 3, v21
    v_mul_f32 v33, s68, v33
    v_mfma_f32_16x16x32_bf16 v[52:55], a[180:183], a[96:99], v[52:55]
    buffer_load_dwordx4 v25, s[44:47], s66 offen offset:1024  lds
    v_mfma_f32_16x16x32_bf16 v[56:59], a[184:187], a[96:99], v[56:59]
    v_cmp_eq_u32 s[72:73], 12, v20
    v_mul_f32 v34, s68, v34
    v_mfma_f32_16x16x32_bf16 v[56:59], a[216:219], a[100:103], v[56:59]
    v_cmp_lt_u32 vcc, 11, v20
    v_mul_f32 v35, s68, v35
    v_mfma_f32_16x16x32_bf16 v[60:63], a[220:223], a[100:103], v[60:63]
    v_mul_u32_u24 v21, 224, v21
    v_mul_f32 v36, s68, v36
    v_mfma_f32_16x16x32_bf16 v[60:63], a[188:191], a[96:99], v[60:63]
    v_lshl_add_u32 v20, v20, 1, v21
    v_mul_f32 v37, s68, v37
    v_mfma_f32_16x16x32_bf16 v[68:71], a[188:191], a[104:107], v[68:71]
    v_mov_b32 v19, 1073741824
    v_mul_f32 v38, s68, v38
    v_mfma_f32_16x16x32_bf16 v[68:71], a[220:223], a[108:111], v[68:71]
    v_add_u32 v21, 32, v20
    v_mul_f32 v39, s68, v39
    v_mfma_f32_16x16x32_bf16 v[64:67], a[216:219], a[108:111], v[64:67]
    v_cndmask_b32 v21, v21, v20, vcc
    v_cvt_pk_bf16_f32 v32, v32, v33
    v_mfma_f32_16x16x32_bf16 v[64:67], a[184:187], a[104:107], v[64:67]
    buffer_load_dwordx4 v26, s[44:47], s66 offen offset:2048  lds
    v_mfma_f32_16x16x32_bf16 v[76:79], a[180:183], a[104:107], v[76:79]
    v_cndmask_b32 v22, v20, v19, s[70:71]
    v_cvt_pk_bf16_f32 v33, v34, v35
    v_mfma_f32_16x16x32_bf16 v[76:79], a[212:215], a[108:111], v[76:79]
    v_cndmask_b32 v23, v21, v19, s[70:71]
    v_cvt_pk_bf16_f32 v34, v36, v37
    s_mul_i32 s76, s14, 1568
    v_mfma_f32_16x16x32_bf16 v[72:75], a[208:211], a[108:111], v[72:75]
    buffer_load_ushort a224, v20, s[92:95], s76 offen offset:0
    v_mfma_f32_16x16x32_bf16 v[72:75], a[176:179], a[104:107], v[72:75]
    buffer_load_ushort a225, v20, s[92:95], s76 offen offset:56
    v_mfma_f32_16x16x32_bf16 v[84:87], a[172:175], a[104:107], v[84:87]
    buffer_load_ushort a226, v20, s[92:95], s76 offen offset:112
    v_mfma_f32_16x16x32_bf16 v[84:87], a[204:207], a[108:111], v[84:87]
    buffer_load_ushort a227, v20, s[92:95], s76 offen offset:168
    v_mfma_f32_16x16x32_bf16 v[80:83], a[200:203], a[108:111], v[80:83]
    buffer_load_ushort a228, v22, s[92:95], s76 offen offset:896
    v_mfma_f32_16x16x32_bf16 v[80:83], a[168:171], a[104:107], v[80:83]
    buffer_load_dwordx4 v27, s[44:47], s66 offen offset:3072  lds
    v_mfma_f32_16x16x32_bf16 v[92:95], a[164:167], a[104:107], v[92:95]
    s_add_u32 s58, s58, 128
    buffer_load_ushort a229, v22, s[92:95], s76 offen offset:952
    v_mfma_f32_16x16x32_bf16 v[92:95], a[196:199], a[108:111], v[92:95]
    buffer_load_ushort a230, v22, s[92:95], s76 offen offset:1008
    v_mfma_f32_16x16x32_bf16 v[88:91], a[192:195], a[108:111], v[88:91]
    buffer_load_ushort a231, v22, s[92:95], s76 offen offset:1064
    v_mfma_f32_16x16x32_bf16 v[88:91], a[160:163], a[104:107], v[88:91]
    v_cvt_pk_bf16_f32 v35, v38, v39
    ds_read_b128 a[148:151], v12 offset:12288
    v_mfma_f32_16x16x32_bf16 v[96:99], a[160:163], a[112:115], v[96:99]
    v_mul_f32 v40, s68, v40
    ds_read_b128 a[152:155], v11 offset:14336
    v_mfma_f32_16x16x32_bf16 v[96:99], a[192:195], a[116:119], v[96:99]
    buffer_load_ushort a232, v21, s[92:95], s76 offen offset:0
    v_mfma_f32_16x16x32_bf16 v[100:103], a[196:199], a[116:119], v[100:103]
    s_add_u32 m0, s63, 49152
    v_mul_f32 v41, s68, v41
    ds_read_b128 a[156:159], v12 offset:14336
    v_mfma_f32_16x16x32_bf16 v[100:103], a[164:167], a[112:115], v[100:103]
    buffer_load_dwordx4 v28, s[48:51], s59 offen offset:0  lds
    v_mfma_f32_16x16x32_bf16 v[104:107], a[168:171], a[112:115], v[104:107]
    buffer_load_ushort a233, v21, s[92:95], s76 offen offset:56
    v_mfma_f32_16x16x32_bf16 v[104:107], a[200:203], a[116:119], v[104:107]
    v_mul_f32 v42, s68, v42
    v_add_u32 v11, s61, v9
    v_mfma_f32_16x16x32_bf16 v[108:111], a[204:207], a[116:119], v[108:111]
    v_mul_f32 v43, s68, v43
    v_add_u32 v12, s61, v10
    v_mfma_f32_16x16x32_bf16 v[108:111], a[172:175], a[112:115], v[108:111]
    buffer_load_ushort a234, v21, s[92:95], s76 offen offset:112
    v_mfma_f32_16x16x32_bf16 v[112:115], a[176:179], a[112:115], v[112:115]
    v_mul_f32 v44, s68, v44
    v_mul_f32 v45, s68, v45
    v_mfma_f32_16x16x32_bf16 v[112:115], a[208:211], a[116:119], v[112:115]
    v_mul_f32 v46, s68, v46
    v_mul_f32 v47, s68, v47
    v_mfma_f32_16x16x32_bf16 v[116:119], a[212:215], a[116:119], v[116:119]
    buffer_load_ushort a235, v21, s[92:95], s76 offen offset:168
    v_mfma_f32_16x16x32_bf16 v[116:119], a[180:183], a[112:115], v[116:119]
    buffer_load_dwordx4 v29, s[48:51], s59 offen offset:1024  lds
    v_mfma_f32_16x16x32_bf16 v[120:123], a[184:187], a[112:115], v[120:123]
    s_add_u32 s59, s59, 86016
    v_cvt_pk_bf16_f32 v36, v40, v41
    v_cvt_pk_bf16_f32 v37, v42, v43
    v_mfma_f32_16x16x32_bf16 v[120:123], a[216:219], a[116:119], v[120:123]
    buffer_load_ushort a236, v23, s[92:95], s76 offen offset:896
    v_mfma_f32_16x16x32_bf16 v[124:127], a[220:223], a[116:119], v[124:127]
    v_cvt_pk_bf16_f32 v38, v44, v45
    v_cvt_pk_bf16_f32 v39, v46, v47
    v_mfma_f32_16x16x32_bf16 v[124:127], a[188:191], a[112:115], v[124:127]
    v_mul_f32 v48, s68, v48
    v_mul_f32 v49, s68, v49
    v_mfma_f32_16x16x32_bf16 v[132:135], a[188:191], a[120:123], v[132:135]
    buffer_load_ushort a237, v23, s[92:95], s76 offen offset:952
    v_mfma_f32_16x16x32_bf16 v[132:135], a[220:223], a[124:127], v[132:135]
    v_mul_f32 v50, s68, v50
    v_mul_f32 v51, s68, v51
    v_mfma_f32_16x16x32_bf16 v[128:131], a[216:219], a[124:127], v[128:131]
    v_mul_f32 v52, s68, v52
    v_mul_f32 v53, s68, v53
    v_mfma_f32_16x16x32_bf16 v[128:131], a[184:187], a[120:123], v[128:131]
    buffer_load_ushort a238, v23, s[92:95], s76 offen offset:1008
    v_mfma_f32_16x16x32_bf16 v[140:143], a[180:183], a[120:123], v[140:143]
    v_mul_f32 v54, s68, v54
    v_mul_f32 v55, s68, v55
    v_mfma_f32_16x16x32_bf16 v[140:143], a[212:215], a[124:127], v[140:143]
    v_cvt_pk_bf16_f32 v40, v48, v49
    v_cvt_pk_bf16_f32 v41, v50, v51
    v_mfma_f32_16x16x32_bf16 v[136:139], a[208:211], a[124:127], v[136:139]
    buffer_load_ushort a239, v23, s[92:95], s76 offen offset:1064
    v_mfma_f32_16x16x32_bf16 v[136:139], a[176:179], a[120:123], v[136:139]
    v_cvt_pk_bf16_f32 v42, v52, v53
    v_cvt_pk_bf16_f32 v43, v54, v55
    v_mfma_f32_16x16x32_bf16 v[148:151], a[172:175], a[120:123], v[148:151]
    v_mul_f32 v56, s68, v56
    v_mul_f32 v57, s68, v57
    v_mfma_f32_16x16x32_bf16 v[148:151], a[204:207], a[124:127], v[148:151]
    v_mul_f32 v58, s68, v58
    v_mul_f32 v59, s68, v59
    v_mfma_f32_16x16x32_bf16 v[144:147], a[200:203], a[124:127], v[144:147]
    v_mul_f32 v60, s68, v60
    v_mul_f32 v61, s68, v61
    v_mfma_f32_16x16x32_bf16 v[144:147], a[168:171], a[120:123], v[144:147]
    v_mul_f32 v62, s68, v62
    v_mul_f32 v63, s68, v63
    v_mfma_f32_16x16x32_bf16 v[156:159], a[164:167], a[120:123], v[156:159]
    v_cvt_pk_bf16_f32 v44, v56, v57
    v_cvt_pk_bf16_f32 v45, v58, v59
    v_mfma_f32_16x16x32_bf16 v[156:159], a[196:199], a[124:127], v[156:159]
    v_cvt_pk_bf16_f32 v46, v60, v61
    v_cvt_pk_bf16_f32 v47, v62, v63
    s_add_u32 s74, s65, 0
    v_mfma_f32_16x16x32_bf16 v[152:155], a[192:195], a[124:127], v[152:155]
    buffer_store_dwordx4 v[32:35], v15, s[40:43], s74 offen offset:0 sc1
    v_mfma_f32_16x16x32_bf16 v[152:155], a[160:163], a[120:123], v[152:155]
    v_mul_f32 v64, s68, v64
    v_mul_f32 v65, s68, v65
    s_waitcnt vmcnt(33) lgkmcnt(0)
    s_barrier
    s_and_b32 s66, s29, 1
    s_lshl_b32 s66, s66, 13
    v_add_u32 v9, s66, v9
    v_add_u32 v10, s66, v10
    v_add_u32 v11, s66, v11
    v_lshrrev_b32 v21, 4, v30
    v_lshl_add_u32 v13, v21, 9, v31
    v_xor_b32 v14, 32, v13
    v_mfma_f32_16x16x32_bf16 v[160:163], a[160:163], a[128:131], v[160:163]
    ds_read_b128 a[32:35], v11 offset:0
    v_mfma_f32_16x16x32_bf16 v[160:163], a[192:195], a[132:135], v[160:163]
    v_mfma_f32_16x16x32_bf16 v[164:167], a[196:199], a[132:135], v[164:167]
    s_mov_b32 m0, s60
    ds_read_b64_tr_b16 a[64:65], v13 offset:0
    v_mfma_f32_16x16x32_bf16 v[164:167], a[164:167], a[128:131], v[164:167]
    buffer_load_dwordx4 v24, s[44:47], s58 offen offset:0  lds
    v_mfma_f32_16x16x32_bf16 v[168:171], a[168:171], a[128:131], v[168:171]
    v_mul_f32 v66, s68, v66
    ds_read_b64_tr_b16 a[66:67], v13 offset:256
    v_mfma_f32_16x16x32_bf16 v[168:171], a[200:203], a[132:135], v[168:171]
    v_mul_f32 v67, s68, v67
    v_mul_f32 v68, s68, v68
    v_mfma_f32_16x16x32_bf16 v[172:175], a[204:207], a[132:135], v[172:175]
    v_mul_f32 v69, s68, v69
    ds_read_b128 a[36:39], v11 offset:2048
    v_mfma_f32_16x16x32_bf16 v[172:175], a[172:175], a[128:131], v[172:175]
    v_mul_f32 v70, s68, v70
    v_mul_f32 v71, s68, v71
    v_mfma_f32_16x16x32_bf16 v[176:179], a[176:179], a[128:131], v[176:179]
    v_cvt_pk_bf16_f32 v48, v64, v65
    ds_read_b64_tr_b16 a[68:69], v14 offset:0
    v_mfma_f32_16x16x32_bf16 v[176:179], a[208:211], a[132:135], v[176:179]
    v_cvt_pk_bf16_f32 v49, v66, v67
    v_cvt_pk_bf16_f32 v50, v68, v69
    v_mfma_f32_16x16x32_bf16 v[180:183], a[212:215], a[132:135], v[180:183]
    v_cvt_pk_bf16_f32 v51, v70, v71
    ds_read_b64_tr_b16 a[70:71], v14 offset:256
    v_mfma_f32_16x16x32_bf16 v[180:183], a[180:183], a[128:131], v[180:183]
    buffer_load_dwordx4 v25, s[44:47], s58 offen offset:1024  lds
    v_mfma_f32_16x16x32_bf16 v[184:187], a[184:187], a[128:131], v[184:187]
    v_mul_f32 v72, s68, v72
    ds_read_b128 a[40:43], v11 offset:4096
    v_mfma_f32_16x16x32_bf16 v[184:187], a[216:219], a[132:135], v[184:187]
    v_mul_f32 v73, s68, v73
    v_mul_f32 v74, s68, v74
    v_mfma_f32_16x16x32_bf16 v[188:191], a[220:223], a[132:135], v[188:191]
    v_mul_f32 v75, s68, v75
    ds_read_b64_tr_b16 a[72:73], v13 offset:4096
    v_mfma_f32_16x16x32_bf16 v[188:191], a[188:191], a[128:131], v[188:191]
    v_mul_f32 v76, s68, v76
    v_mul_f32 v77, s68, v77
    v_mfma_f32_16x16x32_bf16 v[196:199], a[188:191], a[136:139], v[196:199]
    v_mul_f32 v78, s68, v78
    ds_read_b64_tr_b16 a[74:75], v13 offset:4352
    v_mfma_f32_16x16x32_bf16 v[196:199], a[220:223], a[140:143], v[196:199]
    v_mul_f32 v79, s68, v79
    v_cvt_pk_bf16_f32 v52, v72, v73
    v_mfma_f32_16x16x32_bf16 v[192:195], a[216:219], a[140:143], v[192:195]
    v_cvt_pk_bf16_f32 v53, v74, v75
    ds_read_b128 a[44:47], v11 offset:6144
    v_mfma_f32_16x16x32_bf16 v[192:195], a[184:187], a[136:139], v[192:195]
    buffer_load_dwordx4 v26, s[44:47], s58 offen offset:2048  lds
    v_mfma_f32_16x16x32_bf16 v[204:207], a[180:183], a[136:139], v[204:207]
    v_cvt_pk_bf16_f32 v54, v76, v77
    ds_read_b64_tr_b16 a[76:77], v14 offset:4096
    v_mfma_f32_16x16x32_bf16 v[204:207], a[212:215], a[140:143], v[204:207]
    v_cvt_pk_bf16_f32 v55, v78, v79
    v_mul_f32 v80, s68, v80
    v_mfma_f32_16x16x32_bf16 v[200:203], a[208:211], a[140:143], v[200:203]
    v_mul_f32 v81, s68, v81
    ds_read_b64_tr_b16 a[78:79], v14 offset:4352
    v_mfma_f32_16x16x32_bf16 v[200:203], a[176:179], a[136:139], v[200:203]
    v_mul_f32 v82, s68, v82
    v_mul_f32 v83, s68, v83
    v_mfma_f32_16x16x32_bf16 v[212:215], a[172:175], a[136:139], v[212:215]
    v_mul_f32 v84, s68, v84
    ds_read_b64_tr_b16 a[80:81], v13 offset:8192
    v_mfma_f32_16x16x32_bf16 v[212:215], a[204:207], a[140:143], v[212:215]
    v_mul_f32 v85, s68, v85
    v_mul_f32 v86, s68, v86
    v_mfma_f32_16x16x32_bf16 v[208:211], a[200:203], a[140:143], v[208:211]
    v_mul_f32 v87, s68, v87
    ds_read_b64_tr_b16 a[82:83], v13 offset:8448
    v_mfma_f32_16x16x32_bf16 v[208:211], a[168:171], a[136:139], v[208:211]
    buffer_load_dwordx4 v27, s[44:47], s58 offen offset:3072  lds
    v_mfma_f32_16x16x32_bf16 v[220:223], a[164:167], a[136:139], v[220:223]
    v_cvt_pk_bf16_f32 v56, v80, v81
    ds_read_b64_tr_b16 a[84:85], v14 offset:8192
    v_mfma_f32_16x16x32_bf16 v[220:223], a[196:199], a[140:143], v[220:223]
    v_cvt_pk_bf16_f32 v57, v82, v83
    v_cvt_pk_bf16_f32 v58, v84, v85
    v_mfma_f32_16x16x32_bf16 v[216:219], a[192:195], a[140:143], v[216:219]
    v_cvt_pk_bf16_f32 v59, v86, v87
    ds_read_b64_tr_b16 a[86:87], v14 offset:8448
    v_mfma_f32_16x16x32_bf16 v[216:219], a[160:163], a[136:139], v[216:219]
    v_mul_f32 v88, s68, v88
    v_mul_f32 v89, s68, v89
    v_mfma_f32_16x16x32_bf16 v[224:227], a[160:163], a[144:147], v[224:227]
    v_mul_f32 v90, s68, v90
    v_add_u32 v12, s61, v10
    v_mfma_f32_16x16x32_bf16 v[224:227], a[192:195], a[148:151], v[224:227]
    v_mul_f32 v91, s68, v91
    v_mul_f32 v92, s68, v92
    v_mfma_f32_16x16x32_bf16 v[228:231], a[196:199], a[148:151], v[228:231]
    v_mul_f32 v93, s68, v93
    v_mul_f32 v94, s68, v94
    v_mfma_f32_16x16x32_bf16 v[228:231], a[164:167], a[144:147], v[228:231]
    v_mul_f32 v95, s68, v95
    v_cvt_pk_bf16_f32 v60, v88, v89
    v_mfma_f32_16x16x32_bf16 v[232:235], a[168:171], a[144:147], v[232:235]
    v_cvt_pk_bf16_f32 v61, v90, v91
    v_cvt_pk_bf16_f32 v62, v92, v93
    v_mfma_f32_16x16x32_bf16 v[232:235], a[200:203], a[148:151], v[232:235]
    v_cvt_pk_bf16_f32 v63, v94, v95
    v_mul_f32 v96, s68, v96
    v_mfma_f32_16x16x32_bf16 v[236:239], a[204:207], a[148:151], v[236:239]
    v_mul_f32 v97, s68, v97
    v_mul_f32 v98, s68, v98
    v_mfma_f32_16x16x32_bf16 v[236:239], a[172:175], a[144:147], v[236:239]
    v_mul_f32 v99, s68, v99
    v_mul_f32 v100, s68, v100
    v_mfma_f32_16x16x32_bf16 v[240:243], a[176:179], a[144:147], v[240:243]
    v_mul_f32 v101, s68, v101
    v_mul_f32 v102, s68, v102
    v_mfma_f32_16x16x32_bf16 v[240:243], a[208:211], a[148:151], v[240:243]
    v_mul_f32 v103, s68, v103
    v_cvt_pk_bf16_f32 v64, v96, v97
    v_mfma_f32_16x16x32_bf16 v[244:247], a[212:215], a[148:151], v[244:247]
    v_cvt_pk_bf16_f32 v65, v98, v99
    v_cvt_pk_bf16_f32 v66, v100, v101
    v_mfma_f32_16x16x32_bf16 v[244:247], a[180:183], a[144:147], v[244:247]
    v_cvt_pk_bf16_f32 v67, v102, v103
    v_mul_f32 v104, s68, v104
    v_mfma_f32_16x16x32_bf16 v[248:251], a[184:187], a[144:147], v[248:251]
    v_mul_f32 v105, s68, v105
    v_mul_f32 v106, s68, v106
    v_mfma_f32_16x16x32_bf16 v[248:251], a[216:219], a[148:151], v[248:251]
    v_mul_f32 v107, s68, v107
    v_mul_f32 v108, s68, v108
    v_mfma_f32_16x16x32_bf16 v[252:255], a[220:223], a[148:151], v[252:255]
    v_mul_f32 v109, s68, v109
    v_mul_f32 v110, s68, v110
    v_mfma_f32_16x16x32_bf16 v[252:255], a[188:191], a[144:147], v[252:255]
    v_mul_f32 v111, s68, v111
    v_cvt_pk_bf16_f32 v68, v104, v105
    v_mfma_f32_16x16x32_bf16 a[4:7], a[188:191], a[152:155], a[4:7]
    v_cvt_pk_bf16_f32 v69, v106, v107
    v_cvt_pk_bf16_f32 v70, v108, v109
    v_mfma_f32_16x16x32_bf16 a[4:7], a[220:223], a[156:159], a[4:7]
    v_cvt_pk_bf16_f32 v71, v110, v111
    v_mul_f32 v112, s68, v112
    v_mfma_f32_16x16x32_bf16 a[0:3], a[216:219], a[156:159], a[0:3]
    v_mul_f32 v113, s68, v113
    v_mul_f32 v114, s68, v114
    v_mfma_f32_16x16x32_bf16 a[0:3], a[184:187], a[152:155], a[0:3]
    v_mul_f32 v115, s68, v115
    v_mul_f32 v116, s68, v116
    v_mfma_f32_16x16x32_bf16 a[12:15], a[180:183], a[152:155], a[12:15]
    v_mul_f32 v117, s68, v117
    v_mul_f32 v118, s68, v118
    v_mfma_f32_16x16x32_bf16 a[12:15], a[212:215], a[156:159], a[12:15]
    v_mul_f32 v119, s68, v119
    v_cvt_pk_bf16_f32 v72, v112, v113
    v_mfma_f32_16x16x32_bf16 a[8:11], a[208:211], a[156:159], a[8:11]
    v_cvt_pk_bf16_f32 v73, v114, v115
    v_cvt_pk_bf16_f32 v74, v116, v117
    v_mfma_f32_16x16x32_bf16 a[8:11], a[176:179], a[152:155], a[8:11]
    v_cvt_pk_bf16_f32 v75, v118, v119
    v_mul_f32 v120, s68, v120
    v_mfma_f32_16x16x32_bf16 a[20:23], a[172:175], a[152:155], a[20:23]
    v_mul_f32 v121, s68, v121
    v_mul_f32 v122, s68, v122
    v_mfma_f32_16x16x32_bf16 a[20:23], a[204:207], a[156:159], a[20:23]
    v_mul_f32 v123, s68, v123
    v_mul_f32 v124, s68, v124
    v_mfma_f32_16x16x32_bf16 a[16:19], a[200:203], a[156:159], a[16:19]
    v_mul_f32 v125, s68, v125
    v_mul_f32 v126, s68, v126
    v_mfma_f32_16x16x32_bf16 a[16:19], a[168:171], a[152:155], a[16:19]
    v_mul_f32 v127, s68, v127
    v_cvt_pk_bf16_f32 v76, v120, v121
    v_mfma_f32_16x16x32_bf16 a[28:31], a[164:167], a[152:155], a[28:31]
    v_cvt_pk_bf16_f32 v77, v122, v123
    v_cvt_pk_bf16_f32 v78, v124, v125
    v_mfma_f32_16x16x32_bf16 a[28:31], a[196:199], a[156:159], a[28:31]
    s_mov_b32 s67, s60
    v_cvt_pk_bf16_f32 v79, v126, v127
    s_mov_b32 s60, s61
    v_mfma_f32_16x16x32_bf16 a[24:27], a[192:195], a[156:159], a[24:27]
    s_mov_b32 s61, s62
    buffer_store_dwordx4 v[36:39], v15, s[40:43], s74 offen offset:1024 sc1
    s_mov_b32 s62, s67
    v_mfma_f32_16x16x32_bf16 a[24:27], a[160:163], a[152:155], a[24:27]
    v_mul_f32 v128, s68, v128
    v_mul_f32 v129, s68, v129
    v_mul_f32 v130, s68, v130
    v_mul_f32 v131, s68, v131
    v_mul_f32 v132, s68, v132
    v_mul_f32 v133, s68, v133
    v_mul_f32 v134, s68, v134
    v_mul_f32 v135, s68, v135
    v_cvt_pk_bf16_f32 v80, v128, v129
    v_cvt_pk_bf16_f32 v81, v130, v131
    v_cvt_pk_bf16_f32 v82, v132, v133
    v_cvt_pk_bf16_f32 v83, v134, v135
    v_mul_f32 v136, s68, v136
    v_mul_f32 v137, s68, v137
    v_mul_f32 v138, s68, v138
    v_mul_f32 v139, s68, v139
    v_mul_f32 v140, s68, v140
    v_mul_f32 v141, s68, v141
    v_mul_f32 v142, s68, v142
    v_mul_f32 v143, s68, v143
    v_cvt_pk_bf16_f32 v84, v136, v137
    v_cvt_pk_bf16_f32 v85, v138, v139
    v_cvt_pk_bf16_f32 v86, v140, v141
    v_cvt_pk_bf16_f32 v87, v142, v143
    v_pk_mul_f32 v[144:145], v[144:145], s[68:69]
    v_pk_mul_f32 v[146:147], v[146:147], s[68:69]
    v_pk_mul_f32 v[148:149], v[148:149], s[68:69]
    v_pk_mul_f32 v[150:151], v[150:151], s[68:69]
    v_cvt_pk_bf16_f32 v88, v144, v145
    v_cvt_pk_bf16_f32 v89, v146, v147
    v_cvt_pk_bf16_f32 v90, v148, v149
    v_cvt_pk_bf16_f32 v91, v150, v151
    v_pk_mul_f32 v[152:153], v[152:153], s[68:69]
    v_pk_mul_f32 v[154:155], v[154:155], s[68:69]
    v_pk_mul_f32 v[156:157], v[156:157], s[68:69]
    v_pk_mul_f32 v[158:159], v[158:159], s[68:69]
    v_cvt_pk_bf16_f32 v92, v152, v153
    v_cvt_pk_bf16_f32 v93, v154, v155
    v_cvt_pk_bf16_f32 v94, v156, v157
    v_cvt_pk_bf16_f32 v95, v158, v159
    v_pk_mul_f32 v[160:161], v[160:161], s[68:69]
    v_pk_mul_f32 v[162:163], v[162:163], s[68:69]
    v_pk_mul_f32 v[164:165], v[164:165], s[68:69]
    v_pk_mul_f32 v[166:167], v[166:167], s[68:69]
    v_cvt_pk_bf16_f32 v96, v160, v161
    v_cvt_pk_bf16_f32 v97, v162, v163
    v_cvt_pk_bf16_f32 v98, v164, v165
    v_cvt_pk_bf16_f32 v99, v166, v167
    v_pk_mul_f32 v[168:169], v[168:169], s[68:69]
    v_pk_mul_f32 v[170:171], v[170:171], s[68:69]
    v_pk_mul_f32 v[172:173], v[172:173], s[68:69]
    v_pk_mul_f32 v[174:175], v[174:175], s[68:69]
    v_cvt_pk_bf16_f32 v100, v168, v169
    v_cvt_pk_bf16_f32 v101, v170, v171
    v_cvt_pk_bf16_f32 v102, v172, v173
    v_cvt_pk_bf16_f32 v103, v174, v175
    v_pk_mul_f32 v[176:177], v[176:177], s[68:69]
    v_pk_mul_f32 v[178:179], v[178:179], s[68:69]
    v_pk_mul_f32 v[180:181], v[180:181], s[68:69]
    v_pk_mul_f32 v[182:183], v[182:183], s[68:69]
    v_cvt_pk_bf16_f32 v104, v176, v177
    v_cvt_pk_bf16_f32 v105, v178, v179
    v_cvt_pk_bf16_f32 v106, v180, v181
    v_cvt_pk_bf16_f32 v107, v182, v183
    v_pk_mul_f32 v[184:185], v[184:185], s[68:69]
    v_pk_mul_f32 v[186:187], v[186:187], s[68:69]
    v_pk_mul_f32 v[188:189], v[188:189], s[68:69]
    v_pk_mul_f32 v[190:191], v[190:191], s[68:69]
    v_cvt_pk_bf16_f32 v108, v184, v185
    v_cvt_pk_bf16_f32 v109, v186, v187
    v_cvt_pk_bf16_f32 v110, v188, v189
    v_cvt_pk_bf16_f32 v111, v190, v191
    buffer_store_dwordx4 v[40:43], v15, s[40:43], s74 offen offset:2048 sc1
    v_pk_mul_f32 v[192:193], v[192:193], s[68:69]
    v_pk_mul_f32 v[194:195], v[194:195], s[68:69]
    v_pk_mul_f32 v[196:197], v[196:197], s[68:69]
    v_pk_mul_f32 v[198:199], v[198:199], s[68:69]
    v_cvt_pk_bf16_f32 v112, v192, v193
    v_cvt_pk_bf16_f32 v113, v194, v195
    v_cvt_pk_bf16_f32 v114, v196, v197
    v_cvt_pk_bf16_f32 v115, v198, v199
    v_pk_mul_f32 v[200:201], v[200:201], s[68:69]
    v_pk_mul_f32 v[202:203], v[202:203], s[68:69]
    v_pk_mul_f32 v[204:205], v[204:205], s[68:69]
    v_pk_mul_f32 v[206:207], v[206:207], s[68:69]
    v_cvt_pk_bf16_f32 v116, v200, v201
    v_cvt_pk_bf16_f32 v117, v202, v203
    v_cvt_pk_bf16_f32 v118, v204, v205
    v_cvt_pk_bf16_f32 v119, v206, v207
    v_pk_mul_f32 v[208:209], v[208:209], s[68:69]
    v_pk_mul_f32 v[210:211], v[210:211], s[68:69]
    v_pk_mul_f32 v[212:213], v[212:213], s[68:69]
    v_pk_mul_f32 v[214:215], v[214:215], s[68:69]
    v_cvt_pk_bf16_f32 v120, v208, v209
    v_cvt_pk_bf16_f32 v121, v210, v211
    v_cvt_pk_bf16_f32 v122, v212, v213
    v_cvt_pk_bf16_f32 v123, v214, v215
    v_pk_mul_f32 v[216:217], v[216:217], s[68:69]
    v_pk_mul_f32 v[218:219], v[218:219], s[68:69]
    v_pk_mul_f32 v[220:221], v[220:221], s[68:69]
    v_pk_mul_f32 v[222:223], v[222:223], s[68:69]
    v_cvt_pk_bf16_f32 v124, v216, v217
    v_cvt_pk_bf16_f32 v125, v218, v219
    v_cvt_pk_bf16_f32 v126, v220, v221
    v_cvt_pk_bf16_f32 v127, v222, v223
    v_pk_mul_f32 v[224:225], v[224:225], s[68:69]
    v_pk_mul_f32 v[226:227], v[226:227], s[68:69]
    v_pk_mul_f32 v[228:229], v[228:229], s[68:69]
    v_pk_mul_f32 v[230:231], v[230:231], s[68:69]
    v_cvt_pk_bf16_f32 v128, v224, v225
    v_cvt_pk_bf16_f32 v129, v226, v227
    v_cvt_pk_bf16_f32 v130, v228, v229
    v_cvt_pk_bf16_f32 v131, v230, v231
    v_pk_mul_f32 v[232:233], v[232:233], s[68:69]
    v_pk_mul_f32 v[234:235], v[234:235], s[68:69]
    v_pk_mul_f32 v[236:237], v[236:237], s[68:69]
    v_pk_mul_f32 v[238:239], v[238:239], s[68:69]
    v_cvt_pk_bf16_f32 v132, v232, v233
    v_cvt_pk_bf16_f32 v133, v234, v235
    v_cvt_pk_bf16_f32 v134, v236, v237
    v_cvt_pk_bf16_f32 v135, v238, v239
    v_pk_mul_f32 v[240:241], v[240:241], s[68:69]
    v_pk_mul_f32 v[242:243], v[242:243], s[68:69]
    v_pk_mul_f32 v[244:245], v[244:245], s[68:69]
    v_pk_mul_f32 v[246:247], v[246:247], s[68:69]
    v_cvt_pk_bf16_f32 v136, v240, v241
    v_cvt_pk_bf16_f32 v137, v242, v243
    v_cvt_pk_bf16_f32 v138, v244, v245
    v_cvt_pk_bf16_f32 v139, v246, v247
    v_pk_mul_f32 v[248:249], v[248:249], s[68:69]
    v_pk_mul_f32 v[250:251], v[250:251], s[68:69]
    v_pk_mul_f32 v[252:253], v[252:253], s[68:69]
    v_pk_mul_f32 v[254:255], v[254:255], s[68:69]
    v_cvt_pk_bf16_f32 v140, v248, v249
    v_cvt_pk_bf16_f32 v141, v250, v251
    v_cvt_pk_bf16_f32 v142, v252, v253
    v_cvt_pk_bf16_f32 v143, v254, v255
    buffer_store_dwordx4 v[44:47], v15, s[40:43], s74 offen offset:3072 sc1
    v_accvgpr_read_b32 v16, a0
    v_accvgpr_read_b32 v17, a1
    v_accvgpr_read_b32 v18, a2
    v_accvgpr_read_b32 v19, a3
    v_accvgpr_read_b32 v20, a4
    v_accvgpr_read_b32 v21, a5
    v_accvgpr_read_b32 v22, a6
    v_accvgpr_read_b32 v23, a7
    v_pk_mul_f32 v[16:17], v[16:17], s[68:69]
    v_pk_mul_f32 v[18:19], v[18:19], s[68:69]
    v_pk_mul_f32 v[20:21], v[20:21], s[68:69]
    v_pk_mul_f32 v[22:23], v[22:23], s[68:69]
    v_cvt_pk_bf16_f32 v144, v16, v17
    v_cvt_pk_bf16_f32 v145, v18, v19
    v_cvt_pk_bf16_f32 v146, v20, v21
    v_cvt_pk_bf16_f32 v147, v22, v23
    v_accvgpr_read_b32 v16, a8
    v_accvgpr_read_b32 v17, a9
    v_accvgpr_read_b32 v18, a10
    v_accvgpr_read_b32 v19, a11
    v_accvgpr_read_b32 v20, a12
    v_accvgpr_read_b32 v21, a13
    v_accvgpr_read_b32 v22, a14
    v_accvgpr_read_b32 v23, a15
    v_pk_mul_f32 v[16:17], v[16:17], s[68:69]
    v_pk_mul_f32 v[18:19], v[18:19], s[68:69]
    v_pk_mul_f32 v[20:21], v[20:21], s[68:69]
    v_pk_mul_f32 v[22:23], v[22:23], s[68:69]
    v_cvt_pk_bf16_f32 v148, v16, v17
    v_cvt_pk_bf16_f32 v149, v18, v19
    v_cvt_pk_bf16_f32 v150, v20, v21
    v_cvt_pk_bf16_f32 v151, v22, v23
    v_accvgpr_read_b32 v16, a16
    v_accvgpr_read_b32 v17, a17
    v_accvgpr_read_b32 v18, a18
    v_accvgpr_read_b32 v19, a19
    v_accvgpr_read_b32 v20, a20
    v_accvgpr_read_b32 v21, a21
    v_accvgpr_read_b32 v22, a22
    v_accvgpr_read_b32 v23, a23
    v_pk_mul_f32 v[16:17], v[16:17], s[68:69]
    v_pk_mul_f32 v[18:19], v[18:19], s[68:69]
    v_pk_mul_f32 v[20:21], v[20:21], s[68:69]
    v_pk_mul_f32 v[22:23], v[22:23], s[68:69]
    v_cvt_pk_bf16_f32 v152, v16, v17
    v_cvt_pk_bf16_f32 v153, v18, v19
    v_cvt_pk_bf16_f32 v154, v20, v21
    v_cvt_pk_bf16_f32 v155, v22, v23
    v_accvgpr_read_b32 v16, a24
    v_accvgpr_read_b32 v17, a25
    v_accvgpr_read_b32 v18, a26
    v_accvgpr_read_b32 v19, a27
    v_accvgpr_read_b32 v20, a28
    v_accvgpr_read_b32 v21, a29
    v_accvgpr_read_b32 v22, a30
    v_accvgpr_read_b32 v23, a31
    v_pk_mul_f32 v[16:17], v[16:17], s[68:69]
    v_pk_mul_f32 v[18:19], v[18:19], s[68:69]
    v_pk_mul_f32 v[20:21], v[20:21], s[68:69]
    v_pk_mul_f32 v[22:23], v[22:23], s[68:69]
    v_cvt_pk_bf16_f32 v156, v16, v17
    v_cvt_pk_bf16_f32 v157, v18, v19
    v_cvt_pk_bf16_f32 v158, v20, v21
    v_cvt_pk_bf16_f32 v159, v22, v23
    s_waitcnt vmcnt(31) lgkmcnt(0)
    s_barrier
    v_mfma_f32_16x16x32_bf16 v[160:163], a[64:67], a[32:35], 0
    ds_read_b128 a[96:99], v12 offset:0
    s_add_u32 s66, s58, 114688
    v_mfma_f32_16x16x32_bf16 v[164:167], a[68:71], a[32:35], 0
    ds_read_b64_tr_b16 a[128:129], v13 offset:16384
    s_add_u32 m0, s62, 16384
    s_add_u32 s74, s65, 8192
    v_mfma_f32_16x16x32_bf16 v[192:195], a[72:75], a[32:35], 0
    ds_read_b64_tr_b16 a[130:131], v13 offset:16640
    buffer_load_dwordx4 v24, s[44:47], s66 offen offset:0  lds
    v_mfma_f32_16x16x32_bf16 v[196:199], a[76:79], a[32:35], 0
    ds_read_b128 a[100:103], v12 offset:2048
    buffer_store_dwordx4 v[48:51], v15, s[40:43], s74 offen offset:3072 sc1
    v_mfma_f32_16x16x32_bf16 v[224:227], a[32:35], a[80:83], 0
    ds_read_b64_tr_b16 a[132:133], v14 offset:16384
    v_mfma_f32_16x16x32_bf16 v[232:235], a[32:35], a[84:87], 0
    ds_read_b64_tr_b16 a[134:135], v14 offset:16640
    buffer_load_dwordx4 v25, s[44:47], s66 offen offset:1024  lds
    v_mfma_f32_16x16x32_bf16 v[236:239], a[36:39], a[84:87], 0
    ds_read_b128 a[104:107], v12 offset:4096
    buffer_store_dwordx4 v[52:55], v15, s[40:43], s74 offen offset:2048 sc1
    v_mfma_f32_16x16x32_bf16 v[228:231], a[36:39], a[80:83], 0
    ds_read_b64_tr_b16 a[136:137], v13 offset:20480
    v_mfma_f32_16x16x32_bf16 v[204:207], a[76:79], a[36:39], 0
    ds_read_b64_tr_b16 a[138:139], v13 offset:20736
    buffer_load_dwordx4 v26, s[44:47], s66 offen offset:2048  lds
    v_mfma_f32_16x16x32_bf16 v[200:203], a[72:75], a[36:39], 0
    ds_read_b128 a[108:111], v12 offset:6144
    buffer_store_dwordx4 v[56:59], v15, s[40:43], s74 offen offset:1024 sc1
    v_mfma_f32_16x16x32_bf16 v[172:175], a[68:71], a[36:39], 0
    ds_read_b64_tr_b16 a[140:141], v14 offset:20480
    v_mfma_f32_16x16x32_bf16 v[168:171], a[64:67], a[36:39], 0
    ds_read_b64_tr_b16 a[142:143], v14 offset:20736
    buffer_load_dwordx4 v27, s[44:47], s66 offen offset:3072  lds
    v_mfma_f32_16x16x32_bf16 v[176:179], a[64:67], a[40:43], 0
    ds_read_b64_tr_b16 a[144:145], v13 offset:24576
    s_add_u32 s58, s58, 128
    v_mfma_f32_16x16x32_bf16 v[180:183], a[68:71], a[40:43], 0
    ds_read_b64_tr_b16 a[146:147], v13 offset:24832
    s_add_u32 m0, s63, 0
    v_mfma_f32_16x16x32_bf16 v[208:211], a[72:75], a[40:43], 0
    ds_read_b64_tr_b16 a[148:149], v14 offset:24576
    buffer_load_dwordx4 v28, s[48:51], s59 offen offset:0  lds
    v_mfma_f32_16x16x32_bf16 v[212:215], a[76:79], a[40:43], 0
    ds_read_b64_tr_b16 a[150:151], v14 offset:24832
    v_mfma_f32_16x16x32_bf16 v[240:243], a[40:43], a[80:83], 0
    v_xor_b32 v13, 0x8000, v13
    v_xor_b32 v14, 0x8000, v14
    v_mfma_f32_16x16x32_bf16 v[248:251], a[40:43], a[84:87], 0
    v_add_u32 v11, s61, v9
    buffer_load_dwordx4 v29, s[48:51], s59 offen offset:1024  lds
    v_mfma_f32_16x16x32_bf16 v[252:255], a[44:47], a[84:87], 0
    s_add_u32 s59, s59, 86016
    v_mfma_f32_16x16x32_bf16 v[244:247], a[44:47], a[80:83], 0
    v_mfma_f32_16x16x32_bf16 v[220:223], a[76:79], a[44:47], 0
    v_mfma_f32_16x16x32_bf16 v[216:219], a[72:75], a[44:47], 0
    v_mfma_f32_16x16x32_bf16 v[188:191], a[68:71], a[44:47], 0
    v_mfma_f32_16x16x32_bf16 v[184:187], a[64:67], a[44:47], 0
    s_waitcnt vmcnt(21) lgkmcnt(0)
    s_barrier
    v_mfma_f32_16x16x32_bf16 v[160:163], a[128:131], a[96:99], v[160:163]
    ds_read_b128 a[32:35], v11 offset:0
    v_mfma_f32_16x16x32_bf16 v[164:167], a[132:135], a[96:99], v[164:167]
    ds_read_b64_tr_b16 a[64:65], v13 offset:0
    s_mov_b32 m0, s60
    buffer_store_dwordx4 v[60:63], v15, s[40:43], s74 offen offset:0 sc1
    v_mfma_f32_16x16x32_bf16 v[192:195], a[136:139], a[96:99], v[192:195]
    ds_read_b64_tr_b16 a[66:67], v13 offset:256
    buffer_load_dwordx4 v24, s[44:47], s58 offen offset:0  lds
    v_mfma_f32_16x16x32_bf16 v[196:199], a[140:143], a[96:99], v[196:199]
    ds_read_b128 a[36:39], v11 offset:2048
    v_mfma_f32_16x16x32_bf16 v[224:227], a[96:99], a[144:147], v[224:227]
    ds_read_b64_tr_b16 a[68:69], v14 offset:0
    v_mfma_f32_16x16x32_bf16 v[232:235], a[96:99], a[148:151], v[232:235]
    ds_read_b64_tr_b16 a[70:71], v14 offset:256
    buffer_load_dwordx4 v25, s[44:47], s58 offen offset:1024  lds
    v_mfma_f32_16x16x32_bf16 v[236:239], a[100:103], a[148:151], v[236:239]
    ds_read_b128 a[40:43], v11 offset:4096
    v_mfma_f32_16x16x32_bf16 v[228:231], a[100:103], a[144:147], v[228:231]
    ds_read_b64_tr_b16 a[72:73], v13 offset:4096
    s_add_u32 s74, s65, 262144
    buffer_store_dwordx4 v[64:67], v15, s[40:43], s74 offen offset:0 sc1
    v_mfma_f32_16x16x32_bf16 v[204:207], a[140:143], a[100:103], v[204:207]
    ds_read_b64_tr_b16 a[74:75], v13 offset:4352
    buffer_load_dwordx4 v26, s[44:47], s58 offen offset:2048  lds
    v_mfma_f32_16x16x32_bf16 v[200:203], a[136:139], a[100:103], v[200:203]
    ds_read_b128 a[44:47], v11 offset:6144
    v_mfma_f32_16x16x32_bf16 v[172:175], a[132:135], a[100:103], v[172:175]
    ds_read_b64_tr_b16 a[76:77], v14 offset:4096
    v_mfma_f32_16x16x32_bf16 v[168:171], a[128:131], a[100:103], v[168:171]
    ds_read_b64_tr_b16 a[78:79], v14 offset:4352
    buffer_load_dwordx4 v27, s[44:47], s58 offen offset:3072  lds
    v_mfma_f32_16x16x32_bf16 v[176:179], a[128:131], a[104:107], v[176:179]
    ds_read_b64_tr_b16 a[80:81], v13 offset:8192
    v_mfma_f32_16x16x32_bf16 v[180:183], a[132:135], a[104:107], v[180:183]
    ds_read_b64_tr_b16 a[82:83], v13 offset:8448
    s_add_u32 m0, s63, 16384
    v_mfma_f32_16x16x32_bf16 v[208:211], a[136:139], a[104:107], v[208:211]
    ds_read_b64_tr_b16 a[84:85], v14 offset:8192
    buffer_load_dwordx4 v28, s[48:51], s59 offen offset:0  lds
    v_mfma_f32_16x16x32_bf16 v[212:215], a[140:143], a[104:107], v[212:215]
    ds_read_b64_tr_b16 a[86:87], v14 offset:8448
    v_mfma_f32_16x16x32_bf16 v[240:243], a[104:107], a[144:147], v[240:243]
    v_add_u32 v12, s61, v10
    v_mfma_f32_16x16x32_bf16 v[248:251], a[104:107], a[148:151], v[248:251]
    buffer_load_dwordx4 v29, s[48:51], s59 offen offset:1024  lds
    v_mfma_f32_16x16x32_bf16 v[252:255], a[108:111], a[148:151], v[252:255]
    s_add_u32 s59, s59, 86016
    v_mfma_f32_16x16x32_bf16 v[244:247], a[108:111], a[144:147], v[244:247]
    v_mfma_f32_16x16x32_bf16 v[220:223], a[140:143], a[108:111], v[220:223]
    v_mfma_f32_16x16x32_bf16 v[216:219], a[136:139], a[108:111], v[216:219]
    s_xor_b32 s63, s63, 0x8000
    s_mov_b32 s67, s60
    s_mov_b32 s60, s61
    v_mfma_f32_16x16x32_bf16 v[188:191], a[132:135], a[108:111], v[188:191]
    s_mov_b32 s61, s62
    s_mov_b32 s62, s67
    v_mfma_f32_16x16x32_bf16 v[184:187], a[128:131], a[108:111], v[184:187]
    s_waitcnt vmcnt(20) lgkmcnt(0)
    s_barrier
    v_mfma_f32_16x16x32_bf16 v[160:163], a[64:67], a[32:35], v[160:163]
    ds_read_b128 a[96:99], v12 offset:0
    s_add_u32 s66, s58, 114688
    v_mfma_f32_16x16x32_bf16 v[164:167], a[68:71], a[32:35], v[164:167]
    ds_read_b64_tr_b16 a[128:129], v13 offset:16384
    s_add_u32 m0, s62, 16384
    buffer_store_dwordx4 v[68:71], v15, s[40:43], s74 offen offset:1024 sc1
    v_mfma_f32_16x16x32_bf16 v[192:195], a[72:75], a[32:35], v[192:195]
    ds_read_b64_tr_b16 a[130:131], v13 offset:16640
    buffer_load_dwordx4 v24, s[44:47], s66 offen offset:0  lds
    v_mfma_f32_16x16x32_bf16 v[196:199], a[76:79], a[32:35], v[196:199]
    ds_read_b128 a[100:103], v12 offset:2048
    v_mfma_f32_16x16x32_bf16 v[224:227], a[32:35], a[80:83], v[224:227]
    ds_read_b64_tr_b16 a[132:133], v14 offset:16384
    v_mfma_f32_16x16x32_bf16 v[232:235], a[32:35], a[84:87], v[232:235]
    ds_read_b64_tr_b16 a[134:135], v14 offset:16640
    buffer_load_dwordx4 v25, s[44:47], s66 offen offset:1024  lds
    v_mfma_f32_16x16x32_bf16 v[236:239], a[36:39], a[84:87], v[236:239]
    ds_read_b128 a[104:107], v12 offset:4096
    v_mfma_f32_16x16x32_bf16 v[228:231], a[36:39], a[80:83], v[228:231]
    ds_read_b64_tr_b16 a[136:137], v13 offset:20480
    buffer_store_dwordx4 v[72:75], v15, s[40:43], s74 offen offset:2048 sc1
    v_mfma_f32_16x16x32_bf16 v[204:207], a[76:79], a[36:39], v[204:207]
    ds_read_b64_tr_b16 a[138:139], v13 offset:20736
    buffer_load_dwordx4 v26, s[44:47], s66 offen offset:2048  lds
    v_mfma_f32_16x16x32_bf16 v[200:203], a[72:75], a[36:39], v[200:203]
    ds_read_b128 a[108:111], v12 offset:6144
    v_mfma_f32_16x16x32_bf16 v[172:175], a[68:71], a[36:39], v[172:175]
    ds_read_b64_tr_b16 a[140:141], v14 offset:20480
    v_mfma_f32_16x16x32_bf16 v[168:171], a[64:67], a[36:39], v[168:171]
    ds_read_b64_tr_b16 a[142:143], v14 offset:20736
    buffer_load_dwordx4 v27, s[44:47], s66 offen offset:3072  lds
    v_mfma_f32_16x16x32_bf16 v[176:179], a[64:67], a[40:43], v[176:179]
    ds_read_b64_tr_b16 a[144:145], v13 offset:24576
    s_add_u32 s58, s58, 128
    v_mfma_f32_16x16x32_bf16 v[180:183], a[68:71], a[40:43], v[180:183]
    ds_read_b64_tr_b16 a[146:147], v13 offset:24832
    s_add_u32 m0, s63, 0
    v_mfma_f32_16x16x32_bf16 v[208:211], a[72:75], a[40:43], v[208:211]
    ds_read_b64_tr_b16 a[148:149], v14 offset:24576
    buffer_load_dwordx4 v28, s[48:51], s59 offen offset:0  lds
    v_mfma_f32_16x16x32_bf16 v[212:215], a[76:79], a[40:43], v[212:215]
    ds_read_b64_tr_b16 a[150:151], v14 offset:24832
    v_mfma_f32_16x16x32_bf16 v[240:243], a[40:43], a[80:83], v[240:243]
    v_xor_b32 v13, 0x8000, v13
    v_xor_b32 v14, 0x8000, v14
    v_mfma_f32_16x16x32_bf16 v[248:251], a[40:43], a[84:87], v[248:251]
    v_add_u32 v11, s61, v9
    buffer_load_dwordx4 v29, s[48:51], s59 offen offset:1024  lds
    v_mfma_f32_16x16x32_bf16 v[252:255], a[44:47], a[84:87], v[252:255]
    s_add_u32 s59, s59, 86016
    v_mfma_f32_16x16x32_bf16 v[244:247], a[44:47], a[80:83], v[244:247]
    v_mfma_f32_16x16x32_bf16 v[220:223], a[76:79], a[44:47], v[220:223]
    v_mfma_f32_16x16x32_bf16 v[216:219], a[72:75], a[44:47], v[216:219]
    v_mfma_f32_16x16x32_bf16 v[188:191], a[68:71], a[44:47], v[188:191]
    v_mfma_f32_16x16x32_bf16 v[184:187], a[64:67], a[44:47], v[184:187]
    s_waitcnt vmcnt(16) lgkmcnt(0)
    s_barrier
    v_mfma_f32_16x16x32_bf16 v[160:163], a[128:131], a[96:99], v[160:163]
    ds_read_b128 a[32:35], v11 offset:0
    v_mfma_f32_16x16x32_bf16 v[164:167], a[132:135], a[96:99], v[164:167]
    ds_read_b64_tr_b16 a[64:65], v13 offset:0
    s_mov_b32 m0, s60
    buffer_store_dwordx4 v[76:79], v15, s[40:43], s74 offen offset:3072 sc1
    v_mfma_f32_16x16x32_bf16 v[192:195], a[136:139], a[96:99], v[192:195]
    ds_read_b64_tr_b16 a[66:67], v13 offset:256
    buffer_load_dwordx4 v24, s[44:47], s58 offen offset:0  lds
    v_mfma_f32_16x16x32_bf16 v[196:199], a[140:143], a[96:99], v[196:199]
    ds_read_b128 a[36:39], v11 offset:2048
    v_mfma_f32_16x16x32_bf16 v[224:227], a[96:99], a[144:147], v[224:227]
    ds_read_b64_tr_b16 a[68:69], v14 offset:0
    v_mfma_f32_16x16x32_bf16 v[232:235], a[96:99], a[148:151], v[232:235]
    ds_read_b64_tr_b16 a[70:71], v14 offset:256
    buffer_load_dwordx4 v25, s[44:47], s58 offen offset:1024  lds
    v_mfma_f32_16x16x32_bf16 v[236:239], a[100:103], a[148:151], v[236:239]
    ds_read_b128 a[40:43], v11 offset:4096
    v_mfma_f32_16x16x32_bf16 v[228:231], a[100:103], a[144:147], v[228:231]
    ds_read_b64_tr_b16 a[72:73], v13 offset:4096
    s_add_u32 s74, s65, 270336
    buffer_store_dwordx4 v[80:83], v15, s[40:43], s74 offen offset:3072 sc1
    v_mfma_f32_16x16x32_bf16 v[204:207], a[140:143], a[100:103], v[204:207]
    ds_read_b64_tr_b16 a[74:75], v13 offset:4352
    buffer_load_dwordx4 v26, s[44:47], s58 offen offset:2048  lds
    v_mfma_f32_16x16x32_bf16 v[200:203], a[136:139], a[100:103], v[200:203]
    ds_read_b128 a[44:47], v11 offset:6144
    v_mfma_f32_16x16x32_bf16 v[172:175], a[132:135], a[100:103], v[172:175]
    ds_read_b64_tr_b16 a[76:77], v14 offset:4096
    v_mfma_f32_16x16x32_bf16 v[168:171], a[128:131], a[100:103], v[168:171]
    ds_read_b64_tr_b16 a[78:79], v14 offset:4352
    buffer_load_dwordx4 v27, s[44:47], s58 offen offset:3072  lds
    v_mfma_f32_16x16x32_bf16 v[176:179], a[128:131], a[104:107], v[176:179]
    ds_read_b64_tr_b16 a[80:81], v13 offset:8192
    v_mfma_f32_16x16x32_bf16 v[180:183], a[132:135], a[104:107], v[180:183]
    ds_read_b64_tr_b16 a[82:83], v13 offset:8448
    s_add_u32 m0, s63, 16384
    v_mfma_f32_16x16x32_bf16 v[208:211], a[136:139], a[104:107], v[208:211]
    ds_read_b64_tr_b16 a[84:85], v14 offset:8192
    buffer_load_dwordx4 v28, s[48:51], s59 offen offset:0  lds
    v_mfma_f32_16x16x32_bf16 v[212:215], a[140:143], a[104:107], v[212:215]
    ds_read_b64_tr_b16 a[86:87], v14 offset:8448
    v_mfma_f32_16x16x32_bf16 v[240:243], a[104:107], a[144:147], v[240:243]
    v_add_u32 v12, s61, v10
    v_mfma_f32_16x16x32_bf16 v[248:251], a[104:107], a[148:151], v[248:251]
    buffer_load_dwordx4 v29, s[48:51], s59 offen offset:1024  lds
    v_mfma_f32_16x16x32_bf16 v[252:255], a[108:111], a[148:151], v[252:255]
    s_add_u32 s59, s59, 86016
    v_mfma_f32_16x16x32_bf16 v[244:247], a[108:111], a[144:147], v[244:247]
    v_mfma_f32_16x16x32_bf16 v[220:223], a[140:143], a[108:111], v[220:223]
    v_mfma_f32_16x16x32_bf16 v[216:219], a[136:139], a[108:111], v[216:219]
    s_xor_b32 s63, s63, 0x8000
    s_mov_b32 s67, s60
    s_mov_b32 s60, s61
    v_mfma_f32_16x16x32_bf16 v[188:191], a[132:135], a[108:111], v[188:191]
    s_mov_b32 s61, s62
    s_mov_b32 s62, s67
    v_mfma_f32_16x16x32_bf16 v[184:187], a[128:131], a[108:111], v[184:187]
    s_waitcnt vmcnt(16) lgkmcnt(0)
    s_barrier
    v_mfma_f32_16x16x32_bf16 v[160:163], a[64:67], a[32:35], v[160:163]
    ds_read_b128 a[96:99], v12 offset:0
    s_add_u32 s66, s58, 114688
    v_mfma_f32_16x16x32_bf16 v[164:167], a[68:71], a[32:35], v[164:167]
    ds_read_b64_tr_b16 a[128:129], v13 offset:16384
    s_add_u32 m0, s62, 16384
    buffer_store_dwordx4 v[84:87], v15, s[40:43], s74 offen offset:2048 sc1
    v_mfma_f32_16x16x32_bf16 v[192:195], a[72:75], a[32:35], v[192:195]
    ds_read_b64_tr_b16 a[130:131], v13 offset:16640
    buffer_load_dwordx4 v24, s[44:47], s66 offen offset:0  lds
    v_mfma_f32_16x16x32_bf16 v[196:199], a[76:79], a[32:35], v[196:199]
    ds_read_b128 a[100:103], v12 offset:2048
    v_mfma_f32_16x16x32_bf16 v[224:227], a[32:35], a[80:83], v[224:227]
    ds_read_b64_tr_b16 a[132:133], v14 offset:16384
    v_mfma_f32_16x16x32_bf16 v[232:235], a[32:35], a[84:87], v[232:235]
    ds_read_b64_tr_b16 a[134:135], v14 offset:16640
    buffer_load_dwordx4 v25, s[44:47], s66 offen offset:1024  lds
    v_mfma_f32_16x16x32_bf16 v[236:239], a[36:39], a[84:87], v[236:239]
    ds_read_b128 a[104:107], v12 offset:4096
    v_mfma_f32_16x16x32_bf16 v[228:231], a[36:39], a[80:83], v[228:231]
    ds_read_b64_tr_b16 a[136:137], v13 offset:20480
    buffer_store_dwordx4 v[88:91], v15, s[40:43], s74 offen offset:1024 sc1
    v_mfma_f32_16x16x32_bf16 v[204:207], a[76:79], a[36:39], v[204:207]
    ds_read_b64_tr_b16 a[138:139], v13 offset:20736
    buffer_load_dwordx4 v26, s[44:47], s66 offen offset:2048  lds
    v_mfma_f32_16x16x32_bf16 v[200:203], a[72:75], a[36:39], v[200:203]
    ds_read_b128 a[108:111], v12 offset:6144
    v_mfma_f32_16x16x32_bf16 v[172:175], a[68:71], a[36:39], v[172:175]
    ds_read_b64_tr_b16 a[140:141], v14 offset:20480
    v_mfma_f32_16x16x32_bf16 v[168:171], a[64:67], a[36:39], v[168:171]
    ds_read_b64_tr_b16 a[142:143], v14 offset:20736
    buffer_load_dwordx4 v27, s[44:47], s66 offen offset:3072  lds
    v_mfma_f32_16x16x32_bf16 v[176:179], a[64:67], a[40:43], v[176:179]
    ds_read_b64_tr_b16 a[144:145], v13 offset:24576
    s_add_u32 s58, s58, 128
    v_mfma_f32_16x16x32_bf16 v[180:183], a[68:71], a[40:43], v[180:183]
    ds_read_b64_tr_b16 a[146:147], v13 offset:24832
    s_add_u32 m0, s63, 0
    v_mfma_f32_16x16x32_bf16 v[208:211], a[72:75], a[40:43], v[208:211]
    ds_read_b64_tr_b16 a[148:149], v14 offset:24576
    buffer_load_dwordx4 v28, s[48:51], s59 offen offset:0  lds
    v_mfma_f32_16x16x32_bf16 v[212:215], a[76:79], a[40:43], v[212:215]
    ds_read_b64_tr_b16 a[150:151], v14 offset:24832
    v_mfma_f32_16x16x32_bf16 v[240:243], a[40:43], a[80:83], v[240:243]
    v_xor_b32 v13, 0x8000, v13
    v_xor_b32 v14, 0x8000, v14
    v_mfma_f32_16x16x32_bf16 v[248:251], a[40:43], a[84:87], v[248:251]
    v_add_u32 v11, s61, v9
    buffer_load_dwordx4 v29, s[48:51], s59 offen offset:1024  lds
    v_mfma_f32_16x16x32_bf16 v[252:255], a[44:47], a[84:87], v[252:255]
    s_add_u32 s59, s59, 86016
    v_mfma_f32_16x16x32_bf16 v[244:247], a[44:47], a[80:83], v[244:247]
    v_mfma_f32_16x16x32_bf16 v[220:223], a[76:79], a[44:47], v[220:223]
    v_mfma_f32_16x16x32_bf16 v[216:219], a[72:75], a[44:47], v[216:219]
    v_mfma_f32_16x16x32_bf16 v[188:191], a[68:71], a[44:47], v[188:191]
    v_mfma_f32_16x16x32_bf16 v[184:187], a[64:67], a[44:47], v[184:187]
    s_waitcnt vmcnt(16) lgkmcnt(0)
    s_barrier
    v_mfma_f32_16x16x32_bf16 v[160:163], a[128:131], a[96:99], v[160:163]
    ds_read_b128 a[32:35], v11 offset:0
    buffer_store_dword v2, v3, s[40:43], s56 offen sc1
    v_mfma_f32_16x16x32_bf16 v[164:167], a[132:135], a[96:99], v[164:167]
    ds_read_b64_tr_b16 a[64:65], v13 offset:0
    s_mov_b32 m0, s60
    v_mfma_f32_16x16x32_bf16 v[192:195], a[136:139], a[96:99], v[192:195]
    ds_read_b64_tr_b16 a[66:67], v13 offset:256
    buffer_load_dwordx4 v24, s[44:47], s58 offen offset:0  lds
    v_mfma_f32_16x16x32_bf16 v[196:199], a[140:143], a[96:99], v[196:199]
    ds_read_b128 a[36:39], v11 offset:2048
    v_mov_b32 v2, 2
    v_mfma_f32_16x16x32_bf16 v[224:227], a[96:99], a[144:147], v[224:227]
    ds_read_b64_tr_b16 a[68:69], v14 offset:0
    buffer_store_dwordx4 v[92:95], v15, s[40:43], s74 offen offset:0 sc1
    v_mfma_f32_16x16x32_bf16 v[232:235], a[96:99], a[148:151], v[232:235]
    ds_read_b64_tr_b16 a[70:71], v14 offset:256
    buffer_load_dwordx4 v25, s[44:47], s58 offen offset:1024  lds
    v_mfma_f32_16x16x32_bf16 v[236:239], a[100:103], a[148:151], v[236:239]
    ds_read_b128 a[40:43], v11 offset:4096
    v_mfma_f32_16x16x32_bf16 v[228:231], a[100:103], a[144:147], v[228:231]
    ds_read_b64_tr_b16 a[72:73], v13 offset:4096
    s_add_u32 s74, s65, 524288
    buffer_store_dwordx4 v[96:99], v15, s[40:43], s74 offen offset:0 sc1
    v_mfma_f32_16x16x32_bf16 v[204:207], a[140:143], a[100:103], v[204:207]
    ds_read_b64_tr_b16 a[74:75], v13 offset:4352
    buffer_load_dwordx4 v26, s[44:47], s58 offen offset:2048  lds
    v_mfma_f32_16x16x32_bf16 v[200:203], a[136:139], a[100:103], v[200:203]
    ds_read_b128 a[44:47], v11 offset:6144
    v_mfma_f32_16x16x32_bf16 v[172:175], a[132:135], a[100:103], v[172:175]
    ds_read_b64_tr_b16 a[76:77], v14 offset:4096
    v_mfma_f32_16x16x32_bf16 v[168:171], a[128:131], a[100:103], v[168:171]
    ds_read_b64_tr_b16 a[78:79], v14 offset:4352
    buffer_load_dwordx4 v27, s[44:47], s58 offen offset:3072  lds
    v_mfma_f32_16x16x32_bf16 v[176:179], a[128:131], a[104:107], v[176:179]
    ds_read_b64_tr_b16 a[80:81], v13 offset:8192
    v_mfma_f32_16x16x32_bf16 v[180:183], a[132:135], a[104:107], v[180:183]
    ds_read_b64_tr_b16 a[82:83], v13 offset:8448
    s_add_u32 m0, s63, 16384
    v_mfma_f32_16x16x32_bf16 v[208:211], a[136:139], a[104:107], v[208:211]
    ds_read_b64_tr_b16 a[84:85], v14 offset:8192
    buffer_load_dwordx4 v28, s[48:51], s59 offen offset:0  lds
    v_mfma_f32_16x16x32_bf16 v[212:215], a[140:143], a[104:107], v[212:215]
    ds_read_b64_tr_b16 a[86:87], v14 offset:8448
    v_mfma_f32_16x16x32_bf16 v[240:243], a[104:107], a[144:147], v[240:243]
    v_add_u32 v12, s61, v10
    v_mfma_f32_16x16x32_bf16 v[248:251], a[104:107], a[148:151], v[248:251]
    buffer_load_dwordx4 v29, s[48:51], s59 offen offset:1024  lds
    v_mfma_f32_16x16x32_bf16 v[252:255], a[108:111], a[148:151], v[252:255]
    s_add_u32 s59, s59, 86016
    v_mfma_f32_16x16x32_bf16 v[244:247], a[108:111], a[144:147], v[244:247]
    v_mfma_f32_16x16x32_bf16 v[220:223], a[140:143], a[108:111], v[220:223]
    v_mfma_f32_16x16x32_bf16 v[216:219], a[136:139], a[108:111], v[216:219]
    s_xor_b32 s63, s63, 0x8000
    s_mov_b32 s67, s60
    s_mov_b32 s60, s61
    v_mfma_f32_16x16x32_bf16 v[188:191], a[132:135], a[108:111], v[188:191]
    s_mov_b32 s61, s62
    s_mov_b32 s62, s67
    v_mfma_f32_16x16x32_bf16 v[184:187], a[128:131], a[108:111], v[184:187]
    s_waitcnt vmcnt(17) lgkmcnt(0)
    s_barrier
    v_mfma_f32_16x16x32_bf16 v[160:163], a[64:67], a[32:35], v[160:163]
    ds_read_b128 a[96:99], v12 offset:0
    s_add_u32 s66, s58, 114688
    v_mfma_f32_16x16x32_bf16 v[164:167], a[68:71], a[32:35], v[164:167]
    ds_read_b64_tr_b16 a[128:129], v13 offset:16384
    s_add_u32 m0, s62, 16384
    buffer_store_dwordx4 v[100:103], v15, s[40:43], s74 offen offset:1024 sc1
    v_mfma_f32_16x16x32_bf16 v[192:195], a[72:75], a[32:35], v[192:195]
    ds_read_b64_tr_b16 a[130:131], v13 offset:16640
    buffer_load_dwordx4 v24, s[44:47], s66 offen offset:0  lds
    v_mfma_f32_16x16x32_bf16 v[196:199], a[76:79], a[32:35], v[196:199]
    ds_read_b128 a[100:103], v12 offset:2048
    v_mfma_f32_16x16x32_bf16 v[224:227], a[32:35], a[80:83], v[224:227]
    ds_read_b64_tr_b16 a[132:133], v14 offset:16384
    v_mfma_f32_16x16x32_bf16 v[232:235], a[32:35], a[84:87], v[232:235]
    ds_read_b64_tr_b16 a[134:135], v14 offset:16640
    buffer_load_dwordx4 v25, s[44:47], s66 offen offset:1024  lds
    v_mfma_f32_16x16x32_bf16 v[236:239], a[36:39], a[84:87], v[236:239]
    ds_read_b128 a[104:107], v12 offset:4096
    buffer_store_dwordx4 v[104:107], v15, s[40:43], s74 offen offset:2048 sc1
    v_mfma_f32_16x16x32_bf16 v[228:231], a[36:39], a[80:83], v[228:231]
    ds_read_b64_tr_b16 a[136:137], v13 offset:20480
    v_mfma_f32_16x16x32_bf16 v[204:207], a[76:79], a[36:39], v[204:207]
    ds_read_b64_tr_b16 a[138:139], v13 offset:20736
    buffer_load_dwordx4 v26, s[44:47], s66 offen offset:2048  lds
    v_mfma_f32_16x16x32_bf16 v[200:203], a[72:75], a[36:39], v[200:203]
    ds_read_b128 a[108:111], v12 offset:6144
    buffer_store_dwordx4 v[108:111], v15, s[40:43], s74 offen offset:3072 sc1
    v_mfma_f32_16x16x32_bf16 v[172:175], a[68:71], a[36:39], v[172:175]
    ds_read_b64_tr_b16 a[140:141], v14 offset:20480
    v_mfma_f32_16x16x32_bf16 v[168:171], a[64:67], a[36:39], v[168:171]
    ds_read_b64_tr_b16 a[142:143], v14 offset:20736
    buffer_load_dwordx4 v27, s[44:47], s66 offen offset:3072  lds
    v_mfma_f32_16x16x32_bf16 v[176:179], a[64:67], a[40:43], v[176:179]
    ds_read_b64_tr_b16 a[144:145], v13 offset:24576
    s_add_u32 s58, s58, 128
    v_mfma_f32_16x16x32_bf16 v[180:183], a[68:71], a[40:43], v[180:183]
    ds_read_b64_tr_b16 a[146:147], v13 offset:24832
    s_add_u32 m0, s63, 0
    v_mfma_f32_16x16x32_bf16 v[208:211], a[72:75], a[40:43], v[208:211]
    ds_read_b64_tr_b16 a[148:149], v14 offset:24576
    buffer_load_dwordx4 v28, s[48:51], s59 offen offset:0  lds
    v_mfma_f32_16x16x32_bf16 v[212:215], a[76:79], a[40:43], v[212:215]
    ds_read_b64_tr_b16 a[150:151], v14 offset:24832
    v_mfma_f32_16x16x32_bf16 v[240:243], a[40:43], a[80:83], v[240:243]
    v_xor_b32 v13, 0x8000, v13
    v_xor_b32 v14, 0x8000, v14
    v_mfma_f32_16x16x32_bf16 v[248:251], a[40:43], a[84:87], v[248:251]
    v_add_u32 v11, s61, v9
    buffer_load_dwordx4 v29, s[48:51], s59 offen offset:1024  lds
    v_mfma_f32_16x16x32_bf16 v[252:255], a[44:47], a[84:87], v[252:255]
    s_add_u32 s59, s59, 86016
    v_mfma_f32_16x16x32_bf16 v[244:247], a[44:47], a[80:83], v[244:247]
    v_mfma_f32_16x16x32_bf16 v[220:223], a[76:79], a[44:47], v[220:223]
    v_mfma_f32_16x16x32_bf16 v[216:219], a[72:75], a[44:47], v[216:219]
    v_mfma_f32_16x16x32_bf16 v[188:191], a[68:71], a[44:47], v[188:191]
    v_mfma_f32_16x16x32_bf16 v[184:187], a[64:67], a[44:47], v[184:187]
    s_waitcnt vmcnt(18) lgkmcnt(0)
    s_barrier
    v_mfma_f32_16x16x32_bf16 v[160:163], a[128:131], a[96:99], v[160:163]
    ds_read_b128 a[32:35], v11 offset:0
    v_mfma_f32_16x16x32_bf16 v[164:167], a[132:135], a[96:99], v[164:167]
    ds_read_b64_tr_b16 a[64:65], v13 offset:0
    s_mov_b32 m0, s60
    s_add_u32 s74, s65, 532480
    v_mfma_f32_16x16x32_bf16 v[192:195], a[136:139], a[96:99], v[192:195]
    ds_read_b64_tr_b16 a[66:67], v13 offset:256
    buffer_load_dwordx4 v24, s[44:47], s58 offen offset:0  lds
    v_mfma_f32_16x16x32_bf16 v[196:199], a[140:143], a[96:99], v[196:199]
    ds_read_b128 a[36:39], v11 offset:2048
    buffer_store_dwordx4 v[112:115], v15, s[40:43], s74 offen offset:3072 sc1
    v_mfma_f32_16x16x32_bf16 v[224:227], a[96:99], a[144:147], v[224:227]
    ds_read_b64_tr_b16 a[68:69], v14 offset:0
    v_mfma_f32_16x16x32_bf16 v[232:235], a[96:99], a[148:151], v[232:235]
    ds_read_b64_tr_b16 a[70:71], v14 offset:256
    buffer_load_dwordx4 v25, s[44:47], s58 offen offset:1024  lds
    v_mfma_f32_16x16x32_bf16 v[236:239], a[100:103], a[148:151], v[236:239]
    ds_read_b128 a[40:43], v11 offset:4096
    v_mfma_f32_16x16x32_bf16 v[228:231], a[100:103], a[144:147], v[228:231]
    ds_read_b64_tr_b16 a[72:73], v13 offset:4096
    buffer_store_dwordx4 v[116:119], v15, s[40:43], s74 offen offset:2048 sc1
    v_mfma_f32_16x16x32_bf16 v[204:207], a[140:143], a[100:103], v[204:207]
    ds_read_b64_tr_b16 a[74:75], v13 offset:4352
    buffer_load_dwordx4 v26, s[44:47], s58 offen offset:2048  lds
    v_mfma_f32_16x16x32_bf16 v[200:203], a[136:139], a[100:103], v[200:203]
    ds_read_b128 a[44:47], v11 offset:6144
    v_mfma_f32_16x16x32_bf16 v[172:175], a[132:135], a[100:103], v[172:175]
    ds_read_b64_tr_b16 a[76:77], v14 offset:4096
    v_mfma_f32_16x16x32_bf16 v[168:171], a[128:131], a[100:103], v[168:171]
    ds_read_b64_tr_b16 a[78:79], v14 offset:4352
    buffer_load_dwordx4 v27, s[44:47], s58 offen offset:3072  lds
    v_mfma_f32_16x16x32_bf16 v[176:179], a[128:131], a[104:107], v[176:179]
    ds_read_b64_tr_b16 a[80:81], v13 offset:8192
    v_mfma_f32_16x16x32_bf16 v[180:183], a[132:135], a[104:107], v[180:183]
    ds_read_b64_tr_b16 a[82:83], v13 offset:8448
    s_add_u32 m0, s63, 16384
    v_mfma_f32_16x16x32_bf16 v[208:211], a[136:139], a[104:107], v[208:211]
    ds_read_b64_tr_b16 a[84:85], v14 offset:8192
    buffer_load_dwordx4 v28, s[48:51], s59 offen offset:0  lds
    v_mfma_f32_16x16x32_bf16 v[212:215], a[140:143], a[104:107], v[212:215]
    ds_read_b64_tr_b16 a[86:87], v14 offset:8448
    v_mfma_f32_16x16x32_bf16 v[240:243], a[104:107], a[144:147], v[240:243]
    v_add_u32 v12, s61, v10
    v_mfma_f32_16x16x32_bf16 v[248:251], a[104:107], a[148:151], v[248:251]
    buffer_load_dwordx4 v29, s[48:51], s59 offen offset:1024  lds
    v_mfma_f32_16x16x32_bf16 v[252:255], a[108:111], a[148:151], v[252:255]
    s_add_u32 s59, s59, 86016
    v_mfma_f32_16x16x32_bf16 v[244:247], a[108:111], a[144:147], v[244:247]
    v_mfma_f32_16x16x32_bf16 v[220:223], a[140:143], a[108:111], v[220:223]
    v_mfma_f32_16x16x32_bf16 v[216:219], a[136:139], a[108:111], v[216:219]
    s_xor_b32 s63, s63, 0x8000
    s_mov_b32 s67, s60
    s_mov_b32 s60, s61
    v_mfma_f32_16x16x32_bf16 v[188:191], a[132:135], a[108:111], v[188:191]
    s_mov_b32 s61, s62
    s_mov_b32 s62, s67
    v_mfma_f32_16x16x32_bf16 v[184:187], a[128:131], a[108:111], v[184:187]
    s_waitcnt vmcnt(17) lgkmcnt(0)
    s_barrier
    v_mfma_f32_16x16x32_bf16 v[160:163], a[64:67], a[32:35], v[160:163]
    ds_read_b128 a[96:99], v12 offset:0
    s_add_u32 s66, s58, 114688
    v_mfma_f32_16x16x32_bf16 v[164:167], a[68:71], a[32:35], v[164:167]
    ds_read_b64_tr_b16 a[128:129], v13 offset:16384
    s_add_u32 m0, s62, 16384
    buffer_store_dwordx4 v[120:123], v15, s[40:43], s74 offen offset:1024 sc1
    v_mfma_f32_16x16x32_bf16 v[192:195], a[72:75], a[32:35], v[192:195]
    ds_read_b64_tr_b16 a[130:131], v13 offset:16640
    buffer_load_dwordx4 v24, s[44:47], s66 offen offset:0  lds
    v_mfma_f32_16x16x32_bf16 v[196:199], a[76:79], a[32:35], v[196:199]
    ds_read_b128 a[100:103], v12 offset:2048
    v_mfma_f32_16x16x32_bf16 v[224:227], a[32:35], a[80:83], v[224:227]
    ds_read_b64_tr_b16 a[132:133], v14 offset:16384
    v_mfma_f32_16x16x32_bf16 v[232:235], a[32:35], a[84:87], v[232:235]
    ds_read_b64_tr_b16 a[134:135], v14 offset:16640
    buffer_load_dwordx4 v25, s[44:47], s66 offen offset:1024  lds
    v_mfma_f32_16x16x32_bf16 v[236:239], a[36:39], a[84:87], v[236:239]
    ds_read_b128 a[104:107], v12 offset:4096
    v_mfma_f32_16x16x32_bf16 v[228:231], a[36:39], a[80:83], v[228:231]
    ds_read_b64_tr_b16 a[136:137], v13 offset:20480
    buffer_store_dwordx4 v[124:127], v15, s[40:43], s74 offen offset:0 sc1
    v_mfma_f32_16x16x32_bf16 v[204:207], a[76:79], a[36:39], v[204:207]
    ds_read_b64_tr_b16 a[138:139], v13 offset:20736
    buffer_load_dwordx4 v26, s[44:47], s66 offen offset:2048  lds
    v_mfma_f32_16x16x32_bf16 v[200:203], a[72:75], a[36:39], v[200:203]
    ds_read_b128 a[108:111], v12 offset:6144
    v_mfma_f32_16x16x32_bf16 v[172:175], a[68:71], a[36:39], v[172:175]
    ds_read_b64_tr_b16 a[140:141], v14 offset:20480
    v_mfma_f32_16x16x32_bf16 v[168:171], a[64:67], a[36:39], v[168:171]
    ds_read_b64_tr_b16 a[142:143], v14 offset:20736
    buffer_load_dwordx4 v27, s[44:47], s66 offen offset:3072  lds
    v_mfma_f32_16x16x32_bf16 v[176:179], a[64:67], a[40:43], v[176:179]
    ds_read_b64_tr_b16 a[144:145], v13 offset:24576
    s_add_u32 s58, s58, 128
    v_mfma_f32_16x16x32_bf16 v[180:183], a[68:71], a[40:43], v[180:183]
    ds_read_b64_tr_b16 a[146:147], v13 offset:24832
    s_add_u32 m0, s63, 0
    v_mfma_f32_16x16x32_bf16 v[208:211], a[72:75], a[40:43], v[208:211]
    ds_read_b64_tr_b16 a[148:149], v14 offset:24576
    buffer_load_dwordx4 v28, s[48:51], s59 offen offset:0  lds
    v_mfma_f32_16x16x32_bf16 v[212:215], a[76:79], a[40:43], v[212:215]
    ds_read_b64_tr_b16 a[150:151], v14 offset:24832
    v_mfma_f32_16x16x32_bf16 v[240:243], a[40:43], a[80:83], v[240:243]
    v_xor_b32 v13, 0x8000, v13
    v_xor_b32 v14, 0x8000, v14
    v_mfma_f32_16x16x32_bf16 v[248:251], a[40:43], a[84:87], v[248:251]
    v_add_u32 v11, s61, v9
    buffer_load_dwordx4 v29, s[48:51], s59 offen offset:1024  lds
    v_mfma_f32_16x16x32_bf16 v[252:255], a[44:47], a[84:87], v[252:255]
    s_add_u32 s59, s59, 86016
    v_mfma_f32_16x16x32_bf16 v[244:247], a[44:47], a[80:83], v[244:247]
    v_mfma_f32_16x16x32_bf16 v[220:223], a[76:79], a[44:47], v[220:223]
    v_mfma_f32_16x16x32_bf16 v[216:219], a[72:75], a[44:47], v[216:219]
    v_mfma_f32_16x16x32_bf16 v[188:191], a[68:71], a[44:47], v[188:191]
    v_mfma_f32_16x16x32_bf16 v[184:187], a[64:67], a[44:47], v[184:187]
    s_waitcnt vmcnt(16) lgkmcnt(0)
    s_barrier
    v_mfma_f32_16x16x32_bf16 v[160:163], a[128:131], a[96:99], v[160:163]
    ds_read_b128 a[32:35], v11 offset:0
    v_mfma_f32_16x16x32_bf16 v[164:167], a[132:135], a[96:99], v[164:167]
    ds_read_b64_tr_b16 a[64:65], v13 offset:0
    s_add_u32 s74, s65, 786432
    buffer_store_dwordx4 v[128:131], v15, s[40:43], s74 offen offset:0 sc1
    v_mfma_f32_16x16x32_bf16 v[192:195], a[136:139], a[96:99], v[192:195]
    ds_read_b64_tr_b16 a[66:67], v13 offset:256
    v_mfma_f32_16x16x32_bf16 v[196:199], a[140:143], a[96:99], v[196:199]
    ds_read_b128 a[36:39], v11 offset:2048
    v_mfma_f32_16x16x32_bf16 v[224:227], a[96:99], a[144:147], v[224:227]
    ds_read_b64_tr_b16 a[68:69], v14 offset:0
    v_mfma_f32_16x16x32_bf16 v[232:235], a[96:99], a[148:151], v[232:235]
    ds_read_b64_tr_b16 a[70:71], v14 offset:256
    v_mfma_f32_16x16x32_bf16 v[236:239], a[100:103], a[148:151], v[236:239]
    ds_read_b128 a[40:43], v11 offset:4096
    v_mfma_f32_16x16x32_bf16 v[228:231], a[100:103], a[144:147], v[228:231]
    ds_read_b64_tr_b16 a[72:73], v13 offset:4096
    buffer_store_dwordx4 v[132:135], v15, s[40:43], s74 offen offset:1024 sc1
    v_mfma_f32_16x16x32_bf16 v[204:207], a[140:143], a[100:103], v[204:207]
    ds_read_b64_tr_b16 a[74:75], v13 offset:4352
    v_mfma_f32_16x16x32_bf16 v[200:203], a[136:139], a[100:103], v[200:203]
    ds_read_b128 a[44:47], v11 offset:6144
    v_mfma_f32_16x16x32_bf16 v[172:175], a[132:135], a[100:103], v[172:175]
    ds_read_b64_tr_b16 a[76:77], v14 offset:4096
    v_mfma_f32_16x16x32_bf16 v[168:171], a[128:131], a[100:103], v[168:171]
    ds_read_b64_tr_b16 a[78:79], v14 offset:4352
    v_mfma_f32_16x16x32_bf16 v[176:179], a[128:131], a[104:107], v[176:179]
    ds_read_b64_tr_b16 a[80:81], v13 offset:8192
    v_mfma_f32_16x16x32_bf16 v[180:183], a[132:135], a[104:107], v[180:183]
    ds_read_b64_tr_b16 a[82:83], v13 offset:8448
    s_add_u32 m0, s63, 16384
    v_mfma_f32_16x16x32_bf16 v[208:211], a[136:139], a[104:107], v[208:211]
    ds_read_b64_tr_b16 a[84:85], v14 offset:8192
    buffer_load_dwordx4 v28, s[48:51], s59 offen offset:0  lds
    v_mfma_f32_16x16x32_bf16 v[212:215], a[140:143], a[104:107], v[212:215]
    ds_read_b64_tr_b16 a[86:87], v14 offset:8448
    v_mfma_f32_16x16x32_bf16 v[240:243], a[104:107], a[144:147], v[240:243]
    v_add_u32 v12, s61, v10
    v_mfma_f32_16x16x32_bf16 v[248:251], a[104:107], a[148:151], v[248:251]
    buffer_load_dwordx4 v29, s[48:51], s59 offen offset:1024  lds
    v_mfma_f32_16x16x32_bf16 v[252:255], a[108:111], a[148:151], v[252:255]
    s_add_u32 s59, s59, 86016
    v_mfma_f32_16x16x32_bf16 v[244:247], a[108:111], a[144:147], v[244:247]
    v_mfma_f32_16x16x32_bf16 v[220:223], a[140:143], a[108:111], v[220:223]
    v_mfma_f32_16x16x32_bf16 v[216:219], a[136:139], a[108:111], v[216:219]
    s_xor_b32 s63, s63, 0x8000
    s_mov_b32 s67, s60
    s_mov_b32 s60, s61
    v_mfma_f32_16x16x32_bf16 v[188:191], a[132:135], a[108:111], v[188:191]
    s_mov_b32 s61, s62
    s_mov_b32 s62, s67
    v_mfma_f32_16x16x32_bf16 v[184:187], a[128:131], a[108:111], v[184:187]
    s_waitcnt vmcnt(12) lgkmcnt(0)
    s_barrier
    v_mfma_f32_16x16x32_bf16 v[160:163], a[64:67], a[32:35], v[160:163]
    ds_read_b128 a[96:99], v12 offset:0
    v_mfma_f32_16x16x32_bf16 v[164:167], a[68:71], a[32:35], v[164:167]
    ds_read_b64_tr_b16 a[128:129], v13 offset:16384
    buffer_store_dwordx4 v[136:139], v15, s[40:43], s74 offen offset:2048 sc1
    v_mfma_f32_16x16x32_bf16 v[192:195], a[72:75], a[32:35], v[192:195]
    ds_read_b64_tr_b16 a[130:131], v13 offset:16640
    v_mfma_f32_16x16x32_bf16 v[196:199], a[76:79], a[32:35], v[196:199]
    ds_read_b128 a[100:103], v12 offset:2048
    v_mfma_f32_16x16x32_bf16 v[224:227], a[32:35], a[80:83], v[224:227]
    ds_read_b64_tr_b16 a[132:133], v14 offset:16384
    v_mfma_f32_16x16x32_bf16 v[232:235], a[32:35], a[84:87], v[232:235]
    ds_read_b64_tr_b16 a[134:135], v14 offset:16640
    v_mfma_f32_16x16x32_bf16 v[236:239], a[36:39], a[84:87], v[236:239]
    ds_read_b128 a[104:107], v12 offset:4096
    v_mfma_f32_16x16x32_bf16 v[228:231], a[36:39], a[80:83], v[228:231]
    ds_read_b64_tr_b16 a[136:137], v13 offset:20480
    buffer_store_dwordx4 v[140:143], v15, s[40:43], s74 offen offset:3072 sc1
    s_lshr_b32 s66, s2, 3
    v_mfma_f32_16x16x32_bf16 v[204:207], a[76:79], a[36:39], v[204:207]
    ds_read_b64_tr_b16 a[138:139], v13 offset:20736
    s_lshl_b32 s66, s66, 2
    s_add_u32 s66, s66, s29
    v_mfma_f32_16x16x32_bf16 v[200:203], a[72:75], a[36:39], v[200:203]
    ds_read_b128 a[108:111], v12 offset:6144
    s_lshl_b32 s66, s66, 10
    v_and_b32 v20, 0x380, v15
    v_mfma_f32_16x16x32_bf16 v[172:175], a[68:71], a[36:39], v[172:175]
    ds_read_b64_tr_b16 a[140:141], v14 offset:20480
    v_add_u32 v20, s66, v20
    v_mfma_f32_16x16x32_bf16 v[168:171], a[64:67], a[36:39], v[168:171]
    ds_read_b64_tr_b16 a[142:143], v14 offset:20736
    global_load_dword v21, v20, s[30:31]
    v_mfma_f32_16x16x32_bf16 v[176:179], a[64:67], a[40:43], v[176:179]
    ds_read_b64_tr_b16 a[144:145], v13 offset:24576
    v_mfma_f32_16x16x32_bf16 v[180:183], a[68:71], a[40:43], v[180:183]
    ds_read_b64_tr_b16 a[146:147], v13 offset:24832
    v_mfma_f32_16x16x32_bf16 v[208:211], a[72:75], a[40:43], v[208:211]
    ds_read_b64_tr_b16 a[148:149], v14 offset:24576
    v_mfma_f32_16x16x32_bf16 v[212:215], a[76:79], a[40:43], v[212:215]
    ds_read_b64_tr_b16 a[150:151], v14 offset:24832
    v_mfma_f32_16x16x32_bf16 v[240:243], a[40:43], a[80:83], v[240:243]
    v_xor_b32 v13, 0x8000, v13
    v_xor_b32 v14, 0x8000, v14
    v_mfma_f32_16x16x32_bf16 v[248:251], a[40:43], a[84:87], v[248:251]
    v_add_u32 v11, s61, v9
    v_mfma_f32_16x16x32_bf16 v[252:255], a[44:47], a[84:87], v[252:255]
    v_mfma_f32_16x16x32_bf16 v[244:247], a[44:47], a[80:83], v[244:247]
    v_mfma_f32_16x16x32_bf16 v[220:223], a[76:79], a[44:47], v[220:223]
    v_mfma_f32_16x16x32_bf16 v[216:219], a[72:75], a[44:47], v[216:219]
    v_mfma_f32_16x16x32_bf16 v[188:191], a[68:71], a[44:47], v[188:191]
    v_mfma_f32_16x16x32_bf16 v[184:187], a[64:67], a[44:47], v[184:187]
    s_waitcnt vmcnt(7) lgkmcnt(0)
    s_barrier
    v_mfma_f32_16x16x32_bf16 v[160:163], a[128:131], a[96:99], v[160:163]
    ds_read_b128 a[32:35], v11 offset:0
    v_mfma_f32_16x16x32_bf16 v[164:167], a[132:135], a[96:99], v[164:167]
    ds_read_b64_tr_b16 a[64:65], v13 offset:0
    s_add_u32 s74, s65, 794624
    buffer_store_dwordx4 v[144:147], v15, s[40:43], s74 offen offset:3072 sc1
    v_mfma_f32_16x16x32_bf16 v[192:195], a[136:139], a[96:99], v[192:195]
    ds_read_b64_tr_b16 a[66:67], v13 offset:256
    v_mfma_f32_16x16x32_bf16 v[196:199], a[140:143], a[96:99], v[196:199]
    ds_read_b128 a[36:39], v11 offset:2048
    v_mfma_f32_16x16x32_bf16 v[224:227], a[96:99], a[144:147], v[224:227]
    ds_read_b64_tr_b16 a[68:69], v14 offset:0
    v_mfma_f32_16x16x32_bf16 v[232:235], a[96:99], a[148:151], v[232:235]
    ds_read_b64_tr_b16 a[70:71], v14 offset:256
    v_mfma_f32_16x16x32_bf16 v[236:239], a[100:103], a[148:151], v[236:239]
    ds_read_b128 a[40:43], v11 offset:4096
    v_mfma_f32_16x16x32_bf16 v[228:231], a[100:103], a[144:147], v[228:231]
    ds_read_b64_tr_b16 a[72:73], v13 offset:4096
    buffer_store_dwordx4 v[148:151], v15, s[40:43], s74 offen offset:2048 sc1
    v_mfma_f32_16x16x32_bf16 v[204:207], a[140:143], a[100:103], v[204:207]
    ds_read_b64_tr_b16 a[74:75], v13 offset:4352
    v_mfma_f32_16x16x32_bf16 v[200:203], a[136:139], a[100:103], v[200:203]
    ds_read_b128 a[44:47], v11 offset:6144
    v_mfma_f32_16x16x32_bf16 v[172:175], a[132:135], a[100:103], v[172:175]
    ds_read_b64_tr_b16 a[76:77], v14 offset:4096
    v_mfma_f32_16x16x32_bf16 v[168:171], a[128:131], a[100:103], v[168:171]
    ds_read_b64_tr_b16 a[78:79], v14 offset:4352
    v_mfma_f32_16x16x32_bf16 v[176:179], a[128:131], a[104:107], v[176:179]
    ds_read_b64_tr_b16 a[80:81], v13 offset:8192
    v_mfma_f32_16x16x32_bf16 v[180:183], a[132:135], a[104:107], v[180:183]
    ds_read_b64_tr_b16 a[82:83], v13 offset:8448
    v_mfma_f32_16x16x32_bf16 v[208:211], a[136:139], a[104:107], v[208:211]
    ds_read_b64_tr_b16 a[84:85], v14 offset:8192
    v_mfma_f32_16x16x32_bf16 v[212:215], a[140:143], a[104:107], v[212:215]
    ds_read_b64_tr_b16 a[86:87], v14 offset:8448
    v_mfma_f32_16x16x32_bf16 v[240:243], a[104:107], a[144:147], v[240:243]
    v_add_u32 v12, s61, v10
    v_mfma_f32_16x16x32_bf16 v[248:251], a[104:107], a[148:151], v[248:251]
    v_mfma_f32_16x16x32_bf16 v[252:255], a[108:111], a[148:151], v[252:255]
    v_mfma_f32_16x16x32_bf16 v[244:247], a[108:111], a[144:147], v[244:247]
    v_mfma_f32_16x16x32_bf16 v[220:223], a[140:143], a[108:111], v[220:223]
    v_mfma_f32_16x16x32_bf16 v[216:219], a[136:139], a[108:111], v[216:219]
    v_mfma_f32_16x16x32_bf16 v[188:191], a[132:135], a[108:111], v[188:191]
    v_mfma_f32_16x16x32_bf16 v[184:187], a[128:131], a[108:111], v[184:187]
    s_waitcnt vmcnt(5) lgkmcnt(0)
    s_barrier
    v_mfma_f32_16x16x32_bf16 v[160:163], a[64:67], a[32:35], v[160:163]
    ds_read_b128 a[96:99], v12 offset:0
    v_mfma_f32_16x16x32_bf16 v[164:167], a[68:71], a[32:35], v[164:167]
    ds_read_b64_tr_b16 a[128:129], v13 offset:16384
    buffer_store_dwordx4 v[152:155], v15, s[40:43], s74 offen offset:1024 sc1
    v_mfma_f32_16x16x32_bf16 v[192:195], a[72:75], a[32:35], v[192:195]
    ds_read_b64_tr_b16 a[130:131], v13 offset:16640
    v_mfma_f32_16x16x32_bf16 v[196:199], a[76:79], a[32:35], v[196:199]
    ds_read_b128 a[100:103], v12 offset:2048
    v_mfma_f32_16x16x32_bf16 v[224:227], a[32:35], a[80:83], v[224:227]
    ds_read_b64_tr_b16 a[132:133], v14 offset:16384
    v_mfma_f32_16x16x32_bf16 v[232:235], a[32:35], a[84:87], v[232:235]
    ds_read_b64_tr_b16 a[134:135], v14 offset:16640
    v_mfma_f32_16x16x32_bf16 v[236:239], a[36:39], a[84:87], v[236:239]
    ds_read_b128 a[104:107], v12 offset:4096
    v_mfma_f32_16x16x32_bf16 v[228:231], a[36:39], a[80:83], v[228:231]
    ds_read_b64_tr_b16 a[136:137], v13 offset:20480
    buffer_store_dwordx4 v[156:159], v15, s[40:43], s74 offen offset:0 sc1
    s_lshl_b32 s19, s26, 21
    v_mfma_f32_16x16x32_bf16 v[204:207], a[76:79], a[36:39], v[204:207]
    ds_read_b64_tr_b16 a[138:139], v13 offset:20736
    s_lshl_b32 s20, s29, 13
    s_mov_b32 s8, 1073741824
    v_mfma_f32_16x16x32_bf16 v[200:203], a[72:75], a[36:39], v[200:203]
    ds_read_b128 a[108:111], v12 offset:6144
    s_mov_b32 s96, 0x71800000
    s_sub_u32 s18, 15, s27
    v_mfma_f32_16x16x32_bf16 v[172:175], a[68:71], a[36:39], v[172:175]
    ds_read_b64_tr_b16 a[140:141], v14 offset:20480
    s_lshl_b32 s66, s18, 2
    s_lshl_b32 s67, s27, 1
    v_mfma_f32_16x16x32_bf16 v[168:171], a[64:67], a[36:39], v[168:171]
    ds_read_b64_tr_b16 a[142:143], v14 offset:20736
    s_lshr_b32 s67, 0, s67
    s_and_b32 s67, s67, 3
    v_mfma_f32_16x16x32_bf16 v[176:179], a[64:67], a[40:43], v[176:179]
    ds_read_b64_tr_b16 a[144:145], v13 offset:24576
    s_add_u32 s67, s67, 32
    s_lshl_b32 s21, s26, 3
    v_mfma_f32_16x16x32_bf16 v[180:183], a[68:71], a[40:43], v[180:183]
    ds_read_b64_tr_b16 a[146:147], v13 offset:24832
    s_add_u32 s21, s21, s27
    s_lshl_b32 s21, s21, 2
    v_mfma_f32_16x16x32_bf16 v[208:211], a[72:75], a[40:43], v[208:211]
    ds_read_b64_tr_b16 a[148:149], v14 offset:24576
    s_add_u32 s21, s21, s29
    s_lshl_b32 s76, s21, 7
    v_mfma_f32_16x16x32_bf16 v[212:215], a[76:79], a[40:43], v[212:215]
    ds_read_b64_tr_b16 a[150:151], v14 offset:24832
    s_mov_b32 s97, s67
    s_mov_b32 s78, 0
    v_mfma_f32_16x16x32_bf16 v[240:243], a[40:43], a[80:83], v[240:243]
    v_xor_b32 v13, 0x8000, v13
    s_mov_b32 s11, 0
    v_xor_b32 v14, 0x8000, v14
    v_mfma_f32_16x16x32_bf16 v[248:251], a[40:43], a[84:87], v[248:251]
    v_add_u32 v11, s61, v9
    s_mov_b32 s12, 2
    s_mov_b32 s17, 0
    v_mfma_f32_16x16x32_bf16 v[252:255], a[44:47], a[84:87], v[252:255]
    s_mov_b32 s6, s8
    s_mov_b32 s7, 64
    s_lshl_b32 s76, s14, 3
    v_mfma_f32_16x16x32_bf16 v[244:247], a[44:47], a[80:83], v[244:247]
    s_add_u32 s76, s76, s15
    s_lshl_b32 s76, s76, 2
    s_add_u32 s76, s76, s29
    v_mfma_f32_16x16x32_bf16 v[220:223], a[76:79], a[44:47], v[220:223]
    s_lshl_b32 s76, s76, 7
    s_add_u32 s76, s76, 83099648
    s_lshr_b32 s66, s29, 1
    v_mfma_f32_16x16x32_bf16 v[216:219], a[72:75], a[44:47], v[216:219]
    s_sub_u32 s5, s97, s66
    s_lshl_b32 s4, s78, 15
    s_add_u32 s4, s4, s19
    v_mfma_f32_16x16x32_bf16 v[188:191], a[68:71], a[44:47], v[188:191]
    s_lshl_b32 s66, s28, 3
    s_add_u32 s66, s66, s27
    s_xor_b32 s66, s66, 7
    v_mfma_f32_16x16x32_bf16 v[184:187], a[64:67], a[44:47], v[184:187]
    s_lshl_b32 s66, s66, 1
    s_lshr_b32 s46, s2, 7
    s_add_u32 s66, s66, s46
    s_lshr_b32 s47, s66, 2
    s_and_b32 s66, s66, 3
    s_and_b32 s46, s2, 7
    s_lshl_b32 s46, s46, 2
    s_add_u32 s46, s46, s66
    s_lshl_b32 s66, s47, 2
    s_add_u32 s66, s66, s29
    s_lshl_b32 s45, s66, 17
    s_add_u32 s45, s45, 41943040
    s_lshl_b32 s44, s66, 10
    s_add_u32 s44, s44, 82837504
    s_xor_b32 s22, s46, s47
    s_and_b32 s22, s22, 0
    s_cmp_eq_u32 s47, 7
    s_cselect_b32 s22, 0, s22
    s_lshl_b32 s22, s22, 16
    s_add_u32 s45, s45, s22
    s_waitcnt vmcnt(7) lgkmcnt(0)
    s_barrier
    v_mfma_f32_16x16x32_bf16 v[160:163], a[128:131], a[96:99], v[160:163]
    buffer_load_dword v16, v4, s[40:43], s75 offen sc1
    v_mfma_f32_16x16x32_bf16 v[164:167], a[132:135], a[96:99], v[164:167]
    v_mfma_f32_16x16x32_bf16 v[192:195], a[136:139], a[96:99], v[192:195]
    v_mfma_f32_16x16x32_bf16 v[196:199], a[140:143], a[96:99], v[196:199]
    v_mfma_f32_16x16x32_bf16 v[224:227], a[96:99], a[144:147], v[224:227]
    v_mfma_f32_16x16x32_bf16 v[232:235], a[96:99], a[148:151], v[232:235]
    v_mfma_f32_16x16x32_bf16 v[236:239], a[100:103], a[148:151], v[236:239]
    v_mfma_f32_16x16x32_bf16 v[228:231], a[100:103], a[144:147], v[228:231]
    v_mfma_f32_16x16x32_bf16 v[204:207], a[140:143], a[100:103], v[204:207]
    v_mfma_f32_16x16x32_bf16 v[200:203], a[136:139], a[100:103], v[200:203]
    v_mfma_f32_16x16x32_bf16 v[172:175], a[132:135], a[100:103], v[172:175]
    v_mfma_f32_16x16x32_bf16 v[168:171], a[128:131], a[100:103], v[168:171]
    v_mfma_f32_16x16x32_bf16 v[176:179], a[128:131], a[104:107], v[176:179]
    v_mfma_f32_16x16x32_bf16 v[180:183], a[132:135], a[104:107], v[180:183]
    v_mfma_f32_16x16x32_bf16 v[208:211], a[136:139], a[104:107], v[208:211]
    v_mfma_f32_16x16x32_bf16 v[212:215], a[140:143], a[104:107], v[212:215]
    v_mfma_f32_16x16x32_bf16 v[240:243], a[104:107], a[144:147], v[240:243]
    v_mfma_f32_16x16x32_bf16 v[248:251], a[104:107], a[148:151], v[248:251]
    v_mfma_f32_16x16x32_bf16 v[252:255], a[108:111], a[148:151], v[252:255]
    v_mfma_f32_16x16x32_bf16 v[244:247], a[108:111], a[144:147], v[244:247]
    v_mfma_f32_16x16x32_bf16 v[220:223], a[140:143], a[108:111], v[220:223]
    v_mfma_f32_16x16x32_bf16 v[216:219], a[136:139], a[108:111], v[216:219]
    v_mfma_f32_16x16x32_bf16 v[188:191], a[132:135], a[108:111], v[188:191]
    v_mfma_f32_16x16x32_bf16 v[184:187], a[128:131], a[108:111], v[184:187]
    v_accvgpr_read_b32 v128, a224
    v_accvgpr_read_b32 v129, a225
    v_accvgpr_read_b32 v130, a226
    v_accvgpr_read_b32 v131, a227
    v_accvgpr_read_b32 v132, a228
    v_accvgpr_read_b32 v133, a229
    v_accvgpr_read_b32 v134, a230
    v_accvgpr_read_b32 v135, a231
    v_accvgpr_read_b32 v136, a232
    v_accvgpr_read_b32 v137, a233
    v_accvgpr_read_b32 v138, a234
    v_accvgpr_read_b32 v139, a235
    v_accvgpr_read_b32 v140, a236
    v_accvgpr_read_b32 v141, a237
    v_accvgpr_read_b32 v142, a238
    v_accvgpr_read_b32 v143, a239
    v_lshl_or_b32 v144, v129, 16, v128
    v_lshl_or_b32 v145, v131, 16, v130
    v_lshl_or_b32 v146, v133, 16, v132
    v_lshl_or_b32 v147, v135, 16, v134
    v_lshl_or_b32 v148, v137, 16, v136
    v_lshl_or_b32 v149, v139, 16, v138
    v_lshl_or_b32 v150, v141, 16, v140
    v_lshl_or_b32 v151, v143, 16, v142
    v_cvt_pk_bf16_f32 v96, v160, v161
    v_cvt_pk_bf16_f32 v97, v162, v163
    v_cvt_pk_bf16_f32 v98, v164, v165
    v_cvt_pk_bf16_f32 v99, v166, v167
    v_cvt_pk_bf16_f32 v100, v168, v169
    v_cvt_pk_bf16_f32 v101, v170, v171
    v_cvt_pk_bf16_f32 v102, v172, v173
    v_cvt_pk_bf16_f32 v103, v174, v175
    v_cvt_pk_bf16_f32 v104, v176, v177
    v_cvt_pk_bf16_f32 v105, v178, v179
    v_cvt_pk_bf16_f32 v106, v180, v181
    v_cvt_pk_bf16_f32 v107, v182, v183
    v_cvt_pk_bf16_f32 v108, v184, v185
    v_cvt_pk_bf16_f32 v109, v186, v187
    v_cvt_pk_bf16_f32 v110, v188, v189
    v_cvt_pk_bf16_f32 v111, v190, v191
    v_cvt_pk_bf16_f32 v112, v192, v193
    v_cvt_pk_bf16_f32 v113, v194, v195
    v_cvt_pk_bf16_f32 v114, v196, v197
    v_cvt_pk_bf16_f32 v115, v198, v199
    v_cvt_pk_bf16_f32 v116, v200, v201
    v_cvt_pk_bf16_f32 v117, v202, v203
    v_cvt_pk_bf16_f32 v118, v204, v205
    v_cvt_pk_bf16_f32 v119, v206, v207
    v_cvt_pk_bf16_f32 v120, v208, v209
    v_cvt_pk_bf16_f32 v121, v210, v211
    v_cvt_pk_bf16_f32 v122, v212, v213
    v_cvt_pk_bf16_f32 v123, v214, v215
    v_cvt_pk_bf16_f32 v124, v216, v217
    v_cvt_pk_bf16_f32 v125, v218, v219
    v_cvt_pk_bf16_f32 v126, v220, v221
    v_cvt_pk_bf16_f32 v127, v222, v223
    s_nop 1
    v_mfma_f32_16x16x32_bf16 v[32:35], v[144:147], v[96:99], 0
    v_mfma_f32_16x16x32_bf16 v[36:39], v[148:151], v[96:99], 0
    v_mfma_f32_16x16x32_bf16 v[40:43], v[144:147], v[100:103], 0
    v_mfma_f32_16x16x32_bf16 v[44:47], v[148:151], v[100:103], 0
    v_mfma_f32_16x16x32_bf16 v[48:51], v[144:147], v[104:107], 0
    v_mfma_f32_16x16x32_bf16 v[52:55], v[148:151], v[104:107], 0
    v_mfma_f32_16x16x32_bf16 v[56:59], v[144:147], v[108:111], 0
    v_mfma_f32_16x16x32_bf16 v[60:63], v[148:151], v[108:111], 0
    v_mfma_f32_16x16x32_bf16 v[64:67], v[144:147], v[112:115], 0
    v_mfma_f32_16x16x32_bf16 v[68:71], v[148:151], v[112:115], 0
    v_mfma_f32_16x16x32_bf16 v[72:75], v[144:147], v[116:119], 0
    v_mfma_f32_16x16x32_bf16 v[76:79], v[148:151], v[116:119], 0
    v_mfma_f32_16x16x32_bf16 v[80:83], v[144:147], v[120:123], 0
    v_mfma_f32_16x16x32_bf16 v[84:87], v[148:151], v[120:123], 0
    v_mfma_f32_16x16x32_bf16 v[88:91], v[144:147], v[124:127], 0
    v_mfma_f32_16x16x32_bf16 v[92:95], v[148:151], v[124:127], 0
    v_mov_b32 v23, 0x3f803f80
    s_lshl_b32 s66, s29, 12
    s_add_u32 s66, s66, 147456
    v_add_u32 v22, s66, v15
    v_cvt_pk_bf16_f32 v224, v224, v225
    v_cvt_pk_bf16_f32 v225, v226, v227
    v_cvt_pk_bf16_f32 v226, v228, v229
    v_cvt_pk_bf16_f32 v227, v230, v231
    ds_write_b128 v22, v[224:227] offset:0
    v_cvt_pk_bf16_f32 v232, v232, v233
    v_cvt_pk_bf16_f32 v233, v234, v235
    v_cvt_pk_bf16_f32 v234, v236, v237
    v_cvt_pk_bf16_f32 v235, v238, v239
    v_cndmask_b32 v232, v232, v23, s[72:73]
    v_cndmask_b32 v233, v233, v23, s[72:73]
    v_cndmask_b32 v234, v234, v23, s[72:73]
    v_cndmask_b32 v235, v235, v23, s[72:73]
    ds_write_b128 v22, v[232:235] offset:1024
    v_cvt_pk_bf16_f32 v240, v240, v241
    v_cvt_pk_bf16_f32 v241, v242, v243
    v_cvt_pk_bf16_f32 v242, v244, v245
    v_cvt_pk_bf16_f32 v243, v246, v247
    ds_write_b128 v22, v[240:243] offset:2048
    v_cvt_pk_bf16_f32 v248, v248, v249
    v_cvt_pk_bf16_f32 v249, v250, v251
    v_cvt_pk_bf16_f32 v250, v252, v253
    v_cvt_pk_bf16_f32 v251, v254, v255
    v_cndmask_b32 v248, v248, v23, s[72:73]
    v_cndmask_b32 v249, v249, v23, s[72:73]
    v_cndmask_b32 v250, v250, v23, s[72:73]
    v_cndmask_b32 v251, v251, v23, s[72:73]
    ds_write_b128 v22, v[248:251] offset:3072
    s_waitcnt vmcnt(0)
    v_cmp_gt_u32 vcc, 1, v16
    s_nop 0
    s_cmp_lg_u64 vcc, 0
    s_cbranch_scc1 F_spin5
F_spin5r:
    s_mov_b32 s68, 0x3fb8aa3b
    s_mov_b32 s69, s68
    v_mov_b32 v17, 0xff800000
    v_and_b32 v20, 15, v30
    v_bfe_u32 v21, v30, 1, 2
    v_lshlrev_b32 v21, 5, v21
    v_lshl_add_u32 v20, v20, 7, v21
    v_lshrrev_b32 v21, 4, v30
    v_lshl_add_u32 v20, v21, 3, v20
    v_add_u32 v20, s20, v20
    v_xor_b32 v21, 32, v20
    v_xor_b32 v22, 64, v20
    v_xor_b32 v23, 96, v20
    s_lshl_b32 s57, s21, 7
    s_add_u32 s57, s57, 82968576
    s_lshl_b32 s79, s21, 14
    s_add_u32 s79, s79, 33554432
    v_lshlrev_b32 v6, 3, v15
    v_and_b32 v6, 1023, v6
    v_max3_f32 v96, v64, v65, v66
    s_lshr_b32 s66, s20, 1
    v_max3_f32 v98, v72, v73, v74
    s_add_u32 s67, s4, s66
    v_max3_f32 v100, v80, v81, v82
    s_add_u32 m0, s66, 131072
    v_max3_f32 v102, v88, v89, v90
    buffer_load_dwordx4 v15, s[40:43], s67 offen offset:0 sc1 lds
    v_max3_f32 v96, v96, v67, v68
    v_max3_f32 v98, v98, v75, v76
    v_max3_f32 v100, v100, v83, v84
    v_max3_f32 v102, v102, v91, v92
    v_max3_f32 v96, v96, v69, v70
    v_max3_f32 v98, v98, v77, v78
    v_max3_f32 v100, v100, v85, v86
    v_max3_f32 v102, v102, v93, v94
    v_max_f32 v96, v96, v71
    v_max_f32 v98, v98, v79
    v_max_f32 v100, v100, v87
    buffer_load_dwordx4 v15, s[40:43], s67 offen offset:1024 sc1 lds
    v_max_f32 v102, v102, v95
    v_min3_f32 v104, v64, v65, v66
    v_min3_f32 v106, v72, v73, v74
    v_min3_f32 v108, v80, v81, v82
    v_min3_f32 v110, v88, v89, v90
    v_min3_f32 v104, v104, v67, v68
    v_min3_f32 v106, v106, v75, v76
    v_min3_f32 v108, v108, v83, v84
    v_min3_f32 v110, v110, v91, v92
    v_min3_f32 v104, v104, v69, v70
    v_min3_f32 v106, v106, v77, v78
    v_min3_f32 v108, v108, v85, v86
    buffer_load_dwordx4 v15, s[40:43], s67 offen offset:2048 sc1 lds
    v_min3_f32 v110, v110, v93, v94
    v_min_f32 v104, v104, v71
    v_min_f32 v106, v106, v79
    v_min_f32 v108, v108, v87
    v_min_f32 v110, v110, v95
    s_nop 1
    v_permlane32_swap_b32 v96, v100
    v_permlane32_swap_b32 v98, v102
    v_permlane32_swap_b32 v104, v108
    v_permlane32_swap_b32 v106, v110
    v_max_f32 v96, v96, v100
    v_max_f32 v98, v98, v102
    buffer_load_dwordx4 v15, s[40:43], s67 offen offset:3072 sc1 lds
    v_min_f32 v104, v104, v108
    v_min_f32 v106, v106, v110
    s_nop 0
    v_permlane16_swap_b32 v96, v98
    v_permlane16_swap_b32 v104, v106
    v_max_f32 v96, v96, v98
    v_min_f32 v104, v104, v106
    v_mul_f32 v96, s68, -v96
    v_mul_f32 v104, s68, v104
    v_mov_b32 v98, v96
    s_add_u32 s4, s4, s20
    v_mov_b32 v106, v104
    s_add_u32 s4, s4, 16384
    s_nop 0
    s_add_u32 s10, s20, 32768
    v_permlane16_swap_b32 v96, v98
    s_mov_b32 m0, s10
    v_permlane16_swap_b32 v104, v106
    buffer_load_dwordx4 v15, s[40:43], s4 offen offset:0 sc1 lds
    v_mov_b32 v100, v96
    v_mov_b32 v102, v98
    v_mov_b32 v108, v104
    v_mov_b32 v110, v106
    s_nop 0
    v_permlane32_swap_b32 v96, v100
    v_permlane32_swap_b32 v98, v102
    v_permlane32_swap_b32 v104, v108
    v_permlane32_swap_b32 v106, v110
    v_cndmask_b32 v97, v96, v17, s[70:71]
    buffer_load_dwordx4 v15, s[40:43], s4 offen offset:1024 sc1 lds
    v_cndmask_b32 v99, v98, v17, s[70:71]
    v_cndmask_b32 v101, v100, v17, s[70:71]
    v_cndmask_b32 v103, v102, v17, s[70:71]
    v_cndmask_b32 v105, v104, v17, s[70:71]
    v_cndmask_b32 v107, v106, v17, s[70:71]
    v_cndmask_b32 v109, v108, v17, s[70:71]
    v_cndmask_b32 v111, v110, v17, s[70:71]
    v_pk_fma_f32 v[192:193], v[64:65], s[68:69], v[104:105] op_sel:[0,0,0] op_sel_hi:[1,1,0] neg_lo:[1,0,0] neg_hi:[1,0,0]
    v_pk_fma_f32 v[194:195], v[66:67], s[68:69], v[104:105] op_sel:[0,0,0] op_sel_hi:[1,1,0] neg_lo:[1,0,0] neg_hi:[1,0,0]
    v_pk_fma_f32 v[196:197], v[68:69], s[68:69], v[104:105] op_sel:[0,0,1] op_sel_hi:[1,1,1] neg_lo:[1,0,0] neg_hi:[1,0,0]
    v_pk_fma_f32 v[198:199], v[70:71], s[68:69], v[104:105] op_sel:[0,0,1] op_sel_hi:[1,1,1] neg_lo:[1,0,0] neg_hi:[1,0,0]
    v_pk_fma_f32 v[64:65], v[64:65], s[68:69], v[96:97] op_sel:[0,0,0] op_sel_hi:[1,1,0] neg_lo:[0,0,0] neg_hi:[0,0,0]
    buffer_load_dwordx4 v15, s[40:43], s4 offen offset:2048 sc1 lds
    v_pk_fma_f32 v[66:67], v[66:67], s[68:69], v[96:97] op_sel:[0,0,0] op_sel_hi:[1,1,0] neg_lo:[0,0,0] neg_hi:[0,0,0]
    v_pk_fma_f32 v[68:69], v[68:69], s[68:69], v[96:97] op_sel:[0,0,1] op_sel_hi:[1,1,1] neg_lo:[0,0,0] neg_hi:[0,0,0]
    v_pk_fma_f32 v[70:71], v[70:71], s[68:69], v[96:97] op_sel:[0,0,1] op_sel_hi:[1,1,1] neg_lo:[0,0,0] neg_hi:[0,0,0]
    v_exp_f32 v192, v192
    v_exp_f32 v193, v193
    v_exp_f32 v194, v194
    v_exp_f32 v195, v195
    v_exp_f32 v196, v196
    v_exp_f32 v197, v197
    v_exp_f32 v198, v198
    v_exp_f32 v199, v199
    v_exp_f32 v64, v64
    buffer_load_dwordx4 v15, s[40:43], s4 offen offset:3072 sc1 lds
    v_exp_f32 v65, v65
    v_exp_f32 v66, v66
    v_exp_f32 v67, v67
    v_exp_f32 v68, v68
    v_exp_f32 v69, v69
    v_exp_f32 v70, v70
    v_exp_f32 v71, v71
    v_pk_fma_f32 v[200:201], v[72:73], s[68:69], v[106:107] op_sel:[0,0,0] op_sel_hi:[1,1,0] neg_lo:[1,0,0] neg_hi:[1,0,0]
    v_pk_fma_f32 v[202:203], v[74:75], s[68:69], v[106:107] op_sel:[0,0,0] op_sel_hi:[1,1,0] neg_lo:[1,0,0] neg_hi:[1,0,0]
    v_pk_fma_f32 v[204:205], v[76:77], s[68:69], v[106:107] op_sel:[0,0,1] op_sel_hi:[1,1,1] neg_lo:[1,0,0] neg_hi:[1,0,0]
    s_add_u32 s67, s4, 4096
    v_pk_fma_f32 v[206:207], v[78:79], s[68:69], v[106:107] op_sel:[0,0,1] op_sel_hi:[1,1,1] neg_lo:[1,0,0] neg_hi:[1,0,0]
    s_add_u32 m0, s10, 4096
    v_pk_fma_f32 v[72:73], v[72:73], s[68:69], v[98:99] op_sel:[0,0,0] op_sel_hi:[1,1,0] neg_lo:[0,0,0] neg_hi:[0,0,0]
    buffer_load_dwordx4 v15, s[40:43], s67 offen offset:0 sc1 lds
    v_pk_fma_f32 v[74:75], v[74:75], s[68:69], v[98:99] op_sel:[0,0,0] op_sel_hi:[1,1,0] neg_lo:[0,0,0] neg_hi:[0,0,0]
    v_pk_fma_f32 v[76:77], v[76:77], s[68:69], v[98:99] op_sel:[0,0,1] op_sel_hi:[1,1,1] neg_lo:[0,0,0] neg_hi:[0,0,0]
    v_pk_fma_f32 v[78:79], v[78:79], s[68:69], v[98:99] op_sel:[0,0,1] op_sel_hi:[1,1,1] neg_lo:[0,0,0] neg_hi:[0,0,0]
    v_exp_f32 v200, v200
    v_exp_f32 v201, v201
    v_exp_f32 v202, v202
    v_exp_f32 v203, v203
    v_exp_f32 v204, v204
    v_exp_f32 v205, v205
    v_exp_f32 v206, v206
    v_exp_f32 v207, v207
    v_exp_f32 v72, v72
    buffer_load_dwordx4 v15, s[40:43], s67 offen offset:1024 sc1 lds
    v_exp_f32 v73, v73
    v_exp_f32 v74, v74
    v_exp_f32 v75, v75
    v_exp_f32 v76, v76
    v_exp_f32 v77, v77
    v_exp_f32 v78, v78
    v_exp_f32 v79, v79
    v_pk_fma_f32 v[208:209], v[80:81], s[68:69], v[108:109] op_sel:[0,0,0] op_sel_hi:[1,1,0] neg_lo:[1,0,0] neg_hi:[1,0,0]
    v_pk_fma_f32 v[210:211], v[82:83], s[68:69], v[108:109] op_sel:[0,0,0] op_sel_hi:[1,1,0] neg_lo:[1,0,0] neg_hi:[1,0,0]
    v_pk_fma_f32 v[212:213], v[84:85], s[68:69], v[108:109] op_sel:[0,0,1] op_sel_hi:[1,1,1] neg_lo:[1,0,0] neg_hi:[1,0,0]
    v_pk_fma_f32 v[214:215], v[86:87], s[68:69], v[108:109] op_sel:[0,0,1] op_sel_hi:[1,1,1] neg_lo:[1,0,0] neg_hi:[1,0,0]
    v_pk_fma_f32 v[80:81], v[80:81], s[68:69], v[100:101] op_sel:[0,0,0] op_sel_hi:[1,1,0] neg_lo:[0,0,0] neg_hi:[0,0,0]
    buffer_load_dwordx4 v15, s[40:43], s67 offen offset:2048 sc1 lds
    v_pk_fma_f32 v[82:83], v[82:83], s[68:69], v[100:101] op_sel:[0,0,0] op_sel_hi:[1,1,0] neg_lo:[0,0,0] neg_hi:[0,0,0]
    v_pk_fma_f32 v[84:85], v[84:85], s[68:69], v[100:101] op_sel:[0,0,1] op_sel_hi:[1,1,1] neg_lo:[0,0,0] neg_hi:[0,0,0]
    v_pk_fma_f32 v[86:87], v[86:87], s[68:69], v[100:101] op_sel:[0,0,1] op_sel_hi:[1,1,1] neg_lo:[0,0,0] neg_hi:[0,0,0]
    v_exp_f32 v208, v208
    v_exp_f32 v209, v209
    v_exp_f32 v210, v210
    v_exp_f32 v211, v211
    v_exp_f32 v212, v212
    v_exp_f32 v213, v213
    v_exp_f32 v214, v214
    v_exp_f32 v215, v215
    v_exp_f32 v80, v80
    buffer_load_dwordx4 v15, s[40:43], s67 offen offset:3072 sc1 lds
    v_exp_f32 v81, v81
    v_exp_f32 v82, v82
    v_exp_f32 v83, v83
    v_exp_f32 v84, v84
    v_exp_f32 v85, v85
    v_exp_f32 v86, v86
    v_exp_f32 v87, v87
    v_pk_fma_f32 v[216:217], v[88:89], s[68:69], v[110:111] op_sel:[0,0,0] op_sel_hi:[1,1,0] neg_lo:[1,0,0] neg_hi:[1,0,0]
    v_pk_fma_f32 v[218:219], v[90:91], s[68:69], v[110:111] op_sel:[0,0,0] op_sel_hi:[1,1,0] neg_lo:[1,0,0] neg_hi:[1,0,0]
    v_pk_fma_f32 v[220:221], v[92:93], s[68:69], v[110:111] op_sel:[0,0,1] op_sel_hi:[1,1,1] neg_lo:[1,0,0] neg_hi:[1,0,0]
    s_add_u32 s4, s4, 32768
    v_pk_fma_f32 v[222:223], v[94:95], s[68:69], v[110:111] op_sel:[0,0,1] op_sel_hi:[1,1,1] neg_lo:[1,0,0] neg_hi:[1,0,0]
    s_sub_u32 s5, s5, 1
    v_pk_fma_f32 v[88:89], v[88:89], s[68:69], v[102:103] op_sel:[0,0,0] op_sel_hi:[1,1,0] neg_lo:[0,0,0] neg_hi:[0,0,0]
    s_cmp_eq_u32 s5, 0
    s_cselect_b32 s4, s6, s4
    s_cselect_b32 s5, s7, s5
    s_cselect_b32 s6, s8, s6
    v_pk_fma_f32 v[90:91], v[90:91], s[68:69], v[102:103] op_sel:[0,0,0] op_sel_hi:[1,1,0] neg_lo:[0,0,0] neg_hi:[0,0,0]
    s_add_u32 s10, s20, 65536
    v_pk_fma_f32 v[92:93], v[92:93], s[68:69], v[102:103] op_sel:[0,0,1] op_sel_hi:[1,1,1] neg_lo:[0,0,0] neg_hi:[0,0,0]
    s_mov_b32 m0, s10
    v_pk_fma_f32 v[94:95], v[94:95], s[68:69], v[102:103] op_sel:[0,0,1] op_sel_hi:[1,1,1] neg_lo:[0,0,0] neg_hi:[0,0,0]
    buffer_load_dwordx4 v15, s[40:43], s4 offen offset:0 sc1 lds
    v_exp_f32 v216, v216
    v_exp_f32 v217, v217
    v_exp_f32 v218, v218
    v_exp_f32 v219, v219
    v_exp_f32 v220, v220
    v_exp_f32 v221, v221
    v_exp_f32 v222, v222
    v_exp_f32 v223, v223
    v_exp_f32 v88, v88
    buffer_load_dwordx4 v15, s[40:43], s4 offen offset:1024 sc1 lds
    v_exp_f32 v89, v89
    v_exp_f32 v90, v90
    v_exp_f32 v91, v91
    v_exp_f32 v92, v92
    v_exp_f32 v93, v93
    v_exp_f32 v94, v94
    v_exp_f32 v95, v95
    v_pk_add_f32 v[104:105], v[192:193], v[194:195]
    v_pk_add_f32 v[106:107], v[200:201], v[202:203]
    v_pk_add_f32 v[108:109], v[208:209], v[210:211]
    v_pk_add_f32 v[110:111], v[216:217], v[218:219]
    v_pk_add_f32 v[96:97], v[64:65], v[66:67]
    buffer_load_dwordx4 v15, s[40:43], s4 offen offset:2048 sc1 lds
    v_pk_add_f32 v[98:99], v[72:73], v[74:75]
    v_pk_add_f32 v[100:101], v[80:81], v[82:83]
    v_pk_add_f32 v[102:103], v[88:89], v[90:91]
    v_pk_add_f32 v[104:105], v[104:105], v[196:197]
    v_pk_add_f32 v[106:107], v[106:107], v[204:205]
    v_pk_add_f32 v[108:109], v[108:109], v[212:213]
    v_pk_add_f32 v[110:111], v[110:111], v[220:221]
    v_pk_add_f32 v[96:97], v[96:97], v[68:69]
    v_pk_add_f32 v[98:99], v[98:99], v[76:77]
    v_pk_add_f32 v[100:101], v[100:101], v[84:85]
    v_pk_add_f32 v[102:103], v[102:103], v[92:93]
    v_pk_add_f32 v[104:105], v[104:105], v[198:199]
    buffer_load_dwordx4 v15, s[40:43], s4 offen offset:3072 sc1 lds
    v_pk_add_f32 v[106:107], v[106:107], v[206:207]
    v_pk_add_f32 v[108:109], v[108:109], v[214:215]
    v_pk_add_f32 v[110:111], v[110:111], v[222:223]
    v_pk_add_f32 v[96:97], v[96:97], v[70:71]
    v_pk_add_f32 v[98:99], v[98:99], v[78:79]
    v_pk_add_f32 v[100:101], v[100:101], v[86:87]
    v_pk_add_f32 v[102:103], v[102:103], v[94:95]
    v_add_f32 v104, v104, v105
    v_add_f32 v106, v106, v107
    v_add_f32 v108, v108, v109
    s_add_u32 s67, s4, 4096
    v_add_f32 v110, v110, v111
    s_add_u32 m0, s10, 4096
    v_add_f32 v96, v96, v97
    buffer_load_dwordx4 v15, s[40:43], s67 offen offset:0 sc1 lds
    v_add_f32 v98, v98, v99
    v_add_f32 v100, v100, v101
    v_add_f32 v102, v102, v103
    s_nop 1
    v_permlane32_swap_b32 v96, v100
    v_permlane32_swap_b32 v98, v102
    v_permlane32_swap_b32 v104, v108
    v_permlane32_swap_b32 v106, v110
    v_add_f32 v96, v96, v100
    v_add_f32 v98, v98, v102
    v_add_f32 v104, v104, v108
    v_add_f32 v106, v106, v110
    buffer_load_dwordx4 v15, s[40:43], s67 offen offset:1024 sc1 lds
    s_nop 0
    v_permlane16_swap_b32 v96, v98
    v_permlane16_swap_b32 v104, v106
    v_add_f32 v96, v96, v98
    v_add_f32 v104, v104, v106
    v_rcp_f32 v96, v96
    v_rcp_f32 v104, v104
    v_mov_b32 v98, v96
    v_mov_b32 v106, v104
    s_nop 0
    v_permlane16_swap_b32 v96, v98
    v_permlane16_swap_b32 v104, v106
    buffer_load_dwordx4 v15, s[40:43], s67 offen offset:2048 sc1 lds
    v_mov_b32 v100, v96
    v_mov_b32 v102, v98
    v_mov_b32 v108, v104
    v_mov_b32 v110, v106
    s_nop 0
    v_permlane32_swap_b32 v96, v100
    v_permlane32_swap_b32 v98, v102
    v_permlane32_swap_b32 v104, v108
    v_permlane32_swap_b32 v106, v110
    v_pk_mul_f32 v[64:65], v[64:65], v[96:97] op_sel_hi:[1,0]
    v_pk_mul_f32 v[66:67], v[66:67], v[96:97] op_sel_hi:[1,0]
    v_pk_mul_f32 v[68:69], v[68:69], v[96:97] op_sel_hi:[1,0]
    buffer_load_dwordx4 v15, s[40:43], s67 offen offset:3072 sc1 lds
    v_pk_mul_f32 v[70:71], v[70:71], v[96:97] op_sel_hi:[1,0]
    v_cvt_pk_bf16_f32 v64, v64, v65
    v_cvt_pk_bf16_f32 v65, v66, v67
    v_cvt_pk_bf16_f32 v66, v68, v69
    v_cvt_pk_bf16_f32 v67, v70, v71
    ds_write_b64 v20, v[64:65] offset:0
    ds_write_b64 v21, v[66:67] offset:0
    v_pk_mul_f32 v[192:193], v[192:193], v[104:105] op_sel_hi:[1,0]
    v_pk_mul_f32 v[194:195], v[194:195], v[104:105] op_sel_hi:[1,0]
    v_pk_mul_f32 v[196:197], v[196:197], v[104:105] op_sel_hi:[1,0]
    s_add_u32 s4, s4, 32768
    v_pk_mul_f32 v[198:199], v[198:199], v[104:105] op_sel_hi:[1,0]
    s_sub_u32 s5, s5, 1
    v_cvt_pk_bf16_f32 v192, v192, v193
    s_cmp_eq_u32 s5, 0
    s_cselect_b32 s4, s6, s4
    s_cselect_b32 s5, s7, s5
    s_cselect_b32 s6, s8, s6
    v_cvt_pk_bf16_f32 v193, v194, v195
    buffer_load_dword v5, v6, s[40:43], s44 offen sc1
    v_cvt_pk_bf16_f32 v194, v196, v197
    v_cvt_pk_bf16_f32 v195, v198, v199
    ds_write_b64 v22, v[192:193] offset:0
    ds_write_b64 v23, v[194:195] offset:0
    v_pk_mul_f32 v[72:73], v[72:73], v[98:99] op_sel_hi:[1,0]
    v_pk_mul_f32 v[74:75], v[74:75], v[98:99] op_sel_hi:[1,0]
    v_pk_mul_f32 v[76:77], v[76:77], v[98:99] op_sel_hi:[1,0]
    v_pk_mul_f32 v[78:79], v[78:79], v[98:99] op_sel_hi:[1,0]
    v_cvt_pk_bf16_f32 v72, v72, v73
    v_add_u32 v1, 114688, v15
    v_cvt_pk_bf16_f32 v73, v74, v75
    v_cvt_pk_bf16_f32 v74, v76, v77
    v_cvt_pk_bf16_f32 v75, v78, v79
    ds_write_b64 v20, v[72:73] offset:2048
    ds_write_b64 v21, v[74:75] offset:2048
    v_pk_mul_f32 v[200:201], v[200:201], v[106:107] op_sel_hi:[1,0]
    v_pk_mul_f32 v[202:203], v[202:203], v[106:107] op_sel_hi:[1,0]
    v_pk_mul_f32 v[204:205], v[204:205], v[106:107] op_sel_hi:[1,0]
    v_pk_mul_f32 v[206:207], v[206:207], v[106:107] op_sel_hi:[1,0]
    v_cvt_pk_bf16_f32 v200, v200, v201
    v_cvt_pk_bf16_f32 v201, v202, v203
    v_cvt_pk_bf16_f32 v202, v204, v205
    v_cvt_pk_bf16_f32 v203, v206, v207
    ds_write_b64 v22, v[200:201] offset:2048
    ds_write_b64 v23, v[202:203] offset:2048
    v_pk_mul_f32 v[80:81], v[80:81], v[100:101] op_sel_hi:[1,0]
    v_pk_mul_f32 v[82:83], v[82:83], v[100:101] op_sel_hi:[1,0]
    v_pk_mul_f32 v[84:85], v[84:85], v[100:101] op_sel_hi:[1,0]
    v_pk_mul_f32 v[86:87], v[86:87], v[100:101] op_sel_hi:[1,0]
    v_cvt_pk_bf16_f32 v80, v80, v81
    v_cvt_pk_bf16_f32 v81, v82, v83
    v_cvt_pk_bf16_f32 v82, v84, v85
    v_cvt_pk_bf16_f32 v83, v86, v87
    ds_write_b64 v20, v[80:81] offset:4096
    ds_write_b64 v21, v[82:83] offset:4096
    v_pk_mul_f32 v[208:209], v[208:209], v[108:109] op_sel_hi:[1,0]
    v_pk_mul_f32 v[210:211], v[210:211], v[108:109] op_sel_hi:[1,0]
    v_pk_mul_f32 v[212:213], v[212:213], v[108:109] op_sel_hi:[1,0]
    v_pk_mul_f32 v[214:215], v[214:215], v[108:109] op_sel_hi:[1,0]
    v_cvt_pk_bf16_f32 v208, v208, v209
    v_cvt_pk_bf16_f32 v209, v210, v211
    v_cvt_pk_bf16_f32 v210, v212, v213
    v_cvt_pk_bf16_f32 v211, v214, v215
    ds_write_b64 v22, v[208:209] offset:4096
    ds_write_b64 v23, v[210:211] offset:4096
    v_pk_mul_f32 v[88:89], v[88:89], v[102:103] op_sel_hi:[1,0]
    v_pk_mul_f32 v[90:91], v[90:91], v[102:103] op_sel_hi:[1,0]
    v_pk_mul_f32 v[92:93], v[92:93], v[102:103] op_sel_hi:[1,0]
    v_pk_mul_f32 v[94:95], v[94:95], v[102:103] op_sel_hi:[1,0]
    v_cvt_pk_bf16_f32 v88, v88, v89
    v_cvt_pk_bf16_f32 v89, v90, v91
    v_cvt_pk_bf16_f32 v90, v92, v93
    v_cvt_pk_bf16_f32 v91, v94, v95
    ds_write_b64 v20, v[88:89] offset:6144
    ds_write_b64 v21, v[90:91] offset:6144
    v_pk_mul_f32 v[216:217], v[216:217], v[110:111] op_sel_hi:[1,0]
    v_pk_mul_f32 v[218:219], v[218:219], v[110:111] op_sel_hi:[1,0]
    v_pk_mul_f32 v[220:221], v[220:221], v[110:111] op_sel_hi:[1,0]
    v_pk_mul_f32 v[222:223], v[222:223], v[110:111] op_sel_hi:[1,0]
    v_cvt_pk_bf16_f32 v216, v216, v217
    v_cvt_pk_bf16_f32 v217, v218, v219
    v_cvt_pk_bf16_f32 v218, v220, v221
    v_cvt_pk_bf16_f32 v219, v222, v223
    ds_write_b64 v22, v[216:217] offset:6144
    ds_write_b64 v23, v[218:219] offset:6144
    v_lshrrev_b32 v16, 2, v30
    v_bfe_u32 v18, v30, 3, 2
    v_xor_b32 v18, s29, v18
    v_lshlrev_b32 v18, 5, v18
    v_lshl_add_u32 v16, v16, 7, v18
    v_and_b32 v18, 3, v30
    v_lshl_add_u32 v16, v18, 3, v16
    v_add_u32 v18, 147456, v15
    s_waitcnt vmcnt(9) lgkmcnt(0)
    s_barrier
    buffer_store_dword v2, v3, s[40:43], s56 offen sc1
    ds_read_b64_tr_b16 a[128:129], v16 offset:0
    ds_read_b64_tr_b16 a[130:131], v16 offset:2048
    ds_read_b128 a[176:179], v18 offset:0
    ds_read_b128 a[180:183], v18 offset:1024
    ds_read_b64_tr_b16 a[132:133], v16 offset:4096
    ds_read_b64_tr_b16 a[134:135], v16 offset:6144
    ds_read_b128 a[184:187], v18 offset:2048
    ds_read_b128 a[188:191], v18 offset:3072
    ds_read_b64_tr_b16 a[136:137], v16 offset:8192
    ds_read_b64_tr_b16 a[138:139], v16 offset:10240
    ds_read_b128 a[192:195], v18 offset:4096
    ds_read_b128 a[196:199], v18 offset:5120
    ds_read_b64_tr_b16 a[140:141], v16 offset:12288
    ds_read_b64_tr_b16 a[142:143], v16 offset:14336
    ds_read_b128 a[200:203], v18 offset:6144
    ds_read_b128 a[204:207], v18 offset:7168
    ds_read_b64_tr_b16 a[144:145], v16 offset:16384
    ds_read_b64_tr_b16 a[146:147], v16 offset:18432
    ds_read_b128 a[208:211], v18 offset:8192
    ds_read_b128 a[212:215], v18 offset:9216
    ds_read_b64_tr_b16 a[148:149], v16 offset:20480
    ds_read_b64_tr_b16 a[150:151], v16 offset:22528
    ds_read_b128 a[216:219], v18 offset:10240
    ds_read_b128 a[220:223], v18 offset:11264
    ds_read_b64_tr_b16 a[152:153], v16 offset:24576
    ds_read_b64_tr_b16 a[154:155], v16 offset:26624
    ds_read_b128 a[224:227], v18 offset:12288
    ds_read_b128 a[228:231], v18 offset:13312
    ds_read_b64_tr_b16 a[156:157], v16 offset:28672
    ds_read_b64_tr_b16 a[158:159], v16 offset:30720
    ds_read_b128 a[232:235], v18 offset:14336
    ds_read_b128 a[236:239], v18 offset:15360
    ds_read_b128 a[64:67], v1 offset:16384
    ds_read_b128 a[68:71], v1 offset:17408
    ds_read_b128 a[72:75], v1 offset:18432
    ds_read_b128 a[76:79], v1 offset:19456
    ds_read_b128 a[80:83], v1 offset:20480
    ds_read_b128 a[84:87], v1 offset:21504
    ds_read_b128 a[88:91], v1 offset:22528
    ds_read_b128 a[92:95], v1 offset:23552
    ds_read_b128 a[96:99], v1 offset:24576
    ds_read_b128 a[100:103], v1 offset:25600
    ds_read_b128 a[104:107], v1 offset:26624
    ds_read_b128 a[108:111], v1 offset:27648
    ds_read_b128 a[112:115], v1 offset:28672
    ds_read_b128 a[116:119], v1 offset:29696
    ds_read_b128 a[120:123], v1 offset:30720
    ds_read_b128 a[124:127], v1 offset:31744
    v_max3_f32 v96, v32, v33, v34
    s_add_u32 s10, s20, 98304
    v_max3_f32 v98, v40, v41, v42
    s_mov_b32 m0, s10
    v_max3_f32 v100, v48, v49, v50
    buffer_load_dwordx4 v15, s[40:43], s4 offen offset:0 sc1 lds
    v_max3_f32 v102, v56, v57, v58
    v_max3_f32 v96, v96, v35, v36
    v_max3_f32 v98, v98, v43, v44
    v_max3_f32 v100, v100, v51, v52
    v_max3_f32 v102, v102, v59, v60
    v_max3_f32 v96, v96, v37, v38
    v_max3_f32 v98, v98, v45, v46
    v_max3_f32 v100, v100, v53, v54
    buffer_load_dwordx4 v15, s[40:43], s4 offen offset:1024 sc1 lds
    v_max3_f32 v102, v102, v61, v62
    v_max_f32 v96, v96, v39
    v_max_f32 v98, v98, v47
    v_max_f32 v100, v100, v55
    v_max_f32 v102, v102, v63
    v_min3_f32 v104, v32, v33, v34
    v_min3_f32 v106, v40, v41, v42
    v_min3_f32 v108, v48, v49, v50
    buffer_load_dwordx4 v15, s[40:43], s4 offen offset:2048 sc1 lds
    v_min3_f32 v110, v56, v57, v58
    v_min3_f32 v104, v104, v35, v36
    v_min3_f32 v106, v106, v43, v44
    v_min3_f32 v108, v108, v51, v52
    v_min3_f32 v110, v110, v59, v60
    v_min3_f32 v104, v104, v37, v38
    v_min3_f32 v106, v106, v45, v46
    v_min3_f32 v108, v108, v53, v54
    buffer_load_dwordx4 v15, s[40:43], s4 offen offset:3072 sc1 lds
    v_min3_f32 v110, v110, v61, v62
    v_min_f32 v104, v104, v39
    v_min_f32 v106, v106, v47
    v_min_f32 v108, v108, v55
    v_min_f32 v110, v110, v63
    s_nop 1
    s_add_u32 s67, s4, 4096
    v_permlane32_swap_b32 v96, v100
    s_add_u32 m0, s10, 4096
    v_permlane32_swap_b32 v98, v102
    buffer_load_dwordx4 v15, s[40:43], s67 offen offset:0 sc1 lds
    v_permlane32_swap_b32 v104, v108
    v_permlane32_swap_b32 v106, v110
    v_max_f32 v96, v96, v100
    v_max_f32 v98, v98, v102
    v_min_f32 v104, v104, v108
    v_min_f32 v106, v106, v110
    s_nop 0
    v_permlane16_swap_b32 v96, v98
    buffer_load_dwordx4 v15, s[40:43], s67 offen offset:1024 sc1 lds
    v_permlane16_swap_b32 v104, v106
    v_max_f32 v96, v96, v98
    v_min_f32 v104, v104, v106
    v_mul_f32 v96, s68, -v96
    v_mul_f32 v104, s68, v104
    v_mov_b32 v98, v96
    v_mov_b32 v106, v104
    s_nop 0
    buffer_load_dwordx4 v15, s[40:43], s67 offen offset:2048 sc1 lds
    v_permlane16_swap_b32 v96, v98
    v_permlane16_swap_b32 v104, v106
    v_mov_b32 v100, v96
    v_mov_b32 v102, v98
    v_mov_b32 v108, v104
    v_mov_b32 v110, v106
    s_nop 0
    v_permlane32_swap_b32 v96, v100
    buffer_load_dwordx4 v15, s[40:43], s67 offen offset:3072 sc1 lds
    v_permlane32_swap_b32 v98, v102
    v_permlane32_swap_b32 v104, v108
    v_permlane32_swap_b32 v106, v110
    v_cndmask_b32 v97, v96, v17, s[70:71]
    v_cndmask_b32 v99, v98, v17, s[70:71]
    v_cndmask_b32 v101, v100, v17, s[70:71]
    s_add_u32 s4, s4, 32768
    v_cndmask_b32 v103, v102, v17, s[70:71]
    s_sub_u32 s5, s5, 1
    v_cndmask_b32 v105, v104, v17, s[70:71]
    s_cmp_eq_u32 s5, 0
    s_cselect_b32 s4, s6, s4
    s_cselect_b32 s5, s7, s5
    s_cselect_b32 s6, s8, s6
    v_cndmask_b32 v107, v106, v17, s[70:71]
    s_mov_b32 s10, s20
    v_cndmask_b32 v109, v108, v17, s[70:71]
    s_mov_b32 s9, 32768
    v_cndmask_b32 v111, v110, v17, s[70:71]
    v_pk_fma_f32 v[160:161], v[32:33], s[68:69], v[104:105] op_sel:[0,0,0] op_sel_hi:[1,1,0] neg_lo:[1,0,0] neg_hi:[1,0,0]
    v_pk_fma_f32 v[162:163], v[34:35], s[68:69], v[104:105] op_sel:[0,0,0] op_sel_hi:[1,1,0] neg_lo:[1,0,0] neg_hi:[1,0,0]
    v_pk_fma_f32 v[164:165], v[36:37], s[68:69], v[104:105] op_sel:[0,0,1] op_sel_hi:[1,1,1] neg_lo:[1,0,0] neg_hi:[1,0,0]
    v_pk_fma_f32 v[166:167], v[38:39], s[68:69], v[104:105] op_sel:[0,0,1] op_sel_hi:[1,1,1] neg_lo:[1,0,0] neg_hi:[1,0,0]
    v_pk_fma_f32 v[32:33], v[32:33], s[68:69], v[96:97] op_sel:[0,0,0] op_sel_hi:[1,1,0] neg_lo:[0,0,0] neg_hi:[0,0,0]
    v_pk_fma_f32 v[34:35], v[34:35], s[68:69], v[96:97] op_sel:[0,0,0] op_sel_hi:[1,1,0] neg_lo:[0,0,0] neg_hi:[0,0,0]
    v_pk_fma_f32 v[36:37], v[36:37], s[68:69], v[96:97] op_sel:[0,0,1] op_sel_hi:[1,1,1] neg_lo:[0,0,0] neg_hi:[0,0,0]
    v_pk_fma_f32 v[38:39], v[38:39], s[68:69], v[96:97] op_sel:[0,0,1] op_sel_hi:[1,1,1] neg_lo:[0,0,0] neg_hi:[0,0,0]
    v_exp_f32 v160, v160
    v_exp_f32 v161, v161
    v_exp_f32 v162, v162
    v_exp_f32 v163, v163
    v_exp_f32 v164, v164
    v_exp_f32 v165, v165
    v_exp_f32 v166, v166
    v_exp_f32 v167, v167
    v_exp_f32 v32, v32
    v_exp_f32 v33, v33
    v_exp_f32 v34, v34
    v_exp_f32 v35, v35
    v_exp_f32 v36, v36
    v_exp_f32 v37, v37
    v_exp_f32 v38, v38
    v_exp_f32 v39, v39
    v_pk_fma_f32 v[168:169], v[40:41], s[68:69], v[106:107] op_sel:[0,0,0] op_sel_hi:[1,1,0] neg_lo:[1,0,0] neg_hi:[1,0,0]
    v_pk_fma_f32 v[170:171], v[42:43], s[68:69], v[106:107] op_sel:[0,0,0] op_sel_hi:[1,1,0] neg_lo:[1,0,0] neg_hi:[1,0,0]
    v_pk_fma_f32 v[172:173], v[44:45], s[68:69], v[106:107] op_sel:[0,0,1] op_sel_hi:[1,1,1] neg_lo:[1,0,0] neg_hi:[1,0,0]
    v_pk_fma_f32 v[174:175], v[46:47], s[68:69], v[106:107] op_sel:[0,0,1] op_sel_hi:[1,1,1] neg_lo:[1,0,0] neg_hi:[1,0,0]
    v_pk_fma_f32 v[40:41], v[40:41], s[68:69], v[98:99] op_sel:[0,0,0] op_sel_hi:[1,1,0] neg_lo:[0,0,0] neg_hi:[0,0,0]
    v_pk_fma_f32 v[42:43], v[42:43], s[68:69], v[98:99] op_sel:[0,0,0] op_sel_hi:[1,1,0] neg_lo:[0,0,0] neg_hi:[0,0,0]
    v_pk_fma_f32 v[44:45], v[44:45], s[68:69], v[98:99] op_sel:[0,0,1] op_sel_hi:[1,1,1] neg_lo:[0,0,0] neg_hi:[0,0,0]
    v_pk_fma_f32 v[46:47], v[46:47], s[68:69], v[98:99] op_sel:[0,0,1] op_sel_hi:[1,1,1] neg_lo:[0,0,0] neg_hi:[0,0,0]
    v_exp_f32 v168, v168
    v_exp_f32 v169, v169
    v_exp_f32 v170, v170
    v_exp_f32 v171, v171
    v_exp_f32 v172, v172
    v_exp_f32 v173, v173
    v_exp_f32 v174, v174
    v_exp_f32 v175, v175
    v_exp_f32 v40, v40
    v_exp_f32 v41, v41
    v_exp_f32 v42, v42
    v_exp_f32 v43, v43
    v_exp_f32 v44, v44
    v_exp_f32 v45, v45
    v_exp_f32 v46, v46
    v_exp_f32 v47, v47
    v_pk_fma_f32 v[176:177], v[48:49], s[68:69], v[108:109] op_sel:[0,0,0] op_sel_hi:[1,1,0] neg_lo:[1,0,0] neg_hi:[1,0,0]
    v_pk_fma_f32 v[178:179], v[50:51], s[68:69], v[108:109] op_sel:[0,0,0] op_sel_hi:[1,1,0] neg_lo:[1,0,0] neg_hi:[1,0,0]
    v_pk_fma_f32 v[180:181], v[52:53], s[68:69], v[108:109] op_sel:[0,0,1] op_sel_hi:[1,1,1] neg_lo:[1,0,0] neg_hi:[1,0,0]
    v_pk_fma_f32 v[182:183], v[54:55], s[68:69], v[108:109] op_sel:[0,0,1] op_sel_hi:[1,1,1] neg_lo:[1,0,0] neg_hi:[1,0,0]
    v_pk_fma_f32 v[48:49], v[48:49], s[68:69], v[100:101] op_sel:[0,0,0] op_sel_hi:[1,1,0] neg_lo:[0,0,0] neg_hi:[0,0,0]
    v_pk_fma_f32 v[50:51], v[50:51], s[68:69], v[100:101] op_sel:[0,0,0] op_sel_hi:[1,1,0] neg_lo:[0,0,0] neg_hi:[0,0,0]
    v_pk_fma_f32 v[52:53], v[52:53], s[68:69], v[100:101] op_sel:[0,0,1] op_sel_hi:[1,1,1] neg_lo:[0,0,0] neg_hi:[0,0,0]
    v_pk_fma_f32 v[54:55], v[54:55], s[68:69], v[100:101] op_sel:[0,0,1] op_sel_hi:[1,1,1] neg_lo:[0,0,0] neg_hi:[0,0,0]
    v_exp_f32 v176, v176
    v_exp_f32 v177, v177
    v_exp_f32 v178, v178
    v_exp_f32 v179, v179
    v_exp_f32 v180, v180
    v_exp_f32 v181, v181
    v_exp_f32 v182, v182
    v_exp_f32 v183, v183
    buffer_load_dword v19, v3, s[40:43], s57 offen sc1
    v_exp_f32 v48, v48
    v_exp_f32 v49, v49
    v_exp_f32 v50, v50
    v_exp_f32 v51, v51
    v_exp_f32 v52, v52
    v_exp_f32 v53, v53
    v_exp_f32 v54, v54
    v_exp_f32 v55, v55
    v_pk_fma_f32 v[184:185], v[56:57], s[68:69], v[110:111] op_sel:[0,0,0] op_sel_hi:[1,1,0] neg_lo:[1,0,0] neg_hi:[1,0,0]
    v_pk_fma_f32 v[186:187], v[58:59], s[68:69], v[110:111] op_sel:[0,0,0] op_sel_hi:[1,1,0] neg_lo:[1,0,0] neg_hi:[1,0,0]
    v_pk_fma_f32 v[188:189], v[60:61], s[68:69], v[110:111] op_sel:[0,0,1] op_sel_hi:[1,1,1] neg_lo:[1,0,0] neg_hi:[1,0,0]
    v_pk_fma_f32 v[190:191], v[62:63], s[68:69], v[110:111] op_sel:[0,0,1] op_sel_hi:[1,1,1] neg_lo:[1,0,0] neg_hi:[1,0,0]
    v_pk_fma_f32 v[56:57], v[56:57], s[68:69], v[102:103] op_sel:[0,0,0] op_sel_hi:[1,1,0] neg_lo:[0,0,0] neg_hi:[0,0,0]
    v_pk_fma_f32 v[58:59], v[58:59], s[68:69], v[102:103] op_sel:[0,0,0] op_sel_hi:[1,1,0] neg_lo:[0,0,0] neg_hi:[0,0,0]
    v_pk_fma_f32 v[60:61], v[60:61], s[68:69], v[102:103] op_sel:[0,0,1] op_sel_hi:[1,1,1] neg_lo:[0,0,0] neg_hi:[0,0,0]
    v_pk_fma_f32 v[62:63], v[62:63], s[68:69], v[102:103] op_sel:[0,0,1] op_sel_hi:[1,1,1] neg_lo:[0,0,0] neg_hi:[0,0,0]
    v_exp_f32 v184, v184
    v_exp_f32 v185, v185
    v_exp_f32 v186, v186
    v_exp_f32 v187, v187
    v_exp_f32 v188, v188
    v_exp_f32 v189, v189
    v_exp_f32 v190, v190
    v_exp_f32 v191, v191
    v_exp_f32 v56, v56
    v_exp_f32 v57, v57
    v_exp_f32 v58, v58
    v_exp_f32 v59, v59
    v_exp_f32 v60, v60
    v_exp_f32 v61, v61
    v_exp_f32 v62, v62
    v_exp_f32 v63, v63
    v_pk_add_f32 v[104:105], v[160:161], v[162:163]
    v_pk_add_f32 v[106:107], v[168:169], v[170:171]
    v_pk_add_f32 v[108:109], v[176:177], v[178:179]
    v_pk_add_f32 v[110:111], v[184:185], v[186:187]
    v_pk_add_f32 v[96:97], v[32:33], v[34:35]
    v_pk_add_f32 v[98:99], v[40:41], v[42:43]
    v_pk_add_f32 v[100:101], v[48:49], v[50:51]
    v_pk_add_f32 v[102:103], v[56:57], v[58:59]
    v_pk_add_f32 v[104:105], v[104:105], v[164:165]
    v_pk_add_f32 v[106:107], v[106:107], v[172:173]
    v_pk_add_f32 v[108:109], v[108:109], v[180:181]
    v_pk_add_f32 v[110:111], v[110:111], v[188:189]
    v_pk_add_f32 v[96:97], v[96:97], v[36:37]
    v_pk_add_f32 v[98:99], v[98:99], v[44:45]
    v_pk_add_f32 v[100:101], v[100:101], v[52:53]
    v_pk_add_f32 v[102:103], v[102:103], v[60:61]
    v_pk_add_f32 v[104:105], v[104:105], v[166:167]
    v_pk_add_f32 v[106:107], v[106:107], v[174:175]
    v_pk_add_f32 v[108:109], v[108:109], v[182:183]
    v_pk_add_f32 v[110:111], v[110:111], v[190:191]
    v_pk_add_f32 v[96:97], v[96:97], v[38:39]
    v_pk_add_f32 v[98:99], v[98:99], v[46:47]
    v_pk_add_f32 v[100:101], v[100:101], v[54:55]
    v_pk_add_f32 v[102:103], v[102:103], v[62:63]
    v_add_f32 v104, v104, v105
    v_add_f32 v106, v106, v107
    v_add_f32 v108, v108, v109
    v_add_f32 v110, v110, v111
    v_add_f32 v96, v96, v97
    v_add_f32 v98, v98, v99
    v_add_f32 v100, v100, v101
    v_add_f32 v102, v102, v103
    s_nop 1
    v_permlane32_swap_b32 v96, v100
    v_permlane32_swap_b32 v98, v102
    v_permlane32_swap_b32 v104, v108
    v_permlane32_swap_b32 v106, v110
    v_add_f32 v96, v96, v100
    v_add_f32 v98, v98, v102
    v_add_f32 v104, v104, v108
    v_add_f32 v106, v106, v110
    s_nop 0
    v_permlane16_swap_b32 v96, v98
    v_permlane16_swap_b32 v104, v106
    v_add_f32 v96, v96, v98
    v_add_f32 v104, v104, v106
    v_rcp_f32 v96, v96
    v_rcp_f32 v104, v104
    v_mov_b32 v98, v96
    v_mov_b32 v106, v104
    s_nop 0
    v_permlane16_swap_b32 v96, v98
    v_permlane16_swap_b32 v104, v106
    v_mov_b32 v100, v96
    v_mov_b32 v102, v98
    v_mov_b32 v108, v104
    v_mov_b32 v110, v106
    s_nop 0
    v_permlane32_swap_b32 v96, v100
    v_permlane32_swap_b32 v98, v102
    v_permlane32_swap_b32 v104, v108
    v_permlane32_swap_b32 v106, v110
    v_pk_mul_f32 v[32:33], v[32:33], v[96:97] op_sel_hi:[1,0]
    v_pk_mul_f32 v[34:35], v[34:35], v[96:97] op_sel_hi:[1,0]
    v_pk_mul_f32 v[36:37], v[36:37], v[96:97] op_sel_hi:[1,0]
    v_pk_mul_f32 v[38:39], v[38:39], v[96:97] op_sel_hi:[1,0]
    v_cvt_pk_bf16_f32 v64, v32, v33
    s_waitcnt vmcnt(0)
    v_cmp_gt_u32 vcc, 1, v5
    s_nop 0
    s_cmp_lg_u64 vcc, 0
    s_cbranch_scc1 F_spin6
F_spin6r:
    v_cmp_gt_u32 vcc, 1, v19
    s_nop 0
    s_cmp_lg_u64 vcc, 0
    s_cbranch_scc1 F_spin7
F_spin7r:
    v_cvt_pk_bf16_f32 v65, v34, v35
    s_add_u32 s67, s79, 0
    v_cvt_pk_bf16_f32 v66, v36, v37
    buffer_load_dwordx4 a[0:3], v15, s[40:43], s67 offen offset:0 sc1
    v_cvt_pk_bf16_f32 v67, v38, v39
    v_pk_mul_f32 v[160:161], v[160:161], v[104:105] op_sel_hi:[1,0]
    v_pk_mul_f32 v[162:163], v[162:163], v[104:105] op_sel_hi:[1,0]
    v_pk_mul_f32 v[164:165], v[164:165], v[104:105] op_sel_hi:[1,0]
    v_pk_mul_f32 v[166:167], v[166:167], v[104:105] op_sel_hi:[1,0]
    v_cvt_pk_bf16_f32 v68, v160, v161
    buffer_load_dwordx4 a[4:7], v15, s[40:43], s67 offen offset:1024 sc1
    v_cvt_pk_bf16_f32 v69, v162, v163
    v_cvt_pk_bf16_f32 v70, v164, v165
    v_cvt_pk_bf16_f32 v71, v166, v167
    v_pk_mul_f32 v[40:41], v[40:41], v[98:99] op_sel_hi:[1,0]
    v_pk_mul_f32 v[42:43], v[42:43], v[98:99] op_sel_hi:[1,0]
    v_pk_mul_f32 v[44:45], v[44:45], v[98:99] op_sel_hi:[1,0]
    buffer_load_dwordx4 a[8:11], v15, s[40:43], s67 offen offset:2048 sc1
    v_pk_mul_f32 v[46:47], v[46:47], v[98:99] op_sel_hi:[1,0]
    v_cvt_pk_bf16_f32 v72, v40, v41
    v_cvt_pk_bf16_f32 v73, v42, v43
    v_cvt_pk_bf16_f32 v74, v44, v45
    v_cvt_pk_bf16_f32 v75, v46, v47
    v_pk_mul_f32 v[168:169], v[168:169], v[106:107] op_sel_hi:[1,0]
    buffer_load_dwordx4 a[12:15], v15, s[40:43], s67 offen offset:3072 sc1
    v_pk_mul_f32 v[170:171], v[170:171], v[106:107] op_sel_hi:[1,0]
    v_pk_mul_f32 v[172:173], v[172:173], v[106:107] op_sel_hi:[1,0]
    v_pk_mul_f32 v[174:175], v[174:175], v[106:107] op_sel_hi:[1,0]
    v_cvt_pk_bf16_f32 v76, v168, v169
    s_add_u32 s67, s79, 4096
    v_cvt_pk_bf16_f32 v77, v170, v171
    v_cvt_pk_bf16_f32 v78, v172, v173
    buffer_load_dwordx4 a[16:19], v15, s[40:43], s67 offen offset:0 sc1
    v_cvt_pk_bf16_f32 v79, v174, v175
    v_pk_mul_f32 v[48:49], v[48:49], v[100:101] op_sel_hi:[1,0]
    v_pk_mul_f32 v[50:51], v[50:51], v[100:101] op_sel_hi:[1,0]
    v_pk_mul_f32 v[52:53], v[52:53], v[100:101] op_sel_hi:[1,0]
    v_pk_mul_f32 v[54:55], v[54:55], v[100:101] op_sel_hi:[1,0]
    v_cvt_pk_bf16_f32 v80, v48, v49
    buffer_load_dwordx4 a[20:23], v15, s[40:43], s67 offen offset:1024 sc1
    v_cvt_pk_bf16_f32 v81, v50, v51
    v_cvt_pk_bf16_f32 v82, v52, v53
    v_cvt_pk_bf16_f32 v83, v54, v55
    v_pk_mul_f32 v[176:177], v[176:177], v[108:109] op_sel_hi:[1,0]
    v_pk_mul_f32 v[178:179], v[178:179], v[108:109] op_sel_hi:[1,0]
    v_pk_mul_f32 v[180:181], v[180:181], v[108:109] op_sel_hi:[1,0]
    buffer_load_dwordx4 a[24:27], v15, s[40:43], s67 offen offset:2048 sc1
    v_pk_mul_f32 v[182:183], v[182:183], v[108:109] op_sel_hi:[1,0]
    v_cvt_pk_bf16_f32 v84, v176, v177
    v_cvt_pk_bf16_f32 v85, v178, v179
    v_cvt_pk_bf16_f32 v86, v180, v181
    v_cvt_pk_bf16_f32 v87, v182, v183
    v_pk_mul_f32 v[56:57], v[56:57], v[102:103] op_sel_hi:[1,0]
    buffer_load_dwordx4 a[28:31], v15, s[40:43], s67 offen offset:3072 sc1
    v_pk_mul_f32 v[58:59], v[58:59], v[102:103] op_sel_hi:[1,0]
    v_pk_mul_f32 v[60:61], v[60:61], v[102:103] op_sel_hi:[1,0]
    v_pk_mul_f32 v[62:63], v[62:63], v[102:103] op_sel_hi:[1,0]
    v_cvt_pk_bf16_f32 v88, v56, v57
    s_add_u32 s67, s79, 8192
    v_cvt_pk_bf16_f32 v89, v58, v59
    v_cvt_pk_bf16_f32 v90, v60, v61
    buffer_load_dwordx4 a[32:35], v15, s[40:43], s67 offen offset:0 sc1
    v_cvt_pk_bf16_f32 v91, v62, v63
    v_pk_mul_f32 v[184:185], v[184:185], v[110:111] op_sel_hi:[1,0]
    v_pk_mul_f32 v[186:187], v[186:187], v[110:111] op_sel_hi:[1,0]
    v_pk_mul_f32 v[188:189], v[188:189], v[110:111] op_sel_hi:[1,0]
    v_pk_mul_f32 v[190:191], v[190:191], v[110:111] op_sel_hi:[1,0]
    v_cvt_pk_bf16_f32 v92, v184, v185
    buffer_load_dwordx4 a[36:39], v15, s[40:43], s67 offen offset:1024 sc1
    v_cvt_pk_bf16_f32 v93, v186, v187
    v_cvt_pk_bf16_f32 v94, v188, v189
    v_cvt_pk_bf16_f32 v95, v190, v191
    buffer_load_dwordx4 a[40:43], v15, s[40:43], s67 offen offset:2048 sc1
    buffer_load_dwordx4 a[44:47], v15, s[40:43], s67 offen offset:3072 sc1
    s_add_u32 s67, s79, 12288
    buffer_load_dwordx4 a[48:51], v15, s[40:43], s67 offen offset:0 sc1
    buffer_load_dwordx4 a[52:55], v15, s[40:43], s67 offen offset:1024 sc1
    buffer_load_dwordx4 a[56:59], v15, s[40:43], s67 offen offset:2048 sc1
    buffer_load_dwordx4 a[60:63], v15, s[40:43], s67 offen offset:3072 sc1
    s_lshl_b32 s65, s14, 16
    s_lshl_b32 s66, s15, 13
    s_add_u32 s65, s65, s66
    s_lshl_b32 s66, s29, 10
    s_add_u32 s65, s65, s66
    s_add_u32 s65, s65, 79691776
    s_waitcnt lgkmcnt(0)
    s_barrier
    v_mfma_f32_16x16x32_bf16 v[112:115], a[128:131], a[176:179], 0
    v_mfma_f32_16x16x32_bf16 v[116:119], a[128:131], a[180:183], 0
    v_mfma_f32_16x16x32_bf16 v[112:115], a[132:135], a[184:187], v[112:115]
    v_mfma_f32_16x16x32_bf16 v[116:119], a[132:135], a[188:191], v[116:119]
    v_mfma_f32_16x16x32_bf16 v[112:115], a[136:139], a[192:195], v[112:115]
    v_mfma_f32_16x16x32_bf16 v[116:119], a[136:139], a[196:199], v[116:119]
    v_mfma_f32_16x16x32_bf16 v[112:115], a[140:143], a[200:203], v[112:115]
    v_mfma_f32_16x16x32_bf16 v[116:119], a[140:143], a[204:207], v[116:119]
    v_mfma_f32_16x16x32_bf16 v[112:115], a[144:147], a[208:211], v[112:115]
    v_mfma_f32_16x16x32_bf16 v[116:119], a[144:147], a[212:215], v[116:119]
    v_mfma_f32_16x16x32_bf16 v[112:115], a[148:151], a[216:219], v[112:115]
    v_mfma_f32_16x16x32_bf16 v[116:119], a[148:151], a[220:223], v[116:119]
    v_mfma_f32_16x16x32_bf16 v[112:115], a[152:155], a[224:227], v[112:115]
    v_mfma_f32_16x16x32_bf16 v[116:119], a[152:155], a[228:231], v[116:119]
    v_mfma_f32_16x16x32_bf16 v[112:115], a[156:159], a[232:235], v[112:115]
    v_mfma_f32_16x16x32_bf16 v[116:119], a[156:159], a[236:239], v[116:119]
    v_lshrrev_b32 v2, 2, v15
    v_bfe_u32 v3, v15, 2, 7
    v_mov_b32 v4, 0xff800000
    v_and_b32 v8, 0x30, v15
    v_cmp_eq_u32 vcc, 0, v8
    v_mov_b32 v9, 0x3f803f80
    s_nop 0
    v_cndmask_b32 v8, 0, v9, vcc
    v_mov_b32 v9, v8
    v_mov_b32 v10, v8
    v_mov_b32 v11, v8
    v_bfe_u32 v12, v15, 4, 4
    v_lshrrev_b32 v13, 8, v15
    v_lshlrev_b32 v13, 2, v13
    v_cmp_gt_u32 s[88:89], v13, v12
    v_add_u32 v13, 1, v13
    v_cmp_gt_u32 s[90:91], v13, v12
    v_add_u32 v13, 1, v13
    v_cmp_gt_u32 s[92:93], v13, v12
    v_add_u32 v13, 1, v13
    v_cmp_gt_u32 s[94:95], v13, v12
    v_add_u32 v13, 1, v13
    s_mov_b32 s52, 49152
    s_mov_b32 s49, 32768
    s_mov_b32 s48, 0
    s_add_u32 s51, s28, 1
    s_mul_i32 s53, s29, s11
    s_add_u32 s53, s53, s51
    s_add_u32 s53, s53, 1
    s_mov_b32 s13, 2
    s_mov_b32 s98, 1
    v_lshlrev_b32 v6, 3, v15
    v_and_b32 v6, 2047, v6
    s_sub_u32 s16, 3, s29
    s_mul_i32 s16, s16, s11
    s_sub_u32 s64, s97, s16
    s_mov_b32 s77, s64
    s_cmp_eq_u32 s17, 0
    s_cselect_b32 s44, s45, s8
    s_add_u32 s74, s65, 0
    buffer_store_dwordx4 v[112:115], v15, s[40:43], s74 offen offset:0 sc1
    s_add_u32 s74, s65, 4096
    buffer_store_dwordx4 v[116:119], v15, s[40:43], s74 offen offset:0 sc1
    s_waitcnt vmcnt(2)
F_att:
    s_waitcnt lgkmcnt(0)
    v_add_u32 v1, s9, v15
    s_branch F_first
F_seg:
    s_sub_u32 s16, 3, s29
    s_mul_i32 s16, s16, s11
    s_sub_u32 s64, s97, s16
    s_mov_b32 s77, s64
    s_cmp_eq_u32 s17, 0
    s_cselect_b32 s44, s45, s8
    s_waitcnt vmcnt(16) lgkmcnt(0)
    v_add_u32 v1, s9, v15
    s_barrier
F_first:
    s_cmp_eq_u32 s64, s11
    s_cbranch_scc1 F_only
    v_mfma_f32_16x16x32_bf16 v[16:19], a[64:67], a[0:3], 0
    s_mov_b32 m0, s10
    ds_read_b128 a[128:131], v1 offset:0
    ds_read_b128 a[132:135], v1 offset:1024
    v_mfma_f32_16x16x32_bf16 v[16:19], a[68:71], a[4:7], v[16:19]
    buffer_load_dwordx4 v15, s[40:43], s4 offen offset:0 sc1 lds
    v_mfma_f32_16x16x32_bf16 v[16:19], a[72:75], a[8:11], v[16:19]
    ds_read_b128 a[136:139], v1 offset:2048
    ds_read_b128 a[140:143], v1 offset:3072
    v_mfma_f32_16x16x32_bf16 v[16:19], a[76:79], a[12:15], v[16:19]
    buffer_load_dwordx4 v15, s[40:43], s4 offen offset:1024 sc1 lds
    v_mfma_f32_16x16x32_bf16 v[16:19], a[80:83], a[16:19], v[16:19]
    ds_read_b128 a[144:147], v1 offset:4096
    ds_read_b128 a[148:151], v1 offset:5120
    v_mfma_f32_16x16x32_bf16 v[16:19], a[84:87], a[20:23], v[16:19]
    buffer_load_dwordx4 v15, s[40:43], s4 offen offset:2048 sc1 lds
    v_mfma_f32_16x16x32_bf16 v[16:19], a[88:91], a[24:27], v[16:19]
    ds_read_b128 a[152:155], v1 offset:6144
    ds_read_b128 a[156:159], v1 offset:7168
    v_mfma_f32_16x16x32_bf16 v[16:19], a[92:95], a[28:31], v[16:19]
    buffer_load_dwordx4 v15, s[40:43], s4 offen offset:3072 sc1 lds
    v_mfma_f32_16x16x32_bf16 v[20:23], a[124:127], a[28:31], 0
    s_add_u32 s67, s4, 4096
    ds_read_b128 a[160:163], v1 offset:8192
    s_add_u32 m0, s10, 4096
    v_mfma_f32_16x16x32_bf16 v[20:23], a[120:123], a[24:27], v[20:23]
    buffer_load_dwordx4 v15, s[40:43], s67 offen offset:0 sc1 lds
    v_mfma_f32_16x16x32_bf16 v[20:23], a[116:119], a[20:23], v[20:23]
    ds_read_b128 a[164:167], v1 offset:9216
    ds_read_b128 a[168:171], v1 offset:10240
    v_mfma_f32_16x16x32_bf16 v[20:23], a[112:115], a[16:19], v[20:23]
    buffer_load_dwordx4 v15, s[40:43], s67 offen offset:1024 sc1 lds
    v_mfma_f32_16x16x32_bf16 v[20:23], a[108:111], a[12:15], v[20:23]
    ds_read_b128 a[172:175], v1 offset:11264
    ds_read_b128 a[176:179], v1 offset:12288
    v_mfma_f32_16x16x32_bf16 v[20:23], a[104:107], a[8:11], v[20:23]
    buffer_load_dwordx4 v15, s[40:43], s67 offen offset:2048 sc1 lds
    v_mfma_f32_16x16x32_bf16 v[20:23], a[100:103], a[4:7], v[20:23]
    ds_read_b128 a[180:183], v1 offset:13312
    s_add_u32 s79, s44, 0
    ds_read_b128 a[184:187], v1 offset:14336
    v_mfma_f32_16x16x32_bf16 v[20:23], a[96:99], a[0:3], v[20:23]
    buffer_load_dwordx4 v15, s[40:43], s67 offen offset:3072 sc1 lds
    s_add_u32 s4, s4, s49
    s_sub_u32 s5, s5, 1
    v_mfma_f32_16x16x32_bf16 v[24:27], a[64:67], a[32:35], 0
    s_cmp_eq_u32 s5, 0
    ds_read_b128 a[188:191], v1 offset:15360
    s_cbranch_scc1 F_sw8
F_sw8r:
    v_mfma_f32_16x16x32_bf16 v[24:27], a[68:71], a[36:39], v[24:27]
    s_add_u32 s10, s9, s20
    buffer_load_dwordx4 a[192:195], v15, s[40:43], s79 offen offset:0 sc1
    s_add_u32 s9, s9, 32768
    v_mfma_f32_16x16x32_bf16 v[24:27], a[72:75], a[40:43], v[24:27]
    s_and_b32 s9, s9, 0x1ffff
    v_max3_f32 v56, v16, v17, v18
    s_add_u32 s48, s48, 1
    v_mfma_f32_16x16x32_bf16 v[24:27], a[76:79], a[44:47], v[24:27]
    s_sub_u32 s64, s64, 1
    v_max3_f32 v56, v56, v19, v20
    v_max3_f32 v56, v56, v21, v22
    v_mfma_f32_16x16x32_bf16 v[24:27], a[80:83], a[48:51], v[24:27]
    buffer_load_dwordx4 a[196:199], v15, s[40:43], s79 offen offset:1024 sc1
    v_mfma_f32_16x16x32_bf16 v[24:27], a[84:87], a[52:55], v[24:27]
    v_max_f32 v56, v56, v23
    v_mov_b32 v57, v56
    s_nop 1
    v_mfma_f32_16x16x32_bf16 v[24:27], a[88:91], a[56:59], v[24:27]
    v_permlane32_swap_b32 v56, v57
    v_max_f32 v56, v56, v57
    v_mfma_f32_16x16x32_bf16 v[24:27], a[92:95], a[60:63], v[24:27]
    v_mov_b32 v57, v56
    s_nop 1
    v_permlane16_swap_b32 v56, v57
    v_mfma_f32_16x16x32_bf16 v[28:31], a[124:127], a[60:63], 0
    buffer_load_dwordx4 a[200:203], v15, s[40:43], s79 offen offset:2048 sc1
    v_mfma_f32_16x16x32_bf16 v[28:31], a[120:123], a[56:59], v[28:31]
    v_max_f32 v56, v56, v57
    v_sub_f32 v40, 0xc2c80000, v56
    v_mfma_f32_16x16x32_bf16 v[28:31], a[116:119], a[52:55], v[28:31]
    v_add_f32 v16, v16, v40
    v_add_f32 v17, v17, v40
    v_mfma_f32_16x16x32_bf16 v[28:31], a[112:115], a[48:51], v[28:31]
    v_add_f32 v18, v18, v40
    v_add_f32 v19, v19, v40
    v_mfma_f32_16x16x32_bf16 v[28:31], a[108:111], a[44:47], v[28:31]
    buffer_load_dwordx4 a[204:207], v15, s[40:43], s79 offen offset:3072 sc1
    v_mfma_f32_16x16x32_bf16 v[28:31], a[104:107], a[40:43], v[28:31]
    v_add_f32 v20, v20, v40
    v_add_f32 v21, v21, v40
    v_mfma_f32_16x16x32_bf16 v[28:31], a[100:103], a[36:39], v[28:31]
    s_waitcnt lgkmcnt(0)
    v_add_f32 v22, v22, v40
    v_add_f32 v23, v23, v40
    v_mfma_f32_16x16x32_bf16 v[28:31], a[96:99], a[32:35], v[28:31]
    v_exp_f32 v16, v16
    v_exp_f32 v17, v17
    v_exp_f32 v18, v18
    v_exp_f32 v19, v19
    v_exp_f32 v20, v20
    v_exp_f32 v21, v21
    v_exp_f32 v22, v22
    v_exp_f32 v23, v23
    v_cvt_pk_bf16_f32 v32, v16, v17
    v_cvt_pk_bf16_f32 v33, v18, v19
    v_cvt_pk_bf16_f32 v34, v20, v21
    v_cvt_pk_bf16_f32 v35, v22, v23
    s_nop 1
    v_mfma_f32_16x16x32_bf16 v[128:131], a[128:131], v[32:35], 0
    ds_read_b128 a[64:67], v1 offset:16384
    ds_read_b128 a[68:71], v1 offset:17408
    v_mfma_f32_16x16x32_bf16 v[132:135], a[132:135], v[32:35], 0
    ds_read_b128 a[72:75], v1 offset:18432
    s_add_u32 s79, s44, 4096
    ds_read_b128 a[76:79], v1 offset:19456
    v_mfma_f32_16x16x32_bf16 v[136:139], a[136:139], v[32:35], 0
    v_max3_f32 v58, v24, v25, v26
    v_max3_f32 v58, v58, v27, v28
    v_mfma_f32_16x16x32_bf16 v[140:143], a[140:143], v[32:35], 0
    buffer_load_dwordx4 a[208:211], v15, s[40:43], s79 offen offset:0 sc1
    v_mfma_f32_16x16x32_bf16 v[144:147], a[144:147], v[32:35], 0
    v_max3_f32 v58, v58, v29, v30
    v_max_f32 v58, v58, v31
    v_mfma_f32_16x16x32_bf16 v[148:151], a[148:151], v[32:35], 0
    v_mov_b32 v59, v58
    s_nop 1
    v_permlane32_swap_b32 v58, v59
    v_mfma_f32_16x16x32_bf16 v[152:155], a[152:155], v[32:35], 0
    v_max_f32 v58, v58, v59
    v_mov_b32 v59, v58
    s_nop 1
    v_mfma_f32_16x16x32_bf16 v[156:159], a[156:159], v[32:35], 0
    buffer_load_dwordx4 a[212:215], v15, s[40:43], s79 offen offset:1024 sc1
    v_mfma_f32_16x16x32_bf16 v[160:163], a[160:163], v[32:35], 0
    v_permlane16_swap_b32 v58, v59
    v_max_f32 v58, v58, v59
    v_mfma_f32_16x16x32_bf16 v[164:167], a[164:167], v[32:35], 0
    v_sub_f32 v44, 0xc2c80000, v58
    v_add_f32 v24, v24, v44
    v_mfma_f32_16x16x32_bf16 v[168:171], a[168:171], v[32:35], 0
    v_add_f32 v25, v25, v44
    v_add_f32 v26, v26, v44
    v_mfma_f32_16x16x32_bf16 v[172:175], a[172:175], v[32:35], 0
    buffer_load_dwordx4 a[216:219], v15, s[40:43], s79 offen offset:2048 sc1
    v_mfma_f32_16x16x32_bf16 v[176:179], a[176:179], v[32:35], 0
    v_add_f32 v27, v27, v44
    v_add_f32 v28, v28, v44
    v_mfma_f32_16x16x32_bf16 v[180:183], a[180:183], v[32:35], 0
    v_add_f32 v29, v29, v44
    v_add_f32 v30, v30, v44
    v_mfma_f32_16x16x32_bf16 v[184:187], a[184:187], v[32:35], 0
    v_add_f32 v31, v31, v44
    v_mfma_f32_16x16x32_bf16 v[188:191], a[188:191], v[32:35], 0
    buffer_load_dwordx4 a[220:223], v15, s[40:43], s79 offen offset:3072 sc1
    v_mfma_f32_16x16x32_bf16 v[48:51], v[8:11], v[32:35], 0
    s_add_u32 s79, s44, 8192
    v_exp_f32 v24, v24
    v_exp_f32 v25, v25
    v_exp_f32 v26, v26
    v_exp_f32 v27, v27
    v_exp_f32 v28, v28
    v_exp_f32 v29, v29
    v_exp_f32 v30, v30
    v_exp_f32 v31, v31
    v_cvt_pk_bf16_f32 v36, v24, v25
    v_cvt_pk_bf16_f32 v37, v26, v27
    v_cvt_pk_bf16_f32 v38, v28, v29
    v_cvt_pk_bf16_f32 v39, v30, v31
    s_nop 1
    v_mfma_f32_16x16x32_bf16 v[192:195], a[128:131], v[36:39], 0
    ds_read_b128 a[80:83], v1 offset:20480
    ds_read_b128 a[84:87], v1 offset:21504
    v_mfma_f32_16x16x32_bf16 v[196:199], a[132:135], v[36:39], 0
    buffer_load_dwordx4 a[224:227], v15, s[40:43], s79 offen offset:0 sc1
    v_mfma_f32_16x16x32_bf16 v[200:203], a[136:139], v[36:39], 0
    ds_read_b128 a[88:91], v1 offset:22528
    v_mov_b32 v41, v40
    v_mfma_f32_16x16x32_bf16 v[204:207], a[140:143], v[36:39], 0
    ds_read_b128 a[92:95], v1 offset:23552
    v_mov_b32 v42, v40
    v_mfma_f32_16x16x32_bf16 v[208:211], a[144:147], v[36:39], 0
    ds_read_b128 a[96:99], v1 offset:24576
    v_mov_b32 v43, v40
    v_mfma_f32_16x16x32_bf16 v[212:215], a[148:151], v[36:39], 0
    ds_read_b128 a[100:103], v1 offset:25600
    v_mov_b32 v45, v44
    v_mfma_f32_16x16x32_bf16 v[216:219], a[152:155], v[36:39], 0
    ds_read_b128 a[104:107], v1 offset:26624
    v_mov_b32 v46, v44
    v_mfma_f32_16x16x32_bf16 v[220:223], a[156:159], v[36:39], 0
    ds_read_b128 a[108:111], v1 offset:27648
    v_mov_b32 v47, v44
    v_mfma_f32_16x16x32_bf16 v[224:227], a[160:163], v[36:39], 0
    ds_read_b128 a[112:115], v1 offset:28672
    v_mov_b32 v12, 0
    v_mfma_f32_16x16x32_bf16 v[228:231], a[164:167], v[36:39], 0
    ds_read_b128 a[116:119], v1 offset:29696
    v_mov_b32 v13, 0
    v_mfma_f32_16x16x32_bf16 v[232:235], a[168:171], v[36:39], 0
    ds_read_b128 a[120:123], v1 offset:30720
    ds_read_b128 a[124:127], v1 offset:31744
    v_mfma_f32_16x16x32_bf16 v[236:239], a[172:175], v[36:39], 0
    buffer_load_dwordx4 a[228:231], v15, s[40:43], s79 offen offset:1024 sc1
    v_mfma_f32_16x16x32_bf16 v[240:243], a[176:179], v[36:39], 0
    buffer_load_dwordx4 a[232:235], v15, s[40:43], s79 offen offset:2048 sc1
    v_mfma_f32_16x16x32_bf16 v[244:247], a[180:183], v[36:39], 0
    buffer_load_dwordx4 a[236:239], v15, s[40:43], s79 offen offset:3072 sc1
    s_add_u32 s79, s44, 12288
    v_mfma_f32_16x16x32_bf16 v[248:251], a[184:187], v[36:39], 0
    buffer_load_dwordx4 a[240:243], v15, s[40:43], s79 offen offset:0 sc1
    v_mfma_f32_16x16x32_bf16 v[252:255], a[188:191], v[36:39], 0
    buffer_load_dwordx4 a[244:247], v15, s[40:43], s79 offen offset:1024 sc1
    v_mfma_f32_16x16x32_bf16 v[52:55], v[8:11], v[36:39], 0
    buffer_load_dwordx4 a[248:251], v15, s[40:43], s79 offen offset:2048 sc1
    buffer_load_dwordx4 a[252:255], v15, s[40:43], s79 offen offset:3072 sc1
    s_waitcnt vmcnt(24)
    buffer_store_dword v4, v3, s[40:43], s76 offen sc1
    buffer_load_dword v5, v6, s[40:43], s75 offen sc1
    s_cmp_gt_u32 s64, s53
    s_cbranch_scc0 F_loop1
    s_add_u32 s66, s9, 32768
    s_and_b32 s66, s66, 0x1ffff
    v_add_u32 v14, s66, v15
    v_add_u32 v1, s9, v15
    s_waitcnt vmcnt(26) lgkmcnt(0)
    s_barrier
    .p2align 6
F_loop:
    v_mfma_f32_16x16x32_bf16 v[16:19], a[64:67], a[0:3], v[40:43]
    s_cmp_ge_u32 s48, s13
    s_cbranch_scc1 F_hookin1
F_hookret1:
    v_mfma_f32_16x16x32_bf16 v[16:19], a[68:71], a[4:7], v[16:19]
    ds_read_b128 a[128:131], v1 offset:16384
    v_mfma_f32_16x16x32_bf16 v[16:19], a[72:75], a[8:11], v[16:19]
    s_mov_b32 m0, s10
    ds_read_b128 a[132:135], v1 offset:17408
    v_mfma_f32_16x16x32_bf16 v[16:19], a[76:79], a[12:15], v[16:19]
    buffer_load_dwordx4 v15, s[40:43], s4 offen offset:0 sc1 lds
    v_mfma_f32_16x16x32_bf16 v[16:19], a[80:83], a[16:19], v[16:19]
    ds_read_b128 a[136:139], v1 offset:18432
    v_mfma_f32_16x16x32_bf16 v[16:19], a[84:87], a[20:23], v[16:19]
    ds_read_b128 a[140:143], v1 offset:19456
    v_mfma_f32_16x16x32_bf16 v[16:19], a[88:91], a[24:27], v[16:19]
    ds_read_b128 a[144:147], v1 offset:20480
    v_mfma_f32_16x16x32_bf16 v[16:19], a[92:95], a[28:31], v[16:19]
    ds_read_b128 a[148:151], v1 offset:21504
    v_mfma_f32_16x16x32_bf16 v[20:23], a[124:127], a[28:31], v[40:43]
    buffer_load_dwordx4 v15, s[40:43], s4 offen offset:1024 sc1 lds
    v_mfma_f32_16x16x32_bf16 v[20:23], a[120:123], a[24:27], v[20:23]
    ds_read_b128 a[152:155], v1 offset:22528
    v_mfma_f32_16x16x32_bf16 v[20:23], a[116:119], a[20:23], v[20:23]
    ds_read_b128 a[156:159], v1 offset:23552
    v_mfma_f32_16x16x32_bf16 v[20:23], a[112:115], a[16:19], v[20:23]
    ds_read_b128 a[160:163], v1 offset:24576
    v_mfma_f32_16x16x32_bf16 v[20:23], a[108:111], a[12:15], v[20:23]
    v_exp_f32 v16, v16
    v_mfma_f32_16x16x32_bf16 v[20:23], a[104:107], a[8:11], v[20:23]
    ds_read_b128 a[164:167], v1 offset:25600
    v_mfma_f32_16x16x32_bf16 v[20:23], a[100:103], a[4:7], v[20:23]
    v_exp_f32 v17, v17
    v_mfma_f32_16x16x32_bf16 v[20:23], a[96:99], a[0:3], v[20:23]
    buffer_load_dwordx4 v15, s[40:43], s4 offen offset:2048 sc1 lds
    v_mfma_f32_16x16x32_bf16 v[24:27], a[64:67], a[32:35], v[44:47]
    v_exp_f32 v18, v18
    v_mfma_f32_16x16x32_bf16 v[24:27], a[68:71], a[36:39], v[24:27]
    ds_read_b128 a[168:171], v1 offset:26624
    v_cvt_pk_bf16_f32 v32, v16, v17
    v_mfma_f32_16x16x32_bf16 v[24:27], a[72:75], a[40:43], v[24:27]
    v_exp_f32 v19, v19
    v_mfma_f32_16x16x32_bf16 v[24:27], a[76:79], a[44:47], v[24:27]
    ds_read_b128 a[172:175], v1 offset:27648
    v_cvt_pk_bf16_f32 v33, v18, v19
    v_mfma_f32_16x16x32_bf16 v[24:27], a[80:83], a[48:51], v[24:27]
    v_exp_f32 v20, v20
    v_mfma_f32_16x16x32_bf16 v[24:27], a[84:87], a[52:55], v[24:27]
    ds_read_b128 a[176:179], v1 offset:28672
    v_mfma_f32_16x16x32_bf16 v[24:27], a[88:91], a[56:59], v[24:27]
    v_exp_f32 v21, v21
    v_mfma_f32_16x16x32_bf16 v[24:27], a[92:95], a[60:63], v[24:27]
    ds_read_b128 a[180:183], v1 offset:29696
    v_cvt_pk_bf16_f32 v34, v20, v21
    v_mfma_f32_16x16x32_bf16 v[28:31], a[124:127], a[60:63], v[44:47]
    v_exp_f32 v22, v22
    v_mfma_f32_16x16x32_bf16 v[28:31], a[120:123], a[56:59], v[28:31]
    buffer_load_dwordx4 v15, s[40:43], s4 offen offset:3072 sc1 lds
    v_mfma_f32_16x16x32_bf16 v[28:31], a[116:119], a[52:55], v[28:31]
    v_exp_f32 v23, v23
    v_mfma_f32_16x16x32_bf16 v[28:31], a[112:115], a[48:51], v[28:31]
    ds_read_b128 a[184:187], v1 offset:30720
    v_cvt_pk_bf16_f32 v35, v22, v23
    v_mfma_f32_16x16x32_bf16 v[28:31], a[108:111], a[44:47], v[28:31]
    v_exp_f32 v24, v24
    v_mfma_f32_16x16x32_bf16 v[28:31], a[104:107], a[40:43], v[28:31]
    ds_read_b128 a[188:191], v1 offset:31744
    v_mfma_f32_16x16x32_bf16 v[28:31], a[100:103], a[36:39], v[28:31]
    v_exp_f32 v25, v25
    v_mfma_f32_16x16x32_bf16 v[28:31], a[96:99], a[32:35], v[28:31]
    s_waitcnt lgkmcnt(8)
    ds_read_b128 a[64:67], v1 offset:0
    v_cvt_pk_bf16_f32 v36, v24, v25
    v_mfma_f32_16x16x32_bf16 v[16:19], a[128:131], a[0:3], v[40:43]
    v_exp_f32 v26, v26
    v_mfma_f32_16x16x32_bf16 v[16:19], a[132:135], a[4:7], v[16:19]
    ds_read_b128 a[68:71], v14 offset:0
    v_mfma_f32_16x16x32_bf16 v[16:19], a[136:139], a[8:11], v[16:19]
    s_add_u32 s67, s4, 4096
    v_exp_f32 v27, v27
    s_add_u32 m0, s10, 4096
    v_mfma_f32_16x16x32_bf16 v[16:19], a[140:143], a[12:15], v[16:19]
    buffer_load_dwordx4 v15, s[40:43], s67 offen offset:0 sc1 lds
    v_mfma_f32_16x16x32_bf16 v[16:19], a[144:147], a[16:19], v[16:19]
    v_exp_f32 v28, v28
    v_mfma_f32_16x16x32_bf16 v[16:19], a[148:151], a[20:23], v[16:19]
    ds_read_b128 a[72:75], v1 offset:1024
    v_cvt_pk_bf16_f32 v37, v26, v27
    v_mfma_f32_16x16x32_bf16 v[16:19], a[152:155], a[24:27], v[16:19]
    v_exp_f32 v29, v29
    v_mfma_f32_16x16x32_bf16 v[16:19], a[156:159], a[28:31], v[16:19]
    s_waitcnt lgkmcnt(3)
    ds_read_b128 a[76:79], v14 offset:1024
    v_cvt_pk_bf16_f32 v38, v28, v29
    v_mfma_f32_16x16x32_bf16 v[20:23], a[188:191], a[28:31], v[40:43]
    v_exp_f32 v30, v30
    v_mfma_f32_16x16x32_bf16 v[20:23], a[184:187], a[24:27], v[20:23]
    ds_read_b128 a[80:83], v1 offset:2048
    v_mfma_f32_16x16x32_bf16 v[20:23], a[180:183], a[20:23], v[20:23]
    v_exp_f32 v31, v31
    v_mfma_f32_16x16x32_bf16 v[20:23], a[176:179], a[16:19], v[20:23]
    ds_read_b128 a[84:87], v14 offset:2048
    v_cvt_pk_bf16_f32 v39, v30, v31
    v_mfma_f32_16x16x32_bf16 v[20:23], a[172:175], a[12:15], v[20:23]
    v_exp_f32 v16, v16
    v_mfma_f32_16x16x32_bf16 v[20:23], a[168:171], a[8:11], v[20:23]
    buffer_load_dwordx4 v15, s[40:43], s67 offen offset:1024 sc1 lds
    v_mfma_f32_16x16x32_bf16 v[20:23], a[164:167], a[4:7], v[20:23]
    v_exp_f32 v17, v17
    v_mfma_f32_16x16x32_bf16 v[20:23], a[160:163], a[0:3], v[20:23]
    ds_read_b128 a[88:91], v1 offset:3072
    v_cvt_pk_bf16_f32 v56, v16, v17
    v_mfma_f32_16x16x32_bf16 v[24:27], a[128:131], a[32:35], v[44:47]
    v_exp_f32 v18, v18
    v_mfma_f32_16x16x32_bf16 v[24:27], a[132:135], a[36:39], v[24:27]
    ds_read_b128 a[92:95], v14 offset:3072
    v_mfma_f32_16x16x32_bf16 v[24:27], a[136:139], a[40:43], v[24:27]
    v_exp_f32 v19, v19
    v_mfma_f32_16x16x32_bf16 v[24:27], a[140:143], a[44:47], v[24:27]
    ds_read_b128 a[96:99], v1 offset:4096
    v_cvt_pk_bf16_f32 v57, v18, v19
    v_mfma_f32_16x16x32_bf16 v[24:27], a[144:147], a[48:51], v[24:27]
    v_exp_f32 v20, v20
    v_mfma_f32_16x16x32_bf16 v[24:27], a[148:151], a[52:55], v[24:27]
    ds_read_b128 a[100:103], v14 offset:4096
    v_mfma_f32_16x16x32_bf16 v[24:27], a[152:155], a[56:59], v[24:27]
    v_exp_f32 v21, v21
    v_mfma_f32_16x16x32_bf16 v[24:27], a[156:159], a[60:63], v[24:27]
    buffer_load_dwordx4 v15, s[40:43], s67 offen offset:2048 sc1 lds
    v_mfma_f32_16x16x32_bf16 v[28:31], a[188:191], a[60:63], v[44:47]
    v_exp_f32 v22, v22
    v_mfma_f32_16x16x32_bf16 v[28:31], a[184:187], a[56:59], v[28:31]
    ds_read_b128 a[104:107], v1 offset:5120
    v_cvt_pk_bf16_f32 v58, v20, v21
    v_mfma_f32_16x16x32_bf16 v[28:31], a[180:183], a[52:55], v[28:31]
    v_exp_f32 v23, v23
    v_mfma_f32_16x16x32_bf16 v[28:31], a[176:179], a[48:51], v[28:31]
    ds_read_b128 a[108:111], v14 offset:5120
    v_cvt_pk_bf16_f32 v59, v22, v23
    v_mfma_f32_16x16x32_bf16 v[28:31], a[172:175], a[44:47], v[28:31]
    v_exp_f32 v24, v24
    v_mfma_f32_16x16x32_bf16 v[28:31], a[168:171], a[40:43], v[28:31]
    ds_read_b128 a[112:115], v1 offset:6144
    v_mfma_f32_16x16x32_bf16 v[28:31], a[164:167], a[36:39], v[28:31]
    v_exp_f32 v25, v25
    v_mfma_f32_16x16x32_bf16 v[28:31], a[160:163], a[32:35], v[28:31]
    s_waitcnt lgkmcnt(5)
    ds_read_b128 a[116:119], v14 offset:6144
    v_cvt_pk_bf16_f32 v60, v24, v25
    v_mfma_f32_16x16x32_bf16 v[128:131], a[64:67], v[32:35], v[128:131]
    v_exp_f32 v26, v26
    v_mfma_f32_16x16x32_bf16 v[128:131], a[68:71], v[56:59], v[128:131]
    buffer_load_dwordx4 v15, s[40:43], s67 offen offset:3072 sc1 lds
    v_mfma_f32_16x16x32_bf16 v[132:135], a[76:79], v[56:59], v[132:135]
    v_exp_f32 v27, v27
    v_mfma_f32_16x16x32_bf16 v[132:135], a[72:75], v[32:35], v[132:135]
    ds_read_b128 a[120:123], v1 offset:7168
    v_cvt_pk_bf16_f32 v61, v26, v27
    v_mfma_f32_16x16x32_bf16 v[136:139], a[80:83], v[32:35], v[136:139]
    v_exp_f32 v28, v28
    v_mfma_f32_16x16x32_bf16 v[136:139], a[84:87], v[56:59], v[136:139]
    ds_read_b128 a[124:127], v14 offset:7168
    v_mfma_f32_16x16x32_bf16 v[140:143], a[92:95], v[56:59], v[140:143]
    v_exp_f32 v29, v29
    v_mfma_f32_16x16x32_bf16 v[140:143], a[88:91], v[32:35], v[140:143]
    s_waitcnt lgkmcnt(4)
    ds_read_b128 a[128:131], v1 offset:8192
    v_cvt_pk_bf16_f32 v62, v28, v29
    v_mfma_f32_16x16x32_bf16 v[144:147], a[96:99], v[32:35], v[144:147]
    v_exp_f32 v30, v30
    v_mfma_f32_16x16x32_bf16 v[144:147], a[100:103], v[56:59], v[144:147]
    ds_read_b128 a[132:135], v14 offset:8192
    v_mfma_f32_16x16x32_bf16 v[148:151], a[108:111], v[56:59], v[148:151]
    v_exp_f32 v31, v31
    v_mfma_f32_16x16x32_bf16 v[148:151], a[104:107], v[32:35], v[148:151]
    s_waitcnt lgkmcnt(2)
    ds_read_b128 a[136:139], v1 offset:9216
    v_cvt_pk_bf16_f32 v63, v30, v31
    v_mfma_f32_16x16x32_bf16 v[152:155], a[112:115], v[32:35], v[152:155]
    ds_read_b128 a[140:143], v14 offset:9216
    v_mfma_f32_16x16x32_bf16 v[152:155], a[116:119], v[56:59], v[152:155]
    s_add_u32 s4, s4, s49
    ds_read_b128 a[144:147], v1 offset:10240
    v_mfma_f32_16x16x32_bf16 v[156:159], a[124:127], v[56:59], v[156:159]
    s_sub_u32 s5, s5, 1
    ds_read_b128 a[148:151], v14 offset:10240
    v_mfma_f32_16x16x32_bf16 v[156:159], a[120:123], v[32:35], v[156:159]
    s_cmp_eq_u32 s5, 0
    ds_read_b128 a[152:155], v1 offset:11264
    v_mfma_f32_16x16x32_bf16 v[48:51], v[8:11], v[32:35], v[48:51]
    s_cbranch_scc1 F_sw9
F_sw9r:
    ds_read_b128 a[156:159], v14 offset:11264
    v_mfma_f32_16x16x32_bf16 v[48:51], v[8:11], v[56:59], v[48:51]
    s_add_u32 s10, s9, s20
    ds_read_b128 a[160:163], v1 offset:12288
    v_mfma_f32_16x16x32_bf16 v[192:195], a[64:67], v[36:39], v[192:195]
    s_add_u32 s9, s9, 32768
    ds_read_b128 a[164:167], v14 offset:12288
    v_mfma_f32_16x16x32_bf16 v[192:195], a[68:71], v[60:63], v[192:195]
    s_and_b32 s9, s9, 0x1ffff
    ds_read_b128 a[168:171], v1 offset:13312
    v_mfma_f32_16x16x32_bf16 v[196:199], a[76:79], v[60:63], v[196:199]
    s_add_u32 s48, s48, 1
    ds_read_b128 a[172:175], v14 offset:13312
    v_mfma_f32_16x16x32_bf16 v[196:199], a[72:75], v[36:39], v[196:199]
    ds_read_b128 a[176:179], v1 offset:14336
    v_mfma_f32_16x16x32_bf16 v[200:203], a[80:83], v[36:39], v[200:203]
    s_add_u32 s67, s45, s52
    ds_read_b128 a[180:183], v14 offset:14336
    v_mfma_f32_16x16x32_bf16 v[200:203], a[84:87], v[60:63], v[200:203]
    s_add_u32 s66, s20, s52
    ds_read_b128 a[184:187], v1 offset:15360
    v_mfma_f32_16x16x32_bf16 v[204:207], a[92:95], v[60:63], v[204:207]
    s_add_u32 m0, s66, 81920
    ds_read_b128 a[188:191], v14 offset:15360
    v_mfma_f32_16x16x32_bf16 v[204:207], a[88:91], v[36:39], v[204:207]
    buffer_load_dwordx4 v15, s[40:43], s67 offen sc1 lds
    v_mfma_f32_16x16x32_bf16 v[208:211], a[96:99], v[36:39], v[208:211]
    s_add_u32 s52, s52, 1024
    v_mfma_f32_16x16x32_bf16 v[208:211], a[100:103], v[60:63], v[208:211]
    s_min_u32 s52, s52, 56320
    v_mfma_f32_16x16x32_bf16 v[212:215], a[108:111], v[60:63], v[212:215]
    s_waitcnt lgkmcnt(0)
    v_mfma_f32_16x16x32_bf16 v[212:215], a[104:107], v[36:39], v[212:215]
    s_barrier
    v_mfma_f32_16x16x32_bf16 v[216:219], a[112:115], v[36:39], v[216:219]
    s_mov_b32 m0, s10
    ds_read_b128 a[64:67], v14 offset:16384
    v_mfma_f32_16x16x32_bf16 v[216:219], a[116:119], v[60:63], v[216:219]
    buffer_load_dwordx4 v15, s[40:43], s4 offen offset:0 sc1 lds
    v_mfma_f32_16x16x32_bf16 v[220:223], a[124:127], v[60:63], v[220:223]
    ds_read_b128 a[68:71], v14 offset:17408
    v_mfma_f32_16x16x32_bf16 v[220:223], a[120:123], v[36:39], v[220:223]
    ds_read_b128 a[72:75], v14 offset:18432
    v_mfma_f32_16x16x32_bf16 v[52:55], v[8:11], v[36:39], v[52:55]
    buffer_load_dwordx4 v15, s[40:43], s4 offen offset:1024 sc1 lds
    v_mfma_f32_16x16x32_bf16 v[52:55], v[8:11], v[60:63], v[52:55]
    ds_read_b128 a[76:79], v14 offset:19456
    v_mfma_f32_16x16x32_bf16 v[160:163], a[128:131], v[32:35], v[160:163]
    ds_read_b128 a[80:83], v14 offset:20480
    v_mfma_f32_16x16x32_bf16 v[160:163], a[132:135], v[56:59], v[160:163]
    buffer_load_dwordx4 v15, s[40:43], s4 offen offset:2048 sc1 lds
    v_mfma_f32_16x16x32_bf16 v[224:227], a[132:135], v[60:63], v[224:227]
    ds_read_b128 a[84:87], v14 offset:21504
    v_mfma_f32_16x16x32_bf16 v[224:227], a[128:131], v[36:39], v[224:227]
    ds_read_b128 a[88:91], v14 offset:22528
    v_mfma_f32_16x16x32_bf16 v[228:231], a[136:139], v[36:39], v[228:231]
    buffer_load_dwordx4 v15, s[40:43], s4 offen offset:3072 sc1 lds
    v_mfma_f32_16x16x32_bf16 v[228:231], a[140:143], v[60:63], v[228:231]
    ds_read_b128 a[92:95], v14 offset:23552
    v_mfma_f32_16x16x32_bf16 v[164:167], a[140:143], v[56:59], v[164:167]
    s_add_u32 s67, s4, 4096
    ds_read_b128 a[96:99], v14 offset:24576
    s_add_u32 m0, s10, 4096
    v_mfma_f32_16x16x32_bf16 v[164:167], a[136:139], v[32:35], v[164:167]
    buffer_load_dwordx4 v15, s[40:43], s67 offen offset:0 sc1 lds
    v_mfma_f32_16x16x32_bf16 v[168:171], a[144:147], v[32:35], v[168:171]
    ds_read_b128 a[100:103], v14 offset:25600
    v_mfma_f32_16x16x32_bf16 v[168:171], a[148:151], v[56:59], v[168:171]
    ds_read_b128 a[104:107], v14 offset:26624
    v_mfma_f32_16x16x32_bf16 v[232:235], a[148:151], v[60:63], v[232:235]
    buffer_load_dwordx4 v15, s[40:43], s67 offen offset:1024 sc1 lds
    v_mfma_f32_16x16x32_bf16 v[232:235], a[144:147], v[36:39], v[232:235]
    ds_read_b128 a[108:111], v14 offset:27648
    v_mfma_f32_16x16x32_bf16 v[236:239], a[152:155], v[36:39], v[236:239]
    ds_read_b128 a[112:115], v14 offset:28672
    v_mfma_f32_16x16x32_bf16 v[236:239], a[156:159], v[60:63], v[236:239]
    buffer_load_dwordx4 v15, s[40:43], s67 offen offset:2048 sc1 lds
    v_mfma_f32_16x16x32_bf16 v[172:175], a[156:159], v[56:59], v[172:175]
    ds_read_b128 a[116:119], v14 offset:29696
    v_mfma_f32_16x16x32_bf16 v[172:175], a[152:155], v[32:35], v[172:175]
    ds_read_b128 a[120:123], v14 offset:30720
    v_mfma_f32_16x16x32_bf16 v[176:179], a[160:163], v[32:35], v[176:179]
    buffer_load_dwordx4 v15, s[40:43], s67 offen offset:3072 sc1 lds
    v_mfma_f32_16x16x32_bf16 v[176:179], a[164:167], v[56:59], v[176:179]
    s_add_u32 s4, s4, s49
    ds_read_b128 a[124:127], v14 offset:31744
    v_mfma_f32_16x16x32_bf16 v[240:243], a[164:167], v[60:63], v[240:243]
    s_sub_u32 s5, s5, 1
    v_mfma_f32_16x16x32_bf16 v[240:243], a[160:163], v[36:39], v[240:243]
    s_cmp_eq_u32 s5, 0
    v_mfma_f32_16x16x32_bf16 v[244:247], a[168:171], v[36:39], v[244:247]
    s_cbranch_scc1 F_sw10
F_sw10r:
    v_mfma_f32_16x16x32_bf16 v[244:247], a[172:175], v[60:63], v[244:247]
    s_add_u32 s10, s9, s20
    s_add_u32 s9, s9, 32768
    s_and_b32 s9, s9, 0x1ffff
    v_mfma_f32_16x16x32_bf16 v[180:183], a[172:175], v[56:59], v[180:183]
    s_add_u32 s48, s48, 1
    v_mfma_f32_16x16x32_bf16 v[180:183], a[168:171], v[32:35], v[180:183]
    v_mfma_f32_16x16x32_bf16 v[184:187], a[176:179], v[32:35], v[184:187]
    s_waitcnt vmcnt(8) lgkmcnt(0)
    v_mfma_f32_16x16x32_bf16 v[184:187], a[180:183], v[56:59], v[184:187]
    s_barrier
    v_mfma_f32_16x16x32_bf16 v[248:251], a[180:183], v[60:63], v[248:251]
    s_add_u32 s66, s9, 32768
    s_and_b32 s66, s66, 0x1ffff
    v_add_u32 v14, s66, v15
    v_mfma_f32_16x16x32_bf16 v[248:251], a[176:179], v[36:39], v[248:251]
    v_add_u32 v1, s9, v15
    v_mfma_f32_16x16x32_bf16 v[252:255], a[184:187], v[36:39], v[252:255]
    s_sub_u32 s64, s64, 2
    v_mfma_f32_16x16x32_bf16 v[252:255], a[188:191], v[60:63], v[252:255]
    s_cmp_gt_u32 s64, s53
    v_mfma_f32_16x16x32_bf16 v[188:191], a[188:191], v[56:59], v[188:191]
    v_mfma_f32_16x16x32_bf16 v[188:191], a[184:187], v[32:35], v[188:191]
    s_cbranch_scc1 F_loop
F_loop1:
    s_cmp_gt_u32 s64, s51
    s_cbranch_scc0 F_loopend
F_loop2:
    s_waitcnt vmcnt(16) lgkmcnt(0)
    v_add_u32 v1, s9, v15
    s_barrier
    v_mfma_f32_16x16x32_bf16 v[16:19], a[64:67], a[0:3], v[40:43]
    s_cmp_ge_u32 s48, s13
    s_cbranch_scc1 F_hookin0
F_hookret0:
    v_mfma_f32_16x16x32_bf16 v[16:19], a[68:71], a[4:7], v[16:19]
    ds_read_b128 a[128:131], v1 offset:0
    v_mfma_f32_16x16x32_bf16 v[16:19], a[72:75], a[8:11], v[16:19]
    ds_read_b128 a[132:135], v1 offset:1024
    v_mfma_f32_16x16x32_bf16 v[16:19], a[76:79], a[12:15], v[16:19]
    ds_read_b128 a[136:139], v1 offset:2048
    v_mfma_f32_16x16x32_bf16 v[16:19], a[80:83], a[16:19], v[16:19]
    s_mov_b32 m0, s10
    ds_read_b128 a[140:143], v1 offset:3072
    v_mfma_f32_16x16x32_bf16 v[16:19], a[84:87], a[20:23], v[16:19]
    buffer_load_dwordx4 v15, s[40:43], s4 offen offset:0 sc1 lds
    v_mfma_f32_16x16x32_bf16 v[16:19], a[88:91], a[24:27], v[16:19]
    ds_read_b128 a[144:147], v1 offset:4096
    v_mfma_f32_16x16x32_bf16 v[16:19], a[92:95], a[28:31], v[16:19]
    ds_read_b128 a[148:151], v1 offset:5120
    v_mfma_f32_16x16x32_bf16 v[20:23], a[124:127], a[28:31], v[40:43]
    ds_read_b128 a[152:155], v1 offset:6144
    v_mfma_f32_16x16x32_bf16 v[20:23], a[120:123], a[24:27], v[20:23]
    ds_read_b128 a[156:159], v1 offset:7168
    v_mfma_f32_16x16x32_bf16 v[20:23], a[116:119], a[20:23], v[20:23]
    ds_read_b128 a[160:163], v1 offset:8192
    v_mfma_f32_16x16x32_bf16 v[20:23], a[112:115], a[16:19], v[20:23]
    ds_read_b128 a[164:167], v1 offset:9216
    v_mfma_f32_16x16x32_bf16 v[20:23], a[108:111], a[12:15], v[20:23]
    ds_read_b128 a[168:171], v1 offset:10240
    v_mfma_f32_16x16x32_bf16 v[20:23], a[104:107], a[8:11], v[20:23]
    buffer_load_dwordx4 v15, s[40:43], s4 offen offset:1024 sc1 lds
    v_mfma_f32_16x16x32_bf16 v[20:23], a[100:103], a[4:7], v[20:23]
    ds_read_b128 a[172:175], v1 offset:11264
    v_mfma_f32_16x16x32_bf16 v[20:23], a[96:99], a[0:3], v[20:23]
    ds_read_b128 a[176:179], v1 offset:12288
    v_mfma_f32_16x16x32_bf16 v[24:27], a[64:67], a[32:35], v[44:47]
    ds_read_b128 a[180:183], v1 offset:13312
    v_mfma_f32_16x16x32_bf16 v[24:27], a[68:71], a[36:39], v[24:27]
    ds_read_b128 a[184:187], v1 offset:14336
    ds_read_b128 a[188:191], v1 offset:15360
    v_mfma_f32_16x16x32_bf16 v[24:27], a[72:75], a[40:43], v[24:27]
    v_exp_f32 v16, v16
    v_mfma_f32_16x16x32_bf16 v[24:27], a[76:79], a[44:47], v[24:27]
    v_exp_f32 v17, v17
    v_mfma_f32_16x16x32_bf16 v[24:27], a[80:83], a[48:51], v[24:27]
    v_exp_f32 v18, v18
    v_mfma_f32_16x16x32_bf16 v[24:27], a[84:87], a[52:55], v[24:27]
    buffer_load_dwordx4 v15, s[40:43], s4 offen offset:2048 sc1 lds
    v_mfma_f32_16x16x32_bf16 v[24:27], a[88:91], a[56:59], v[24:27]
    v_exp_f32 v19, v19
    v_mfma_f32_16x16x32_bf16 v[24:27], a[92:95], a[60:63], v[24:27]
    v_exp_f32 v20, v20
    v_mfma_f32_16x16x32_bf16 v[28:31], a[124:127], a[60:63], v[44:47]
    v_exp_f32 v21, v21
    v_mfma_f32_16x16x32_bf16 v[28:31], a[120:123], a[56:59], v[28:31]
    v_exp_f32 v22, v22
    v_mfma_f32_16x16x32_bf16 v[28:31], a[116:119], a[52:55], v[28:31]
    v_exp_f32 v23, v23
    v_mfma_f32_16x16x32_bf16 v[28:31], a[112:115], a[48:51], v[28:31]
    v_cvt_pk_bf16_f32 v32, v16, v17
    v_cvt_pk_bf16_f32 v33, v18, v19
    v_mfma_f32_16x16x32_bf16 v[28:31], a[108:111], a[44:47], v[28:31]
    v_cvt_pk_bf16_f32 v34, v20, v21
    v_cvt_pk_bf16_f32 v35, v22, v23
    v_mfma_f32_16x16x32_bf16 v[28:31], a[104:107], a[40:43], v[28:31]
    buffer_load_dwordx4 v15, s[40:43], s4 offen offset:3072 sc1 lds
    v_mfma_f32_16x16x32_bf16 v[28:31], a[100:103], a[36:39], v[28:31]
    s_waitcnt lgkmcnt(0)
    v_mfma_f32_16x16x32_bf16 v[28:31], a[96:99], a[32:35], v[28:31]
    v_mfma_f32_16x16x32_bf16 v[128:131], a[128:131], v[32:35], v[128:131]
    ds_read_b128 a[64:67], v1 offset:16384
    v_mfma_f32_16x16x32_bf16 v[132:135], a[132:135], v[32:35], v[132:135]
    ds_read_b128 a[68:71], v1 offset:17408
    v_mfma_f32_16x16x32_bf16 v[136:139], a[136:139], v[32:35], v[136:139]
    ds_read_b128 a[72:75], v1 offset:18432
    v_mfma_f32_16x16x32_bf16 v[140:143], a[140:143], v[32:35], v[140:143]
    v_exp_f32 v24, v24
    v_mfma_f32_16x16x32_bf16 v[144:147], a[144:147], v[32:35], v[144:147]
    s_add_u32 s67, s4, 4096
    v_exp_f32 v25, v25
    s_add_u32 m0, s10, 4096
    v_mfma_f32_16x16x32_bf16 v[148:151], a[148:151], v[32:35], v[148:151]
    buffer_load_dwordx4 v15, s[40:43], s67 offen offset:0 sc1 lds
    v_mfma_f32_16x16x32_bf16 v[152:155], a[152:155], v[32:35], v[152:155]
    v_exp_f32 v26, v26
    v_mfma_f32_16x16x32_bf16 v[156:159], a[156:159], v[32:35], v[156:159]
    v_exp_f32 v27, v27
    v_mfma_f32_16x16x32_bf16 v[160:163], a[160:163], v[32:35], v[160:163]
    v_exp_f32 v28, v28
    v_mfma_f32_16x16x32_bf16 v[164:167], a[164:167], v[32:35], v[164:167]
    v_exp_f32 v29, v29
    v_mfma_f32_16x16x32_bf16 v[168:171], a[168:171], v[32:35], v[168:171]
    v_exp_f32 v30, v30
    v_mfma_f32_16x16x32_bf16 v[172:175], a[172:175], v[32:35], v[172:175]
    v_exp_f32 v31, v31
    v_mfma_f32_16x16x32_bf16 v[176:179], a[176:179], v[32:35], v[176:179]
    v_cvt_pk_bf16_f32 v36, v24, v25
    v_cvt_pk_bf16_f32 v37, v26, v27
    v_mfma_f32_16x16x32_bf16 v[180:183], a[180:183], v[32:35], v[180:183]
    buffer_load_dwordx4 v15, s[40:43], s67 offen offset:1024 sc1 lds
    v_mfma_f32_16x16x32_bf16 v[184:187], a[184:187], v[32:35], v[184:187]
    ds_read_b128 a[76:79], v1 offset:19456
    v_cvt_pk_bf16_f32 v38, v28, v29
    v_mfma_f32_16x16x32_bf16 v[188:191], a[188:191], v[32:35], v[188:191]
    ds_read_b128 a[80:83], v1 offset:20480
    v_cvt_pk_bf16_f32 v39, v30, v31
    v_mfma_f32_16x16x32_bf16 v[48:51], v[8:11], v[32:35], v[48:51]
    ds_read_b128 a[84:87], v1 offset:21504
    v_mfma_f32_16x16x32_bf16 v[192:195], a[128:131], v[36:39], v[192:195]
    ds_read_b128 a[88:91], v1 offset:22528
    v_mfma_f32_16x16x32_bf16 v[196:199], a[132:135], v[36:39], v[196:199]
    ds_read_b128 a[92:95], v1 offset:23552
    v_mfma_f32_16x16x32_bf16 v[200:203], a[136:139], v[36:39], v[200:203]
    ds_read_b128 a[96:99], v1 offset:24576
    v_mfma_f32_16x16x32_bf16 v[204:207], a[140:143], v[36:39], v[204:207]
    ds_read_b128 a[100:103], v1 offset:25600
    v_mfma_f32_16x16x32_bf16 v[208:211], a[144:147], v[36:39], v[208:211]
    buffer_load_dwordx4 v15, s[40:43], s67 offen offset:2048 sc1 lds
    v_mfma_f32_16x16x32_bf16 v[212:215], a[148:151], v[36:39], v[212:215]
    ds_read_b128 a[104:107], v1 offset:26624
    v_mfma_f32_16x16x32_bf16 v[216:219], a[152:155], v[36:39], v[216:219]
    ds_read_b128 a[108:111], v1 offset:27648
    v_mfma_f32_16x16x32_bf16 v[220:223], a[156:159], v[36:39], v[220:223]
    ds_read_b128 a[112:115], v1 offset:28672
    v_mfma_f32_16x16x32_bf16 v[224:227], a[160:163], v[36:39], v[224:227]
    ds_read_b128 a[116:119], v1 offset:29696
    v_mfma_f32_16x16x32_bf16 v[228:231], a[164:167], v[36:39], v[228:231]
    ds_read_b128 a[120:123], v1 offset:30720
    v_mfma_f32_16x16x32_bf16 v[232:235], a[168:171], v[36:39], v[232:235]
    ds_read_b128 a[124:127], v1 offset:31744
    v_mfma_f32_16x16x32_bf16 v[236:239], a[172:175], v[36:39], v[236:239]
    v_mfma_f32_16x16x32_bf16 v[240:243], a[176:179], v[36:39], v[240:243]
    buffer_load_dwordx4 v15, s[40:43], s67 offen offset:3072 sc1 lds
    s_add_u32 s4, s4, s49
    s_sub_u32 s5, s5, 1
    v_mfma_f32_16x16x32_bf16 v[244:247], a[180:183], v[36:39], v[244:247]
    s_cmp_eq_u32 s5, 0
    s_cbranch_scc1 F_sw11
F_sw11r:
    s_add_u32 s10, s9, s20
    v_mfma_f32_16x16x32_bf16 v[248:251], a[184:187], v[36:39], v[248:251]
    s_add_u32 s9, s9, 32768
    s_and_b32 s9, s9, 0x1ffff
    s_add_u32 s48, s48, 1
    v_mfma_f32_16x16x32_bf16 v[252:255], a[188:191], v[36:39], v[252:255]
    s_sub_u32 s64, s64, 1
    s_cmp_gt_u32 s64, s51
    v_mfma_f32_16x16x32_bf16 v[52:55], v[8:11], v[36:39], v[52:55]
    s_cbranch_scc1 F_loop2
F_loopx:
F_loopend:
    s_cmp_eq_u32 s11, 1
    s_cbranch_scc1 F_last
    s_waitcnt vmcnt(8)
    s_waitcnt vmcnt(16) lgkmcnt(0)
    v_add_u32 v1, s9, v15
    s_barrier
    v_mfma_f32_16x16x32_bf16 v[16:19], a[64:67], a[0:3], v[40:43]
    v_cmp_gt_u32 vcc, 1, v5
    s_nop 0
    s_cmp_lg_u64 vcc, 0
    s_cbranch_scc1 F_spin12
F_spin12r:
    v_mfma_f32_16x16x32_bf16 v[16:19], a[68:71], a[4:7], v[16:19]
    s_lshl_b32 s66, s21, 10
    ds_read_b128 a[128:131], v1 offset:0
    s_add_u32 s66, s66, 81788928
    v_mfma_f32_16x16x32_bf16 v[16:19], a[72:75], a[8:11], v[16:19]
    ds_read_b128 a[132:135], v1 offset:1024
    ds_read_b128 a[136:139], v1 offset:2048
    v_mfma_f32_16x16x32_bf16 v[16:19], a[76:79], a[12:15], v[16:19]
    buffer_load_dword v12, v2, s[40:43], s66 offen offset:0 sc1
    v_mfma_f32_16x16x32_bf16 v[16:19], a[80:83], a[16:19], v[16:19]
    s_mov_b32 m0, s10
    ds_read_b128 a[140:143], v1 offset:3072
    ds_read_b128 a[144:147], v1 offset:4096
    v_mfma_f32_16x16x32_bf16 v[16:19], a[84:87], a[20:23], v[16:19]
    buffer_load_dwordx4 v15, s[40:43], s4 offen offset:0 sc1 lds
    v_mfma_f32_16x16x32_bf16 v[16:19], a[88:91], a[24:27], v[16:19]
    ds_read_b128 a[148:151], v1 offset:5120
    v_mfma_f32_16x16x32_bf16 v[16:19], a[92:95], a[28:31], v[16:19]
    buffer_load_dword v13, v2, s[40:43], s66 offen offset:256 sc1
    v_mfma_f32_16x16x32_bf16 v[20:23], a[124:127], a[28:31], v[40:43]
    ds_read_b128 a[152:155], v1 offset:6144
    ds_read_b128 a[156:159], v1 offset:7168
    v_mfma_f32_16x16x32_bf16 v[20:23], a[120:123], a[24:27], v[20:23]
    s_lshl_b32 s79, s21, 14
    ds_read_b128 a[160:163], v1 offset:8192
    s_add_u32 s66, s79, 67108864
    v_mfma_f32_16x16x32_bf16 v[20:23], a[116:119], a[20:23], v[20:23]
    ds_read_b128 a[164:167], v1 offset:9216
    v_mfma_f32_16x16x32_bf16 v[20:23], a[112:115], a[16:19], v[20:23]
    buffer_load_dwordx4 v[64:67], v15, s[40:43], s66 offen offset:0 sc1
    v_mfma_f32_16x16x32_bf16 v[20:23], a[108:111], a[12:15], v[20:23]
    ds_read_b128 a[168:171], v1 offset:10240
    ds_read_b128 a[172:175], v1 offset:11264
    v_mfma_f32_16x16x32_bf16 v[20:23], a[104:107], a[8:11], v[20:23]
    buffer_load_dwordx4 v15, s[40:43], s4 offen offset:1024 sc1 lds
    v_mfma_f32_16x16x32_bf16 v[20:23], a[100:103], a[4:7], v[20:23]
    ds_read_b128 a[176:179], v1 offset:12288
    v_mfma_f32_16x16x32_bf16 v[20:23], a[96:99], a[0:3], v[20:23]
    buffer_load_dwordx4 v[68:71], v15, s[40:43], s66 offen offset:1024 sc1
    v_mfma_f32_16x16x32_bf16 v[24:27], a[64:67], a[32:35], v[44:47]
    ds_read_b128 a[180:183], v1 offset:13312
    ds_read_b128 a[184:187], v1 offset:14336
    v_mfma_f32_16x16x32_bf16 v[24:27], a[68:71], a[36:39], v[24:27]
    ds_read_b128 a[188:191], v1 offset:15360
    v_mfma_f32_16x16x32_bf16 v[24:27], a[72:75], a[40:43], v[24:27]
    v_exp_f32 v16, v16
    v_mfma_f32_16x16x32_bf16 v[24:27], a[76:79], a[44:47], v[24:27]
    v_exp_f32 v17, v17
    v_mfma_f32_16x16x32_bf16 v[24:27], a[80:83], a[48:51], v[24:27]
    v_exp_f32 v18, v18
    v_mfma_f32_16x16x32_bf16 v[24:27], a[84:87], a[52:55], v[24:27]
    buffer_load_dwordx4 v15, s[40:43], s4 offen offset:2048 sc1 lds
    v_mfma_f32_16x16x32_bf16 v[24:27], a[88:91], a[56:59], v[24:27]
    v_exp_f32 v19, v19
    v_mfma_f32_16x16x32_bf16 v[24:27], a[92:95], a[60:63], v[24:27]
    v_exp_f32 v20, v20
    v_mfma_f32_16x16x32_bf16 v[28:31], a[124:127], a[60:63], v[44:47]
    v_exp_f32 v21, v21
    v_mfma_f32_16x16x32_bf16 v[28:31], a[120:123], a[56:59], v[28:31]
    v_exp_f32 v22, v22
    v_mfma_f32_16x16x32_bf16 v[28:31], a[116:119], a[52:55], v[28:31]
    v_exp_f32 v23, v23
    v_mfma_f32_16x16x32_bf16 v[28:31], a[112:115], a[48:51], v[28:31]
    v_cvt_pk_bf16_f32 v32, v16, v17
    v_cvt_pk_bf16_f32 v33, v18, v19
    v_mfma_f32_16x16x32_bf16 v[28:31], a[108:111], a[44:47], v[28:31]
    v_cvt_pk_bf16_f32 v34, v20, v21
    v_cvt_pk_bf16_f32 v35, v22, v23
    v_mfma_f32_16x16x32_bf16 v[28:31], a[104:107], a[40:43], v[28:31]
    buffer_load_dwordx4 v15, s[40:43], s4 offen offset:3072 sc1 lds
    v_mfma_f32_16x16x32_bf16 v[28:31], a[100:103], a[36:39], v[28:31]
    s_waitcnt lgkmcnt(0)
    v_mfma_f32_16x16x32_bf16 v[28:31], a[96:99], a[32:35], v[28:31]
    buffer_load_dwordx4 v[72:75], v15, s[40:43], s66 offen offset:2048 sc1
    v_mfma_f32_16x16x32_bf16 v[128:131], a[128:131], v[32:35], v[128:131]
    ds_read_b128 a[64:67], v1 offset:16384
    v_mfma_f32_16x16x32_bf16 v[132:135], a[132:135], v[32:35], v[132:135]
    ds_read_b128 a[68:71], v1 offset:17408
    v_mfma_f32_16x16x32_bf16 v[136:139], a[136:139], v[32:35], v[136:139]
    ds_read_b128 a[72:75], v1 offset:18432
    v_mfma_f32_16x16x32_bf16 v[140:143], a[140:143], v[32:35], v[140:143]
    v_exp_f32 v24, v24
    v_mfma_f32_16x16x32_bf16 v[144:147], a[144:147], v[32:35], v[144:147]
    s_add_u32 s67, s4, 4096
    v_exp_f32 v25, v25
    s_add_u32 m0, s10, 4096
    v_mfma_f32_16x16x32_bf16 v[148:151], a[148:151], v[32:35], v[148:151]
    buffer_load_dwordx4 v15, s[40:43], s67 offen offset:0 sc1 lds
    v_mfma_f32_16x16x32_bf16 v[152:155], a[152:155], v[32:35], v[152:155]
    v_exp_f32 v26, v26
    v_mfma_f32_16x16x32_bf16 v[156:159], a[156:159], v[32:35], v[156:159]
    v_exp_f32 v27, v27
    v_mfma_f32_16x16x32_bf16 v[160:163], a[160:163], v[32:35], v[160:163]
    v_exp_f32 v28, v28
    v_mfma_f32_16x16x32_bf16 v[164:167], a[164:167], v[32:35], v[164:167]
    v_exp_f32 v29, v29
    v_mfma_f32_16x16x32_bf16 v[168:171], a[168:171], v[32:35], v[168:171]
    v_exp_f32 v30, v30
    v_mfma_f32_16x16x32_bf16 v[172:175], a[172:175], v[32:35], v[172:175]
    v_exp_f32 v31, v31
    v_mfma_f32_16x16x32_bf16 v[176:179], a[176:179], v[32:35], v[176:179]
    v_cvt_pk_bf16_f32 v36, v24, v25
    v_cvt_pk_bf16_f32 v37, v26, v27
    v_mfma_f32_16x16x32_bf16 v[180:183], a[180:183], v[32:35], v[180:183]
    buffer_load_dwordx4 v15, s[40:43], s67 offen offset:1024 sc1 lds
    v_mfma_f32_16x16x32_bf16 v[184:187], a[184:187], v[32:35], v[184:187]
    ds_read_b128 a[76:79], v1 offset:19456
    v_cvt_pk_bf16_f32 v38, v28, v29
    v_cvt_pk_bf16_f32 v39, v30, v31
    v_mfma_f32_16x16x32_bf16 v[188:191], a[188:191], v[32:35], v[188:191]
    ds_read_b128 a[80:83], v1 offset:20480
    v_mfma_f32_16x16x32_bf16 v[48:51], v[8:11], v[32:35], v[48:51]
    ds_read_b128 a[84:87], v1 offset:21504
    v_mfma_f32_16x16x32_bf16 v[192:195], a[128:131], v[36:39], v[192:195]
    buffer_load_dwordx4 v[76:79], v15, s[40:43], s66 offen offset:3072 sc1
    v_mfma_f32_16x16x32_bf16 v[196:199], a[132:135], v[36:39], v[196:199]
    ds_read_b128 a[88:91], v1 offset:22528
    ds_read_b128 a[92:95], v1 offset:23552
    v_mfma_f32_16x16x32_bf16 v[200:203], a[136:139], v[36:39], v[200:203]
    ds_read_b128 a[96:99], v1 offset:24576
    v_mfma_f32_16x16x32_bf16 v[204:207], a[140:143], v[36:39], v[204:207]
    ds_read_b128 a[100:103], v1 offset:25600
    ds_read_b128 a[104:107], v1 offset:26624
    v_mfma_f32_16x16x32_bf16 v[208:211], a[144:147], v[36:39], v[208:211]
    buffer_load_dwordx4 v15, s[40:43], s67 offen offset:2048 sc1 lds
    s_add_u32 s66, s79, 67112960
    v_mfma_f32_16x16x32_bf16 v[212:215], a[148:151], v[36:39], v[212:215]
    ds_read_b128 a[108:111], v1 offset:27648
    v_mfma_f32_16x16x32_bf16 v[216:219], a[152:155], v[36:39], v[216:219]
    buffer_load_dwordx4 v[80:83], v15, s[40:43], s66 offen offset:0 sc1
    v_mfma_f32_16x16x32_bf16 v[220:223], a[156:159], v[36:39], v[220:223]
    ds_read_b128 a[112:115], v1 offset:28672
    ds_read_b128 a[116:119], v1 offset:29696
    v_mfma_f32_16x16x32_bf16 v[224:227], a[160:163], v[36:39], v[224:227]
    ds_read_b128 a[120:123], v1 offset:30720
    v_mfma_f32_16x16x32_bf16 v[228:231], a[164:167], v[36:39], v[228:231]
    ds_read_b128 a[124:127], v1 offset:31744
    v_mfma_f32_16x16x32_bf16 v[232:235], a[168:171], v[36:39], v[232:235]
    buffer_load_dwordx4 v[84:87], v15, s[40:43], s66 offen offset:1024 sc1
    v_mfma_f32_16x16x32_bf16 v[236:239], a[172:175], v[36:39], v[236:239]
    v_mfma_f32_16x16x32_bf16 v[240:243], a[176:179], v[36:39], v[240:243]
    buffer_load_dwordx4 v15, s[40:43], s67 offen offset:3072 sc1 lds
    v_mfma_f32_16x16x32_bf16 v[244:247], a[180:183], v[36:39], v[244:247]
    s_add_u32 s4, s4, s49
    v_mfma_f32_16x16x32_bf16 v[248:251], a[184:187], v[36:39], v[248:251]
    s_add_u32 s10, s9, s20
    buffer_load_dwordx4 v[88:91], v15, s[40:43], s66 offen offset:2048 sc1
    s_add_u32 s9, s9, 32768
    v_mfma_f32_16x16x32_bf16 v[252:255], a[188:191], v[36:39], v[252:255]
    s_and_b32 s9, s9, 0x1ffff
    s_add_u32 s48, s48, 1
    v_mfma_f32_16x16x32_bf16 v[52:55], v[8:11], v[36:39], v[52:55]
    buffer_load_dwordx4 v[92:95], v15, s[40:43], s66 offen offset:3072 sc1
    s_waitcnt vmcnt(16) lgkmcnt(0)
    v_add_u32 v1, s9, v15
    s_barrier
    v_mfma_f32_16x16x32_bf16 v[16:19], a[64:67], a[0:3], v[40:43]
    v_mfma_f32_16x16x32_bf16 v[16:19], a[68:71], a[4:7], v[16:19]
    s_add_u32 s66, s79, 67117056
    ds_read_b128 a[128:131], v1 offset:0
    ds_read_b128 a[132:135], v1 offset:1024
    v_mfma_f32_16x16x32_bf16 v[16:19], a[72:75], a[8:11], v[16:19]
    ds_read_b128 a[136:139], v1 offset:2048
    v_mfma_f32_16x16x32_bf16 v[16:19], a[76:79], a[12:15], v[16:19]
    buffer_load_dwordx4 v[96:99], v15, s[40:43], s66 offen offset:0 sc1
    v_mfma_f32_16x16x32_bf16 v[16:19], a[80:83], a[16:19], v[16:19]
    s_mov_b32 m0, s10
    ds_read_b128 a[140:143], v1 offset:3072
    ds_read_b128 a[144:147], v1 offset:4096
    v_mfma_f32_16x16x32_bf16 v[16:19], a[84:87], a[20:23], v[16:19]
    buffer_load_dwordx4 v15, s[40:43], s4 offen offset:0 sc1 lds
    v_mfma_f32_16x16x32_bf16 v[16:19], a[88:91], a[24:27], v[16:19]
    ds_read_b128 a[148:151], v1 offset:5120
    v_mfma_f32_16x16x32_bf16 v[16:19], a[92:95], a[28:31], v[16:19]
    buffer_load_dwordx4 v[100:103], v15, s[40:43], s66 offen offset:1024 sc1
    v_mfma_f32_16x16x32_bf16 v[20:23], a[124:127], a[28:31], v[40:43]
    ds_read_b128 a[152:155], v1 offset:6144
    ds_read_b128 a[156:159], v1 offset:7168
    v_mfma_f32_16x16x32_bf16 v[20:23], a[120:123], a[24:27], v[20:23]
    ds_read_b128 a[160:163], v1 offset:8192
    v_mfma_f32_16x16x32_bf16 v[20:23], a[116:119], a[20:23], v[20:23]
    ds_read_b128 a[164:167], v1 offset:9216
    v_mfma_f32_16x16x32_bf16 v[20:23], a[112:115], a[16:19], v[20:23]
    buffer_load_dwordx4 v[104:107], v15, s[40:43], s66 offen offset:2048 sc1
    v_mfma_f32_16x16x32_bf16 v[20:23], a[108:111], a[12:15], v[20:23]
    ds_read_b128 a[168:171], v1 offset:10240
    ds_read_b128 a[172:175], v1 offset:11264
    v_mfma_f32_16x16x32_bf16 v[20:23], a[104:107], a[8:11], v[20:23]
    buffer_load_dwordx4 v15, s[40:43], s4 offen offset:1024 sc1 lds
    v_mfma_f32_16x16x32_bf16 v[20:23], a[100:103], a[4:7], v[20:23]
    ds_read_b128 a[176:179], v1 offset:12288
    v_mfma_f32_16x16x32_bf16 v[20:23], a[96:99], a[0:3], v[20:23]
    buffer_load_dwordx4 v[108:111], v15, s[40:43], s66 offen offset:3072 sc1
    v_mfma_f32_16x16x32_bf16 v[24:27], a[64:67], a[32:35], v[44:47]
    ds_read_b128 a[180:183], v1 offset:13312
    ds_read_b128 a[184:187], v1 offset:14336
    v_mfma_f32_16x16x32_bf16 v[24:27], a[68:71], a[36:39], v[24:27]
    s_add_u32 s66, s79, 67121152
    ds_read_b128 a[188:191], v1 offset:15360
    v_mfma_f32_16x16x32_bf16 v[24:27], a[72:75], a[40:43], v[24:27]
    v_exp_f32 v16, v16
    v_mfma_f32_16x16x32_bf16 v[24:27], a[76:79], a[44:47], v[24:27]
    buffer_load_dwordx4 v[112:115], v15, s[40:43], s66 offen offset:0 sc1
    v_mfma_f32_16x16x32_bf16 v[24:27], a[80:83], a[48:51], v[24:27]
    v_exp_f32 v17, v17
    v_mfma_f32_16x16x32_bf16 v[24:27], a[84:87], a[52:55], v[24:27]
    v_exp_f32 v18, v18
    v_mfma_f32_16x16x32_bf16 v[24:27], a[88:91], a[56:59], v[24:27]
    v_exp_f32 v19, v19
    v_mfma_f32_16x16x32_bf16 v[24:27], a[92:95], a[60:63], v[24:27]
    buffer_load_dwordx4 v[116:119], v15, s[40:43], s66 offen offset:1024 sc1
    v_mfma_f32_16x16x32_bf16 v[28:31], a[124:127], a[60:63], v[44:47]
    v_exp_f32 v20, v20
    v_mfma_f32_16x16x32_bf16 v[28:31], a[120:123], a[56:59], v[28:31]
    v_exp_f32 v21, v21
    v_mfma_f32_16x16x32_bf16 v[28:31], a[116:119], a[52:55], v[28:31]
    v_exp_f32 v22, v22
    v_mfma_f32_16x16x32_bf16 v[28:31], a[112:115], a[48:51], v[28:31]
    v_exp_f32 v23, v23
    v_mfma_f32_16x16x32_bf16 v[28:31], a[108:111], a[44:47], v[28:31]
    v_cvt_pk_bf16_f32 v32, v16, v17
    v_cvt_pk_bf16_f32 v33, v18, v19
    v_mfma_f32_16x16x32_bf16 v[28:31], a[104:107], a[40:43], v[28:31]
    v_cvt_pk_bf16_f32 v34, v20, v21
    v_cvt_pk_bf16_f32 v35, v22, v23
    v_mfma_f32_16x16x32_bf16 v[28:31], a[100:103], a[36:39], v[28:31]
    s_waitcnt lgkmcnt(0)
    v_mfma_f32_16x16x32_bf16 v[28:31], a[96:99], a[32:35], v[28:31]
    buffer_load_dwordx4 v[120:123], v15, s[40:43], s66 offen offset:2048 sc1
    v_mfma_f32_16x16x32_bf16 v[128:131], a[128:131], v[32:35], v[128:131]
    v_mfma_f32_16x16x32_bf16 v[132:135], a[132:135], v[32:35], v[132:135]
    buffer_load_dwordx4 v[124:127], v15, s[40:43], s66 offen offset:3072 sc1
    v_mfma_f32_16x16x32_bf16 v[136:139], a[136:139], v[32:35], v[136:139]
    buffer_load_dwordx4 v15, s[40:43], s4 offen offset:2048 sc1 lds
    v_mfma_f32_16x16x32_bf16 v[140:143], a[140:143], v[32:35], v[140:143]
    v_exp_f32 v24, v24
    v_mfma_f32_16x16x32_bf16 v[144:147], a[144:147], v[32:35], v[144:147]
    v_exp_f32 v25, v25
    v_mfma_f32_16x16x32_bf16 v[148:151], a[148:151], v[32:35], v[148:151]
    v_exp_f32 v26, v26
    v_mfma_f32_16x16x32_bf16 v[152:155], a[152:155], v[32:35], v[152:155]
    v_exp_f32 v27, v27
    v_mfma_f32_16x16x32_bf16 v[156:159], a[156:159], v[32:35], v[156:159]
    v_exp_f32 v28, v28
    v_mfma_f32_16x16x32_bf16 v[160:163], a[160:163], v[32:35], v[160:163]
    v_exp_f32 v29, v29
    v_mfma_f32_16x16x32_bf16 v[164:167], a[164:167], v[32:35], v[164:167]
    v_exp_f32 v30, v30
    v_mfma_f32_16x16x32_bf16 v[168:171], a[168:171], v[32:35], v[168:171]
    v_exp_f32 v31, v31
    v_mfma_f32_16x16x32_bf16 v[172:175], a[172:175], v[32:35], v[172:175]
    v_cvt_pk_bf16_f32 v36, v24, v25
    v_cvt_pk_bf16_f32 v37, v26, v27
    v_mfma_f32_16x16x32_bf16 v[176:179], a[176:179], v[32:35], v[176:179]
    v_cvt_pk_bf16_f32 v38, v28, v29
    v_cvt_pk_bf16_f32 v39, v30, v31
    v_mfma_f32_16x16x32_bf16 v[180:183], a[180:183], v[32:35], v[180:183]
    v_mfma_f32_16x16x32_bf16 v[184:187], a[184:187], v[32:35], v[184:187]
    buffer_load_dwordx4 v15, s[40:43], s4 offen offset:3072 sc1 lds
    v_mfma_f32_16x16x32_bf16 v[188:191], a[188:191], v[32:35], v[188:191]
    v_mfma_f32_16x16x32_bf16 v[48:51], v[8:11], v[32:35], v[48:51]
    v_mfma_f32_16x16x32_bf16 v[192:195], a[128:131], v[36:39], v[192:195]
    s_add_u32 s67, s4, 4096
    s_add_u32 m0, s10, 4096
    v_mfma_f32_16x16x32_bf16 v[196:199], a[132:135], v[36:39], v[196:199]
    buffer_load_dwordx4 v15, s[40:43], s67 offen offset:0 sc1 lds
    v_mfma_f32_16x16x32_bf16 v[200:203], a[136:139], v[36:39], v[200:203]
    v_mfma_f32_16x16x32_bf16 v[204:207], a[140:143], v[36:39], v[204:207]
    v_mfma_f32_16x16x32_bf16 v[208:211], a[144:147], v[36:39], v[208:211]
    v_mfma_f32_16x16x32_bf16 v[212:215], a[148:151], v[36:39], v[212:215]
    buffer_load_dwordx4 v15, s[40:43], s67 offen offset:1024 sc1 lds
    v_mfma_f32_16x16x32_bf16 v[216:219], a[152:155], v[36:39], v[216:219]
    v_mfma_f32_16x16x32_bf16 v[220:223], a[156:159], v[36:39], v[220:223]
    v_mfma_f32_16x16x32_bf16 v[224:227], a[160:163], v[36:39], v[224:227]
    v_mfma_f32_16x16x32_bf16 v[228:231], a[164:167], v[36:39], v[228:231]
    buffer_load_dwordx4 v15, s[40:43], s67 offen offset:2048 sc1 lds
    v_mfma_f32_16x16x32_bf16 v[232:235], a[168:171], v[36:39], v[232:235]
    v_mfma_f32_16x16x32_bf16 v[236:239], a[172:175], v[36:39], v[236:239]
    v_mfma_f32_16x16x32_bf16 v[240:243], a[176:179], v[36:39], v[240:243]
    v_mfma_f32_16x16x32_bf16 v[244:247], a[180:183], v[36:39], v[244:247]
    buffer_load_dwordx4 v15, s[40:43], s67 offen offset:3072 sc1 lds
    s_add_u32 s4, s4, s49
    v_mfma_f32_16x16x32_bf16 v[248:251], a[184:187], v[36:39], v[248:251]
    s_add_u32 s10, s9, s20
    s_add_u32 s9, s9, 32768
    s_and_b32 s9, s9, 0x1ffff
    v_mfma_f32_16x16x32_bf16 v[252:255], a[188:191], v[36:39], v[252:255]
    s_add_u32 s48, s48, 1
    v_mfma_f32_16x16x32_bf16 v[52:55], v[8:11], v[36:39], v[52:55]
F_done:
    v_max3_f32 v56, abs(v128), abs(v129), abs(v130)
    v_max3_f32 v56, v56, abs(v131), abs(v132)
    v_max3_f32 v56, v56, abs(v133), abs(v134)
    v_max3_f32 v56, v56, abs(v135), abs(v136)
    v_max3_f32 v57, abs(v192), abs(v193), abs(v194)
    v_max3_f32 v57, v57, abs(v195), abs(v196)
    v_max3_f32 v57, v57, abs(v197), abs(v198)
    v_max3_f32 v57, v57, abs(v199), abs(v200)
    v_min_f32 v56, v56, v57
    v_max_f32 v57, v48, v52
    v_cmp_gt_f32 vcc, 0x01000000, v56
    v_cmp_ngt_f32 s[72:73], s96, v57
    s_nop 0
    s_or_b64 vcc, vcc, s[72:73]
    s_cbranch_scc1 F_slow
F_checked:
    s_cmp_eq_u32 s16, 0
    s_cbranch_scc1 F_epi
    s_waitcnt vmcnt(16) lgkmcnt(0)
    v_add_u32 v1, s9, v15
    s_barrier
    s_mov_b32 m0, s10
    s_nop 0
    buffer_load_dwordx4 v15, s[40:43], s4 offen offset:0 sc1 lds
    buffer_load_dwordx4 v15, s[40:43], s4 offen offset:1024 sc1 lds
    buffer_load_dwordx4 v15, s[40:43], s4 offen offset:2048 sc1 lds
    buffer_load_dwordx4 v15, s[40:43], s4 offen offset:3072 sc1 lds
    s_add_u32 s67, s4, 4096
    s_add_u32 m0, s10, 4096
    s_nop 0
    buffer_load_dwordx4 v15, s[40:43], s67 offen offset:0 sc1 lds
    buffer_load_dwordx4 v15, s[40:43], s67 offen offset:1024 sc1 lds
    buffer_load_dwordx4 v15, s[40:43], s67 offen offset:2048 sc1 lds
    buffer_load_dwordx4 v15, s[40:43], s67 offen offset:3072 sc1 lds
    s_add_u32 s4, s4, s49
    s_sub_u32 s5, s5, 1
    s_cmp_eq_u32 s5, 0
    s_cbranch_scc1 F_sw13
F_sw13r:
    s_add_u32 s10, s9, s20
    s_add_u32 s9, s9, 32768
    s_and_b32 s9, s9, 0x1ffff
    s_add_u32 s48, s48, 1
    s_sub_u32 s16, s16, 1
    s_cmp_lg_u32 s16, 0
    s_cbranch_scc1 F_epi
    ds_read_b128 a[64:67], v1 offset:16384
    ds_read_b128 a[68:71], v1 offset:17408
    ds_read_b128 a[72:75], v1 offset:18432
    ds_read_b128 a[76:79], v1 offset:19456
    ds_read_b128 a[80:83], v1 offset:20480
    ds_read_b128 a[84:87], v1 offset:21504
    ds_read_b128 a[88:91], v1 offset:22528
    ds_read_b128 a[92:95], v1 offset:23552
    ds_read_b128 a[96:99], v1 offset:24576
    ds_read_b128 a[100:103], v1 offset:25600
    ds_read_b128 a[104:107], v1 offset:26624
    ds_read_b128 a[108:111], v1 offset:27648
    ds_read_b128 a[112:115], v1 offset:28672
    ds_read_b128 a[116:119], v1 offset:29696
    ds_read_b128 a[120:123], v1 offset:30720
    ds_read_b128 a[124:127], v1 offset:31744
F_epi:
    v_rcp_f32 v56, v48
    v_rcp_f32 v58, v52
    v_log_f32 v60, v48
    v_log_f32 v62, v52
    s_cmp_eq_u32 s12, 2
    s_cbranch_scc1 F_merge
    v_mov_b32 v57, v56
    v_mov_b32 v59, v58
    v_sub_f32 v60, v60, v40
    v_sub_f32 v62, v62, v44
    s_lshl_b32 s79, s18, 20
    s_lshl_b32 s66, s29, 18
    s_add_u32 s79, s79, s66
    s_lshl_b32 s66, s26, 13
    s_add_u32 s79, s79, s66
    s_add_u32 s79, s79, 50331648
    s_lshl_b32 s66, s21, 10
    s_add_u32 s66, s66, 81788928
    s_lshl_b32 s67, s21, 14
    s_add_u32 s67, s67, 67108864
    s_cmp_eq_u32 s12, 1
    s_cselect_b32 s66, s66, s8
    s_cselect_b32 s79, s67, s79
    s_mov_b32 s65, 131072
    s_cselect_b32 s65, 8192, s65
    s_add_u32 s74, s65, 4096
    buffer_store_dword v60, v2, s[40:43], s66 offen offset:0 sc1
    buffer_store_dword v62, v2, s[40:43], s66 offen offset:256 sc1
    v_pk_mul_f32 v[128:129], v[128:129], v[56:57]
    v_pk_mul_f32 v[130:131], v[130:131], v[56:57]
    v_pk_mul_f32 v[132:133], v[132:133], v[56:57]
    v_pk_mul_f32 v[134:135], v[134:135], v[56:57]
    v_cvt_pk_bf16_f32 v128, v128, v129
    v_cvt_pk_bf16_f32 v129, v130, v131
    v_cvt_pk_bf16_f32 v130, v132, v133
    v_cvt_pk_bf16_f32 v131, v134, v135
    s_add_u32 s67, s79, 0
    buffer_store_dwordx4 v[128:131], v15, s[40:43], s67 offen offset:0 sc1
    v_pk_mul_f32 v[136:137], v[136:137], v[56:57]
    v_pk_mul_f32 v[138:139], v[138:139], v[56:57]
    v_pk_mul_f32 v[140:141], v[140:141], v[56:57]
    v_pk_mul_f32 v[142:143], v[142:143], v[56:57]
    v_cvt_pk_bf16_f32 v136, v136, v137
    v_cvt_pk_bf16_f32 v137, v138, v139
    v_cvt_pk_bf16_f32 v138, v140, v141
    v_cvt_pk_bf16_f32 v139, v142, v143
    buffer_store_dwordx4 v[136:139], v15, s[40:43], s67 offen offset:1024 sc1
    v_pk_mul_f32 v[144:145], v[144:145], v[56:57]
    v_pk_mul_f32 v[146:147], v[146:147], v[56:57]
    v_pk_mul_f32 v[148:149], v[148:149], v[56:57]
    v_pk_mul_f32 v[150:151], v[150:151], v[56:57]
    v_cvt_pk_bf16_f32 v144, v144, v145
    v_cvt_pk_bf16_f32 v145, v146, v147
    v_cvt_pk_bf16_f32 v146, v148, v149
    v_cvt_pk_bf16_f32 v147, v150, v151
    buffer_store_dwordx4 v[144:147], v15, s[40:43], s67 offen offset:2048 sc1
    v_pk_mul_f32 v[152:153], v[152:153], v[56:57]
    v_pk_mul_f32 v[154:155], v[154:155], v[56:57]
    v_pk_mul_f32 v[156:157], v[156:157], v[56:57]
    v_pk_mul_f32 v[158:159], v[158:159], v[56:57]
    v_cvt_pk_bf16_f32 v152, v152, v153
    v_cvt_pk_bf16_f32 v153, v154, v155
    v_cvt_pk_bf16_f32 v154, v156, v157
    v_cvt_pk_bf16_f32 v155, v158, v159
    buffer_store_dwordx4 v[152:155], v15, s[40:43], s67 offen offset:3072 sc1
    v_pk_mul_f32 v[160:161], v[160:161], v[56:57]
    v_pk_mul_f32 v[162:163], v[162:163], v[56:57]
    v_pk_mul_f32 v[164:165], v[164:165], v[56:57]
    v_pk_mul_f32 v[166:167], v[166:167], v[56:57]
    v_cvt_pk_bf16_f32 v160, v160, v161
    v_cvt_pk_bf16_f32 v161, v162, v163
    v_cvt_pk_bf16_f32 v162, v164, v165
    v_cvt_pk_bf16_f32 v163, v166, v167
    s_add_u32 s67, s79, 4096
    buffer_store_dwordx4 v[160:163], v15, s[40:43], s67 offen offset:0 sc1
    v_pk_mul_f32 v[168:169], v[168:169], v[56:57]
    v_pk_mul_f32 v[170:171], v[170:171], v[56:57]
    v_pk_mul_f32 v[172:173], v[172:173], v[56:57]
    v_pk_mul_f32 v[174:175], v[174:175], v[56:57]
    v_cvt_pk_bf16_f32 v168, v168, v169
    v_cvt_pk_bf16_f32 v169, v170, v171
    v_cvt_pk_bf16_f32 v170, v172, v173
    v_cvt_pk_bf16_f32 v171, v174, v175
    buffer_store_dwordx4 v[168:171], v15, s[40:43], s67 offen offset:1024 sc1
    v_pk_mul_f32 v[176:177], v[176:177], v[56:57]
    v_pk_mul_f32 v[178:179], v[178:179], v[56:57]
    v_pk_mul_f32 v[180:181], v[180:181], v[56:57]
    v_pk_mul_f32 v[182:183], v[182:183], v[56:57]
    v_cvt_pk_bf16_f32 v176, v176, v177
    v_cvt_pk_bf16_f32 v177, v178, v179
    v_cvt_pk_bf16_f32 v178, v180, v181
    v_cvt_pk_bf16_f32 v179, v182, v183
    buffer_store_dwordx4 v[176:179], v15, s[40:43], s67 offen offset:2048 sc1
    v_pk_mul_f32 v[184:185], v[184:185], v[56:57]
    v_pk_mul_f32 v[186:187], v[186:187], v[56:57]
    v_pk_mul_f32 v[188:189], v[188:189], v[56:57]
    v_pk_mul_f32 v[190:191], v[190:191], v[56:57]
    v_cvt_pk_bf16_f32 v184, v184, v185
    v_cvt_pk_bf16_f32 v185, v186, v187
    v_cvt_pk_bf16_f32 v186, v188, v189
    v_cvt_pk_bf16_f32 v187, v190, v191
    buffer_store_dwordx4 v[184:187], v15, s[40:43], s67 offen offset:3072 sc1
    v_pk_mul_f32 v[192:193], v[192:193], v[58:59]
    v_pk_mul_f32 v[194:195], v[194:195], v[58:59]
    v_pk_mul_f32 v[196:197], v[196:197], v[58:59]
    v_pk_mul_f32 v[198:199], v[198:199], v[58:59]
    v_cvt_pk_bf16_f32 v192, v192, v193
    v_cvt_pk_bf16_f32 v193, v194, v195
    v_cvt_pk_bf16_f32 v194, v196, v197
    v_cvt_pk_bf16_f32 v195, v198, v199
    s_add_u32 s67, s79, s65
    buffer_store_dwordx4 v[192:195], v15, s[40:43], s67 offen offset:0 sc1
    v_pk_mul_f32 v[200:201], v[200:201], v[58:59]
    v_pk_mul_f32 v[202:203], v[202:203], v[58:59]
    v_pk_mul_f32 v[204:205], v[204:205], v[58:59]
    v_pk_mul_f32 v[206:207], v[206:207], v[58:59]
    v_cvt_pk_bf16_f32 v200, v200, v201
    v_cvt_pk_bf16_f32 v201, v202, v203
    v_cvt_pk_bf16_f32 v202, v204, v205
    v_cvt_pk_bf16_f32 v203, v206, v207
    buffer_store_dwordx4 v[200:203], v15, s[40:43], s67 offen offset:1024 sc1
    v_pk_mul_f32 v[208:209], v[208:209], v[58:59]
    v_pk_mul_f32 v[210:211], v[210:211], v[58:59]
    v_pk_mul_f32 v[212:213], v[212:213], v[58:59]
    v_pk_mul_f32 v[214:215], v[214:215], v[58:59]
    v_cvt_pk_bf16_f32 v208, v208, v209
    v_cvt_pk_bf16_f32 v209, v210, v211
    v_cvt_pk_bf16_f32 v210, v212, v213
    v_cvt_pk_bf16_f32 v211, v214, v215
    buffer_store_dwordx4 v[208:211], v15, s[40:43], s67 offen offset:2048 sc1
    v_pk_mul_f32 v[216:217], v[216:217], v[58:59]
    v_pk_mul_f32 v[218:219], v[218:219], v[58:59]
    v_pk_mul_f32 v[220:221], v[220:221], v[58:59]
    v_pk_mul_f32 v[222:223], v[222:223], v[58:59]
    v_cvt_pk_bf16_f32 v216, v216, v217
    v_cvt_pk_bf16_f32 v217, v218, v219
    v_cvt_pk_bf16_f32 v218, v220, v221
    v_cvt_pk_bf16_f32 v219, v222, v223
    buffer_store_dwordx4 v[216:219], v15, s[40:43], s67 offen offset:3072 sc1
    v_pk_mul_f32 v[224:225], v[224:225], v[58:59]
    v_pk_mul_f32 v[226:227], v[226:227], v[58:59]
    v_pk_mul_f32 v[228:229], v[228:229], v[58:59]
    v_pk_mul_f32 v[230:231], v[230:231], v[58:59]
    v_cvt_pk_bf16_f32 v224, v224, v225
    v_cvt_pk_bf16_f32 v225, v226, v227
    v_cvt_pk_bf16_f32 v226, v228, v229
    v_cvt_pk_bf16_f32 v227, v230, v231
    s_add_u32 s67, s79, s74
    buffer_store_dwordx4 v[224:227], v15, s[40:43], s67 offen offset:0 sc1
    v_pk_mul_f32 v[232:233], v[232:233], v[58:59]
    v_pk_mul_f32 v[234:235], v[234:235], v[58:59]
    v_pk_mul_f32 v[236:237], v[236:237], v[58:59]
    v_pk_mul_f32 v[238:239], v[238:239], v[58:59]
    v_cvt_pk_bf16_f32 v232, v232, v233
    v_cvt_pk_bf16_f32 v233, v234, v235
    v_cvt_pk_bf16_f32 v234, v236, v237
    v_cvt_pk_bf16_f32 v235, v238, v239
    buffer_store_dwordx4 v[232:235], v15, s[40:43], s67 offen offset:1024 sc1
    v_pk_mul_f32 v[240:241], v[240:241], v[58:59]
    v_pk_mul_f32 v[242:243], v[242:243], v[58:59]
    v_pk_mul_f32 v[244:245], v[244:245], v[58:59]
    v_pk_mul_f32 v[246:247], v[246:247], v[58:59]
    v_cvt_pk_bf16_f32 v240, v240, v241
    v_cvt_pk_bf16_f32 v241, v242, v243
    v_cvt_pk_bf16_f32 v242, v244, v245
    v_cvt_pk_bf16_f32 v243, v246, v247
    buffer_store_dwordx4 v[240:243], v15, s[40:43], s67 offen offset:2048 sc1
    v_pk_mul_f32 v[248:249], v[248:249], v[58:59]
    v_pk_mul_f32 v[250:251], v[250:251], v[58:59]
    v_pk_mul_f32 v[252:253], v[252:253], v[58:59]
    v_pk_mul_f32 v[254:255], v[254:255], v[58:59]
    v_cvt_pk_bf16_f32 v248, v248, v249
    v_cvt_pk_bf16_f32 v249, v250, v251
    v_cvt_pk_bf16_f32 v250, v252, v253
    v_cvt_pk_bf16_f32 v251, v254, v255
    buffer_store_dwordx4 v[248:251], v15, s[40:43], s67 offen offset:3072 sc1
F_post:
    s_cmp_eq_u32 s16, 0
    s_cbranch_scc1 F_post2
    s_waitcnt vmcnt(16) lgkmcnt(0)
    v_add_u32 v1, s9, v15
    s_barrier
    s_mov_b32 m0, s10
    s_nop 0
    buffer_load_dwordx4 v15, s[40:43], s4 offen offset:0 sc1 lds
    buffer_load_dwordx4 v15, s[40:43], s4 offen offset:1024 sc1 lds
    buffer_load_dwordx4 v15, s[40:43], s4 offen offset:2048 sc1 lds
    buffer_load_dwordx4 v15, s[40:43], s4 offen offset:3072 sc1 lds
    s_add_u32 s67, s4, 4096
    s_add_u32 m0, s10, 4096
    s_nop 0
    buffer_load_dwordx4 v15, s[40:43], s67 offen offset:0 sc1 lds
    buffer_load_dwordx4 v15, s[40:43], s67 offen offset:1024 sc1 lds
    buffer_load_dwordx4 v15, s[40:43], s67 offen offset:2048 sc1 lds
    buffer_load_dwordx4 v15, s[40:43], s67 offen offset:3072 sc1 lds
    s_add_u32 s4, s4, s49
    s_sub_u32 s5, s5, 1
    s_cmp_eq_u32 s5, 0
    s_cbranch_scc1 F_sw14
F_sw14r:
    s_add_u32 s10, s9, s20
    s_add_u32 s9, s9, 32768
    s_and_b32 s9, s9, 0x1ffff
    s_add_u32 s48, s48, 1
    s_sub_u32 s16, s16, 1
    s_cmp_lg_u32 s16, 0
    s_cbranch_scc1 F_post1
    ds_read_b128 a[64:67], v1 offset:16384
    ds_read_b128 a[68:71], v1 offset:17408
    ds_read_b128 a[72:75], v1 offset:18432
    ds_read_b128 a[76:79], v1 offset:19456
    ds_read_b128 a[80:83], v1 offset:20480
    ds_read_b128 a[84:87], v1 offset:21504
    ds_read_b128 a[88:91], v1 offset:22528
    ds_read_b128 a[92:95], v1 offset:23552
    ds_read_b128 a[96:99], v1 offset:24576
    ds_read_b128 a[100:103], v1 offset:25600
    ds_read_b128 a[104:107], v1 offset:26624
    ds_read_b128 a[108:111], v1 offset:27648
    ds_read_b128 a[112:115], v1 offset:28672
    ds_read_b128 a[116:119], v1 offset:29696
    ds_read_b128 a[120:123], v1 offset:30720
    ds_read_b128 a[124:127], v1 offset:31744
F_post1:
    s_branch F_post
F_post2:
    s_cmp_eq_u32 s17, 0
    s_cbranch_scc1 F_p3
    v_accvgpr_write_b32 a0, v64
    v_accvgpr_write_b32 a1, v65
    v_accvgpr_write_b32 a2, v66
    v_accvgpr_write_b32 a3, v67
    s_add_u32 s79, s45, 114688
    buffer_load_dwordx4 v[64:67], v15, s[40:43], s79 offen offset:0 sc1
    v_accvgpr_write_b32 a4, v68
    v_accvgpr_write_b32 a5, v69
    v_accvgpr_write_b32 a6, v70
    v_accvgpr_write_b32 a7, v71
    buffer_load_dwordx4 v[68:71], v15, s[40:43], s79 offen offset:1024 sc1
    v_accvgpr_write_b32 a8, v72
    v_accvgpr_write_b32 a9, v73
    v_accvgpr_write_b32 a10, v74
    v_accvgpr_write_b32 a11, v75
    buffer_load_dwordx4 v[72:75], v15, s[40:43], s79 offen offset:2048 sc1
    v_accvgpr_write_b32 a12, v76
    v_accvgpr_write_b32 a13, v77
    v_accvgpr_write_b32 a14, v78
    v_accvgpr_write_b32 a15, v79
    buffer_load_dwordx4 v[76:79], v15, s[40:43], s79 offen offset:3072 sc1
    v_accvgpr_write_b32 a16, v80
    v_accvgpr_write_b32 a17, v81
    v_accvgpr_write_b32 a18, v82
    v_accvgpr_write_b32 a19, v83
    s_add_u32 s79, s45, 118784
    buffer_load_dwordx4 v[80:83], v15, s[40:43], s79 offen offset:0 sc1
    v_accvgpr_write_b32 a20, v84
    v_accvgpr_write_b32 a21, v85
    v_accvgpr_write_b32 a22, v86
    v_accvgpr_write_b32 a23, v87
    buffer_load_dwordx4 v[84:87], v15, s[40:43], s79 offen offset:1024 sc1
    v_accvgpr_write_b32 a24, v88
    v_accvgpr_write_b32 a25, v89
    v_accvgpr_write_b32 a26, v90
    v_accvgpr_write_b32 a27, v91
    buffer_load_dwordx4 v[88:91], v15, s[40:43], s79 offen offset:2048 sc1
    v_accvgpr_write_b32 a28, v92
    v_accvgpr_write_b32 a29, v93
    v_accvgpr_write_b32 a30, v94
    v_accvgpr_write_b32 a31, v95
    buffer_load_dwordx4 v[92:95], v15, s[40:43], s79 offen offset:3072 sc1
    v_accvgpr_write_b32 a32, v96
    v_accvgpr_write_b32 a33, v97
    v_accvgpr_write_b32 a34, v98
    v_accvgpr_write_b32 a35, v99
    s_add_u32 s79, s45, 122880
    buffer_load_dwordx4 v[96:99], v15, s[40:43], s79 offen offset:0 sc1
    v_accvgpr_write_b32 a36, v100
    v_accvgpr_write_b32 a37, v101
    v_accvgpr_write_b32 a38, v102
    v_accvgpr_write_b32 a39, v103
    buffer_load_dwordx4 v[100:103], v15, s[40:43], s79 offen offset:1024 sc1
    v_accvgpr_write_b32 a40, v104
    v_accvgpr_write_b32 a41, v105
    v_accvgpr_write_b32 a42, v106
    v_accvgpr_write_b32 a43, v107
    buffer_load_dwordx4 v[104:107], v15, s[40:43], s79 offen offset:2048 sc1
    v_accvgpr_write_b32 a44, v108
    v_accvgpr_write_b32 a45, v109
    v_accvgpr_write_b32 a46, v110
    v_accvgpr_write_b32 a47, v111
    buffer_load_dwordx4 v[108:111], v15, s[40:43], s79 offen offset:3072 sc1
    v_accvgpr_write_b32 a48, v112
    v_accvgpr_write_b32 a49, v113
    v_accvgpr_write_b32 a50, v114
    v_accvgpr_write_b32 a51, v115
    s_add_u32 s79, s45, 126976
    buffer_load_dwordx4 v[112:115], v15, s[40:43], s79 offen offset:0 sc1
    v_accvgpr_write_b32 a52, v116
    v_accvgpr_write_b32 a53, v117
    v_accvgpr_write_b32 a54, v118
    v_accvgpr_write_b32 a55, v119
    buffer_load_dwordx4 v[116:119], v15, s[40:43], s79 offen offset:1024 sc1
    v_accvgpr_write_b32 a56, v120
    v_accvgpr_write_b32 a57, v121
    v_accvgpr_write_b32 a58, v122
    v_accvgpr_write_b32 a59, v123
    buffer_load_dwordx4 v[120:123], v15, s[40:43], s79 offen offset:2048 sc1
    v_accvgpr_write_b32 a60, v124
    v_accvgpr_write_b32 a61, v125
    v_accvgpr_write_b32 a62, v126
    v_accvgpr_write_b32 a63, v127
    buffer_load_dwordx4 v[124:127], v15, s[40:43], s79 offen offset:3072 sc1
    s_mov_b32 s17, 0
    s_mov_b32 s12, 0
    s_mov_b32 s78, 0
    s_mov_b32 s18, s27
    s_lshl_b32 s97, s27, 2
    s_add_u32 s97, s97, 4
    s_add_u32 s76, s76, 65536
    s_add_u32 s66, s48, 2
    s_max_u32 s13, s13, s66
    s_branch F_seg
F_last:
    s_waitcnt vmcnt(16) lgkmcnt(0)
    v_add_u32 v1, s9, v15
    s_barrier
    v_mfma_f32_16x16x32_bf16 v[16:19], a[64:67], a[0:3], v[40:43]
    ds_read_b128 a[128:131], v1 offset:0
    ds_read_b128 a[132:135], v1 offset:1024
    v_mfma_f32_16x16x32_bf16 v[16:19], a[68:71], a[4:7], v[16:19]
    ds_read_b128 a[136:139], v1 offset:2048
    ds_read_b128 a[140:143], v1 offset:3072
    v_mfma_f32_16x16x32_bf16 v[16:19], a[72:75], a[8:11], v[16:19]
    ds_read_b128 a[144:147], v1 offset:4096
    v_mov_b32 v34, 0
    v_mfma_f32_16x16x32_bf16 v[16:19], a[76:79], a[12:15], v[16:19]
    s_mov_b32 m0, s10
    ds_read_b128 a[148:151], v1 offset:5120
    v_mov_b32 v35, 0
    v_mfma_f32_16x16x32_bf16 v[16:19], a[80:83], a[16:19], v[16:19]
    buffer_load_dwordx4 v15, s[40:43], s4 offen offset:0 sc1 lds
    v_mfma_f32_16x16x32_bf16 v[16:19], a[84:87], a[20:23], v[16:19]
    ds_read_b128 a[152:155], v1 offset:6144
    ds_read_b128 a[156:159], v1 offset:7168
    v_mfma_f32_16x16x32_bf16 v[16:19], a[88:91], a[24:27], v[16:19]
    ds_read_b128 a[160:163], v1 offset:8192
    ds_read_b128 a[164:167], v1 offset:9216
    v_mfma_f32_16x16x32_bf16 v[16:19], a[92:95], a[28:31], v[16:19]
    ds_read_b128 a[168:171], v1 offset:10240
    ds_read_b128 a[172:175], v1 offset:11264
    v_mfma_f32_16x16x32_bf16 v[24:27], a[64:67], a[32:35], v[44:47]
    ds_read_b128 a[176:179], v1 offset:12288
    ds_read_b128 a[180:183], v1 offset:13312
    v_mfma_f32_16x16x32_bf16 v[24:27], a[68:71], a[36:39], v[24:27]
    ds_read_b128 a[184:187], v1 offset:14336
    ds_read_b128 a[188:191], v1 offset:15360
    v_mfma_f32_16x16x32_bf16 v[24:27], a[72:75], a[40:43], v[24:27]
    buffer_load_dwordx4 v15, s[40:43], s4 offen offset:1024 sc1 lds
    v_mfma_f32_16x16x32_bf16 v[24:27], a[76:79], a[44:47], v[24:27]
    v_cndmask_b32 v16, v16, v4, s[88:89]
    v_cndmask_b32 v17, v17, v4, s[90:91]
    v_mfma_f32_16x16x32_bf16 v[24:27], a[80:83], a[48:51], v[24:27]
    v_cndmask_b32 v18, v18, v4, s[92:93]
    v_cndmask_b32 v19, v19, v4, s[94:95]
    v_mfma_f32_16x16x32_bf16 v[24:27], a[84:87], a[52:55], v[24:27]
    v_exp_f32 v16, v16
    v_mfma_f32_16x16x32_bf16 v[24:27], a[88:91], a[56:59], v[24:27]
    v_exp_f32 v17, v17
    v_mfma_f32_16x16x32_bf16 v[24:27], a[92:95], a[60:63], v[24:27]
    v_exp_f32 v18, v18
    v_mfma_f32_16x16x32_bf16 v[28:31], a[124:127], a[60:63], v[44:47]
    v_exp_f32 v19, v19
    v_mfma_f32_16x16x32_bf16 v[28:31], a[120:123], a[56:59], v[28:31]
    v_cvt_pk_bf16_f32 v32, v16, v17
    v_cvt_pk_bf16_f32 v33, v18, v19
    v_mfma_f32_16x16x32_bf16 v[28:31], a[116:119], a[52:55], v[28:31]
    v_mfma_f32_16x16x32_bf16 v[28:31], a[112:115], a[48:51], v[28:31]
    v_mfma_f32_16x16x32_bf16 v[28:31], a[108:111], a[44:47], v[28:31]
    buffer_load_dwordx4 v15, s[40:43], s4 offen offset:2048 sc1 lds
    v_mfma_f32_16x16x32_bf16 v[28:31], a[104:107], a[40:43], v[28:31]
    v_mfma_f32_16x16x32_bf16 v[28:31], a[100:103], a[36:39], v[28:31]
    s_waitcnt lgkmcnt(0)
    v_mfma_f32_16x16x32_bf16 v[28:31], a[96:99], a[32:35], v[28:31]
    buffer_load_dwordx4 v15, s[40:43], s4 offen offset:3072 sc1 lds
    v_mfma_f32_16x16x32_bf16 v[128:131], a[128:131], v[32:35], v[128:131]
    ds_read_b128 a[64:67], v1 offset:16384
    ds_read_b128 a[68:71], v1 offset:17408
    v_mfma_f32_16x16x32_bf16 v[132:135], a[132:135], v[32:35], v[132:135]
    ds_read_b128 a[72:75], v1 offset:18432
    ds_read_b128 a[76:79], v1 offset:19456
    v_mfma_f32_16x16x32_bf16 v[136:139], a[136:139], v[32:35], v[136:139]
    ds_read_b128 a[80:83], v1 offset:20480
    ds_read_b128 a[84:87], v1 offset:21504
    v_mfma_f32_16x16x32_bf16 v[140:143], a[140:143], v[32:35], v[140:143]
    v_exp_f32 v24, v24
    v_mfma_f32_16x16x32_bf16 v[144:147], a[144:147], v[32:35], v[144:147]
    v_exp_f32 v25, v25
    v_mfma_f32_16x16x32_bf16 v[148:151], a[148:151], v[32:35], v[148:151]
    v_exp_f32 v26, v26
    v_mfma_f32_16x16x32_bf16 v[152:155], a[152:155], v[32:35], v[152:155]
    v_exp_f32 v27, v27
    v_mfma_f32_16x16x32_bf16 v[156:159], a[156:159], v[32:35], v[156:159]
    v_cndmask_b32 v28, v28, v4, s[88:89]
    v_cndmask_b32 v29, v29, v4, s[90:91]
    v_mfma_f32_16x16x32_bf16 v[160:163], a[160:163], v[32:35], v[160:163]
    v_cndmask_b32 v30, v30, v4, s[92:93]
    v_cndmask_b32 v31, v31, v4, s[94:95]
    v_mfma_f32_16x16x32_bf16 v[164:167], a[164:167], v[32:35], v[164:167]
    v_exp_f32 v28, v28
    v_mfma_f32_16x16x32_bf16 v[168:171], a[168:171], v[32:35], v[168:171]
    v_exp_f32 v29, v29
    v_mfma_f32_16x16x32_bf16 v[172:175], a[172:175], v[32:35], v[172:175]
    v_exp_f32 v30, v30
    v_mfma_f32_16x16x32_bf16 v[176:179], a[176:179], v[32:35], v[176:179]
    v_exp_f32 v31, v31
    v_mfma_f32_16x16x32_bf16 v[180:183], a[180:183], v[32:35], v[180:183]
    v_cvt_pk_bf16_f32 v36, v24, v25
    v_cvt_pk_bf16_f32 v37, v26, v27
    v_mfma_f32_16x16x32_bf16 v[184:187], a[184:187], v[32:35], v[184:187]
    s_add_u32 s67, s4, 4096
    v_cvt_pk_bf16_f32 v38, v28, v29
    s_add_u32 m0, s10, 4096
    v_cvt_pk_bf16_f32 v39, v30, v31
    v_mfma_f32_16x16x32_bf16 v[188:191], a[188:191], v[32:35], v[188:191]
    buffer_load_dwordx4 v15, s[40:43], s67 offen offset:0 sc1 lds
    v_mfma_f32_16x16x32_bf16 v[48:51], v[8:11], v[32:35], v[48:51]
    ds_read_b128 a[88:91], v1 offset:22528
    v_mfma_f32_16x16x32_bf16 v[192:195], a[128:131], v[36:39], v[192:195]
    ds_read_b128 a[92:95], v1 offset:23552
    v_mfma_f32_16x16x32_bf16 v[196:199], a[132:135], v[36:39], v[196:199]
    ds_read_b128 a[96:99], v1 offset:24576
    v_mfma_f32_16x16x32_bf16 v[200:203], a[136:139], v[36:39], v[200:203]
    ds_read_b128 a[100:103], v1 offset:25600
    v_mfma_f32_16x16x32_bf16 v[204:207], a[140:143], v[36:39], v[204:207]
    buffer_load_dwordx4 v15, s[40:43], s67 offen offset:1024 sc1 lds
    v_mfma_f32_16x16x32_bf16 v[208:211], a[144:147], v[36:39], v[208:211]
    ds_read_b128 a[104:107], v1 offset:26624
    v_mfma_f32_16x16x32_bf16 v[212:215], a[148:151], v[36:39], v[212:215]
    ds_read_b128 a[108:111], v1 offset:27648
    v_mfma_f32_16x16x32_bf16 v[216:219], a[152:155], v[36:39], v[216:219]
    ds_read_b128 a[112:115], v1 offset:28672
    v_mfma_f32_16x16x32_bf16 v[220:223], a[156:159], v[36:39], v[220:223]
    ds_read_b128 a[116:119], v1 offset:29696
    v_mfma_f32_16x16x32_bf16 v[224:227], a[160:163], v[36:39], v[224:227]
    ds_read_b128 a[120:123], v1 offset:30720
    v_mfma_f32_16x16x32_bf16 v[228:231], a[164:167], v[36:39], v[228:231]
    ds_read_b128 a[124:127], v1 offset:31744
    v_mfma_f32_16x16x32_bf16 v[232:235], a[168:171], v[36:39], v[232:235]
    buffer_load_dwordx4 v15, s[40:43], s67 offen offset:2048 sc1 lds
    v_mfma_f32_16x16x32_bf16 v[236:239], a[172:175], v[36:39], v[236:239]
    v_mfma_f32_16x16x32_bf16 v[240:243], a[176:179], v[36:39], v[240:243]
    v_mfma_f32_16x16x32_bf16 v[244:247], a[180:183], v[36:39], v[244:247]
    buffer_load_dwordx4 v15, s[40:43], s67 offen offset:3072 sc1 lds
    s_add_u32 s4, s4, s49
    s_sub_u32 s5, s5, 1
    v_mfma_f32_16x16x32_bf16 v[248:251], a[184:187], v[36:39], v[248:251]
    s_cmp_eq_u32 s5, 0
    s_cbranch_scc1 F_sw15
F_sw15r:
    s_add_u32 s10, s9, s20
    v_mfma_f32_16x16x32_bf16 v[252:255], a[188:191], v[36:39], v[252:255]
    s_add_u32 s9, s9, 32768
    s_and_b32 s9, s9, 0x1ffff
    s_add_u32 s48, s48, 1
    v_mfma_f32_16x16x32_bf16 v[52:55], v[8:11], v[36:39], v[52:55]
    s_sub_u32 s64, s64, 1
    s_branch F_done
F_only:
    v_mfma_f32_16x16x32_bf16 v[16:19], a[64:67], a[0:3], 0
    ds_read_b128 a[128:131], v1 offset:0
    s_mov_b32 m0, s10
    v_mfma_f32_16x16x32_bf16 v[16:19], a[68:71], a[4:7], v[16:19]
    buffer_load_dwordx4 v15, s[40:43], s4 offen offset:0 sc1 lds
    v_mfma_f32_16x16x32_bf16 v[16:19], a[72:75], a[8:11], v[16:19]
    ds_read_b128 a[132:135], v1 offset:1024
    v_mfma_f32_16x16x32_bf16 v[16:19], a[76:79], a[12:15], v[16:19]
    v_mfma_f32_16x16x32_bf16 v[16:19], a[80:83], a[16:19], v[16:19]
    ds_read_b128 a[136:139], v1 offset:2048
    v_mfma_f32_16x16x32_bf16 v[16:19], a[84:87], a[20:23], v[16:19]
    buffer_load_dwordx4 v15, s[40:43], s4 offen offset:1024 sc1 lds
    v_mfma_f32_16x16x32_bf16 v[16:19], a[88:91], a[24:27], v[16:19]
    ds_read_b128 a[140:143], v1 offset:3072
    v_mfma_f32_16x16x32_bf16 v[16:19], a[92:95], a[28:31], v[16:19]
    v_mfma_f32_16x16x32_bf16 v[20:23], a[124:127], a[28:31], 0
    ds_read_b128 a[144:147], v1 offset:4096
    v_mfma_f32_16x16x32_bf16 v[20:23], a[120:123], a[24:27], v[20:23]
    buffer_load_dwordx4 v15, s[40:43], s4 offen offset:2048 sc1 lds
    v_mfma_f32_16x16x32_bf16 v[20:23], a[116:119], a[20:23], v[20:23]
    ds_read_b128 a[148:151], v1 offset:5120
    v_mfma_f32_16x16x32_bf16 v[20:23], a[112:115], a[16:19], v[20:23]
    v_mfma_f32_16x16x32_bf16 v[20:23], a[108:111], a[12:15], v[20:23]
    ds_read_b128 a[152:155], v1 offset:6144
    v_mfma_f32_16x16x32_bf16 v[20:23], a[104:107], a[8:11], v[20:23]
    buffer_load_dwordx4 v15, s[40:43], s4 offen offset:3072 sc1 lds
    v_mfma_f32_16x16x32_bf16 v[20:23], a[100:103], a[4:7], v[20:23]
    ds_read_b128 a[156:159], v1 offset:7168
    v_mfma_f32_16x16x32_bf16 v[20:23], a[96:99], a[0:3], v[20:23]
    v_mfma_f32_16x16x32_bf16 v[24:27], a[64:67], a[32:35], 0
    ds_read_b128 a[160:163], v1 offset:8192
    s_add_u32 s67, s4, 4096
    s_add_u32 m0, s10, 4096
    v_mfma_f32_16x16x32_bf16 v[24:27], a[68:71], a[36:39], v[24:27]
    buffer_load_dwordx4 v15, s[40:43], s67 offen offset:0 sc1 lds
    v_mfma_f32_16x16x32_bf16 v[24:27], a[72:75], a[40:43], v[24:27]
    ds_read_b128 a[164:167], v1 offset:9216
    v_mfma_f32_16x16x32_bf16 v[24:27], a[76:79], a[44:47], v[24:27]
    v_mfma_f32_16x16x32_bf16 v[24:27], a[80:83], a[48:51], v[24:27]
    ds_read_b128 a[168:171], v1 offset:10240
    v_mfma_f32_16x16x32_bf16 v[24:27], a[84:87], a[52:55], v[24:27]
    buffer_load_dwordx4 v15, s[40:43], s67 offen offset:1024 sc1 lds
    v_mfma_f32_16x16x32_bf16 v[24:27], a[88:91], a[56:59], v[24:27]
    ds_read_b128 a[172:175], v1 offset:11264
    v_mfma_f32_16x16x32_bf16 v[24:27], a[92:95], a[60:63], v[24:27]
    v_mfma_f32_16x16x32_bf16 v[28:31], a[124:127], a[60:63], 0
    ds_read_b128 a[176:179], v1 offset:12288
    v_mfma_f32_16x16x32_bf16 v[28:31], a[120:123], a[56:59], v[28:31]
    buffer_load_dwordx4 v15, s[40:43], s67 offen offset:2048 sc1 lds
    v_mfma_f32_16x16x32_bf16 v[28:31], a[116:119], a[52:55], v[28:31]
    ds_read_b128 a[180:183], v1 offset:13312
    v_mfma_f32_16x16x32_bf16 v[28:31], a[112:115], a[48:51], v[28:31]
    v_mfma_f32_16x16x32_bf16 v[28:31], a[108:111], a[44:47], v[28:31]
    ds_read_b128 a[184:187], v1 offset:14336
    v_mfma_f32_16x16x32_bf16 v[28:31], a[104:107], a[40:43], v[28:31]
    buffer_load_dwordx4 v15, s[40:43], s67 offen offset:3072 sc1 lds
    v_mfma_f32_16x16x32_bf16 v[28:31], a[100:103], a[36:39], v[28:31]
    ds_read_b128 a[188:191], v1 offset:15360
    v_mfma_f32_16x16x32_bf16 v[28:31], a[96:99], a[32:35], v[28:31]
    s_add_u32 s4, s4, s49
    s_sub_u32 s5, s5, 1
    s_cmp_eq_u32 s5, 0
    s_cbranch_scc1 F_sw16
F_sw16r:
    s_add_u32 s10, s9, s20
    s_add_u32 s9, s9, 32768
    s_and_b32 s9, s9, 0x1ffff
    s_add_u32 s48, s48, 1
    s_sub_u32 s64, s64, 1
    v_cndmask_b32 v16, v16, v4, s[88:89]
    v_cndmask_b32 v17, v17, v4, s[90:91]
    v_cndmask_b32 v18, v18, v4, s[92:93]
    v_cndmask_b32 v19, v19, v4, s[94:95]
    v_cndmask_b32 v28, v28, v4, s[88:89]
    v_cndmask_b32 v29, v29, v4, s[90:91]
    v_cndmask_b32 v30, v30, v4, s[92:93]
    v_cndmask_b32 v31, v31, v4, s[94:95]
    v_mov_b32 v20, v4
    v_mov_b32 v21, v4
    v_mov_b32 v22, v4
    v_mov_b32 v23, v4
    v_max3_f32 v56, v16, v17, v18
    v_max3_f32 v57, v24, v25, v26
    v_max3_f32 v56, v56, v19, v20
    v_max3_f32 v57, v57, v27, v28
    v_max3_f32 v56, v56, v21, v22
    v_max3_f32 v57, v57, v29, v30
    v_max_f32 v56, v56, v23
    v_max_f32 v57, v57, v31
    v_mov_b32 v58, v56
    v_mov_b32 v59, v57
    s_nop 1
    v_permlane32_swap_b32 v56, v58
    v_permlane32_swap_b32 v57, v59
    v_max_f32 v56, v56, v58
    v_max_f32 v57, v57, v59
    v_mov_b32 v58, v56
    v_mov_b32 v59, v57
    s_nop 1
    v_permlane16_swap_b32 v56, v58
    v_permlane16_swap_b32 v57, v59
    v_max_f32 v56, v56, v58
    v_max_f32 v57, v57, v59
    v_sub_f32 v40, 0xc2c80000, v56
    v_sub_f32 v41, 0xc2c80000, v56
    v_sub_f32 v42, 0xc2c80000, v56
    v_sub_f32 v43, 0xc2c80000, v56
    v_sub_f32 v44, 0xc2c80000, v57
    v_sub_f32 v45, 0xc2c80000, v57
    v_sub_f32 v46, 0xc2c80000, v57
    v_sub_f32 v47, 0xc2c80000, v57
    v_add_f32 v16, v16, v40
    v_add_f32 v17, v17, v40
    v_add_f32 v18, v18, v40
    v_add_f32 v19, v19, v40
    v_add_f32 v20, v20, v40
    v_add_f32 v21, v21, v40
    v_add_f32 v22, v22, v40
    v_add_f32 v23, v23, v40
    v_add_f32 v24, v24, v44
    v_add_f32 v25, v25, v44
    v_add_f32 v26, v26, v44
    v_add_f32 v27, v27, v44
    v_add_f32 v28, v28, v44
    v_add_f32 v29, v29, v44
    v_add_f32 v30, v30, v44
    v_add_f32 v31, v31, v44
    v_exp_f32 v16, v16
    v_exp_f32 v17, v17
    v_exp_f32 v18, v18
    v_exp_f32 v19, v19
    v_exp_f32 v20, v20
    v_exp_f32 v21, v21
    v_exp_f32 v22, v22
    v_exp_f32 v23, v23
    v_cvt_pk_bf16_f32 v32, v16, v17
    v_cvt_pk_bf16_f32 v33, v18, v19
    v_cvt_pk_bf16_f32 v34, v20, v21
    v_cvt_pk_bf16_f32 v35, v22, v23
    v_exp_f32 v24, v24
    v_exp_f32 v25, v25
    v_exp_f32 v26, v26
    v_exp_f32 v27, v27
    v_exp_f32 v28, v28
    v_exp_f32 v29, v29
    v_exp_f32 v30, v30
    v_exp_f32 v31, v31
    v_cvt_pk_bf16_f32 v36, v24, v25
    v_cvt_pk_bf16_f32 v37, v26, v27
    v_cvt_pk_bf16_f32 v38, v28, v29
    v_cvt_pk_bf16_f32 v39, v30, v31
    s_waitcnt lgkmcnt(0)
    v_mfma_f32_16x16x32_bf16 v[128:131], a[128:131], v[32:35], 0
    ds_read_b128 a[64:67], v1 offset:16384
    s_add_u32 s79, s44, 0
    v_mfma_f32_16x16x32_bf16 v[132:135], a[132:135], v[32:35], 0
    ds_read_b128 a[68:71], v1 offset:17408
    buffer_load_dwordx4 a[192:195], v15, s[40:43], s79 offen offset:0 sc1
    v_mfma_f32_16x16x32_bf16 v[136:139], a[136:139], v[32:35], 0
    v_mfma_f32_16x16x32_bf16 v[140:143], a[140:143], v[32:35], 0
    buffer_load_dwordx4 a[196:199], v15, s[40:43], s79 offen offset:1024 sc1
    v_mfma_f32_16x16x32_bf16 v[144:147], a[144:147], v[32:35], 0
    v_mfma_f32_16x16x32_bf16 v[148:151], a[148:151], v[32:35], 0
    buffer_load_dwordx4 a[200:203], v15, s[40:43], s79 offen offset:2048 sc1
    v_mfma_f32_16x16x32_bf16 v[152:155], a[152:155], v[32:35], 0
    v_mfma_f32_16x16x32_bf16 v[156:159], a[156:159], v[32:35], 0
    buffer_load_dwordx4 a[204:207], v15, s[40:43], s79 offen offset:3072 sc1
    s_add_u32 s79, s44, 4096
    v_mfma_f32_16x16x32_bf16 v[160:163], a[160:163], v[32:35], 0
    v_mfma_f32_16x16x32_bf16 v[164:167], a[164:167], v[32:35], 0
    buffer_load_dwordx4 a[208:211], v15, s[40:43], s79 offen offset:0 sc1
    v_mfma_f32_16x16x32_bf16 v[168:171], a[168:171], v[32:35], 0
    v_mfma_f32_16x16x32_bf16 v[172:175], a[172:175], v[32:35], 0
    buffer_load_dwordx4 a[212:215], v15, s[40:43], s79 offen offset:1024 sc1
    v_mfma_f32_16x16x32_bf16 v[176:179], a[176:179], v[32:35], 0
    ds_read_b128 a[72:75], v1 offset:18432
    v_mfma_f32_16x16x32_bf16 v[180:183], a[180:183], v[32:35], 0
    ds_read_b128 a[76:79], v1 offset:19456
    buffer_load_dwordx4 a[216:219], v15, s[40:43], s79 offen offset:2048 sc1
    v_mfma_f32_16x16x32_bf16 v[184:187], a[184:187], v[32:35], 0
    ds_read_b128 a[80:83], v1 offset:20480
    v_mfma_f32_16x16x32_bf16 v[188:191], a[188:191], v[32:35], 0
    ds_read_b128 a[84:87], v1 offset:21504
    buffer_load_dwordx4 a[220:223], v15, s[40:43], s79 offen offset:3072 sc1
    s_add_u32 s79, s44, 8192
    v_mfma_f32_16x16x32_bf16 v[48:51], v[8:11], v[32:35], 0
    ds_read_b128 a[88:91], v1 offset:22528
    v_mfma_f32_16x16x32_bf16 v[192:195], a[128:131], v[36:39], 0
    ds_read_b128 a[92:95], v1 offset:23552
    buffer_load_dwordx4 a[224:227], v15, s[40:43], s79 offen offset:0 sc1
    v_mfma_f32_16x16x32_bf16 v[196:199], a[132:135], v[36:39], 0
    ds_read_b128 a[96:99], v1 offset:24576
    v_mfma_f32_16x16x32_bf16 v[200:203], a[136:139], v[36:39], 0
    ds_read_b128 a[100:103], v1 offset:25600
    buffer_load_dwordx4 a[228:231], v15, s[40:43], s79 offen offset:1024 sc1
    v_mfma_f32_16x16x32_bf16 v[204:207], a[140:143], v[36:39], 0
    ds_read_b128 a[104:107], v1 offset:26624
    v_mfma_f32_16x16x32_bf16 v[208:211], a[144:147], v[36:39], 0
    ds_read_b128 a[108:111], v1 offset:27648
    buffer_load_dwordx4 a[232:235], v15, s[40:43], s79 offen offset:2048 sc1
    v_mfma_f32_16x16x32_bf16 v[212:215], a[148:151], v[36:39], 0
    ds_read_b128 a[112:115], v1 offset:28672
    v_mfma_f32_16x16x32_bf16 v[216:219], a[152:155], v[36:39], 0
    ds_read_b128 a[116:119], v1 offset:29696
    buffer_load_dwordx4 a[236:239], v15, s[40:43], s79 offen offset:3072 sc1
    s_add_u32 s79, s44, 12288
    v_mfma_f32_16x16x32_bf16 v[220:223], a[156:159], v[36:39], 0
    ds_read_b128 a[120:123], v1 offset:30720
    v_mfma_f32_16x16x32_bf16 v[224:227], a[160:163], v[36:39], 0
    ds_read_b128 a[124:127], v1 offset:31744
    buffer_load_dwordx4 a[240:243], v15, s[40:43], s79 offen offset:0 sc1
    v_mfma_f32_16x16x32_bf16 v[228:231], a[164:167], v[36:39], 0
    v_mfma_f32_16x16x32_bf16 v[232:235], a[168:171], v[36:39], 0
    buffer_load_dwordx4 a[244:247], v15, s[40:43], s79 offen offset:1024 sc1
    v_mfma_f32_16x16x32_bf16 v[236:239], a[172:175], v[36:39], 0
    v_mfma_f32_16x16x32_bf16 v[240:243], a[176:179], v[36:39], 0
    buffer_load_dwordx4 a[248:251], v15, s[40:43], s79 offen offset:2048 sc1
    v_mfma_f32_16x16x32_bf16 v[244:247], a[180:183], v[36:39], 0
    v_mfma_f32_16x16x32_bf16 v[248:251], a[184:187], v[36:39], 0
    buffer_load_dwordx4 a[252:255], v15, s[40:43], s79 offen offset:3072 sc1
    v_mfma_f32_16x16x32_bf16 v[252:255], a[188:191], v[36:39], 0
    v_mfma_f32_16x16x32_bf16 v[52:55], v[8:11], v[36:39], 0
    s_waitcnt vmcnt(24)
    buffer_store_dword v4, v3, s[40:43], s76 offen sc1
    buffer_load_dword v5, v6, s[40:43], s75 offen sc1
    s_branch F_done
F_hookret:
    s_cmp_eq_u32 s3, 0
    s_cbranch_scc1 F_hookret0
    s_branch F_hookret1
F_hookin1:
    s_mov_b32 s3, 1
    s_branch F_hook
F_hookin0:
    s_mov_b32 s3, 0
F_hook:
    s_cmp_eq_u32 s98, 1
    s_cbranch_scc1 F_hook1
    s_cmp_eq_u32 s98, 6
    s_cbranch_scc1 F_hook6
    s_cmp_eq_u32 s98, 7
    s_cbranch_scc1 F_hook7
    s_cmp_eq_u32 s98, 8
    s_cbranch_scc1 F_hook8
    s_cmp_eq_u32 s98, 9
    s_cbranch_scc1 F_hook9
    s_cmp_eq_u32 s98, 2
    s_cbranch_scc1 F_hook2
    s_cmp_eq_u32 s98, 3
    s_cbranch_scc1 F_hook3
    s_cmp_eq_u32 s98, 4
    s_cbranch_scc1 F_hook4
    s_cmp_eq_u32 s98, 5
    s_cbranch_scc1 F_hook5
    v_lshlrev_b32 v6, 3, v15
    v_and_b32 v6, 2047, v6
    buffer_load_dword v5, v6, s[40:43], s75 offen sc1
    s_add_u32 s13, s48, 1
    s_add_u32 s98, s98, 1
    s_branch F_hookret
F_hook1:
    s_waitcnt vmcnt(8)
    v_cmp_gt_u32 vcc, 2, v5
    s_nop 0
    s_cmp_lg_u64 vcc, 0
    s_cbranch_scc1 F_spin17
F_spin17r:
    s_lshr_b32 s66, s27, 1
    s_cmp_eq_u32 s66, 0
    s_cselect_b32 s98, 2, 6
    s_cselect_b32 s13, 8, 19
    s_cmp_eq_u32 s28, 1
    s_cselect_b32 s13, s13, -1
    s_branch F_hookret
F_hook2:
    s_lshl_b32 s44, s26, 5
    s_add_u32 s44, s44, s29
    s_lshl_b32 s44, s44, 7
    s_add_u32 s44, s44, 83099648
    v_lshlrev_b32 v6, 5, v15
    v_and_b32 v6, 0xfff, v6
    buffer_load_dword v5, v6, s[40:43], s44 offen sc1
    s_add_u32 s13, s48, 1
    s_add_u32 s98, s98, 1
    s_branch F_hookret
F_hook3:
    s_and_b32 s66, s27, 1
    s_lshl_b32 s66, s66, 2
    s_add_u32 s66, s66, s29
    s_lshl_b32 s66, s66, 10
    s_lshl_b32 s79, s26, 16
    s_add_u32 s79, s79, s66
    s_add_u32 s79, s79, 79691776
    s_waitcnt vmcnt(8)
    v_cmp_gt_u32 vcc, 1, v5
    s_nop 0
    s_cmp_lg_u64 vcc, 0
    s_cbranch_scc1 F_spin18
F_spin18r:
    buffer_load_dwordx4 v[96:99], v15, s[40:43], s79 offen sc1
    s_add_u32 s79, s79, 8192
    buffer_load_dwordx4 v[100:103], v15, s[40:43], s79 offen sc1
    s_add_u32 s79, s79, 8192
    buffer_load_dwordx4 v[104:107], v15, s[40:43], s79 offen sc1
    s_add_u32 s79, s79, 8192
    buffer_load_dwordx4 v[108:111], v15, s[40:43], s79 offen sc1
    s_add_u32 s79, s79, 8192
    buffer_load_dwordx4 v[112:115], v15, s[40:43], s79 offen sc1
    s_add_u32 s79, s79, 8192
    buffer_load_dwordx4 v[116:119], v15, s[40:43], s79 offen sc1
    s_add_u32 s79, s79, 8192
    buffer_load_dwordx4 v[120:123], v15, s[40:43], s79 offen sc1
    s_add_u32 s79, s79, 8192
    buffer_load_dwordx4 v[124:127], v15, s[40:43], s79 offen sc1
    s_add_u32 s79, s79, 8192
    s_add_u32 s13, s48, 2
    s_add_u32 s98, s98, 1
    s_branch F_hookret
F_hook4:
    s_and_b32 s66, s27, 1
    s_lshl_b32 s66, s66, 2
    s_add_u32 s66, s66, s29
    s_lshl_b32 s79, s26, 3
    s_add_u32 s79, s79, s66
    s_lshl_b32 s44, s79, 7
    s_add_u32 s44, s44, 83296256
    s_lshl_b32 s79, s79, 9
    s_add_u32 s79, s79, 80740352
    v_pk_add_f32 v[96:97], v[96:97], v[100:101]
    v_pk_add_f32 v[98:99], v[98:99], v[102:103]
    v_pk_add_f32 v[96:97], v[96:97], v[104:105]
    v_pk_add_f32 v[98:99], v[98:99], v[106:107]
    v_pk_add_f32 v[96:97], v[96:97], v[108:109]
    v_pk_add_f32 v[98:99], v[98:99], v[110:111]
    v_pk_add_f32 v[96:97], v[96:97], v[112:113]
    v_pk_add_f32 v[98:99], v[98:99], v[114:115]
    v_pk_add_f32 v[96:97], v[96:97], v[116:117]
    v_pk_add_f32 v[98:99], v[98:99], v[118:119]
    v_pk_add_f32 v[96:97], v[96:97], v[120:121]
    v_pk_add_f32 v[98:99], v[98:99], v[122:123]
    v_pk_add_f32 v[96:97], v[96:97], v[124:125]
    v_pk_add_f32 v[98:99], v[98:99], v[126:127]
    v_lshrrev_b32 v6, 1, v15
    v_cvt_pk_bf16_f32 v96, v96, v97
    v_cvt_pk_bf16_f32 v97, v98, v99
    buffer_store_dwordx2 v[96:97], v6, s[40:43], s79 offen sc1
    s_add_u32 s13, s48, 2
    s_add_u32 s98, s98, 1
    s_branch F_hookret
F_hook5:
    buffer_store_dword v4, v3, s[40:43], s44 offen sc1
    s_add_u32 s13, s48, 6
    s_add_u32 s98, s98, 1
    s_branch F_hookret
F_hook6:
    s_lshl_b32 s44, s14, 10
    s_add_u32 s44, s44, 83296256
    v_lshlrev_b32 v6, 3, v15
    v_and_b32 v6, 1023, v6
    buffer_load_dword v5, v6, s[40:43], s44 offen sc1
    s_add_u32 s13, s48, 1
    s_add_u32 s98, s98, 1
    s_branch F_hookret
F_hook7:
    s_waitcnt vmcnt(8)
    v_cmp_gt_u32 vcc, 1, v5
    s_nop 0
    s_cmp_lg_u64 vcc, 0
    s_cbranch_scc1 F_spin19
F_spin19r:
    s_lshl_b32 s79, s14, 12
    s_add_u32 s79, s79, 80740352
    v_lshrrev_b32 v6, 1, v15
    buffer_load_dwordx2 v[96:97], v6, s[40:43], s79 offen offset:0 sc1
    buffer_load_dwordx2 v[98:99], v6, s[40:43], s79 offen offset:512 sc1
    buffer_load_dwordx2 v[100:101], v6, s[40:43], s79 offen offset:1024 sc1
    buffer_load_dwordx2 v[102:103], v6, s[40:43], s79 offen offset:1536 sc1
    buffer_load_dwordx2 v[104:105], v6, s[40:43], s79 offen offset:2048 sc1
    buffer_load_dwordx2 v[106:107], v6, s[40:43], s79 offen offset:2560 sc1
    buffer_load_dwordx2 v[108:109], v6, s[40:43], s79 offen offset:3072 sc1
    buffer_load_dwordx2 v[110:111], v6, s[40:43], s79 offen offset:3584 sc1
    s_add_u32 s13, s48, 2
    s_add_u32 s98, s98, 1
    s_branch F_hookret
F_hook8:
    s_lshl_b32 s79, s15, 2
    s_add_u32 s79, s79, s29
    s_lshl_b32 s79, s79, 4
    s_add_u32 s79, s79, s14
    s_lshl_b32 s44, s79, 7
    s_add_u32 s44, s44, 83361792
    s_lshl_b32 s79, s79, 12
    s_add_u32 s79, s79, 75497472
    v_and_b32 v6, 0x3c, v2
    v_add_u32 v6, 192, v6
    v_mfma_f32_16x16x32_bf16 v[116:119], v[104:107], v[64:67], 0
    v_mfma_f32_16x16x32_bf16 v[116:119], v[108:111], v[68:71], v[116:119]
    v_mfma_f32_16x16x32_bf16 v[112:115], v[96:99], v[64:67], 0
    v_mfma_f32_16x16x32_bf16 v[112:115], v[100:103], v[68:71], v[112:115]
    v_mfma_f32_16x16x32_bf16 v[124:127], v[104:107], v[72:75], 0
    v_mfma_f32_16x16x32_bf16 v[124:127], v[108:111], v[76:79], v[124:127]
    v_mfma_f32_16x16x32_bf16 v[120:123], v[96:99], v[72:75], 0
    v_mfma_f32_16x16x32_bf16 v[120:123], v[100:103], v[76:79], v[120:123]
    v_mfma_f32_16x16x32_bf16 v[68:71], v[104:107], v[80:83], 0
    v_mfma_f32_16x16x32_bf16 v[68:71], v[108:111], v[84:87], v[68:71]
    v_mfma_f32_16x16x32_bf16 v[64:67], v[96:99], v[80:83], 0
    v_mfma_f32_16x16x32_bf16 v[64:67], v[100:103], v[84:87], v[64:67]
    v_mfma_f32_16x16x32_bf16 v[76:79], v[104:107], v[88:91], 0
    v_mfma_f32_16x16x32_bf16 v[76:79], v[108:111], v[92:95], v[76:79]
    v_mfma_f32_16x16x32_bf16 v[72:75], v[96:99], v[88:91], 0
    v_mfma_f32_16x16x32_bf16 v[72:75], v[100:103], v[92:95], v[72:75]
    s_nop 4
    ds_bpermute_b32 v56, v6, v116
    ds_bpermute_b32 v58, v6, v124
    ds_bpermute_b32 v60, v6, v68
    ds_bpermute_b32 v62, v6, v76
    s_waitcnt lgkmcnt(0)
    v_add_f32 v56, 0x358637bd, v56
    v_add_f32 v58, 0x358637bd, v58
    v_add_f32 v60, 0x358637bd, v60
    v_add_f32 v62, 0x358637bd, v62
    v_rcp_f32 v56, v56
    v_rcp_f32 v58, v58
    v_rcp_f32 v60, v60
    v_rcp_f32 v62, v62
    v_pk_mul_f32 v[112:113], v[112:113], v[56:57] op_sel_hi:[1,0]
    v_pk_mul_f32 v[114:115], v[114:115], v[56:57] op_sel_hi:[1,0]
    v_pk_mul_f32 v[116:117], v[116:117], v[56:57] op_sel_hi:[1,0]
    v_pk_mul_f32 v[118:119], v[118:119], v[56:57] op_sel_hi:[1,0]
    v_cvt_pk_bf16_f32 v112, v112, v113
    v_cvt_pk_bf16_f32 v113, v114, v115
    v_cvt_pk_bf16_f32 v114, v116, v117
    v_cvt_pk_bf16_f32 v115, v118, v119
    v_cndmask_b32 v114, v114, 0, s[70:71]
    v_cndmask_b32 v115, v115, 0, s[70:71]
    buffer_store_dwordx4 v[112:115], v15, s[40:43], s79 offen offset:0 sc1
    v_pk_mul_f32 v[120:121], v[120:121], v[58:59] op_sel_hi:[1,0]
    v_pk_mul_f32 v[122:123], v[122:123], v[58:59] op_sel_hi:[1,0]
    v_pk_mul_f32 v[124:125], v[124:125], v[58:59] op_sel_hi:[1,0]
    v_pk_mul_f32 v[126:127], v[126:127], v[58:59] op_sel_hi:[1,0]
    v_cvt_pk_bf16_f32 v120, v120, v121
    v_cvt_pk_bf16_f32 v121, v122, v123
    v_cvt_pk_bf16_f32 v122, v124, v125
    v_cvt_pk_bf16_f32 v123, v126, v127
    v_cndmask_b32 v122, v122, 0, s[70:71]
    v_cndmask_b32 v123, v123, 0, s[70:71]
    buffer_store_dwordx4 v[120:123], v15, s[40:43], s79 offen offset:1024 sc1
    v_pk_mul_f32 v[64:65], v[64:65], v[60:61] op_sel_hi:[1,0]
    v_pk_mul_f32 v[66:67], v[66:67], v[60:61] op_sel_hi:[1,0]
    v_pk_mul_f32 v[68:69], v[68:69], v[60:61] op_sel_hi:[1,0]
    v_pk_mul_f32 v[70:71], v[70:71], v[60:61] op_sel_hi:[1,0]
    v_cvt_pk_bf16_f32 v64, v64, v65
    v_cvt_pk_bf16_f32 v65, v66, v67
    v_cvt_pk_bf16_f32 v66, v68, v69
    v_cvt_pk_bf16_f32 v67, v70, v71
    v_cndmask_b32 v66, v66, 0, s[70:71]
    v_cndmask_b32 v67, v67, 0, s[70:71]
    buffer_store_dwordx4 v[64:67], v15, s[40:43], s79 offen offset:2048 sc1
    v_pk_mul_f32 v[72:73], v[72:73], v[62:63] op_sel_hi:[1,0]
    v_pk_mul_f32 v[74:75], v[74:75], v[62:63] op_sel_hi:[1,0]
    v_pk_mul_f32 v[76:77], v[76:77], v[62:63] op_sel_hi:[1,0]
    v_pk_mul_f32 v[78:79], v[78:79], v[62:63] op_sel_hi:[1,0]
    v_cvt_pk_bf16_f32 v72, v72, v73
    v_cvt_pk_bf16_f32 v73, v74, v75
    v_cvt_pk_bf16_f32 v74, v76, v77
    v_cvt_pk_bf16_f32 v75, v78, v79
    v_cndmask_b32 v74, v74, 0, s[70:71]
    v_cndmask_b32 v75, v75, 0, s[70:71]
    buffer_store_dwordx4 v[72:75], v15, s[40:43], s79 offen offset:3072 sc1
    s_sub_u32 s13, s97, 4
    s_mov_b32 s98, 9
    s_branch F_hookret
F_hook9:
    buffer_store_dword v4, v3, s[40:43], s44 offen sc1
    s_lshl_b32 s44, s21, 7
    s_add_u32 s44, s44, 83034112
    buffer_load_dword v5, v3, s[40:43], s44 offen sc1
    s_lshr_b32 s66, s2, 3
    s_lshl_b32 s66, s66, 2
    s_add_u32 s66, s66, s29
    s_lshl_b32 s66, s66, 10
    v_and_b32 v6, 0x380, v15
    v_add_u32 v6, s66, v6
    global_load_dword v7, v6, s[30:31]
    v_xor_b32 v6, 0x8000, v6
    global_load_dword v7, v6, s[30:31]
    s_mov_b32 s13, -1
    s_branch F_hookret
F_slow:
    s_waitcnt vmcnt(0) lgkmcnt(0)
    s_lshl_b32 s79, s78, 15
    s_add_u32 s79, s79, s19
    s_mov_b32 s64, s77
    v_mov_b32 v60, v4
    v_mov_b32 v61, v4
F_slow0:
    s_add_u32 s67, s79, 0
    buffer_load_dwordx4 a[64:67], v15, s[40:43], s67 offen offset:0 sc1
    buffer_load_dwordx4 a[68:71], v15, s[40:43], s67 offen offset:1024 sc1
    buffer_load_dwordx4 a[72:75], v15, s[40:43], s67 offen offset:2048 sc1
    buffer_load_dwordx4 a[76:79], v15, s[40:43], s67 offen offset:3072 sc1
    s_add_u32 s67, s79, 4096
    buffer_load_dwordx4 a[80:83], v15, s[40:43], s67 offen offset:0 sc1
    buffer_load_dwordx4 a[84:87], v15, s[40:43], s67 offen offset:1024 sc1
    buffer_load_dwordx4 a[88:91], v15, s[40:43], s67 offen offset:2048 sc1
    buffer_load_dwordx4 a[92:95], v15, s[40:43], s67 offen offset:3072 sc1
    s_add_u32 s67, s79, 8192
    buffer_load_dwordx4 a[96:99], v15, s[40:43], s67 offen offset:0 sc1
    buffer_load_dwordx4 a[100:103], v15, s[40:43], s67 offen offset:1024 sc1
    buffer_load_dwordx4 a[104:107], v15, s[40:43], s67 offen offset:2048 sc1
    buffer_load_dwordx4 a[108:111], v15, s[40:43], s67 offen offset:3072 sc1
    s_add_u32 s67, s79, 12288
    buffer_load_dwordx4 a[112:115], v15, s[40:43], s67 offen offset:0 sc1
    buffer_load_dwordx4 a[116:119], v15, s[40:43], s67 offen offset:1024 sc1
    buffer_load_dwordx4 a[120:123], v15, s[40:43], s67 offen offset:2048 sc1
    buffer_load_dwordx4 a[124:127], v15, s[40:43], s67 offen offset:3072 sc1
    s_add_u32 s79, s79, 32768
    s_sub_u32 s64, s64, 1
    s_waitcnt vmcnt(0)
    v_mfma_f32_16x16x32_bf16 v[16:19], a[64:67], a[0:3], 0
    v_mfma_f32_16x16x32_bf16 v[16:19], a[68:71], a[4:7], v[16:19]
    v_mfma_f32_16x16x32_bf16 v[16:19], a[72:75], a[8:11], v[16:19]
    v_mfma_f32_16x16x32_bf16 v[16:19], a[76:79], a[12:15], v[16:19]
    v_mfma_f32_16x16x32_bf16 v[16:19], a[80:83], a[16:19], v[16:19]
    v_mfma_f32_16x16x32_bf16 v[16:19], a[84:87], a[20:23], v[16:19]
    v_mfma_f32_16x16x32_bf16 v[16:19], a[88:91], a[24:27], v[16:19]
    v_mfma_f32_16x16x32_bf16 v[16:19], a[92:95], a[28:31], v[16:19]
    v_mfma_f32_16x16x32_bf16 v[20:23], a[124:127], a[28:31], 0
    v_mfma_f32_16x16x32_bf16 v[20:23], a[120:123], a[24:27], v[20:23]
    v_mfma_f32_16x16x32_bf16 v[20:23], a[116:119], a[20:23], v[20:23]
    v_mfma_f32_16x16x32_bf16 v[20:23], a[112:115], a[16:19], v[20:23]
    v_mfma_f32_16x16x32_bf16 v[20:23], a[108:111], a[12:15], v[20:23]
    v_mfma_f32_16x16x32_bf16 v[20:23], a[104:107], a[8:11], v[20:23]
    v_mfma_f32_16x16x32_bf16 v[20:23], a[100:103], a[4:7], v[20:23]
    v_mfma_f32_16x16x32_bf16 v[20:23], a[96:99], a[0:3], v[20:23]
    v_mfma_f32_16x16x32_bf16 v[24:27], a[64:67], a[32:35], 0
    v_mfma_f32_16x16x32_bf16 v[24:27], a[68:71], a[36:39], v[24:27]
    v_mfma_f32_16x16x32_bf16 v[24:27], a[72:75], a[40:43], v[24:27]
    v_mfma_f32_16x16x32_bf16 v[24:27], a[76:79], a[44:47], v[24:27]
    v_mfma_f32_16x16x32_bf16 v[24:27], a[80:83], a[48:51], v[24:27]
    v_mfma_f32_16x16x32_bf16 v[24:27], a[84:87], a[52:55], v[24:27]
    v_mfma_f32_16x16x32_bf16 v[24:27], a[88:91], a[56:59], v[24:27]
    v_mfma_f32_16x16x32_bf16 v[24:27], a[92:95], a[60:63], v[24:27]
    v_mfma_f32_16x16x32_bf16 v[28:31], a[124:127], a[60:63], 0
    v_mfma_f32_16x16x32_bf16 v[28:31], a[120:123], a[56:59], v[28:31]
    v_mfma_f32_16x16x32_bf16 v[28:31], a[116:119], a[52:55], v[28:31]
    v_mfma_f32_16x16x32_bf16 v[28:31], a[112:115], a[48:51], v[28:31]
    v_mfma_f32_16x16x32_bf16 v[28:31], a[108:111], a[44:47], v[28:31]
    v_mfma_f32_16x16x32_bf16 v[28:31], a[104:107], a[40:43], v[28:31]
    v_mfma_f32_16x16x32_bf16 v[28:31], a[100:103], a[36:39], v[28:31]
    v_mfma_f32_16x16x32_bf16 v[28:31], a[96:99], a[32:35], v[28:31]
    s_nop 7
    s_cmp_ge_u32 s64, s11
    s_cbranch_scc1 F_slown0
    v_cndmask_b32 v16, v16, v4, s[88:89]
    v_cndmask_b32 v17, v17, v4, s[90:91]
    v_cndmask_b32 v18, v18, v4, s[92:93]
    v_cndmask_b32 v19, v19, v4, s[94:95]
    v_cndmask_b32 v28, v28, v4, s[88:89]
    v_cndmask_b32 v29, v29, v4, s[90:91]
    v_cndmask_b32 v30, v30, v4, s[92:93]
    v_cndmask_b32 v31, v31, v4, s[94:95]
    v_mov_b32 v20, v4
    v_mov_b32 v21, v4
    v_mov_b32 v22, v4
    v_mov_b32 v23, v4
F_slown0:
    v_max3_f32 v56, v16, v17, v18
    v_max3_f32 v57, v24, v25, v26
    v_max3_f32 v56, v56, v19, v20
    v_max3_f32 v57, v57, v27, v28
    v_max3_f32 v56, v56, v21, v22
    v_max3_f32 v57, v57, v29, v30
    v_max_f32 v56, v56, v23
    v_max_f32 v57, v57, v31
    v_max_f32 v60, v60, v56
    v_max_f32 v61, v61, v57
    s_cmp_lg_u32 s64, 0
    s_cbranch_scc1 F_slow0
    v_mov_b32 v62, v60
    v_mov_b32 v63, v61
    s_nop 1
    v_permlane32_swap_b32 v60, v62
    v_permlane32_swap_b32 v61, v63
    v_max_f32 v60, v60, v62
    v_max_f32 v61, v61, v63
    v_mov_b32 v62, v60
    v_mov_b32 v63, v61
    s_nop 1
    v_permlane16_swap_b32 v60, v62
    v_permlane16_swap_b32 v61, v63
    v_max_f32 v60, v60, v62
    v_max_f32 v61, v61, v63
    v_sub_f32 v40, 0x80000000, v60
    v_sub_f32 v41, 0x80000000, v60
    v_sub_f32 v42, 0x80000000, v60
    v_sub_f32 v43, 0x80000000, v60
    v_sub_f32 v44, 0x80000000, v61
    v_sub_f32 v45, 0x80000000, v61
    v_sub_f32 v46, 0x80000000, v61
    v_sub_f32 v47, 0x80000000, v61
    s_lshl_b32 s79, s78, 15
    s_add_u32 s79, s79, s19
    s_mov_b32 s64, s77
    v_mov_b32 v128, 0
    v_mov_b32 v129, 0
    v_mov_b32 v130, 0
    v_mov_b32 v131, 0
    v_mov_b32 v132, 0
    v_mov_b32 v133, 0
    v_mov_b32 v134, 0
    v_mov_b32 v135, 0
    v_mov_b32 v136, 0
    v_mov_b32 v137, 0
    v_mov_b32 v138, 0
    v_mov_b32 v139, 0
    v_mov_b32 v140, 0
    v_mov_b32 v141, 0
    v_mov_b32 v142, 0
    v_mov_b32 v143, 0
    v_mov_b32 v144, 0
    v_mov_b32 v145, 0
    v_mov_b32 v146, 0
    v_mov_b32 v147, 0
    v_mov_b32 v148, 0
    v_mov_b32 v149, 0
    v_mov_b32 v150, 0
    v_mov_b32 v151, 0
    v_mov_b32 v152, 0
    v_mov_b32 v153, 0
    v_mov_b32 v154, 0
    v_mov_b32 v155, 0
    v_mov_b32 v156, 0
    v_mov_b32 v157, 0
    v_mov_b32 v158, 0
    v_mov_b32 v159, 0
    v_mov_b32 v160, 0
    v_mov_b32 v161, 0
    v_mov_b32 v162, 0
    v_mov_b32 v163, 0
    v_mov_b32 v164, 0
    v_mov_b32 v165, 0
    v_mov_b32 v166, 0
    v_mov_b32 v167, 0
    v_mov_b32 v168, 0
    v_mov_b32 v169, 0
    v_mov_b32 v170, 0
    v_mov_b32 v171, 0
    v_mov_b32 v172, 0
    v_mov_b32 v173, 0
    v_mov_b32 v174, 0
    v_mov_b32 v175, 0
    v_mov_b32 v176, 0
    v_mov_b32 v177, 0
    v_mov_b32 v178, 0
    v_mov_b32 v179, 0
    v_mov_b32 v180, 0
    v_mov_b32 v181, 0
    v_mov_b32 v182, 0
    v_mov_b32 v183, 0
    v_mov_b32 v184, 0
    v_mov_b32 v185, 0
    v_mov_b32 v186, 0
    v_mov_b32 v187, 0
    v_mov_b32 v188, 0
    v_mov_b32 v189, 0
    v_mov_b32 v190, 0
    v_mov_b32 v191, 0
    v_mov_b32 v192, 0
    v_mov_b32 v193, 0
    v_mov_b32 v194, 0
    v_mov_b32 v195, 0
    v_mov_b32 v196, 0
    v_mov_b32 v197, 0
    v_mov_b32 v198, 0
    v_mov_b32 v199, 0
    v_mov_b32 v200, 0
    v_mov_b32 v201, 0
    v_mov_b32 v202, 0
    v_mov_b32 v203, 0
    v_mov_b32 v204, 0
    v_mov_b32 v205, 0
    v_mov_b32 v206, 0
    v_mov_b32 v207, 0
    v_mov_b32 v208, 0
    v_mov_b32 v209, 0
    v_mov_b32 v210, 0
    v_mov_b32 v211, 0
    v_mov_b32 v212, 0
    v_mov_b32 v213, 0
    v_mov_b32 v214, 0
    v_mov_b32 v215, 0
    v_mov_b32 v216, 0
    v_mov_b32 v217, 0
    v_mov_b32 v218, 0
    v_mov_b32 v219, 0
    v_mov_b32 v220, 0
    v_mov_b32 v221, 0
    v_mov_b32 v222, 0
    v_mov_b32 v223, 0
    v_mov_b32 v224, 0
    v_mov_b32 v225, 0
    v_mov_b32 v226, 0
    v_mov_b32 v227, 0
    v_mov_b32 v228, 0
    v_mov_b32 v229, 0
    v_mov_b32 v230, 0
    v_mov_b32 v231, 0
    v_mov_b32 v232, 0
    v_mov_b32 v233, 0
    v_mov_b32 v234, 0
    v_mov_b32 v235, 0
    v_mov_b32 v236, 0
    v_mov_b32 v237, 0
    v_mov_b32 v238, 0
    v_mov_b32 v239, 0
    v_mov_b32 v240, 0
    v_mov_b32 v241, 0
    v_mov_b32 v242, 0
    v_mov_b32 v243, 0
    v_mov_b32 v244, 0
    v_mov_b32 v245, 0
    v_mov_b32 v246, 0
    v_mov_b32 v247, 0
    v_mov_b32 v248, 0
    v_mov_b32 v249, 0
    v_mov_b32 v250, 0
    v_mov_b32 v251, 0
    v_mov_b32 v252, 0
    v_mov_b32 v253, 0
    v_mov_b32 v254, 0
    v_mov_b32 v255, 0
    v_mov_b32 v48, 0
    v_mov_b32 v49, 0
    v_mov_b32 v50, 0
    v_mov_b32 v51, 0
    v_mov_b32 v52, 0
    v_mov_b32 v53, 0
    v_mov_b32 v54, 0
    v_mov_b32 v55, 0
F_slow1:
    s_add_u32 s67, s79, 0
    buffer_load_dwordx4 a[64:67], v15, s[40:43], s67 offen offset:0 sc1
    buffer_load_dwordx4 a[68:71], v15, s[40:43], s67 offen offset:1024 sc1
    buffer_load_dwordx4 a[72:75], v15, s[40:43], s67 offen offset:2048 sc1
    buffer_load_dwordx4 a[76:79], v15, s[40:43], s67 offen offset:3072 sc1
    s_add_u32 s67, s79, 4096
    buffer_load_dwordx4 a[80:83], v15, s[40:43], s67 offen offset:0 sc1
    buffer_load_dwordx4 a[84:87], v15, s[40:43], s67 offen offset:1024 sc1
    buffer_load_dwordx4 a[88:91], v15, s[40:43], s67 offen offset:2048 sc1
    buffer_load_dwordx4 a[92:95], v15, s[40:43], s67 offen offset:3072 sc1
    s_add_u32 s67, s79, 8192
    buffer_load_dwordx4 a[96:99], v15, s[40:43], s67 offen offset:0 sc1
    buffer_load_dwordx4 a[100:103], v15, s[40:43], s67 offen offset:1024 sc1
    buffer_load_dwordx4 a[104:107], v15, s[40:43], s67 offen offset:2048 sc1
    buffer_load_dwordx4 a[108:111], v15, s[40:43], s67 offen offset:3072 sc1
    s_add_u32 s67, s79, 12288
    buffer_load_dwordx4 a[112:115], v15, s[40:43], s67 offen offset:0 sc1
    buffer_load_dwordx4 a[116:119], v15, s[40:43], s67 offen offset:1024 sc1
    buffer_load_dwordx4 a[120:123], v15, s[40:43], s67 offen offset:2048 sc1
    buffer_load_dwordx4 a[124:127], v15, s[40:43], s67 offen offset:3072 sc1
    s_add_u32 s67, s79, 16384
    buffer_load_dwordx4 a[128:131], v15, s[40:43], s67 offen offset:0 sc1
    buffer_load_dwordx4 a[132:135], v15, s[40:43], s67 offen offset:1024 sc1
    buffer_load_dwordx4 a[136:139], v15, s[40:43], s67 offen offset:2048 sc1
    buffer_load_dwordx4 a[140:143], v15, s[40:43], s67 offen offset:3072 sc1
    s_add_u32 s67, s79, 20480
    buffer_load_dwordx4 a[144:147], v15, s[40:43], s67 offen offset:0 sc1
    buffer_load_dwordx4 a[148:151], v15, s[40:43], s67 offen offset:1024 sc1
    buffer_load_dwordx4 a[152:155], v15, s[40:43], s67 offen offset:2048 sc1
    buffer_load_dwordx4 a[156:159], v15, s[40:43], s67 offen offset:3072 sc1
    s_add_u32 s67, s79, 24576
    buffer_load_dwordx4 a[160:163], v15, s[40:43], s67 offen offset:0 sc1
    buffer_load_dwordx4 a[164:167], v15, s[40:43], s67 offen offset:1024 sc1
    buffer_load_dwordx4 a[168:171], v15, s[40:43], s67 offen offset:2048 sc1
    buffer_load_dwordx4 a[172:175], v15, s[40:43], s67 offen offset:3072 sc1
    s_add_u32 s67, s79, 28672
    buffer_load_dwordx4 a[176:179], v15, s[40:43], s67 offen offset:0 sc1
    buffer_load_dwordx4 a[180:183], v15, s[40:43], s67 offen offset:1024 sc1
    buffer_load_dwordx4 a[184:187], v15, s[40:43], s67 offen offset:2048 sc1
    buffer_load_dwordx4 a[188:191], v15, s[40:43], s67 offen offset:3072 sc1
    s_add_u32 s79, s79, 32768
    s_sub_u32 s64, s64, 1
    s_waitcnt vmcnt(0)
    v_mfma_f32_16x16x32_bf16 v[16:19], a[64:67], a[0:3], v[40:43]
    v_mfma_f32_16x16x32_bf16 v[16:19], a[68:71], a[4:7], v[16:19]
    v_mfma_f32_16x16x32_bf16 v[16:19], a[72:75], a[8:11], v[16:19]
    v_mfma_f32_16x16x32_bf16 v[16:19], a[76:79], a[12:15], v[16:19]
    v_mfma_f32_16x16x32_bf16 v[16:19], a[80:83], a[16:19], v[16:19]
    v_mfma_f32_16x16x32_bf16 v[16:19], a[84:87], a[20:23], v[16:19]
    v_mfma_f32_16x16x32_bf16 v[16:19], a[88:91], a[24:27], v[16:19]
    v_mfma_f32_16x16x32_bf16 v[16:19], a[92:95], a[28:31], v[16:19]
    v_mfma_f32_16x16x32_bf16 v[20:23], a[124:127], a[28:31], v[40:43]
    v_mfma_f32_16x16x32_bf16 v[20:23], a[120:123], a[24:27], v[20:23]
    v_mfma_f32_16x16x32_bf16 v[20:23], a[116:119], a[20:23], v[20:23]
    v_mfma_f32_16x16x32_bf16 v[20:23], a[112:115], a[16:19], v[20:23]
    v_mfma_f32_16x16x32_bf16 v[20:23], a[108:111], a[12:15], v[20:23]
    v_mfma_f32_16x16x32_bf16 v[20:23], a[104:107], a[8:11], v[20:23]
    v_mfma_f32_16x16x32_bf16 v[20:23], a[100:103], a[4:7], v[20:23]
    v_mfma_f32_16x16x32_bf16 v[20:23], a[96:99], a[0:3], v[20:23]
    v_mfma_f32_16x16x32_bf16 v[24:27], a[64:67], a[32:35], v[44:47]
    v_mfma_f32_16x16x32_bf16 v[24:27], a[68:71], a[36:39], v[24:27]
    v_mfma_f32_16x16x32_bf16 v[24:27], a[72:75], a[40:43], v[24:27]
    v_mfma_f32_16x16x32_bf16 v[24:27], a[76:79], a[44:47], v[24:27]
    v_mfma_f32_16x16x32_bf16 v[24:27], a[80:83], a[48:51], v[24:27]
    v_mfma_f32_16x16x32_bf16 v[24:27], a[84:87], a[52:55], v[24:27]
    v_mfma_f32_16x16x32_bf16 v[24:27], a[88:91], a[56:59], v[24:27]
    v_mfma_f32_16x16x32_bf16 v[24:27], a[92:95], a[60:63], v[24:27]
    v_mfma_f32_16x16x32_bf16 v[28:31], a[124:127], a[60:63], v[44:47]
    v_mfma_f32_16x16x32_bf16 v[28:31], a[120:123], a[56:59], v[28:31]
    v_mfma_f32_16x16x32_bf16 v[28:31], a[116:119], a[52:55], v[28:31]
    v_mfma_f32_16x16x32_bf16 v[28:31], a[112:115], a[48:51], v[28:31]
    v_mfma_f32_16x16x32_bf16 v[28:31], a[108:111], a[44:47], v[28:31]
    v_mfma_f32_16x16x32_bf16 v[28:31], a[104:107], a[40:43], v[28:31]
    v_mfma_f32_16x16x32_bf16 v[28:31], a[100:103], a[36:39], v[28:31]
    v_mfma_f32_16x16x32_bf16 v[28:31], a[96:99], a[32:35], v[28:31]
    s_nop 7
    s_cmp_ge_u32 s64, s11
    s_cbranch_scc1 F_slown1
    v_cndmask_b32 v16, v16, v4, s[88:89]
    v_cndmask_b32 v17, v17, v4, s[90:91]
    v_cndmask_b32 v18, v18, v4, s[92:93]
    v_cndmask_b32 v19, v19, v4, s[94:95]
    v_cndmask_b32 v28, v28, v4, s[88:89]
    v_cndmask_b32 v29, v29, v4, s[90:91]
    v_cndmask_b32 v30, v30, v4, s[92:93]
    v_cndmask_b32 v31, v31, v4, s[94:95]
    v_mov_b32 v20, v4
    v_mov_b32 v21, v4
    v_mov_b32 v22, v4
    v_mov_b32 v23, v4
F_slown1:
    v_exp_f32 v16, v16
    v_exp_f32 v17, v17
    v_exp_f32 v18, v18
    v_exp_f32 v19, v19
    v_exp_f32 v20, v20
    v_exp_f32 v21, v21
    v_exp_f32 v22, v22
    v_exp_f32 v23, v23
    v_cvt_pk_bf16_f32 v32, v16, v17
    v_cvt_pk_bf16_f32 v33, v18, v19
    v_cvt_pk_bf16_f32 v34, v20, v21
    v_cvt_pk_bf16_f32 v35, v22, v23
    v_exp_f32 v24, v24
    v_exp_f32 v25, v25
    v_exp_f32 v26, v26
    v_exp_f32 v27, v27
    v_exp_f32 v28, v28
    v_exp_f32 v29, v29
    v_exp_f32 v30, v30
    v_exp_f32 v31, v31
    v_cvt_pk_bf16_f32 v36, v24, v25
    v_cvt_pk_bf16_f32 v37, v26, v27
    v_cvt_pk_bf16_f32 v38, v28, v29
    v_cvt_pk_bf16_f32 v39, v30, v31
    s_nop 1
    v_mfma_f32_16x16x32_bf16 v[128:131], a[128:131], v[32:35], v[128:131]
    v_mfma_f32_16x16x32_bf16 v[132:135], a[132:135], v[32:35], v[132:135]
    v_mfma_f32_16x16x32_bf16 v[136:139], a[136:139], v[32:35], v[136:139]
    v_mfma_f32_16x16x32_bf16 v[140:143], a[140:143], v[32:35], v[140:143]
    v_mfma_f32_16x16x32_bf16 v[144:147], a[144:147], v[32:35], v[144:147]
    v_mfma_f32_16x16x32_bf16 v[148:151], a[148:151], v[32:35], v[148:151]
    v_mfma_f32_16x16x32_bf16 v[152:155], a[152:155], v[32:35], v[152:155]
    v_mfma_f32_16x16x32_bf16 v[156:159], a[156:159], v[32:35], v[156:159]
    v_mfma_f32_16x16x32_bf16 v[160:163], a[160:163], v[32:35], v[160:163]
    v_mfma_f32_16x16x32_bf16 v[164:167], a[164:167], v[32:35], v[164:167]
    v_mfma_f32_16x16x32_bf16 v[168:171], a[168:171], v[32:35], v[168:171]
    v_mfma_f32_16x16x32_bf16 v[172:175], a[172:175], v[32:35], v[172:175]
    v_mfma_f32_16x16x32_bf16 v[176:179], a[176:179], v[32:35], v[176:179]
    v_mfma_f32_16x16x32_bf16 v[180:183], a[180:183], v[32:35], v[180:183]
    v_mfma_f32_16x16x32_bf16 v[184:187], a[184:187], v[32:35], v[184:187]
    v_mfma_f32_16x16x32_bf16 v[188:191], a[188:191], v[32:35], v[188:191]
    v_mfma_f32_16x16x32_bf16 v[48:51], v[8:11], v[32:35], v[48:51]
    v_mfma_f32_16x16x32_bf16 v[192:195], a[128:131], v[36:39], v[192:195]
    v_mfma_f32_16x16x32_bf16 v[196:199], a[132:135], v[36:39], v[196:199]
    v_mfma_f32_16x16x32_bf16 v[200:203], a[136:139], v[36:39], v[200:203]
    v_mfma_f32_16x16x32_bf16 v[204:207], a[140:143], v[36:39], v[204:207]
    v_mfma_f32_16x16x32_bf16 v[208:211], a[144:147], v[36:39], v[208:211]
    v_mfma_f32_16x16x32_bf16 v[212:215], a[148:151], v[36:39], v[212:215]
    v_mfma_f32_16x16x32_bf16 v[216:219], a[152:155], v[36:39], v[216:219]
    v_mfma_f32_16x16x32_bf16 v[220:223], a[156:159], v[36:39], v[220:223]
    v_mfma_f32_16x16x32_bf16 v[224:227], a[160:163], v[36:39], v[224:227]
    v_mfma_f32_16x16x32_bf16 v[228:231], a[164:167], v[36:39], v[228:231]
    v_mfma_f32_16x16x32_bf16 v[232:235], a[168:171], v[36:39], v[232:235]
    v_mfma_f32_16x16x32_bf16 v[236:239], a[172:175], v[36:39], v[236:239]
    v_mfma_f32_16x16x32_bf16 v[240:243], a[176:179], v[36:39], v[240:243]
    v_mfma_f32_16x16x32_bf16 v[244:247], a[180:183], v[36:39], v[244:247]
    v_mfma_f32_16x16x32_bf16 v[248:251], a[184:187], v[36:39], v[248:251]
    v_mfma_f32_16x16x32_bf16 v[252:255], a[188:191], v[36:39], v[252:255]
    v_mfma_f32_16x16x32_bf16 v[52:55], v[8:11], v[36:39], v[52:55]
    s_cmp_lg_u32 s64, 0
    s_cbranch_scc1 F_slow1
    ds_read_b128 a[64:67], v1 offset:16384
    ds_read_b128 a[68:71], v1 offset:17408
    ds_read_b128 a[72:75], v1 offset:18432
    ds_read_b128 a[76:79], v1 offset:19456
    ds_read_b128 a[80:83], v1 offset:20480
    ds_read_b128 a[84:87], v1 offset:21504
    ds_read_b128 a[88:91], v1 offset:22528
    ds_read_b128 a[92:95], v1 offset:23552
    ds_read_b128 a[96:99], v1 offset:24576
    ds_read_b128 a[100:103], v1 offset:25600
    ds_read_b128 a[104:107], v1 offset:26624
    ds_read_b128 a[108:111], v1 offset:27648
    ds_read_b128 a[112:115], v1 offset:28672
    ds_read_b128 a[116:119], v1 offset:29696
    ds_read_b128 a[120:123], v1 offset:30720
    ds_read_b128 a[124:127], v1 offset:31744
    s_branch F_checked
F_spin4:
    s_mov_b32 s99, 0x200000
F_spin4a:
    s_sleep 4
    buffer_load_dword v1, v4, s[88:91], 0 offen sc1
    s_waitcnt vmcnt(0)
    s_sub_u32 s99, s99, 1
    s_cbranch_scc1 F_spin4r
    v_cmp_gt_u32 vcc, 16843009, v1
    s_nop 0
    s_cmp_lg_u64 vcc, 0
    s_cbranch_scc1 F_spin4a
    s_branch F_spin4r
F_spin5:
    s_mov_b32 s99, 0x200000
F_spin5a:
    s_sleep 4
    buffer_load_dword v16, v4, s[40:43], s75 offen sc1
    s_waitcnt vmcnt(0)
    s_sub_u32 s99, s99, 1
    s_cbranch_scc1 F_spin5r
    v_cmp_gt_u32 vcc, 1, v16
    s_nop 0
    s_cmp_lg_u64 vcc, 0
    s_cbranch_scc1 F_spin5a
    s_branch F_spin5r
F_spin6:
    s_mov_b32 s99, 0x200000
F_spin6a:
    s_sleep 4
    buffer_load_dword v5, v6, s[40:43], s44 offen sc1
    s_waitcnt vmcnt(0)
    s_sub_u32 s99, s99, 1
    s_cbranch_scc1 F_spin6r
    v_cmp_gt_u32 vcc, 1, v5
    s_nop 0
    s_cmp_lg_u64 vcc, 0
    s_cbranch_scc1 F_spin6a
    s_branch F_spin6r
F_spin7:
    s_mov_b32 s99, 0x200000
F_spin7a:
    s_sleep 4
    buffer_load_dword v19, v3, s[40:43], s57 offen sc1
    s_waitcnt vmcnt(0)
    s_sub_u32 s99, s99, 1
    s_cbranch_scc1 F_spin7r
    v_cmp_gt_u32 vcc, 1, v19
    s_nop 0
    s_cmp_lg_u64 vcc, 0
    s_cbranch_scc1 F_spin7a
    s_branch F_spin7r
F_sw8:
    s_mov_b32 s4, s6
    s_mov_b32 s5, s7
    s_mov_b32 s6, s8
    s_cmp_eq_u32 s4, s8
    s_cbranch_scc0 F_sw8r
    s_add_u32 s4, s45, 16384
    s_mov_b32 s50, s9
    s_mov_b32 s49, 8192
    s_mov_b32 s5, 4096
    s_branch F_sw8r
F_sw9:
    s_mov_b32 s4, s6
    s_mov_b32 s5, s7
    s_mov_b32 s6, s8
    s_cmp_eq_u32 s4, s8
    s_cbranch_scc0 F_sw9r
    s_add_u32 s4, s45, 16384
    s_mov_b32 s50, s9
    s_mov_b32 s49, 8192
    s_mov_b32 s5, 4096
    s_branch F_sw9r
F_sw10:
    s_mov_b32 s4, s6
    s_mov_b32 s5, s7
    s_mov_b32 s6, s8
    s_cmp_eq_u32 s4, s8
    s_cbranch_scc0 F_sw10r
    s_add_u32 s4, s45, 16384
    s_mov_b32 s50, s9
    s_mov_b32 s49, 8192
    s_mov_b32 s5, 4096
    s_branch F_sw10r
F_sw11:
    s_mov_b32 s4, s6
    s_mov_b32 s5, s7
    s_mov_b32 s6, s8
    s_cmp_eq_u32 s4, s8
    s_cbranch_scc0 F_sw11r
    s_add_u32 s4, s45, 16384
    s_mov_b32 s50, s9
    s_mov_b32 s49, 8192
    s_mov_b32 s5, 4096
    s_branch F_sw11r
F_spin12:
    s_mov_b32 s99, 0x200000
F_spin12a:
    s_sleep 4
    buffer_load_dword v5, v3, s[40:43], s44 offen sc1
    s_waitcnt vmcnt(0)
    s_sub_u32 s99, s99, 1
    s_cbranch_scc1 F_spin12r
    v_cmp_gt_u32 vcc, 1, v5
    s_nop 0
    s_cmp_lg_u64 vcc, 0
    s_cbranch_scc1 F_spin12a
    s_branch F_spin12r
F_sw13:
    s_mov_b32 s4, s6
    s_mov_b32 s5, s7
    s_mov_b32 s6, s8
    s_cmp_eq_u32 s4, s8
    s_cbranch_scc0 F_sw13r
    s_add_u32 s4, s45, 16384
    s_mov_b32 s50, s9
    s_mov_b32 s49, 8192
    s_mov_b32 s5, 4096
    s_branch F_sw13r
F_sw14:
    s_mov_b32 s4, s6
    s_mov_b32 s5, s7
    s_mov_b32 s6, s8
    s_cmp_eq_u32 s4, s8
    s_cbranch_scc0 F_sw14r
    s_add_u32 s4, s45, 16384
    s_mov_b32 s50, s9
    s_mov_b32 s49, 8192
    s_mov_b32 s5, 4096
    s_branch F_sw14r
F_sw15:
    s_mov_b32 s4, s6
    s_mov_b32 s5, s7
    s_mov_b32 s6, s8
    s_cmp_eq_u32 s4, s8
    s_cbranch_scc0 F_sw15r
    s_add_u32 s4, s45, 16384
    s_mov_b32 s50, s9
    s_mov_b32 s49, 8192
    s_mov_b32 s5, 4096
    s_branch F_sw15r
F_sw16:
    s_mov_b32 s4, s6
    s_mov_b32 s5, s7
    s_mov_b32 s6, s8
    s_cmp_eq_u32 s4, s8
    s_cbranch_scc0 F_sw16r
    s_add_u32 s4, s45, 16384
    s_mov_b32 s50, s9
    s_mov_b32 s49, 8192
    s_mov_b32 s5, 4096
    s_branch F_sw16r
F_spin17:
    s_mov_b32 s99, 0x200000
F_spin17a:
    s_sleep 4
    buffer_load_dword v5, v6, s[40:43], s75 offen sc1
    s_waitcnt vmcnt(0)
    s_sub_u32 s99, s99, 1
    s_cbranch_scc1 F_spin17r
    v_cmp_gt_u32 vcc, 2, v5
    s_nop 0
    s_cmp_lg_u64 vcc, 0
    s_cbranch_scc1 F_spin17a
    s_branch F_spin17r
F_spin18:
    s_mov_b32 s99, 0x200000
F_spin18a:
    s_sleep 4
    buffer_load_dword v5, v6, s[40:43], s44 offen sc1
    s_waitcnt vmcnt(0)
    s_sub_u32 s99, s99, 1
    s_cbranch_scc1 F_spin18r
    v_cmp_gt_u32 vcc, 1, v5
    s_nop 0
    s_cmp_lg_u64 vcc, 0
    s_cbranch_scc1 F_spin18a
    s_branch F_spin18r
F_spin19:
    s_mov_b32 s99, 0x200000
F_spin19a:
    s_sleep 4
    buffer_load_dword v5, v6, s[40:43], s44 offen sc1
    s_waitcnt vmcnt(0)
    s_sub_u32 s99, s99, 1
    s_cbranch_scc1 F_spin19r
    v_cmp_gt_u32 vcc, 1, v5
    s_nop 0
    s_cmp_lg_u64 vcc, 0
    s_cbranch_scc1 F_spin19a
    s_branch F_spin19r
F_merge:
    s_waitcnt vmcnt(16)
    v_sub_f32 v60, v60, v40
    v_sub_f32 v62, v62, v44
    v_sub_f32 v60, v60, v12
    v_sub_f32 v62, v62, v13
    v_exp_f32 v57, -v60
    v_exp_f32 v59, -v62
    v_exp_f32 v60, v60
    v_exp_f32 v62, v62
    v_add_f32 v57, 1.0, v57
    v_add_f32 v59, 1.0, v59
    v_add_f32 v60, 1.0, v60
    v_add_f32 v62, 1.0, v62
    v_rcp_f32 v57, v57
    v_rcp_f32 v59, v59
    v_rcp_f32 v60, v60
    v_rcp_f32 v62, v62
    v_mul_f32 v56, v56, v57
    v_mul_f32 v58, v58, v59
    v_mov_b32 v61, v60
    v_mov_b32 v63, v62
    v_mov_b32 v57, v56
    v_mov_b32 v59, v58
    s_lshl_b32 s79, s18, 20
    s_lshl_b32 s66, s29, 18
    s_add_u32 s79, s79, s66
    s_lshl_b32 s66, s26, 13
    s_add_u32 s79, s79, s66
    s_add_u32 s79, s79, 50331648
    v_pk_mul_f32 v[128:129], v[128:129], v[56:57]
    v_pk_mul_f32 v[130:131], v[130:131], v[56:57]
    v_pk_mul_f32 v[132:133], v[132:133], v[56:57]
    v_pk_mul_f32 v[134:135], v[134:135], v[56:57]
    v_lshlrev_b32 v16, 16, v64
    v_and_b32 v17, 0xffff0000, v64
    v_lshlrev_b32 v18, 16, v65
    v_and_b32 v19, 0xffff0000, v65
    v_lshlrev_b32 v20, 16, v66
    v_and_b32 v21, 0xffff0000, v66
    v_lshlrev_b32 v22, 16, v67
    v_and_b32 v23, 0xffff0000, v67
    v_pk_fma_f32 v[128:129], v[16:17], v[60:61], v[128:129]
    v_pk_fma_f32 v[130:131], v[18:19], v[60:61], v[130:131]
    v_pk_fma_f32 v[132:133], v[20:21], v[60:61], v[132:133]
    v_pk_fma_f32 v[134:135], v[22:23], v[60:61], v[134:135]
    v_cvt_pk_bf16_f32 v128, v128, v129
    v_cvt_pk_bf16_f32 v129, v130, v131
    v_cvt_pk_bf16_f32 v130, v132, v133
    v_cvt_pk_bf16_f32 v131, v134, v135
    s_add_u32 s67, s79, 0
    buffer_store_dwordx4 v[128:131], v15, s[40:43], s67 offen offset:0 sc1
    v_pk_mul_f32 v[136:137], v[136:137], v[56:57]
    v_pk_mul_f32 v[138:139], v[138:139], v[56:57]
    v_pk_mul_f32 v[140:141], v[140:141], v[56:57]
    v_pk_mul_f32 v[142:143], v[142:143], v[56:57]
    v_lshlrev_b32 v16, 16, v68
    v_and_b32 v17, 0xffff0000, v68
    v_lshlrev_b32 v18, 16, v69
    v_and_b32 v19, 0xffff0000, v69
    v_lshlrev_b32 v20, 16, v70
    v_and_b32 v21, 0xffff0000, v70
    v_lshlrev_b32 v22, 16, v71
    v_and_b32 v23, 0xffff0000, v71
    v_pk_fma_f32 v[136:137], v[16:17], v[60:61], v[136:137]
    v_pk_fma_f32 v[138:139], v[18:19], v[60:61], v[138:139]
    v_pk_fma_f32 v[140:141], v[20:21], v[60:61], v[140:141]
    v_pk_fma_f32 v[142:143], v[22:23], v[60:61], v[142:143]
    v_cvt_pk_bf16_f32 v136, v136, v137
    v_cvt_pk_bf16_f32 v137, v138, v139
    v_cvt_pk_bf16_f32 v138, v140, v141
    v_cvt_pk_bf16_f32 v139, v142, v143
    buffer_store_dwordx4 v[136:139], v15, s[40:43], s67 offen offset:1024 sc1
    v_pk_mul_f32 v[144:145], v[144:145], v[56:57]
    v_pk_mul_f32 v[146:147], v[146:147], v[56:57]
    v_pk_mul_f32 v[148:149], v[148:149], v[56:57]
    v_pk_mul_f32 v[150:151], v[150:151], v[56:57]
    v_lshlrev_b32 v16, 16, v72
    v_and_b32 v17, 0xffff0000, v72
    v_lshlrev_b32 v18, 16, v73
    v_and_b32 v19, 0xffff0000, v73
    v_lshlrev_b32 v20, 16, v74
    v_and_b32 v21, 0xffff0000, v74
    v_lshlrev_b32 v22, 16, v75
    v_and_b32 v23, 0xffff0000, v75
    v_pk_fma_f32 v[144:145], v[16:17], v[60:61], v[144:145]
    v_pk_fma_f32 v[146:147], v[18:19], v[60:61], v[146:147]
    v_pk_fma_f32 v[148:149], v[20:21], v[60:61], v[148:149]
    v_pk_fma_f32 v[150:151], v[22:23], v[60:61], v[150:151]
    v_cvt_pk_bf16_f32 v144, v144, v145
    v_cvt_pk_bf16_f32 v145, v146, v147
    v_cvt_pk_bf16_f32 v146, v148, v149
    v_cvt_pk_bf16_f32 v147, v150, v151
    buffer_store_dwordx4 v[144:147], v15, s[40:43], s67 offen offset:2048 sc1
    v_pk_mul_f32 v[152:153], v[152:153], v[56:57]
    v_pk_mul_f32 v[154:155], v[154:155], v[56:57]
    v_pk_mul_f32 v[156:157], v[156:157], v[56:57]
    v_pk_mul_f32 v[158:159], v[158:159], v[56:57]
    v_lshlrev_b32 v16, 16, v76
    v_and_b32 v17, 0xffff0000, v76
    v_lshlrev_b32 v18, 16, v77
    v_and_b32 v19, 0xffff0000, v77
    v_lshlrev_b32 v20, 16, v78
    v_and_b32 v21, 0xffff0000, v78
    v_lshlrev_b32 v22, 16, v79
    v_and_b32 v23, 0xffff0000, v79
    v_pk_fma_f32 v[152:153], v[16:17], v[60:61], v[152:153]
    v_pk_fma_f32 v[154:155], v[18:19], v[60:61], v[154:155]
    v_pk_fma_f32 v[156:157], v[20:21], v[60:61], v[156:157]
    v_pk_fma_f32 v[158:159], v[22:23], v[60:61], v[158:159]
    v_cvt_pk_bf16_f32 v152, v152, v153
    v_cvt_pk_bf16_f32 v153, v154, v155
    v_cvt_pk_bf16_f32 v154, v156, v157
    v_cvt_pk_bf16_f32 v155, v158, v159
    buffer_store_dwordx4 v[152:155], v15, s[40:43], s67 offen offset:3072 sc1
    v_pk_mul_f32 v[160:161], v[160:161], v[56:57]
    v_pk_mul_f32 v[162:163], v[162:163], v[56:57]
    v_pk_mul_f32 v[164:165], v[164:165], v[56:57]
    v_pk_mul_f32 v[166:167], v[166:167], v[56:57]
    v_lshlrev_b32 v16, 16, v80
    v_and_b32 v17, 0xffff0000, v80
    v_lshlrev_b32 v18, 16, v81
    v_and_b32 v19, 0xffff0000, v81
    v_lshlrev_b32 v20, 16, v82
    v_and_b32 v21, 0xffff0000, v82
    v_lshlrev_b32 v22, 16, v83
    v_and_b32 v23, 0xffff0000, v83
    v_pk_fma_f32 v[160:161], v[16:17], v[60:61], v[160:161]
    v_pk_fma_f32 v[162:163], v[18:19], v[60:61], v[162:163]
    v_pk_fma_f32 v[164:165], v[20:21], v[60:61], v[164:165]
    v_pk_fma_f32 v[166:167], v[22:23], v[60:61], v[166:167]
    v_cvt_pk_bf16_f32 v160, v160, v161
    v_cvt_pk_bf16_f32 v161, v162, v163
    v_cvt_pk_bf16_f32 v162, v164, v165
    v_cvt_pk_bf16_f32 v163, v166, v167
    s_add_u32 s67, s79, 4096
    buffer_store_dwordx4 v[160:163], v15, s[40:43], s67 offen offset:0 sc1
    v_pk_mul_f32 v[168:169], v[168:169], v[56:57]
    v_pk_mul_f32 v[170:171], v[170:171], v[56:57]
    v_pk_mul_f32 v[172:173], v[172:173], v[56:57]
    v_pk_mul_f32 v[174:175], v[174:175], v[56:57]
    v_lshlrev_b32 v16, 16, v84
    v_and_b32 v17, 0xffff0000, v84
    v_lshlrev_b32 v18, 16, v85
    v_and_b32 v19, 0xffff0000, v85
    v_lshlrev_b32 v20, 16, v86
    v_and_b32 v21, 0xffff0000, v86
    v_lshlrev_b32 v22, 16, v87
    v_and_b32 v23, 0xffff0000, v87
    v_pk_fma_f32 v[168:169], v[16:17], v[60:61], v[168:169]
    v_pk_fma_f32 v[170:171], v[18:19], v[60:61], v[170:171]
    v_pk_fma_f32 v[172:173], v[20:21], v[60:61], v[172:173]
    v_pk_fma_f32 v[174:175], v[22:23], v[60:61], v[174:175]
    v_cvt_pk_bf16_f32 v168, v168, v169
    v_cvt_pk_bf16_f32 v169, v170, v171
    v_cvt_pk_bf16_f32 v170, v172, v173
    v_cvt_pk_bf16_f32 v171, v174, v175
    buffer_store_dwordx4 v[168:171], v15, s[40:43], s67 offen offset:1024 sc1
    v_pk_mul_f32 v[176:177], v[176:177], v[56:57]
    v_pk_mul_f32 v[178:179], v[178:179], v[56:57]
    v_pk_mul_f32 v[180:181], v[180:181], v[56:57]
    v_pk_mul_f32 v[182:183], v[182:183], v[56:57]
    v_lshlrev_b32 v16, 16, v88
    v_and_b32 v17, 0xffff0000, v88
    v_lshlrev_b32 v18, 16, v89
    v_and_b32 v19, 0xffff0000, v89
    v_lshlrev_b32 v20, 16, v90
    v_and_b32 v21, 0xffff0000, v90
    v_lshlrev_b32 v22, 16, v91
    v_and_b32 v23, 0xffff0000, v91
    v_pk_fma_f32 v[176:177], v[16:17], v[60:61], v[176:177]
    v_pk_fma_f32 v[178:179], v[18:19], v[60:61], v[178:179]
    v_pk_fma_f32 v[180:181], v[20:21], v[60:61], v[180:181]
    v_pk_fma_f32 v[182:183], v[22:23], v[60:61], v[182:183]
    v_cvt_pk_bf16_f32 v176, v176, v177
    v_cvt_pk_bf16_f32 v177, v178, v179
    v_cvt_pk_bf16_f32 v178, v180, v181
    v_cvt_pk_bf16_f32 v179, v182, v183
    buffer_store_dwordx4 v[176:179], v15, s[40:43], s67 offen offset:2048 sc1
    v_pk_mul_f32 v[184:185], v[184:185], v[56:57]
    v_pk_mul_f32 v[186:187], v[186:187], v[56:57]
    v_pk_mul_f32 v[188:189], v[188:189], v[56:57]
    v_pk_mul_f32 v[190:191], v[190:191], v[56:57]
    v_lshlrev_b32 v16, 16, v92
    v_and_b32 v17, 0xffff0000, v92
    v_lshlrev_b32 v18, 16, v93
    v_and_b32 v19, 0xffff0000, v93
    v_lshlrev_b32 v20, 16, v94
    v_and_b32 v21, 0xffff0000, v94
    v_lshlrev_b32 v22, 16, v95
    v_and_b32 v23, 0xffff0000, v95
    v_pk_fma_f32 v[184:185], v[16:17], v[60:61], v[184:185]
    v_pk_fma_f32 v[186:187], v[18:19], v[60:61], v[186:187]
    v_pk_fma_f32 v[188:189], v[20:21], v[60:61], v[188:189]
    v_pk_fma_f32 v[190:191], v[22:23], v[60:61], v[190:191]
    v_cvt_pk_bf16_f32 v184, v184, v185
    v_cvt_pk_bf16_f32 v185, v186, v187
    v_cvt_pk_bf16_f32 v186, v188, v189
    v_cvt_pk_bf16_f32 v187, v190, v191
    buffer_store_dwordx4 v[184:187], v15, s[40:43], s67 offen offset:3072 sc1
    s_waitcnt vmcnt(14)
    v_pk_mul_f32 v[192:193], v[192:193], v[58:59]
    v_pk_mul_f32 v[194:195], v[194:195], v[58:59]
    v_pk_mul_f32 v[196:197], v[196:197], v[58:59]
    v_pk_mul_f32 v[198:199], v[198:199], v[58:59]
    v_lshlrev_b32 v16, 16, v96
    v_and_b32 v17, 0xffff0000, v96
    v_lshlrev_b32 v18, 16, v97
    v_and_b32 v19, 0xffff0000, v97
    v_lshlrev_b32 v20, 16, v98
    v_and_b32 v21, 0xffff0000, v98
    v_lshlrev_b32 v22, 16, v99
    v_and_b32 v23, 0xffff0000, v99
    v_pk_fma_f32 v[192:193], v[16:17], v[62:63], v[192:193]
    v_pk_fma_f32 v[194:195], v[18:19], v[62:63], v[194:195]
    v_pk_fma_f32 v[196:197], v[20:21], v[62:63], v[196:197]
    v_pk_fma_f32 v[198:199], v[22:23], v[62:63], v[198:199]
    v_cvt_pk_bf16_f32 v192, v192, v193
    v_cvt_pk_bf16_f32 v193, v194, v195
    v_cvt_pk_bf16_f32 v194, v196, v197
    v_cvt_pk_bf16_f32 v195, v198, v199
    s_add_u32 s67, s79, 131072
    buffer_store_dwordx4 v[192:195], v15, s[40:43], s67 offen offset:0 sc1
    v_pk_mul_f32 v[200:201], v[200:201], v[58:59]
    v_pk_mul_f32 v[202:203], v[202:203], v[58:59]
    v_pk_mul_f32 v[204:205], v[204:205], v[58:59]
    v_pk_mul_f32 v[206:207], v[206:207], v[58:59]
    v_lshlrev_b32 v16, 16, v100
    v_and_b32 v17, 0xffff0000, v100
    v_lshlrev_b32 v18, 16, v101
    v_and_b32 v19, 0xffff0000, v101
    v_lshlrev_b32 v20, 16, v102
    v_and_b32 v21, 0xffff0000, v102
    v_lshlrev_b32 v22, 16, v103
    v_and_b32 v23, 0xffff0000, v103
    v_pk_fma_f32 v[200:201], v[16:17], v[62:63], v[200:201]
    v_pk_fma_f32 v[202:203], v[18:19], v[62:63], v[202:203]
    v_pk_fma_f32 v[204:205], v[20:21], v[62:63], v[204:205]
    v_pk_fma_f32 v[206:207], v[22:23], v[62:63], v[206:207]
    v_cvt_pk_bf16_f32 v200, v200, v201
    v_cvt_pk_bf16_f32 v201, v202, v203
    v_cvt_pk_bf16_f32 v202, v204, v205
    v_cvt_pk_bf16_f32 v203, v206, v207
    buffer_store_dwordx4 v[200:203], v15, s[40:43], s67 offen offset:1024 sc1
    v_pk_mul_f32 v[208:209], v[208:209], v[58:59]
    v_pk_mul_f32 v[210:211], v[210:211], v[58:59]
    v_pk_mul_f32 v[212:213], v[212:213], v[58:59]
    v_pk_mul_f32 v[214:215], v[214:215], v[58:59]
    v_lshlrev_b32 v16, 16, v104
    v_and_b32 v17, 0xffff0000, v104
    v_lshlrev_b32 v18, 16, v105
    v_and_b32 v19, 0xffff0000, v105
    v_lshlrev_b32 v20, 16, v106
    v_and_b32 v21, 0xffff0000, v106
    v_lshlrev_b32 v22, 16, v107
    v_and_b32 v23, 0xffff0000, v107
    v_pk_fma_f32 v[208:209], v[16:17], v[62:63], v[208:209]
    v_pk_fma_f32 v[210:211], v[18:19], v[62:63], v[210:211]
    v_pk_fma_f32 v[212:213], v[20:21], v[62:63], v[212:213]
    v_pk_fma_f32 v[214:215], v[22:23], v[62:63], v[214:215]
    v_cvt_pk_bf16_f32 v208, v208, v209
    v_cvt_pk_bf16_f32 v209, v210, v211
    v_cvt_pk_bf16_f32 v210, v212, v213
    v_cvt_pk_bf16_f32 v211, v214, v215
    buffer_store_dwordx4 v[208:211], v15, s[40:43], s67 offen offset:2048 sc1
    v_pk_mul_f32 v[216:217], v[216:217], v[58:59]
    v_pk_mul_f32 v[218:219], v[218:219], v[58:59]
    v_pk_mul_f32 v[220:221], v[220:221], v[58:59]
    v_pk_mul_f32 v[222:223], v[222:223], v[58:59]
    v_lshlrev_b32 v16, 16, v108
    v_and_b32 v17, 0xffff0000, v108
    v_lshlrev_b32 v18, 16, v109
    v_and_b32 v19, 0xffff0000, v109
    v_lshlrev_b32 v20, 16, v110
    v_and_b32 v21, 0xffff0000, v110
    v_lshlrev_b32 v22, 16, v111
    v_and_b32 v23, 0xffff0000, v111
    v_pk_fma_f32 v[216:217], v[16:17], v[62:63], v[216:217]
    v_pk_fma_f32 v[218:219], v[18:19], v[62:63], v[218:219]
    v_pk_fma_f32 v[220:221], v[20:21], v[62:63], v[220:221]
    v_pk_fma_f32 v[222:223], v[22:23], v[62:63], v[222:223]
    v_cvt_pk_bf16_f32 v216, v216, v217
    v_cvt_pk_bf16_f32 v217, v218, v219
    v_cvt_pk_bf16_f32 v218, v220, v221
    v_cvt_pk_bf16_f32 v219, v222, v223
    buffer_store_dwordx4 v[216:219], v15, s[40:43], s67 offen offset:3072 sc1
    v_pk_mul_f32 v[224:225], v[224:225], v[58:59]
    v_pk_mul_f32 v[226:227], v[226:227], v[58:59]
    v_pk_mul_f32 v[228:229], v[228:229], v[58:59]
    v_pk_mul_f32 v[230:231], v[230:231], v[58:59]
    v_lshlrev_b32 v16, 16, v112
    v_and_b32 v17, 0xffff0000, v112
    v_lshlrev_b32 v18, 16, v113
    v_and_b32 v19, 0xffff0000, v113
    v_lshlrev_b32 v20, 16, v114
    v_and_b32 v21, 0xffff0000, v114
    v_lshlrev_b32 v22, 16, v115
    v_and_b32 v23, 0xffff0000, v115
    v_pk_fma_f32 v[224:225], v[16:17], v[62:63], v[224:225]
    v_pk_fma_f32 v[226:227], v[18:19], v[62:63], v[226:227]
    v_pk_fma_f32 v[228:229], v[20:21], v[62:63], v[228:229]
    v_pk_fma_f32 v[230:231], v[22:23], v[62:63], v[230:231]
    v_cvt_pk_bf16_f32 v224, v224, v225
    v_cvt_pk_bf16_f32 v225, v226, v227
    v_cvt_pk_bf16_f32 v226, v228, v229
    v_cvt_pk_bf16_f32 v227, v230, v231
    s_add_u32 s67, s79, 135168
    buffer_store_dwordx4 v[224:227], v15, s[40:43], s67 offen offset:0 sc1
    v_pk_mul_f32 v[232:233], v[232:233], v[58:59]
    v_pk_mul_f32 v[234:235], v[234:235], v[58:59]
    v_pk_mul_f32 v[236:237], v[236:237], v[58:59]
    v_pk_mul_f32 v[238:239], v[238:239], v[58:59]
    v_lshlrev_b32 v16, 16, v116
    v_and_b32 v17, 0xffff0000, v116
    v_lshlrev_b32 v18, 16, v117
    v_and_b32 v19, 0xffff0000, v117
    v_lshlrev_b32 v20, 16, v118
    v_and_b32 v21, 0xffff0000, v118
    v_lshlrev_b32 v22, 16, v119
    v_and_b32 v23, 0xffff0000, v119
    v_pk_fma_f32 v[232:233], v[16:17], v[62:63], v[232:233]
    v_pk_fma_f32 v[234:235], v[18:19], v[62:63], v[234:235]
    v_pk_fma_f32 v[236:237], v[20:21], v[62:63], v[236:237]
    v_pk_fma_f32 v[238:239], v[22:23], v[62:63], v[238:239]
    v_cvt_pk_bf16_f32 v232, v232, v233
    v_cvt_pk_bf16_f32 v233, v234, v235
    v_cvt_pk_bf16_f32 v234, v236, v237
    v_cvt_pk_bf16_f32 v235, v238, v239
    buffer_store_dwordx4 v[232:235], v15, s[40:43], s67 offen offset:1024 sc1
    v_pk_mul_f32 v[240:241], v[240:241], v[58:59]
    v_pk_mul_f32 v[242:243], v[242:243], v[58:59]
    v_pk_mul_f32 v[244:245], v[244:245], v[58:59]
    v_pk_mul_f32 v[246:247], v[246:247], v[58:59]
    v_lshlrev_b32 v16, 16, v120
    v_and_b32 v17, 0xffff0000, v120
    v_lshlrev_b32 v18, 16, v121
    v_and_b32 v19, 0xffff0000, v121
    v_lshlrev_b32 v20, 16, v122
    v_and_b32 v21, 0xffff0000, v122
    v_lshlrev_b32 v22, 16, v123
    v_and_b32 v23, 0xffff0000, v123
    v_pk_fma_f32 v[240:241], v[16:17], v[62:63], v[240:241]
    v_pk_fma_f32 v[242:243], v[18:19], v[62:63], v[242:243]
    v_pk_fma_f32 v[244:245], v[20:21], v[62:63], v[244:245]
    v_pk_fma_f32 v[246:247], v[22:23], v[62:63], v[246:247]
    v_cvt_pk_bf16_f32 v240, v240, v241
    v_cvt_pk_bf16_f32 v241, v242, v243
    v_cvt_pk_bf16_f32 v242, v244, v245
    v_cvt_pk_bf16_f32 v243, v246, v247
    buffer_store_dwordx4 v[240:243], v15, s[40:43], s67 offen offset:2048 sc1
    v_pk_mul_f32 v[248:249], v[248:249], v[58:59]
    v_pk_mul_f32 v[250:251], v[250:251], v[58:59]
    v_pk_mul_f32 v[252:253], v[252:253], v[58:59]
    v_pk_mul_f32 v[254:255], v[254:255], v[58:59]
    v_lshlrev_b32 v16, 16, v124
    v_and_b32 v17, 0xffff0000, v124
    v_lshlrev_b32 v18, 16, v125
    v_and_b32 v19, 0xffff0000, v125
    v_lshlrev_b32 v20, 16, v126
    v_and_b32 v21, 0xffff0000, v126
    v_lshlrev_b32 v22, 16, v127
    v_and_b32 v23, 0xffff0000, v127
    v_pk_fma_f32 v[248:249], v[16:17], v[62:63], v[248:249]
    v_pk_fma_f32 v[250:251], v[18:19], v[62:63], v[250:251]
    v_pk_fma_f32 v[252:253], v[20:21], v[62:63], v[252:253]
    v_pk_fma_f32 v[254:255], v[22:23], v[62:63], v[254:255]
    v_cvt_pk_bf16_f32 v248, v248, v249
    v_cvt_pk_bf16_f32 v249, v250, v251
    v_cvt_pk_bf16_f32 v250, v252, v253
    v_cvt_pk_bf16_f32 v251, v254, v255
    buffer_store_dwordx4 v[248:251], v15, s[40:43], s67 offen offset:3072 sc1
F_p3:
    s_waitcnt lgkmcnt(0)
    s_lshl_b32 s79, s46, 11
    s_add_u32 s79, s79, 83361792
    s_cmp_eq_u32 s47, 7
    s_cselect_b32 s79, s79, s8
    v_lshlrev_b32 v25, 3, v15
    v_and_b32 v25, 2047, v25
    buffer_load_dword v24, v25, s[40:43], s79 offen sc1
    s_add_u32 s67, s45, 57344
    buffer_load_dwordx4 a[160:163], v15, s[40:43], s67 offen offset:0 sc1
    buffer_load_dwordx4 a[164:167], v15, s[40:43], s67 offen offset:1024 sc1
    buffer_load_dwordx4 a[168:171], v15, s[40:43], s67 offen offset:2048 sc1
    buffer_load_dwordx4 a[172:175], v15, s[40:43], s67 offen offset:3072 sc1
    s_add_u32 s67, s45, 61440
    buffer_load_dwordx4 a[176:179], v15, s[40:43], s67 offen offset:0 sc1
    buffer_load_dwordx4 a[180:183], v15, s[40:43], s67 offen offset:1024 sc1
    buffer_load_dwordx4 a[184:187], v15, s[40:43], s67 offen offset:2048 sc1
    buffer_load_dwordx4 a[188:191], v15, s[40:43], s67 offen offset:3072 sc1
    s_load_dwordx2 s[36:37], s[0:1], 80
    s_lshl_b32 s62, s18, 1
    s_lshr_b32 s66, s29, 1
    s_add_u32 s62, s62, s66
    s_lshl_b32 s62, s62, 4
    s_add_u32 s62, s62, s26
    s_lshl_b32 s62, s62, 1
    s_and_b32 s66, s29, 1
    s_add_u32 s62, s62, s66
    s_lshl_b32 s62, s62, 7
    s_add_u32 s62, s62, 83165184
    s_add_u32 s63, s50, 0
    s_and_b32 s63, s63, 0x1ffff
    s_add_u32 s63, s63, s20
    s_add_u32 s65, s50, 32768
    s_and_b32 s65, s65, 0x1ffff
    s_add_u32 s65, s65, s20
    s_add_u32 s74, s50, 65536
    s_and_b32 s74, s74, 0x1ffff
    s_add_u32 s74, s74, s20
    s_add_u32 s75, s50, 98304
    s_and_b32 s75, s75, 0x1ffff
    s_add_u32 s75, s75, s20
    s_add_u32 s69, s20, 131072
    s_lshl_b32 s23, s22, 1
    s_sub_u32 s23, s45, s23
    v_lshrrev_b32 v1, 4, v15
    v_add_u32 v32, s63, v15
    v_add_u32 v33, s65, v15
    v_add_u32 v34, s74, v15
    v_add_u32 v35, s75, v15
    v_add_u32 v36, s69, v15
    s_lshl_b32 s66, s28, 1
    s_add_u32 s66, s66, s29
    s_cmp_ge_u32 s66, 2
    s_cbranch_scc1 F_p3e
    s_waitcnt vmcnt(9)
F_p3e:
    s_waitcnt vmcnt(25)
    ds_read_b128 a[0:3], v32 offset:0
    ds_read_b128 a[4:7], v32 offset:1024
    ds_read_b128 a[8:11], v32 offset:2048
    ds_read_b128 a[12:15], v32 offset:3072
    ds_read_b128 a[16:19], v32 offset:4096
    ds_read_b128 a[20:23], v32 offset:5120
    ds_read_b128 a[24:27], v32 offset:6144
    ds_read_b128 a[28:31], v32 offset:7168
    ds_read_b128 a[32:35], v33 offset:0
    ds_read_b128 a[36:39], v33 offset:1024
    ds_read_b128 a[40:43], v33 offset:2048
    ds_read_b128 a[44:47], v33 offset:3072
    ds_read_b128 a[48:51], v33 offset:4096
    ds_read_b128 a[52:55], v33 offset:5120
    ds_read_b128 a[56:59], v33 offset:6144
    ds_read_b128 a[60:63], v33 offset:7168
    ds_read_b128 a[64:67], v34 offset:0
    ds_read_b128 a[68:71], v34 offset:1024
    ds_read_b128 a[72:75], v34 offset:2048
    ds_read_b128 a[76:79], v34 offset:3072
    ds_read_b128 a[80:83], v34 offset:4096
    ds_read_b128 a[84:87], v34 offset:5120
    ds_read_b128 a[88:91], v34 offset:6144
    ds_read_b128 a[92:95], v34 offset:7168
    ds_read_b128 a[128:131], v36 offset:0
    ds_read_b128 a[132:135], v36 offset:1024
    ds_read_b128 a[136:139], v36 offset:2048
    ds_read_b128 a[140:143], v36 offset:3072
    ds_read_b128 a[144:147], v36 offset:4096
    ds_read_b128 a[148:151], v36 offset:5120
    ds_read_b128 a[152:155], v36 offset:6144
    ds_read_b128 a[156:159], v36 offset:7168
F_p3t:
    s_cmp_lt_u32 s29, 2
    s_cbranch_scc1 F_p3v
    ds_read_b128 a[96:99], v35 offset:0
    ds_read_b128 a[100:103], v35 offset:1024
    ds_read_b128 a[104:107], v35 offset:2048
    ds_read_b128 a[108:111], v35 offset:3072
    ds_read_b128 a[112:115], v35 offset:4096
    ds_read_b128 a[116:119], v35 offset:5120
    ds_read_b128 a[120:123], v35 offset:6144
    ds_read_b128 a[124:127], v35 offset:7168
    s_branch F_p3k
F_p3v:
    s_add_u32 s67, s45, 40960
    buffer_load_dwordx4 a[96:99], v15, s[40:43], s67 offen offset:0 sc1
    buffer_load_dwordx4 a[100:103], v15, s[40:43], s67 offen offset:1024 sc1
    buffer_load_dwordx4 a[104:107], v15, s[40:43], s67 offen offset:2048 sc1
    buffer_load_dwordx4 a[108:111], v15, s[40:43], s67 offen offset:3072 sc1
    s_add_u32 s67, s45, 45056
    buffer_load_dwordx4 a[112:115], v15, s[40:43], s67 offen offset:0 sc1
    buffer_load_dwordx4 a[116:119], v15, s[40:43], s67 offen offset:1024 sc1
    buffer_load_dwordx4 a[120:123], v15, s[40:43], s67 offen offset:2048 sc1
    buffer_load_dwordx4 a[124:127], v15, s[40:43], s67 offen offset:3072 sc1
F_p3k:
    s_waitcnt lgkmcnt(0)
    s_mov_b32 s32, s36
    s_and_b32 s33, s37, 0xffff
    s_mov_b32 s34, 3670016
    s_mov_b32 s35, 0x20000
    s_cmp_eq_u32 s47, 7
    s_cbranch_scc1 F_p3b
    s_lshl_b32 s58, s46, 19
    s_lshl_b32 s66, s29, 15
    s_add_u32 s58, s58, s66
    s_add_u32 s58, s58, 50331648
    v_add_u32 v8, 0, v15
    v_add_u32 v9, 131072, v15
    v_add_u32 v10, 262144, v15
    v_add_u32 v11, 393216, v15
    s_lshl_b32 s79, s46, 12
    s_lshl_b32 s66, s29, 10
    s_add_u32 s79, s79, s66
    s_add_u32 s79, s79, 83165184
    v_lshlrev_b32 v25, 3, v15
    v_and_b32 v25, 1023, v25
    s_add_u32 m0, s65, 0
    s_add_u32 s67, s23, 65536
    buffer_load_dwordx4 v15, s[40:43], s67 offen offset:0 sc1 lds
    buffer_load_dwordx4 v15, s[40:43], s67 offen offset:1024 sc1 lds
    buffer_load_dwordx4 v15, s[40:43], s67 offen offset:2048 sc1 lds
    buffer_load_dwordx4 v15, s[40:43], s67 offen offset:3072 sc1 lds
    s_add_u32 m0, s65, 4096
    s_add_u32 s67, s23, 69632
    buffer_load_dwordx4 v15, s[40:43], s67 offen offset:0 sc1 lds
    buffer_load_dwordx4 v15, s[40:43], s67 offen offset:1024 sc1 lds
    buffer_load_dwordx4 v15, s[40:43], s67 offen offset:2048 sc1 lds
    buffer_load_dwordx4 v15, s[40:43], s67 offen offset:3072 sc1 lds
    s_waitcnt vmcnt(17)
    buffer_store_dword v4, v3, s[40:43], s62 offen sc1
    s_add_u32 m0, s74, 0
    s_add_u32 s67, s23, 73728
    buffer_load_dwordx4 v15, s[40:43], s67 offen offset:0 sc1 lds
    buffer_load_dwordx4 v15, s[40:43], s67 offen offset:1024 sc1 lds
    buffer_load_dwordx4 v15, s[40:43], s67 offen offset:2048 sc1 lds
    buffer_load_dwordx4 v15, s[40:43], s67 offen offset:3072 sc1 lds
    s_add_u32 m0, s74, 4096
    s_add_u32 s67, s23, 77824
    buffer_load_dwordx4 v15, s[40:43], s67 offen offset:0 sc1 lds
    buffer_load_dwordx4 v15, s[40:43], s67 offen offset:1024 sc1 lds
    buffer_load_dwordx4 v15, s[40:43], s67 offen offset:2048 sc1 lds
    buffer_load_dwordx4 v15, s[40:43], s67 offen offset:3072 sc1 lds
    s_barrier
    s_cmp_eq_u32 s28, 0
    s_cbranch_scc1 F_p3w
    s_add_u32 s67, s23, 114688
    buffer_load_dwordx4 v[64:67], v15, s[40:43], s67 offen offset:0 sc1
    buffer_load_dwordx4 v[68:71], v15, s[40:43], s67 offen offset:1024 sc1
    buffer_load_dwordx4 v[72:75], v15, s[40:43], s67 offen offset:2048 sc1
    buffer_load_dwordx4 v[76:79], v15, s[40:43], s67 offen offset:3072 sc1
    s_add_u32 s67, s23, 118784
    buffer_load_dwordx4 v[80:83], v15, s[40:43], s67 offen offset:0 sc1
    buffer_load_dwordx4 v[84:87], v15, s[40:43], s67 offen offset:1024 sc1
    buffer_load_dwordx4 v[88:91], v15, s[40:43], s67 offen offset:2048 sc1
    buffer_load_dwordx4 v[92:95], v15, s[40:43], s67 offen offset:3072 sc1
    s_add_u32 s67, s23, 122880
    buffer_load_dwordx4 v[96:99], v15, s[40:43], s67 offen offset:0 sc1
    buffer_load_dwordx4 v[100:103], v15, s[40:43], s67 offen offset:1024 sc1
    buffer_load_dwordx4 v[104:107], v15, s[40:43], s67 offen offset:2048 sc1
    buffer_load_dwordx4 v[108:111], v15, s[40:43], s67 offen offset:3072 sc1
    s_add_u32 s67, s23, 126976
    buffer_load_dwordx4 v[112:115], v15, s[40:43], s67 offen offset:0 sc1
    buffer_load_dwordx4 v[116:119], v15, s[40:43], s67 offen offset:1024 sc1
    buffer_load_dwordx4 v[120:123], v15, s[40:43], s67 offen offset:2048 sc1
    buffer_load_dwordx4 v[124:127], v15, s[40:43], s67 offen offset:3072 sc1
F_p3w:
    s_add_u32 m0, s69, 0
    s_add_u32 s67, s23, 90112
    buffer_load_dwordx4 v15, s[40:43], s67 offen offset:0 sc1 lds
    buffer_load_dwordx4 v15, s[40:43], s67 offen offset:1024 sc1 lds
    buffer_load_dwordx4 v15, s[40:43], s67 offen offset:2048 sc1 lds
    buffer_load_dwordx4 v15, s[40:43], s67 offen offset:3072 sc1 lds
    s_add_u32 m0, s69, 4096
    s_add_u32 s67, s23, 94208
    buffer_load_dwordx4 v15, s[40:43], s67 offen offset:0 sc1 lds
    buffer_load_dwordx4 v15, s[40:43], s67 offen offset:1024 sc1 lds
    buffer_load_dwordx4 v15, s[40:43], s67 offen offset:2048 sc1 lds
    buffer_load_dwordx4 v15, s[40:43], s67 offen offset:3072 sc1 lds
    s_add_u32 m0, s63, 0
    s_add_u32 s67, s23, 98304
    buffer_load_dwordx4 v15, s[40:43], s67 offen offset:0 sc1 lds
    buffer_load_dwordx4 v15, s[40:43], s67 offen offset:1024 sc1 lds
    buffer_load_dwordx4 v15, s[40:43], s67 offen offset:2048 sc1 lds
    buffer_load_dwordx4 v15, s[40:43], s67 offen offset:3072 sc1 lds
    s_add_u32 m0, s63, 4096
    s_add_u32 s67, s23, 102400
    buffer_load_dwordx4 v15, s[40:43], s67 offen offset:0 sc1 lds
    buffer_load_dwordx4 v15, s[40:43], s67 offen offset:1024 sc1 lds
    buffer_load_dwordx4 v15, s[40:43], s67 offen offset:2048 sc1 lds
    buffer_load_dwordx4 v15, s[40:43], s67 offen offset:3072 sc1 lds
    s_add_u32 m0, s75, 0
    s_add_u32 s67, s23, 81920
    buffer_load_dwordx4 v15, s[40:43], s67 offen offset:0 sc1 lds
    buffer_load_dwordx4 v15, s[40:43], s67 offen offset:1024 sc1 lds
    buffer_load_dwordx4 v15, s[40:43], s67 offen offset:2048 sc1 lds
    buffer_load_dwordx4 v15, s[40:43], s67 offen offset:3072 sc1 lds
    buffer_load_dword v24, v25, s[40:43], s79 offen sc1
    s_add_u32 m0, s75, 4096
    s_add_u32 s67, s23, 86016
    buffer_load_dwordx4 v15, s[40:43], s67 offen offset:0 sc1 lds
    buffer_load_dwordx4 v15, s[40:43], s67 offen offset:1024 sc1 lds
    buffer_load_dwordx4 v15, s[40:43], s67 offen offset:2048 sc1 lds
    buffer_load_dwordx4 v15, s[40:43], s67 offen offset:3072 sc1 lds
    s_add_u32 s67, s23, 110592
    buffer_load_dwordx4 v[240:243], v15, s[40:43], s67 offen offset:0 sc1
    buffer_load_dwordx4 v[244:247], v15, s[40:43], s67 offen offset:1024 sc1
    buffer_load_dwordx4 v[248:251], v15, s[40:43], s67 offen offset:2048 sc1
    buffer_load_dwordx4 v[252:255], v15, s[40:43], s67 offen offset:3072 sc1
    s_waitcnt vmcnt(8)
    v_cmp_gt_u32 vcc, 1, v24
    s_nop 0
    s_cmp_lg_u64 vcc, 0
    s_cbranch_scc1 F_spin20
F_spin20r:
    buffer_load_dwordx4 v[192:195], v8, s[40:43], s58 offen offset:0 sc1
    buffer_load_dwordx4 v[196:199], v9, s[40:43], s58 offen offset:0 sc1
    buffer_load_dwordx4 v[200:203], v10, s[40:43], s58 offen offset:0 sc1
    buffer_load_dwordx4 v[204:207], v11, s[40:43], s58 offen offset:0 sc1
    s_add_u32 s58, s58, 1024
    buffer_load_dwordx4 v[208:211], v8, s[40:43], s58 offen offset:0 sc1
    buffer_load_dwordx4 v[212:215], v9, s[40:43], s58 offen offset:0 sc1
    buffer_load_dwordx4 v[216:219], v10, s[40:43], s58 offen offset:0 sc1
    buffer_load_dwordx4 v[220:223], v11, s[40:43], s58 offen offset:0 sc1
    s_add_u32 s58, s58, 1024
    buffer_load_dwordx4 v[224:227], v8, s[40:43], s58 offen offset:0 sc1
    buffer_load_dwordx4 v[228:231], v9, s[40:43], s58 offen offset:0 sc1
    buffer_load_dwordx4 v[232:235], v10, s[40:43], s58 offen offset:0 sc1
    buffer_load_dwordx4 v[236:239], v11, s[40:43], s58 offen offset:0 sc1
    s_add_u32 s58, s58, 1024
    v_lshrrev_b32 v24, 5, v1
    v_lshlrev_b32 v24, 5, v24
    v_xor_b32 v24, v24, v15
    v_add_u32 v44, s20, v24
    v_xor_b32 v45, 64, v44
    v_xor_b32 v46, 128, v44
    v_xor_b32 v47, 192, v44
    v_lshrrev_b32 v25, 3, v1
    v_and_b32 v26, 7, v1
    v_lshlrev_b32 v27, 1, v26
    v_xor_b32 v27, v27, v25
    v_lshlrev_b32 v27, 4, v27
    v_lshl_add_u32 v27, v26, 9, v27
    s_and_b32 s66, s29, 1
    s_lshl_b32 s66, s66, 12
    s_lshr_b32 s67, s29, 1
    s_lshl_b32 s67, s67, 15
    s_add_u32 s66, s66, s67
    v_add_u32 v27, s66, v27
    v_xor_b32 v28, 128, v27
    s_waitcnt vmcnt(8) lgkmcnt(0)
    v_mfma_f32_16x16x32_bf16 v[128:131], a[192:195], v[192:195], 0
    v_mfma_f32_16x16x32_bf16 v[132:135], a[196:199], v[192:195], 0
    v_mfma_f32_16x16x32_bf16 v[136:139], a[200:203], v[192:195], 0
    v_mfma_f32_16x16x32_bf16 v[140:143], a[204:207], v[192:195], 0
    buffer_load_dwordx4 v[192:195], v8, s[40:43], s58 offen offset:0 sc1
    v_mfma_f32_16x16x32_bf16 v[156:159], a[204:207], v[196:199], 0
    v_mfma_f32_16x16x32_bf16 v[152:155], a[200:203], v[196:199], 0
    v_mfma_f32_16x16x32_bf16 v[148:151], a[196:199], v[196:199], 0
    v_mfma_f32_16x16x32_bf16 v[144:147], a[192:195], v[196:199], 0
    buffer_load_dwordx4 v[196:199], v9, s[40:43], s58 offen offset:0 sc1
    v_mfma_f32_16x16x32_bf16 v[160:163], a[192:195], v[200:203], 0
    v_mfma_f32_16x16x32_bf16 v[164:167], a[196:199], v[200:203], 0
    v_mfma_f32_16x16x32_bf16 v[168:171], a[200:203], v[200:203], 0
    v_mfma_f32_16x16x32_bf16 v[172:175], a[204:207], v[200:203], 0
    buffer_load_dwordx4 v[200:203], v10, s[40:43], s58 offen offset:0 sc1
    v_mfma_f32_16x16x32_bf16 v[188:191], a[204:207], v[204:207], 0
    v_mfma_f32_16x16x32_bf16 v[184:187], a[200:203], v[204:207], 0
    v_mfma_f32_16x16x32_bf16 v[180:183], a[196:199], v[204:207], 0
    v_mfma_f32_16x16x32_bf16 v[176:179], a[192:195], v[204:207], 0
    buffer_load_dwordx4 v[204:207], v11, s[40:43], s58 offen offset:0 sc1
    s_add_u32 s58, s58, 1024
    s_waitcnt vmcnt(8) lgkmcnt(0)
    v_mfma_f32_16x16x32_bf16 v[128:131], a[208:211], v[208:211], v[128:131]
    v_mfma_f32_16x16x32_bf16 v[132:135], a[212:215], v[208:211], v[132:135]
    ds_read_b128 a[192:195], v33 offset:0
    v_mfma_f32_16x16x32_bf16 v[136:139], a[216:219], v[208:211], v[136:139]
    v_mfma_f32_16x16x32_bf16 v[140:143], a[220:223], v[208:211], v[140:143]
    buffer_load_dwordx4 v[208:211], v8, s[40:43], s58 offen offset:0 sc1
    v_mfma_f32_16x16x32_bf16 v[156:159], a[220:223], v[212:215], v[156:159]
    v_mfma_f32_16x16x32_bf16 v[152:155], a[216:219], v[212:215], v[152:155]
    ds_read_b128 a[196:199], v33 offset:1024
    v_mfma_f32_16x16x32_bf16 v[148:151], a[212:215], v[212:215], v[148:151]
    v_mfma_f32_16x16x32_bf16 v[144:147], a[208:211], v[212:215], v[144:147]
    buffer_load_dwordx4 v[212:215], v9, s[40:43], s58 offen offset:0 sc1
    v_mfma_f32_16x16x32_bf16 v[160:163], a[208:211], v[216:219], v[160:163]
    v_mfma_f32_16x16x32_bf16 v[164:167], a[212:215], v[216:219], v[164:167]
    ds_read_b128 a[200:203], v33 offset:2048
    v_mfma_f32_16x16x32_bf16 v[168:171], a[216:219], v[216:219], v[168:171]
    v_mfma_f32_16x16x32_bf16 v[172:175], a[220:223], v[216:219], v[172:175]
    buffer_load_dwordx4 v[216:219], v10, s[40:43], s58 offen offset:0 sc1
    v_mfma_f32_16x16x32_bf16 v[188:191], a[220:223], v[220:223], v[188:191]
    v_mfma_f32_16x16x32_bf16 v[184:187], a[216:219], v[220:223], v[184:187]
    ds_read_b128 a[204:207], v33 offset:3072
    v_mfma_f32_16x16x32_bf16 v[180:183], a[212:215], v[220:223], v[180:183]
    v_mfma_f32_16x16x32_bf16 v[176:179], a[208:211], v[220:223], v[176:179]
    buffer_load_dwordx4 v[220:223], v11, s[40:43], s58 offen offset:0 sc1
    s_add_u32 s58, s58, 1024
    s_waitcnt vmcnt(8) lgkmcnt(0)
    v_mfma_f32_16x16x32_bf16 v[128:131], a[224:227], v[224:227], v[128:131]
    v_mfma_f32_16x16x32_bf16 v[132:135], a[228:231], v[224:227], v[132:135]
    ds_read_b128 a[208:211], v33 offset:4096
    v_mfma_f32_16x16x32_bf16 v[136:139], a[232:235], v[224:227], v[136:139]
    v_mfma_f32_16x16x32_bf16 v[140:143], a[236:239], v[224:227], v[140:143]
    buffer_load_dwordx4 v[224:227], v8, s[40:43], s58 offen offset:0 sc1
    v_mfma_f32_16x16x32_bf16 v[156:159], a[236:239], v[228:231], v[156:159]
    v_mfma_f32_16x16x32_bf16 v[152:155], a[232:235], v[228:231], v[152:155]
    ds_read_b128 a[212:215], v33 offset:5120
    v_mfma_f32_16x16x32_bf16 v[148:151], a[228:231], v[228:231], v[148:151]
    v_mfma_f32_16x16x32_bf16 v[144:147], a[224:227], v[228:231], v[144:147]
    buffer_load_dwordx4 v[228:231], v9, s[40:43], s58 offen offset:0 sc1
    v_mfma_f32_16x16x32_bf16 v[160:163], a[224:227], v[232:235], v[160:163]
    v_mfma_f32_16x16x32_bf16 v[164:167], a[228:231], v[232:235], v[164:167]
    ds_read_b128 a[216:219], v33 offset:6144
    v_mfma_f32_16x16x32_bf16 v[168:171], a[232:235], v[232:235], v[168:171]
    v_mfma_f32_16x16x32_bf16 v[172:175], a[236:239], v[232:235], v[172:175]
    buffer_load_dwordx4 v[232:235], v10, s[40:43], s58 offen offset:0 sc1
    v_mfma_f32_16x16x32_bf16 v[188:191], a[236:239], v[236:239], v[188:191]
    v_mfma_f32_16x16x32_bf16 v[184:187], a[232:235], v[236:239], v[184:187]
    ds_read_b128 a[220:223], v33 offset:7168
    v_mfma_f32_16x16x32_bf16 v[180:183], a[228:231], v[236:239], v[180:183]
    v_mfma_f32_16x16x32_bf16 v[176:179], a[224:227], v[236:239], v[176:179]
    buffer_load_dwordx4 v[236:239], v11, s[40:43], s58 offen offset:0 sc1
    s_add_u32 s58, s58, 1024
    s_waitcnt vmcnt(8) lgkmcnt(0)
    v_mfma_f32_16x16x32_bf16 v[128:131], a[240:243], v[192:195], v[128:131]
    v_mfma_f32_16x16x32_bf16 v[132:135], a[244:247], v[192:195], v[132:135]
    ds_read_b128 a[224:227], v34 offset:0
    v_mfma_f32_16x16x32_bf16 v[136:139], a[248:251], v[192:195], v[136:139]
    v_mfma_f32_16x16x32_bf16 v[140:143], a[252:255], v[192:195], v[140:143]
    buffer_load_dwordx4 v[192:195], v8, s[40:43], s58 offen offset:0 sc1
    v_mfma_f32_16x16x32_bf16 v[156:159], a[252:255], v[196:199], v[156:159]
    v_mfma_f32_16x16x32_bf16 v[152:155], a[248:251], v[196:199], v[152:155]
    ds_read_b128 a[228:231], v34 offset:1024
    v_mfma_f32_16x16x32_bf16 v[148:151], a[244:247], v[196:199], v[148:151]
    v_mfma_f32_16x16x32_bf16 v[144:147], a[240:243], v[196:199], v[144:147]
    buffer_load_dwordx4 v[196:199], v9, s[40:43], s58 offen offset:0 sc1
    v_mfma_f32_16x16x32_bf16 v[160:163], a[240:243], v[200:203], v[160:163]
    v_mfma_f32_16x16x32_bf16 v[164:167], a[244:247], v[200:203], v[164:167]
    ds_read_b128 a[232:235], v34 offset:2048
    v_mfma_f32_16x16x32_bf16 v[168:171], a[248:251], v[200:203], v[168:171]
    v_mfma_f32_16x16x32_bf16 v[172:175], a[252:255], v[200:203], v[172:175]
    buffer_load_dwordx4 v[200:203], v10, s[40:43], s58 offen offset:0 sc1
    v_mfma_f32_16x16x32_bf16 v[188:191], a[252:255], v[204:207], v[188:191]
    v_mfma_f32_16x16x32_bf16 v[184:187], a[248:251], v[204:207], v[184:187]
    ds_read_b128 a[236:239], v34 offset:3072
    v_mfma_f32_16x16x32_bf16 v[180:183], a[244:247], v[204:207], v[180:183]
    v_mfma_f32_16x16x32_bf16 v[176:179], a[240:243], v[204:207], v[176:179]
    buffer_load_dwordx4 v[204:207], v11, s[40:43], s58 offen offset:0 sc1
    s_add_u32 s58, s58, 1024
    s_waitcnt vmcnt(8) lgkmcnt(0)
    v_mfma_f32_16x16x32_bf16 v[128:131], a[0:3], v[208:211], v[128:131]
    v_mfma_f32_16x16x32_bf16 v[132:135], a[4:7], v[208:211], v[132:135]
    ds_read_b128 a[240:243], v34 offset:4096
    v_mfma_f32_16x16x32_bf16 v[136:139], a[8:11], v[208:211], v[136:139]
    v_mfma_f32_16x16x32_bf16 v[140:143], a[12:15], v[208:211], v[140:143]
    buffer_load_dwordx4 v[208:211], v8, s[40:43], s58 offen offset:0 sc1
    v_mfma_f32_16x16x32_bf16 v[156:159], a[12:15], v[212:215], v[156:159]
    v_mfma_f32_16x16x32_bf16 v[152:155], a[8:11], v[212:215], v[152:155]
    ds_read_b128 a[244:247], v34 offset:5120
    v_mfma_f32_16x16x32_bf16 v[148:151], a[4:7], v[212:215], v[148:151]
    v_mfma_f32_16x16x32_bf16 v[144:147], a[0:3], v[212:215], v[144:147]
    buffer_load_dwordx4 v[212:215], v9, s[40:43], s58 offen offset:0 sc1
    v_mfma_f32_16x16x32_bf16 v[160:163], a[0:3], v[216:219], v[160:163]
    v_mfma_f32_16x16x32_bf16 v[164:167], a[4:7], v[216:219], v[164:167]
    ds_read_b128 a[248:251], v34 offset:6144
    v_mfma_f32_16x16x32_bf16 v[168:171], a[8:11], v[216:219], v[168:171]
    v_mfma_f32_16x16x32_bf16 v[172:175], a[12:15], v[216:219], v[172:175]
    buffer_load_dwordx4 v[216:219], v10, s[40:43], s58 offen offset:0 sc1
    v_mfma_f32_16x16x32_bf16 v[188:191], a[12:15], v[220:223], v[188:191]
    v_mfma_f32_16x16x32_bf16 v[184:187], a[8:11], v[220:223], v[184:187]
    ds_read_b128 a[252:255], v34 offset:7168
    v_mfma_f32_16x16x32_bf16 v[180:183], a[4:7], v[220:223], v[180:183]
    v_mfma_f32_16x16x32_bf16 v[176:179], a[0:3], v[220:223], v[176:179]
    buffer_load_dwordx4 v[220:223], v11, s[40:43], s58 offen offset:0 sc1
    s_add_u32 s58, s58, 1024
    s_waitcnt vmcnt(8) lgkmcnt(0)
    v_mfma_f32_16x16x32_bf16 v[128:131], a[16:19], v[224:227], v[128:131]
    v_mfma_f32_16x16x32_bf16 v[132:135], a[20:23], v[224:227], v[132:135]
    ds_read_b128 a[0:3], v35 offset:0
    v_mfma_f32_16x16x32_bf16 v[136:139], a[24:27], v[224:227], v[136:139]
    v_mfma_f32_16x16x32_bf16 v[140:143], a[28:31], v[224:227], v[140:143]
    buffer_load_dwordx4 v[224:227], v8, s[40:43], s58 offen offset:0 sc1
    v_mfma_f32_16x16x32_bf16 v[156:159], a[28:31], v[228:231], v[156:159]
    v_mfma_f32_16x16x32_bf16 v[152:155], a[24:27], v[228:231], v[152:155]
    ds_read_b128 a[4:7], v35 offset:1024
    v_mfma_f32_16x16x32_bf16 v[148:151], a[20:23], v[228:231], v[148:151]
    v_mfma_f32_16x16x32_bf16 v[144:147], a[16:19], v[228:231], v[144:147]
    buffer_load_dwordx4 v[228:231], v9, s[40:43], s58 offen offset:0 sc1
    v_mfma_f32_16x16x32_bf16 v[160:163], a[16:19], v[232:235], v[160:163]
    v_mfma_f32_16x16x32_bf16 v[164:167], a[20:23], v[232:235], v[164:167]
    ds_read_b128 a[8:11], v35 offset:2048
    v_mfma_f32_16x16x32_bf16 v[168:171], a[24:27], v[232:235], v[168:171]
    v_mfma_f32_16x16x32_bf16 v[172:175], a[28:31], v[232:235], v[172:175]
    buffer_load_dwordx4 v[232:235], v10, s[40:43], s58 offen offset:0 sc1
    v_mfma_f32_16x16x32_bf16 v[188:191], a[28:31], v[236:239], v[188:191]
    v_mfma_f32_16x16x32_bf16 v[184:187], a[24:27], v[236:239], v[184:187]
    ds_read_b128 a[12:15], v35 offset:3072
    v_mfma_f32_16x16x32_bf16 v[180:183], a[20:23], v[236:239], v[180:183]
    v_mfma_f32_16x16x32_bf16 v[176:179], a[16:19], v[236:239], v[176:179]
    buffer_load_dwordx4 v[236:239], v11, s[40:43], s58 offen offset:0 sc1
    s_add_u32 s58, s58, 1024
    s_waitcnt vmcnt(8) lgkmcnt(0)
    v_mfma_f32_16x16x32_bf16 v[128:131], a[32:35], v[192:195], v[128:131]
    v_mfma_f32_16x16x32_bf16 v[132:135], a[36:39], v[192:195], v[132:135]
    ds_read_b128 a[16:19], v35 offset:4096
    v_mfma_f32_16x16x32_bf16 v[136:139], a[40:43], v[192:195], v[136:139]
    v_mfma_f32_16x16x32_bf16 v[140:143], a[44:47], v[192:195], v[140:143]
    buffer_load_dwordx4 v[192:195], v8, s[40:43], s58 offen offset:0 sc1
    v_mfma_f32_16x16x32_bf16 v[156:159], a[44:47], v[196:199], v[156:159]
    v_mfma_f32_16x16x32_bf16 v[152:155], a[40:43], v[196:199], v[152:155]
    ds_read_b128 a[20:23], v35 offset:5120
    v_mfma_f32_16x16x32_bf16 v[148:151], a[36:39], v[196:199], v[148:151]
    v_mfma_f32_16x16x32_bf16 v[144:147], a[32:35], v[196:199], v[144:147]
    buffer_load_dwordx4 v[196:199], v9, s[40:43], s58 offen offset:0 sc1
    v_mfma_f32_16x16x32_bf16 v[160:163], a[32:35], v[200:203], v[160:163]
    v_mfma_f32_16x16x32_bf16 v[164:167], a[36:39], v[200:203], v[164:167]
    ds_read_b128 a[24:27], v35 offset:6144
    v_mfma_f32_16x16x32_bf16 v[168:171], a[40:43], v[200:203], v[168:171]
    v_mfma_f32_16x16x32_bf16 v[172:175], a[44:47], v[200:203], v[172:175]
    buffer_load_dwordx4 v[200:203], v10, s[40:43], s58 offen offset:0 sc1
    v_mfma_f32_16x16x32_bf16 v[188:191], a[44:47], v[204:207], v[188:191]
    v_mfma_f32_16x16x32_bf16 v[184:187], a[40:43], v[204:207], v[184:187]
    ds_read_b128 a[28:31], v35 offset:7168
    v_mfma_f32_16x16x32_bf16 v[180:183], a[36:39], v[204:207], v[180:183]
    v_mfma_f32_16x16x32_bf16 v[176:179], a[32:35], v[204:207], v[176:179]
    buffer_load_dwordx4 v[204:207], v11, s[40:43], s58 offen offset:0 sc1
    s_add_u32 s58, s58, 1024
    s_waitcnt vmcnt(8) lgkmcnt(0)
    v_mfma_f32_16x16x32_bf16 v[128:131], a[48:51], v[208:211], v[128:131]
    v_mfma_f32_16x16x32_bf16 v[132:135], a[52:55], v[208:211], v[132:135]
    ds_read_b128 a[32:35], v36 offset:0
    v_mfma_f32_16x16x32_bf16 v[136:139], a[56:59], v[208:211], v[136:139]
    v_mfma_f32_16x16x32_bf16 v[140:143], a[60:63], v[208:211], v[140:143]
    buffer_load_dwordx4 v[208:211], v8, s[40:43], s58 offen offset:0 sc1
    v_mfma_f32_16x16x32_bf16 v[156:159], a[60:63], v[212:215], v[156:159]
    v_mfma_f32_16x16x32_bf16 v[152:155], a[56:59], v[212:215], v[152:155]
    ds_read_b128 a[36:39], v36 offset:1024
    v_mfma_f32_16x16x32_bf16 v[148:151], a[52:55], v[212:215], v[148:151]
    v_mfma_f32_16x16x32_bf16 v[144:147], a[48:51], v[212:215], v[144:147]
    buffer_load_dwordx4 v[212:215], v9, s[40:43], s58 offen offset:0 sc1
    v_mfma_f32_16x16x32_bf16 v[160:163], a[48:51], v[216:219], v[160:163]
    v_mfma_f32_16x16x32_bf16 v[164:167], a[52:55], v[216:219], v[164:167]
    ds_read_b128 a[40:43], v36 offset:2048
    v_mfma_f32_16x16x32_bf16 v[168:171], a[56:59], v[216:219], v[168:171]
    v_mfma_f32_16x16x32_bf16 v[172:175], a[60:63], v[216:219], v[172:175]
    buffer_load_dwordx4 v[216:219], v10, s[40:43], s58 offen offset:0 sc1
    v_mfma_f32_16x16x32_bf16 v[188:191], a[60:63], v[220:223], v[188:191]
    v_mfma_f32_16x16x32_bf16 v[184:187], a[56:59], v[220:223], v[184:187]
    ds_read_b128 a[44:47], v36 offset:3072
    v_mfma_f32_16x16x32_bf16 v[180:183], a[52:55], v[220:223], v[180:183]
    v_mfma_f32_16x16x32_bf16 v[176:179], a[48:51], v[220:223], v[176:179]
    buffer_load_dwordx4 v[220:223], v11, s[40:43], s58 offen offset:0 sc1
    s_add_u32 s58, s58, 1024
    s_waitcnt vmcnt(8) lgkmcnt(0)
    v_mfma_f32_16x16x32_bf16 v[128:131], a[64:67], v[224:227], v[128:131]
    v_mfma_f32_16x16x32_bf16 v[132:135], a[68:71], v[224:227], v[132:135]
    ds_read_b128 a[48:51], v36 offset:4096
    v_mfma_f32_16x16x32_bf16 v[136:139], a[72:75], v[224:227], v[136:139]
    v_mfma_f32_16x16x32_bf16 v[140:143], a[76:79], v[224:227], v[140:143]
    buffer_load_dwordx4 v[224:227], v8, s[40:43], s58 offen offset:0 sc1
    v_mfma_f32_16x16x32_bf16 v[156:159], a[76:79], v[228:231], v[156:159]
    v_mfma_f32_16x16x32_bf16 v[152:155], a[72:75], v[228:231], v[152:155]
    ds_read_b128 a[52:55], v36 offset:5120
    v_mfma_f32_16x16x32_bf16 v[148:151], a[68:71], v[228:231], v[148:151]
    v_mfma_f32_16x16x32_bf16 v[144:147], a[64:67], v[228:231], v[144:147]
    buffer_load_dwordx4 v[228:231], v9, s[40:43], s58 offen offset:0 sc1
    v_mfma_f32_16x16x32_bf16 v[160:163], a[64:67], v[232:235], v[160:163]
    v_mfma_f32_16x16x32_bf16 v[164:167], a[68:71], v[232:235], v[164:167]
    ds_read_b128 a[56:59], v36 offset:6144
    v_mfma_f32_16x16x32_bf16 v[168:171], a[72:75], v[232:235], v[168:171]
    v_mfma_f32_16x16x32_bf16 v[172:175], a[76:79], v[232:235], v[172:175]
    buffer_load_dwordx4 v[232:235], v10, s[40:43], s58 offen offset:0 sc1
    v_mfma_f32_16x16x32_bf16 v[188:191], a[76:79], v[236:239], v[188:191]
    v_mfma_f32_16x16x32_bf16 v[184:187], a[72:75], v[236:239], v[184:187]
    ds_read_b128 a[60:63], v36 offset:7168
    v_mfma_f32_16x16x32_bf16 v[180:183], a[68:71], v[236:239], v[180:183]
    v_mfma_f32_16x16x32_bf16 v[176:179], a[64:67], v[236:239], v[176:179]
    buffer_load_dwordx4 v[236:239], v11, s[40:43], s58 offen offset:0 sc1
    s_add_u32 s58, s58, 1024
    s_waitcnt vmcnt(8) lgkmcnt(0)
    v_mfma_f32_16x16x32_bf16 v[128:131], a[80:83], v[192:195], v[128:131]
    v_mfma_f32_16x16x32_bf16 v[132:135], a[84:87], v[192:195], v[132:135]
    ds_read_b128 a[64:67], v32 offset:0
    v_mfma_f32_16x16x32_bf16 v[136:139], a[88:91], v[192:195], v[136:139]
    v_mfma_f32_16x16x32_bf16 v[140:143], a[92:95], v[192:195], v[140:143]
    buffer_load_dwordx4 v[192:195], v8, s[40:43], s58 offen offset:0 sc1
    v_mfma_f32_16x16x32_bf16 v[156:159], a[92:95], v[196:199], v[156:159]
    v_mfma_f32_16x16x32_bf16 v[152:155], a[88:91], v[196:199], v[152:155]
    ds_read_b128 a[68:71], v32 offset:1024
    v_mfma_f32_16x16x32_bf16 v[148:151], a[84:87], v[196:199], v[148:151]
    v_mfma_f32_16x16x32_bf16 v[144:147], a[80:83], v[196:199], v[144:147]
    buffer_load_dwordx4 v[196:199], v9, s[40:43], s58 offen offset:0 sc1
    v_mfma_f32_16x16x32_bf16 v[160:163], a[80:83], v[200:203], v[160:163]
    v_mfma_f32_16x16x32_bf16 v[164:167], a[84:87], v[200:203], v[164:167]
    ds_read_b128 a[72:75], v32 offset:2048
    v_mfma_f32_16x16x32_bf16 v[168:171], a[88:91], v[200:203], v[168:171]
    v_mfma_f32_16x16x32_bf16 v[172:175], a[92:95], v[200:203], v[172:175]
    buffer_load_dwordx4 v[200:203], v10, s[40:43], s58 offen offset:0 sc1
    v_mfma_f32_16x16x32_bf16 v[188:191], a[92:95], v[204:207], v[188:191]
    v_mfma_f32_16x16x32_bf16 v[184:187], a[88:91], v[204:207], v[184:187]
    ds_read_b128 a[76:79], v32 offset:3072
    v_mfma_f32_16x16x32_bf16 v[180:183], a[84:87], v[204:207], v[180:183]
    v_mfma_f32_16x16x32_bf16 v[176:179], a[80:83], v[204:207], v[176:179]
    buffer_load_dwordx4 v[204:207], v11, s[40:43], s58 offen offset:0 sc1
    s_add_u32 s58, s58, 1024
    s_waitcnt vmcnt(8) lgkmcnt(0)
    v_mfma_f32_16x16x32_bf16 v[128:131], a[96:99], v[208:211], v[128:131]
    v_mfma_f32_16x16x32_bf16 v[132:135], a[100:103], v[208:211], v[132:135]
    ds_read_b128 a[80:83], v32 offset:4096
    v_mfma_f32_16x16x32_bf16 v[136:139], a[104:107], v[208:211], v[136:139]
    v_mfma_f32_16x16x32_bf16 v[140:143], a[108:111], v[208:211], v[140:143]
    buffer_load_dwordx4 v[208:211], v8, s[40:43], s58 offen offset:0 sc1
    v_mfma_f32_16x16x32_bf16 v[156:159], a[108:111], v[212:215], v[156:159]
    v_mfma_f32_16x16x32_bf16 v[152:155], a[104:107], v[212:215], v[152:155]
    ds_read_b128 a[84:87], v32 offset:5120
    v_mfma_f32_16x16x32_bf16 v[148:151], a[100:103], v[212:215], v[148:151]
    v_mfma_f32_16x16x32_bf16 v[144:147], a[96:99], v[212:215], v[144:147]
    buffer_load_dwordx4 v[212:215], v9, s[40:43], s58 offen offset:0 sc1
    v_mfma_f32_16x16x32_bf16 v[160:163], a[96:99], v[216:219], v[160:163]
    v_mfma_f32_16x16x32_bf16 v[164:167], a[100:103], v[216:219], v[164:167]
    ds_read_b128 a[88:91], v32 offset:6144
    v_mfma_f32_16x16x32_bf16 v[168:171], a[104:107], v[216:219], v[168:171]
    v_mfma_f32_16x16x32_bf16 v[172:175], a[108:111], v[216:219], v[172:175]
    buffer_load_dwordx4 v[216:219], v10, s[40:43], s58 offen offset:0 sc1
    v_mfma_f32_16x16x32_bf16 v[188:191], a[108:111], v[220:223], v[188:191]
    v_mfma_f32_16x16x32_bf16 v[184:187], a[104:107], v[220:223], v[184:187]
    ds_read_b128 a[92:95], v32 offset:7168
    v_mfma_f32_16x16x32_bf16 v[180:183], a[100:103], v[220:223], v[180:183]
    v_mfma_f32_16x16x32_bf16 v[176:179], a[96:99], v[220:223], v[176:179]
    buffer_load_dwordx4 v[220:223], v11, s[40:43], s58 offen offset:0 sc1
    s_add_u32 s58, s58, 1024
    s_waitcnt vmcnt(8) lgkmcnt(0)
    v_mfma_f32_16x16x32_bf16 v[128:131], a[112:115], v[224:227], v[128:131]
    s_add_u32 s67, s23, 106496
    v_mfma_f32_16x16x32_bf16 v[132:135], a[116:119], v[224:227], v[132:135]
    v_mfma_f32_16x16x32_bf16 v[136:139], a[120:123], v[224:227], v[136:139]
    buffer_load_dwordx4 a[96:99], v15, s[40:43], s67 offen offset:0 sc1
    v_mfma_f32_16x16x32_bf16 v[140:143], a[124:127], v[224:227], v[140:143]
    buffer_load_dwordx4 v[224:227], v8, s[40:43], s58 offen offset:0 sc1
    v_mfma_f32_16x16x32_bf16 v[156:159], a[124:127], v[228:231], v[156:159]
    v_mfma_f32_16x16x32_bf16 v[152:155], a[120:123], v[228:231], v[152:155]
    v_mfma_f32_16x16x32_bf16 v[148:151], a[116:119], v[228:231], v[148:151]
    buffer_load_dwordx4 a[100:103], v15, s[40:43], s67 offen offset:1024 sc1
    v_mfma_f32_16x16x32_bf16 v[144:147], a[112:115], v[228:231], v[144:147]
    buffer_load_dwordx4 v[228:231], v9, s[40:43], s58 offen offset:0 sc1
    v_mfma_f32_16x16x32_bf16 v[160:163], a[112:115], v[232:235], v[160:163]
    v_mfma_f32_16x16x32_bf16 v[164:167], a[116:119], v[232:235], v[164:167]
    v_mfma_f32_16x16x32_bf16 v[168:171], a[120:123], v[232:235], v[168:171]
    buffer_load_dwordx4 a[104:107], v15, s[40:43], s67 offen offset:2048 sc1
    v_mfma_f32_16x16x32_bf16 v[172:175], a[124:127], v[232:235], v[172:175]
    buffer_load_dwordx4 v[232:235], v10, s[40:43], s58 offen offset:0 sc1
    v_mfma_f32_16x16x32_bf16 v[188:191], a[124:127], v[236:239], v[188:191]
    v_mfma_f32_16x16x32_bf16 v[184:187], a[120:123], v[236:239], v[184:187]
    v_mfma_f32_16x16x32_bf16 v[180:183], a[116:119], v[236:239], v[180:183]
    buffer_load_dwordx4 a[108:111], v15, s[40:43], s67 offen offset:3072 sc1
    v_mfma_f32_16x16x32_bf16 v[176:179], a[112:115], v[236:239], v[176:179]
    buffer_load_dwordx4 v[236:239], v11, s[40:43], s58 offen offset:0 sc1
    s_add_u32 s58, s58, 1024
    s_waitcnt vmcnt(12) lgkmcnt(0)
    v_mfma_f32_16x16x32_bf16 v[128:131], a[128:131], v[192:195], v[128:131]
    v_mfma_f32_16x16x32_bf16 v[132:135], a[132:135], v[192:195], v[132:135]
    v_mfma_f32_16x16x32_bf16 v[136:139], a[136:139], v[192:195], v[136:139]
    v_mfma_f32_16x16x32_bf16 v[140:143], a[140:143], v[192:195], v[140:143]
    buffer_load_dwordx4 v[192:195], v8, s[40:43], s58 offen offset:0 sc1
    v_mfma_f32_16x16x32_bf16 v[156:159], a[140:143], v[196:199], v[156:159]
    v_mfma_f32_16x16x32_bf16 v[152:155], a[136:139], v[196:199], v[152:155]
    v_mfma_f32_16x16x32_bf16 v[148:151], a[132:135], v[196:199], v[148:151]
    v_mfma_f32_16x16x32_bf16 v[144:147], a[128:131], v[196:199], v[144:147]
    buffer_load_dwordx4 v[196:199], v9, s[40:43], s58 offen offset:0 sc1
    v_mfma_f32_16x16x32_bf16 v[160:163], a[128:131], v[200:203], v[160:163]
    v_mfma_f32_16x16x32_bf16 v[164:167], a[132:135], v[200:203], v[164:167]
    v_mfma_f32_16x16x32_bf16 v[168:171], a[136:139], v[200:203], v[168:171]
    v_mfma_f32_16x16x32_bf16 v[172:175], a[140:143], v[200:203], v[172:175]
    buffer_load_dwordx4 v[200:203], v10, s[40:43], s58 offen offset:0 sc1
    v_mfma_f32_16x16x32_bf16 v[188:191], a[140:143], v[204:207], v[188:191]
    v_mfma_f32_16x16x32_bf16 v[184:187], a[136:139], v[204:207], v[184:187]
    v_mfma_f32_16x16x32_bf16 v[180:183], a[132:135], v[204:207], v[180:183]
    v_mfma_f32_16x16x32_bf16 v[176:179], a[128:131], v[204:207], v[176:179]
    buffer_load_dwordx4 v[204:207], v11, s[40:43], s58 offen offset:0 sc1
    s_add_u32 s58, s58, 1024
    s_waitcnt vmcnt(12) lgkmcnt(0)
    v_mfma_f32_16x16x32_bf16 v[128:131], a[144:147], v[208:211], v[128:131]
    v_mfma_f32_16x16x32_bf16 v[132:135], a[148:151], v[208:211], v[132:135]
    v_mfma_f32_16x16x32_bf16 v[136:139], a[152:155], v[208:211], v[136:139]
    v_mfma_f32_16x16x32_bf16 v[140:143], a[156:159], v[208:211], v[140:143]
    buffer_load_dwordx4 v[208:211], v8, s[40:43], s58 offen offset:0 sc1
    v_mfma_f32_16x16x32_bf16 v[156:159], a[156:159], v[212:215], v[156:159]
    v_mfma_f32_16x16x32_bf16 v[152:155], a[152:155], v[212:215], v[152:155]
    v_mfma_f32_16x16x32_bf16 v[148:151], a[148:151], v[212:215], v[148:151]
    v_mfma_f32_16x16x32_bf16 v[144:147], a[144:147], v[212:215], v[144:147]
    buffer_load_dwordx4 v[212:215], v9, s[40:43], s58 offen offset:0 sc1
    v_mfma_f32_16x16x32_bf16 v[160:163], a[144:147], v[216:219], v[160:163]
    v_mfma_f32_16x16x32_bf16 v[164:167], a[148:151], v[216:219], v[164:167]
    v_mfma_f32_16x16x32_bf16 v[168:171], a[152:155], v[216:219], v[168:171]
    v_mfma_f32_16x16x32_bf16 v[172:175], a[156:159], v[216:219], v[172:175]
    buffer_load_dwordx4 v[216:219], v10, s[40:43], s58 offen offset:0 sc1
    v_mfma_f32_16x16x32_bf16 v[188:191], a[156:159], v[220:223], v[188:191]
    v_mfma_f32_16x16x32_bf16 v[184:187], a[152:155], v[220:223], v[184:187]
    v_mfma_f32_16x16x32_bf16 v[180:183], a[148:151], v[220:223], v[180:183]
    v_mfma_f32_16x16x32_bf16 v[176:179], a[144:147], v[220:223], v[176:179]
    buffer_load_dwordx4 v[220:223], v11, s[40:43], s58 offen offset:0 sc1
    s_add_u32 s58, s58, 1024
    s_waitcnt vmcnt(8) lgkmcnt(0)
    v_mfma_f32_16x16x32_bf16 v[128:131], a[160:163], v[224:227], v[128:131]
    v_mfma_f32_16x16x32_bf16 v[132:135], a[164:167], v[224:227], v[132:135]
    v_mfma_f32_16x16x32_bf16 v[136:139], a[168:171], v[224:227], v[136:139]
    v_mfma_f32_16x16x32_bf16 v[140:143], a[172:175], v[224:227], v[140:143]
    buffer_load_dwordx4 v[224:227], v8, s[40:43], s58 offen offset:0 sc1
    v_mfma_f32_16x16x32_bf16 v[156:159], a[172:175], v[228:231], v[156:159]
    v_mfma_f32_16x16x32_bf16 v[152:155], a[168:171], v[228:231], v[152:155]
    v_mfma_f32_16x16x32_bf16 v[148:151], a[164:167], v[228:231], v[148:151]
    v_mfma_f32_16x16x32_bf16 v[144:147], a[160:163], v[228:231], v[144:147]
    buffer_load_dwordx4 v[228:231], v9, s[40:43], s58 offen offset:0 sc1
    v_mfma_f32_16x16x32_bf16 v[160:163], a[160:163], v[232:235], v[160:163]
    v_mfma_f32_16x16x32_bf16 v[164:167], a[164:167], v[232:235], v[164:167]
    v_mfma_f32_16x16x32_bf16 v[168:171], a[168:171], v[232:235], v[168:171]
    v_mfma_f32_16x16x32_bf16 v[172:175], a[172:175], v[232:235], v[172:175]
    buffer_load_dwordx4 v[232:235], v10, s[40:43], s58 offen offset:0 sc1
    v_mfma_f32_16x16x32_bf16 v[188:191], a[172:175], v[236:239], v[188:191]
    v_mfma_f32_16x16x32_bf16 v[184:187], a[168:171], v[236:239], v[184:187]
    v_mfma_f32_16x16x32_bf16 v[180:183], a[164:167], v[236:239], v[180:183]
    v_mfma_f32_16x16x32_bf16 v[176:179], a[160:163], v[236:239], v[176:179]
    buffer_load_dwordx4 v[236:239], v11, s[40:43], s58 offen offset:0 sc1
    s_add_u32 s58, s58, 1024
    s_waitcnt vmcnt(8) lgkmcnt(0)
    v_mfma_f32_16x16x32_bf16 v[128:131], a[176:179], v[192:195], v[128:131]
    v_mfma_f32_16x16x32_bf16 v[132:135], a[180:183], v[192:195], v[132:135]
    v_mfma_f32_16x16x32_bf16 v[136:139], a[184:187], v[192:195], v[136:139]
    v_mfma_f32_16x16x32_bf16 v[140:143], a[188:191], v[192:195], v[140:143]
    buffer_load_dwordx4 v[192:195], v8, s[40:43], s58 offen offset:0 sc1
    v_mfma_f32_16x16x32_bf16 v[156:159], a[188:191], v[196:199], v[156:159]
    v_mfma_f32_16x16x32_bf16 v[152:155], a[184:187], v[196:199], v[152:155]
    v_mfma_f32_16x16x32_bf16 v[148:151], a[180:183], v[196:199], v[148:151]
    v_mfma_f32_16x16x32_bf16 v[144:147], a[176:179], v[196:199], v[144:147]
    buffer_load_dwordx4 v[196:199], v9, s[40:43], s58 offen offset:0 sc1
    v_mfma_f32_16x16x32_bf16 v[160:163], a[176:179], v[200:203], v[160:163]
    v_mfma_f32_16x16x32_bf16 v[164:167], a[180:183], v[200:203], v[164:167]
    v_mfma_f32_16x16x32_bf16 v[168:171], a[184:187], v[200:203], v[168:171]
    v_mfma_f32_16x16x32_bf16 v[172:175], a[188:191], v[200:203], v[172:175]
    buffer_load_dwordx4 v[200:203], v10, s[40:43], s58 offen offset:0 sc1
    v_mfma_f32_16x16x32_bf16 v[188:191], a[188:191], v[204:207], v[188:191]
    v_mfma_f32_16x16x32_bf16 v[184:187], a[184:187], v[204:207], v[184:187]
    v_mfma_f32_16x16x32_bf16 v[180:183], a[180:183], v[204:207], v[180:183]
    v_mfma_f32_16x16x32_bf16 v[176:179], a[176:179], v[204:207], v[176:179]
    buffer_load_dwordx4 v[204:207], v11, s[40:43], s58 offen offset:0 sc1
    s_add_u32 s58, s58, 1024
    s_waitcnt vmcnt(8) lgkmcnt(0)
    v_mfma_f32_16x16x32_bf16 v[128:131], a[192:195], v[208:211], v[128:131]
    v_mfma_f32_16x16x32_bf16 v[132:135], a[196:199], v[208:211], v[132:135]
    v_mfma_f32_16x16x32_bf16 v[136:139], a[200:203], v[208:211], v[136:139]
    v_mfma_f32_16x16x32_bf16 v[140:143], a[204:207], v[208:211], v[140:143]
    buffer_load_dwordx4 v[208:211], v8, s[40:43], s58 offen offset:0 sc1
    v_mfma_f32_16x16x32_bf16 v[156:159], a[204:207], v[212:215], v[156:159]
    v_mfma_f32_16x16x32_bf16 v[152:155], a[200:203], v[212:215], v[152:155]
    v_mfma_f32_16x16x32_bf16 v[148:151], a[196:199], v[212:215], v[148:151]
    v_mfma_f32_16x16x32_bf16 v[144:147], a[192:195], v[212:215], v[144:147]
    buffer_load_dwordx4 v[212:215], v9, s[40:43], s58 offen offset:0 sc1
    v_mfma_f32_16x16x32_bf16 v[160:163], a[192:195], v[216:219], v[160:163]
    v_mfma_f32_16x16x32_bf16 v[164:167], a[196:199], v[216:219], v[164:167]
    v_mfma_f32_16x16x32_bf16 v[168:171], a[200:203], v[216:219], v[168:171]
    v_mfma_f32_16x16x32_bf16 v[172:175], a[204:207], v[216:219], v[172:175]
    buffer_load_dwordx4 v[216:219], v10, s[40:43], s58 offen offset:0 sc1
    v_mfma_f32_16x16x32_bf16 v[188:191], a[204:207], v[220:223], v[188:191]
    v_mfma_f32_16x16x32_bf16 v[184:187], a[200:203], v[220:223], v[184:187]
    v_mfma_f32_16x16x32_bf16 v[180:183], a[196:199], v[220:223], v[180:183]
    v_mfma_f32_16x16x32_bf16 v[176:179], a[192:195], v[220:223], v[176:179]
    buffer_load_dwordx4 v[220:223], v11, s[40:43], s58 offen offset:0 sc1
    s_add_u32 s58, s58, 1024
    s_waitcnt vmcnt(8) lgkmcnt(0)
    v_mfma_f32_16x16x32_bf16 v[128:131], a[208:211], v[224:227], v[128:131]
    v_mfma_f32_16x16x32_bf16 v[132:135], a[212:215], v[224:227], v[132:135]
    v_mfma_f32_16x16x32_bf16 v[136:139], a[216:219], v[224:227], v[136:139]
    v_mfma_f32_16x16x32_bf16 v[140:143], a[220:223], v[224:227], v[140:143]
    buffer_load_dwordx4 v[224:227], v8, s[40:43], s58 offen offset:0 sc1
    v_mfma_f32_16x16x32_bf16 v[156:159], a[220:223], v[228:231], v[156:159]
    v_mfma_f32_16x16x32_bf16 v[152:155], a[216:219], v[228:231], v[152:155]
    v_mfma_f32_16x16x32_bf16 v[148:151], a[212:215], v[228:231], v[148:151]
    v_mfma_f32_16x16x32_bf16 v[144:147], a[208:211], v[228:231], v[144:147]
    buffer_load_dwordx4 v[228:231], v9, s[40:43], s58 offen offset:0 sc1
    v_mfma_f32_16x16x32_bf16 v[160:163], a[208:211], v[232:235], v[160:163]
    v_mfma_f32_16x16x32_bf16 v[164:167], a[212:215], v[232:235], v[164:167]
    v_mfma_f32_16x16x32_bf16 v[168:171], a[216:219], v[232:235], v[168:171]
    v_mfma_f32_16x16x32_bf16 v[172:175], a[220:223], v[232:235], v[172:175]
    buffer_load_dwordx4 v[232:235], v10, s[40:43], s58 offen offset:0 sc1
    v_mfma_f32_16x16x32_bf16 v[188:191], a[220:223], v[236:239], v[188:191]
    v_mfma_f32_16x16x32_bf16 v[184:187], a[216:219], v[236:239], v[184:187]
    v_mfma_f32_16x16x32_bf16 v[180:183], a[212:215], v[236:239], v[180:183]
    v_mfma_f32_16x16x32_bf16 v[176:179], a[208:211], v[236:239], v[176:179]
    buffer_load_dwordx4 v[236:239], v11, s[40:43], s58 offen offset:0 sc1
    s_add_u32 s58, s58, 1024
    s_waitcnt vmcnt(8) lgkmcnt(0)
    v_mfma_f32_16x16x32_bf16 v[128:131], a[224:227], v[192:195], v[128:131]
    v_mfma_f32_16x16x32_bf16 v[132:135], a[228:231], v[192:195], v[132:135]
    v_mfma_f32_16x16x32_bf16 v[136:139], a[232:235], v[192:195], v[136:139]
    v_mfma_f32_16x16x32_bf16 v[140:143], a[236:239], v[192:195], v[140:143]
    buffer_load_dwordx4 v[192:195], v8, s[40:43], s58 offen offset:0 sc1
    v_mfma_f32_16x16x32_bf16 v[156:159], a[236:239], v[196:199], v[156:159]
    v_mfma_f32_16x16x32_bf16 v[152:155], a[232:235], v[196:199], v[152:155]
    v_mfma_f32_16x16x32_bf16 v[148:151], a[228:231], v[196:199], v[148:151]
    v_mfma_f32_16x16x32_bf16 v[144:147], a[224:227], v[196:199], v[144:147]
    buffer_load_dwordx4 v[196:199], v9, s[40:43], s58 offen offset:0 sc1
    v_mfma_f32_16x16x32_bf16 v[160:163], a[224:227], v[200:203], v[160:163]
    v_mfma_f32_16x16x32_bf16 v[164:167], a[228:231], v[200:203], v[164:167]
    v_mfma_f32_16x16x32_bf16 v[168:171], a[232:235], v[200:203], v[168:171]
    v_mfma_f32_16x16x32_bf16 v[172:175], a[236:239], v[200:203], v[172:175]
    buffer_load_dwordx4 v[200:203], v10, s[40:43], s58 offen offset:0 sc1
    v_mfma_f32_16x16x32_bf16 v[188:191], a[236:239], v[204:207], v[188:191]
    v_mfma_f32_16x16x32_bf16 v[184:187], a[232:235], v[204:207], v[184:187]
    v_mfma_f32_16x16x32_bf16 v[180:183], a[228:231], v[204:207], v[180:183]
    v_mfma_f32_16x16x32_bf16 v[176:179], a[224:227], v[204:207], v[176:179]
    buffer_load_dwordx4 v[204:207], v11, s[40:43], s58 offen offset:0 sc1
    s_add_u32 s58, s58, 1024
    s_waitcnt vmcnt(8) lgkmcnt(0)
    v_mfma_f32_16x16x32_bf16 v[128:131], a[240:243], v[208:211], v[128:131]
    v_mfma_f32_16x16x32_bf16 v[132:135], a[244:247], v[208:211], v[132:135]
    v_mfma_f32_16x16x32_bf16 v[136:139], a[248:251], v[208:211], v[136:139]
    v_mfma_f32_16x16x32_bf16 v[140:143], a[252:255], v[208:211], v[140:143]
    buffer_load_dwordx4 v[208:211], v8, s[40:43], s58 offen offset:0 sc1
    v_mfma_f32_16x16x32_bf16 v[156:159], a[252:255], v[212:215], v[156:159]
    v_mfma_f32_16x16x32_bf16 v[152:155], a[248:251], v[212:215], v[152:155]
    v_mfma_f32_16x16x32_bf16 v[148:151], a[244:247], v[212:215], v[148:151]
    v_mfma_f32_16x16x32_bf16 v[144:147], a[240:243], v[212:215], v[144:147]
    buffer_load_dwordx4 v[212:215], v9, s[40:43], s58 offen offset:0 sc1
    v_mfma_f32_16x16x32_bf16 v[160:163], a[240:243], v[216:219], v[160:163]
    v_mfma_f32_16x16x32_bf16 v[164:167], a[244:247], v[216:219], v[164:167]
    v_mfma_f32_16x16x32_bf16 v[168:171], a[248:251], v[216:219], v[168:171]
    v_mfma_f32_16x16x32_bf16 v[172:175], a[252:255], v[216:219], v[172:175]
    buffer_load_dwordx4 v[216:219], v10, s[40:43], s58 offen offset:0 sc1
    v_mfma_f32_16x16x32_bf16 v[188:191], a[252:255], v[220:223], v[188:191]
    v_mfma_f32_16x16x32_bf16 v[184:187], a[248:251], v[220:223], v[184:187]
    v_mfma_f32_16x16x32_bf16 v[180:183], a[244:247], v[220:223], v[180:183]
    v_mfma_f32_16x16x32_bf16 v[176:179], a[240:243], v[220:223], v[176:179]
    buffer_load_dwordx4 v[220:223], v11, s[40:43], s58 offen offset:0 sc1
    s_add_u32 s58, s58, 1024
    s_waitcnt vmcnt(8) lgkmcnt(0)
    v_mfma_f32_16x16x32_bf16 v[128:131], a[0:3], v[224:227], v[128:131]
    v_mfma_f32_16x16x32_bf16 v[132:135], a[4:7], v[224:227], v[132:135]
    v_mfma_f32_16x16x32_bf16 v[136:139], a[8:11], v[224:227], v[136:139]
    v_mfma_f32_16x16x32_bf16 v[140:143], a[12:15], v[224:227], v[140:143]
    buffer_load_dwordx4 v[224:227], v8, s[40:43], s58 offen offset:0 sc1
    v_mfma_f32_16x16x32_bf16 v[156:159], a[12:15], v[228:231], v[156:159]
    v_mfma_f32_16x16x32_bf16 v[152:155], a[8:11], v[228:231], v[152:155]
    v_mfma_f32_16x16x32_bf16 v[148:151], a[4:7], v[228:231], v[148:151]
    v_mfma_f32_16x16x32_bf16 v[144:147], a[0:3], v[228:231], v[144:147]
    buffer_load_dwordx4 v[228:231], v9, s[40:43], s58 offen offset:0 sc1
    v_mfma_f32_16x16x32_bf16 v[160:163], a[0:3], v[232:235], v[160:163]
    v_mfma_f32_16x16x32_bf16 v[164:167], a[4:7], v[232:235], v[164:167]
    v_mfma_f32_16x16x32_bf16 v[168:171], a[8:11], v[232:235], v[168:171]
    v_mfma_f32_16x16x32_bf16 v[172:175], a[12:15], v[232:235], v[172:175]
    buffer_load_dwordx4 v[232:235], v10, s[40:43], s58 offen offset:0 sc1
    v_mfma_f32_16x16x32_bf16 v[188:191], a[12:15], v[236:239], v[188:191]
    v_mfma_f32_16x16x32_bf16 v[184:187], a[8:11], v[236:239], v[184:187]
    v_mfma_f32_16x16x32_bf16 v[180:183], a[4:7], v[236:239], v[180:183]
    v_mfma_f32_16x16x32_bf16 v[176:179], a[0:3], v[236:239], v[176:179]
    buffer_load_dwordx4 v[236:239], v11, s[40:43], s58 offen offset:0 sc1
    s_add_u32 s58, s58, 1024
    s_waitcnt vmcnt(8) lgkmcnt(0)
    v_mfma_f32_16x16x32_bf16 v[128:131], a[16:19], v[192:195], v[128:131]
    v_mfma_f32_16x16x32_bf16 v[132:135], a[20:23], v[192:195], v[132:135]
    v_mfma_f32_16x16x32_bf16 v[136:139], a[24:27], v[192:195], v[136:139]
    v_mfma_f32_16x16x32_bf16 v[140:143], a[28:31], v[192:195], v[140:143]
    buffer_load_dwordx4 v[192:195], v8, s[40:43], s58 offen offset:0 sc1
    v_mfma_f32_16x16x32_bf16 v[156:159], a[28:31], v[196:199], v[156:159]
    v_mfma_f32_16x16x32_bf16 v[152:155], a[24:27], v[196:199], v[152:155]
    v_mfma_f32_16x16x32_bf16 v[148:151], a[20:23], v[196:199], v[148:151]
    v_mfma_f32_16x16x32_bf16 v[144:147], a[16:19], v[196:199], v[144:147]
    buffer_load_dwordx4 v[196:199], v9, s[40:43], s58 offen offset:0 sc1
    v_mfma_f32_16x16x32_bf16 v[160:163], a[16:19], v[200:203], v[160:163]
    v_mfma_f32_16x16x32_bf16 v[164:167], a[20:23], v[200:203], v[164:167]
    v_mfma_f32_16x16x32_bf16 v[168:171], a[24:27], v[200:203], v[168:171]
    v_mfma_f32_16x16x32_bf16 v[172:175], a[28:31], v[200:203], v[172:175]
    buffer_load_dwordx4 v[200:203], v10, s[40:43], s58 offen offset:0 sc1
    v_mfma_f32_16x16x32_bf16 v[188:191], a[28:31], v[204:207], v[188:191]
    v_mfma_f32_16x16x32_bf16 v[184:187], a[24:27], v[204:207], v[184:187]
    v_mfma_f32_16x16x32_bf16 v[180:183], a[20:23], v[204:207], v[180:183]
    v_mfma_f32_16x16x32_bf16 v[176:179], a[16:19], v[204:207], v[176:179]
    buffer_load_dwordx4 v[204:207], v11, s[40:43], s58 offen offset:0 sc1
    s_add_u32 s58, s58, 1024
    s_waitcnt vmcnt(8) lgkmcnt(0)
    v_mfma_f32_16x16x32_bf16 v[128:131], a[32:35], v[208:211], v[128:131]
    v_mfma_f32_16x16x32_bf16 v[132:135], a[36:39], v[208:211], v[132:135]
    v_mfma_f32_16x16x32_bf16 v[136:139], a[40:43], v[208:211], v[136:139]
    v_mfma_f32_16x16x32_bf16 v[140:143], a[44:47], v[208:211], v[140:143]
    buffer_load_dwordx4 v[208:211], v8, s[40:43], s58 offen offset:0 sc1
    v_mfma_f32_16x16x32_bf16 v[156:159], a[44:47], v[212:215], v[156:159]
    v_mfma_f32_16x16x32_bf16 v[152:155], a[40:43], v[212:215], v[152:155]
    v_mfma_f32_16x16x32_bf16 v[148:151], a[36:39], v[212:215], v[148:151]
    v_mfma_f32_16x16x32_bf16 v[144:147], a[32:35], v[212:215], v[144:147]
    buffer_load_dwordx4 v[212:215], v9, s[40:43], s58 offen offset:0 sc1
    v_mfma_f32_16x16x32_bf16 v[160:163], a[32:35], v[216:219], v[160:163]
    v_mfma_f32_16x16x32_bf16 v[164:167], a[36:39], v[216:219], v[164:167]
    v_mfma_f32_16x16x32_bf16 v[168:171], a[40:43], v[216:219], v[168:171]
    v_mfma_f32_16x16x32_bf16 v[172:175], a[44:47], v[216:219], v[172:175]
    buffer_load_dwordx4 v[216:219], v10, s[40:43], s58 offen offset:0 sc1
    v_mfma_f32_16x16x32_bf16 v[188:191], a[44:47], v[220:223], v[188:191]
    v_mfma_f32_16x16x32_bf16 v[184:187], a[40:43], v[220:223], v[184:187]
    v_mfma_f32_16x16x32_bf16 v[180:183], a[36:39], v[220:223], v[180:183]
    v_mfma_f32_16x16x32_bf16 v[176:179], a[32:35], v[220:223], v[176:179]
    buffer_load_dwordx4 v[220:223], v11, s[40:43], s58 offen offset:0 sc1
    s_add_u32 s58, s58, 1024
    s_waitcnt vmcnt(8) lgkmcnt(0)
    v_mfma_f32_16x16x32_bf16 v[128:131], a[48:51], v[224:227], v[128:131]
    v_mfma_f32_16x16x32_bf16 v[132:135], a[52:55], v[224:227], v[132:135]
    v_mfma_f32_16x16x32_bf16 v[136:139], a[56:59], v[224:227], v[136:139]
    v_mfma_f32_16x16x32_bf16 v[140:143], a[60:63], v[224:227], v[140:143]
    buffer_load_dwordx4 v[224:227], v8, s[40:43], s58 offen offset:0 sc1
    v_mfma_f32_16x16x32_bf16 v[156:159], a[60:63], v[228:231], v[156:159]
    v_mfma_f32_16x16x32_bf16 v[152:155], a[56:59], v[228:231], v[152:155]
    v_mfma_f32_16x16x32_bf16 v[148:151], a[52:55], v[228:231], v[148:151]
    v_mfma_f32_16x16x32_bf16 v[144:147], a[48:51], v[228:231], v[144:147]
    buffer_load_dwordx4 v[228:231], v9, s[40:43], s58 offen offset:0 sc1
    v_mfma_f32_16x16x32_bf16 v[160:163], a[48:51], v[232:235], v[160:163]
    v_mfma_f32_16x16x32_bf16 v[164:167], a[52:55], v[232:235], v[164:167]
    v_mfma_f32_16x16x32_bf16 v[168:171], a[56:59], v[232:235], v[168:171]
    v_mfma_f32_16x16x32_bf16 v[172:175], a[60:63], v[232:235], v[172:175]
    buffer_load_dwordx4 v[232:235], v10, s[40:43], s58 offen offset:0 sc1
    v_mfma_f32_16x16x32_bf16 v[188:191], a[60:63], v[236:239], v[188:191]
    v_mfma_f32_16x16x32_bf16 v[184:187], a[56:59], v[236:239], v[184:187]
    v_mfma_f32_16x16x32_bf16 v[180:183], a[52:55], v[236:239], v[180:183]
    v_mfma_f32_16x16x32_bf16 v[176:179], a[48:51], v[236:239], v[176:179]
    buffer_load_dwordx4 v[236:239], v11, s[40:43], s58 offen offset:0 sc1
    s_add_u32 s58, s58, 1024
    s_waitcnt vmcnt(8) lgkmcnt(0)
    v_mfma_f32_16x16x32_bf16 v[128:131], a[64:67], v[192:195], v[128:131]
    v_mfma_f32_16x16x32_bf16 v[132:135], a[68:71], v[192:195], v[132:135]
    v_mfma_f32_16x16x32_bf16 v[136:139], a[72:75], v[192:195], v[136:139]
    v_mfma_f32_16x16x32_bf16 v[140:143], a[76:79], v[192:195], v[140:143]
    buffer_load_dwordx4 v[192:195], v8, s[40:43], s58 offen offset:0 sc1
    v_mfma_f32_16x16x32_bf16 v[156:159], a[76:79], v[196:199], v[156:159]
    v_mfma_f32_16x16x32_bf16 v[152:155], a[72:75], v[196:199], v[152:155]
    v_mfma_f32_16x16x32_bf16 v[148:151], a[68:71], v[196:199], v[148:151]
    v_mfma_f32_16x16x32_bf16 v[144:147], a[64:67], v[196:199], v[144:147]
    buffer_load_dwordx4 v[196:199], v9, s[40:43], s58 offen offset:0 sc1
    v_mfma_f32_16x16x32_bf16 v[160:163], a[64:67], v[200:203], v[160:163]
    v_mfma_f32_16x16x32_bf16 v[164:167], a[68:71], v[200:203], v[164:167]
    v_mfma_f32_16x16x32_bf16 v[168:171], a[72:75], v[200:203], v[168:171]
    v_mfma_f32_16x16x32_bf16 v[172:175], a[76:79], v[200:203], v[172:175]
    buffer_load_dwordx4 v[200:203], v10, s[40:43], s58 offen offset:0 sc1
    v_mfma_f32_16x16x32_bf16 v[188:191], a[76:79], v[204:207], v[188:191]
    v_mfma_f32_16x16x32_bf16 v[184:187], a[72:75], v[204:207], v[184:187]
    v_mfma_f32_16x16x32_bf16 v[180:183], a[68:71], v[204:207], v[180:183]
    v_mfma_f32_16x16x32_bf16 v[176:179], a[64:67], v[204:207], v[176:179]
    buffer_load_dwordx4 v[204:207], v11, s[40:43], s58 offen offset:0 sc1
    s_add_u32 s58, s58, 1024
    s_waitcnt vmcnt(8) lgkmcnt(0)
    v_mfma_f32_16x16x32_bf16 v[128:131], a[80:83], v[208:211], v[128:131]
    v_mfma_f32_16x16x32_bf16 v[132:135], a[84:87], v[208:211], v[132:135]
    v_mfma_f32_16x16x32_bf16 v[136:139], a[88:91], v[208:211], v[136:139]
    v_mfma_f32_16x16x32_bf16 v[140:143], a[92:95], v[208:211], v[140:143]
    buffer_load_dwordx4 v[208:211], v8, s[40:43], s58 offen offset:0 sc1
    v_mfma_f32_16x16x32_bf16 v[156:159], a[92:95], v[212:215], v[156:159]
    v_mfma_f32_16x16x32_bf16 v[152:155], a[88:91], v[212:215], v[152:155]
    v_mfma_f32_16x16x32_bf16 v[148:151], a[84:87], v[212:215], v[148:151]
    v_mfma_f32_16x16x32_bf16 v[144:147], a[80:83], v[212:215], v[144:147]
    buffer_load_dwordx4 v[212:215], v8, s[40:43], s58 offen offset:1024 sc1
    v_mfma_f32_16x16x32_bf16 v[160:163], a[80:83], v[216:219], v[160:163]
    v_mfma_f32_16x16x32_bf16 v[164:167], a[84:87], v[216:219], v[164:167]
    v_mfma_f32_16x16x32_bf16 v[168:171], a[88:91], v[216:219], v[168:171]
    v_mfma_f32_16x16x32_bf16 v[172:175], a[92:95], v[216:219], v[172:175]
    buffer_load_dwordx4 v[216:219], v8, s[40:43], s58 offen offset:2048 sc1
    v_mfma_f32_16x16x32_bf16 v[188:191], a[92:95], v[220:223], v[188:191]
    v_mfma_f32_16x16x32_bf16 v[184:187], a[88:91], v[220:223], v[184:187]
    v_mfma_f32_16x16x32_bf16 v[180:183], a[84:87], v[220:223], v[180:183]
    v_mfma_f32_16x16x32_bf16 v[176:179], a[80:83], v[220:223], v[176:179]
    buffer_load_dwordx4 v[220:223], v8, s[40:43], s58 offen offset:3072 sc1
    s_add_u32 s58, s58, 0
    s_waitcnt vmcnt(8) lgkmcnt(0)
    v_mfma_f32_16x16x32_bf16 v[128:131], a[96:99], v[224:227], v[128:131]
    v_mfma_f32_16x16x32_bf16 v[132:135], a[100:103], v[224:227], v[132:135]
    v_mfma_f32_16x16x32_bf16 v[136:139], a[104:107], v[224:227], v[136:139]
    v_mfma_f32_16x16x32_bf16 v[140:143], a[108:111], v[224:227], v[140:143]
    buffer_load_dwordx4 v[224:227], v9, s[40:43], s58 offen offset:0 sc1
    v_mfma_f32_16x16x32_bf16 v[156:159], a[108:111], v[228:231], v[156:159]
    v_mfma_f32_16x16x32_bf16 v[152:155], a[104:107], v[228:231], v[152:155]
    v_mfma_f32_16x16x32_bf16 v[148:151], a[100:103], v[228:231], v[148:151]
    v_mfma_f32_16x16x32_bf16 v[144:147], a[96:99], v[228:231], v[144:147]
    buffer_load_dwordx4 v[228:231], v9, s[40:43], s58 offen offset:1024 sc1
    v_mfma_f32_16x16x32_bf16 v[160:163], a[96:99], v[232:235], v[160:163]
    v_mfma_f32_16x16x32_bf16 v[164:167], a[100:103], v[232:235], v[164:167]
    v_mfma_f32_16x16x32_bf16 v[168:171], a[104:107], v[232:235], v[168:171]
    v_mfma_f32_16x16x32_bf16 v[172:175], a[108:111], v[232:235], v[172:175]
    buffer_load_dwordx4 v[232:235], v9, s[40:43], s58 offen offset:2048 sc1
    v_mfma_f32_16x16x32_bf16 v[188:191], a[108:111], v[236:239], v[188:191]
    v_mfma_f32_16x16x32_bf16 v[184:187], a[104:107], v[236:239], v[184:187]
    v_mfma_f32_16x16x32_bf16 v[180:183], a[100:103], v[236:239], v[180:183]
    v_mfma_f32_16x16x32_bf16 v[176:179], a[96:99], v[236:239], v[176:179]
    buffer_load_dwordx4 v[236:239], v9, s[40:43], s58 offen offset:3072 sc1
    s_add_u32 s58, s58, 0
    s_waitcnt vmcnt(8) lgkmcnt(0)
    v_mfma_f32_16x16x32_bf16 v[128:131], v[240:243], v[192:195], v[128:131]
    v_mfma_f32_16x16x32_bf16 v[132:135], v[244:247], v[192:195], v[132:135]
    v_mfma_f32_16x16x32_bf16 v[136:139], v[248:251], v[192:195], v[136:139]
    v_mfma_f32_16x16x32_bf16 v[140:143], v[252:255], v[192:195], v[140:143]
    buffer_load_dwordx4 v[192:195], v10, s[40:43], s58 offen offset:0 sc1
    v_mfma_f32_16x16x32_bf16 v[156:159], v[252:255], v[196:199], v[156:159]
    v_mfma_f32_16x16x32_bf16 v[152:155], v[248:251], v[196:199], v[152:155]
    v_mfma_f32_16x16x32_bf16 v[148:151], v[244:247], v[196:199], v[148:151]
    v_mfma_f32_16x16x32_bf16 v[144:147], v[240:243], v[196:199], v[144:147]
    buffer_load_dwordx4 v[196:199], v10, s[40:43], s58 offen offset:1024 sc1
    v_mfma_f32_16x16x32_bf16 v[160:163], v[240:243], v[200:203], v[160:163]
    v_mfma_f32_16x16x32_bf16 v[164:167], v[244:247], v[200:203], v[164:167]
    v_mfma_f32_16x16x32_bf16 v[168:171], v[248:251], v[200:203], v[168:171]
    v_mfma_f32_16x16x32_bf16 v[172:175], v[252:255], v[200:203], v[172:175]
    buffer_load_dwordx4 v[200:203], v10, s[40:43], s58 offen offset:2048 sc1
    v_mfma_f32_16x16x32_bf16 v[188:191], v[252:255], v[204:207], v[188:191]
    v_mfma_f32_16x16x32_bf16 v[184:187], v[248:251], v[204:207], v[184:187]
    v_mfma_f32_16x16x32_bf16 v[180:183], v[244:247], v[204:207], v[180:183]
    v_mfma_f32_16x16x32_bf16 v[176:179], v[240:243], v[204:207], v[176:179]
    buffer_load_dwordx4 v[204:207], v10, s[40:43], s58 offen offset:3072 sc1
    s_add_u32 s58, s58, 0
    s_waitcnt vmcnt(8)
    v_mfma_f32_16x16x32_bf16 v[128:131], v[64:67], v[208:211], v[128:131]
    v_mfma_f32_16x16x32_bf16 v[128:131], v[80:83], v[212:215], v[128:131]
    v_mfma_f32_16x16x32_bf16 v[128:131], v[96:99], v[216:219], v[128:131]
    v_mfma_f32_16x16x32_bf16 v[128:131], v[112:115], v[220:223], v[128:131]
    v_mfma_f32_16x16x32_bf16 v[132:135], v[116:119], v[220:223], v[132:135]
    v_mfma_f32_16x16x32_bf16 v[132:135], v[100:103], v[216:219], v[132:135]
    v_mfma_f32_16x16x32_bf16 v[132:135], v[84:87], v[212:215], v[132:135]
    v_mfma_f32_16x16x32_bf16 v[132:135], v[68:71], v[208:211], v[132:135]
    v_mfma_f32_16x16x32_bf16 v[136:139], v[72:75], v[208:211], v[136:139]
    v_mfma_f32_16x16x32_bf16 v[136:139], v[88:91], v[212:215], v[136:139]
    v_mfma_f32_16x16x32_bf16 v[136:139], v[104:107], v[216:219], v[136:139]
    v_mfma_f32_16x16x32_bf16 v[136:139], v[120:123], v[220:223], v[136:139]
    v_mfma_f32_16x16x32_bf16 v[140:143], v[124:127], v[220:223], v[140:143]
    v_mfma_f32_16x16x32_bf16 v[140:143], v[108:111], v[216:219], v[140:143]
    v_mfma_f32_16x16x32_bf16 v[140:143], v[92:95], v[212:215], v[140:143]
    v_mfma_f32_16x16x32_bf16 v[140:143], v[76:79], v[208:211], v[140:143]
    buffer_load_dwordx4 v[208:211], v11, s[40:43], s58 offen offset:0 sc1
    buffer_load_dwordx4 v[212:215], v11, s[40:43], s58 offen offset:1024 sc1
    buffer_load_dwordx4 v[216:219], v11, s[40:43], s58 offen offset:2048 sc1
    buffer_load_dwordx4 v[220:223], v11, s[40:43], s58 offen offset:3072 sc1
    s_add_u32 s58, s58, 0
    s_waitcnt vmcnt(8)
    v_mfma_f32_16x16x32_bf16 v[144:147], v[64:67], v[224:227], v[144:147]
    v_mfma_f32_16x16x32_bf16 v[144:147], v[80:83], v[228:231], v[144:147]
    ds_write_b128 v44, v[128:131] offset:0
    v_mfma_f32_16x16x32_bf16 v[144:147], v[96:99], v[232:235], v[144:147]
    v_mfma_f32_16x16x32_bf16 v[144:147], v[112:115], v[236:239], v[144:147]
    v_mfma_f32_16x16x32_bf16 v[148:151], v[116:119], v[236:239], v[148:151]
    ds_write_b128 v45, v[132:135] offset:1024
    v_mfma_f32_16x16x32_bf16 v[148:151], v[100:103], v[232:235], v[148:151]
    v_mfma_f32_16x16x32_bf16 v[148:151], v[84:87], v[228:231], v[148:151]
    v_mfma_f32_16x16x32_bf16 v[148:151], v[68:71], v[224:227], v[148:151]
    ds_write_b128 v46, v[136:139] offset:2048
    v_mfma_f32_16x16x32_bf16 v[152:155], v[72:75], v[224:227], v[152:155]
    v_mfma_f32_16x16x32_bf16 v[152:155], v[88:91], v[228:231], v[152:155]
    v_mfma_f32_16x16x32_bf16 v[152:155], v[104:107], v[232:235], v[152:155]
    ds_write_b128 v47, v[140:143] offset:3072
    v_mfma_f32_16x16x32_bf16 v[152:155], v[120:123], v[236:239], v[152:155]
    v_mfma_f32_16x16x32_bf16 v[156:159], v[124:127], v[236:239], v[156:159]
    v_mfma_f32_16x16x32_bf16 v[156:159], v[108:111], v[232:235], v[156:159]
    v_mfma_f32_16x16x32_bf16 v[156:159], v[92:95], v[228:231], v[156:159]
    v_mfma_f32_16x16x32_bf16 v[156:159], v[76:79], v[224:227], v[156:159]
    s_waitcnt vmcnt(4)
    v_mfma_f32_16x16x32_bf16 v[160:163], v[64:67], v[192:195], v[160:163]
    v_mfma_f32_16x16x32_bf16 v[160:163], v[80:83], v[196:199], v[160:163]
    ds_write_b128 v44, v[144:147] offset:4096
    v_mfma_f32_16x16x32_bf16 v[160:163], v[96:99], v[200:203], v[160:163]
    v_mfma_f32_16x16x32_bf16 v[160:163], v[112:115], v[204:207], v[160:163]
    v_mfma_f32_16x16x32_bf16 v[164:167], v[116:119], v[204:207], v[164:167]
    ds_write_b128 v45, v[148:151] offset:5120
    v_mfma_f32_16x16x32_bf16 v[164:167], v[100:103], v[200:203], v[164:167]
    v_mfma_f32_16x16x32_bf16 v[164:167], v[84:87], v[196:199], v[164:167]
    v_mfma_f32_16x16x32_bf16 v[164:167], v[68:71], v[192:195], v[164:167]
    ds_write_b128 v46, v[152:155] offset:6144
    v_mfma_f32_16x16x32_bf16 v[168:171], v[72:75], v[192:195], v[168:171]
    v_mfma_f32_16x16x32_bf16 v[168:171], v[88:91], v[196:199], v[168:171]
    v_mfma_f32_16x16x32_bf16 v[168:171], v[104:107], v[200:203], v[168:171]
    ds_write_b128 v47, v[156:159] offset:7168
    v_mfma_f32_16x16x32_bf16 v[168:171], v[120:123], v[204:207], v[168:171]
    v_mfma_f32_16x16x32_bf16 v[172:175], v[124:127], v[204:207], v[172:175]
    v_mfma_f32_16x16x32_bf16 v[172:175], v[108:111], v[200:203], v[172:175]
    v_mfma_f32_16x16x32_bf16 v[172:175], v[92:95], v[196:199], v[172:175]
    v_mfma_f32_16x16x32_bf16 v[172:175], v[76:79], v[192:195], v[172:175]
    s_waitcnt vmcnt(0)
    v_mfma_f32_16x16x32_bf16 v[176:179], v[64:67], v[208:211], v[176:179]
    v_mfma_f32_16x16x32_bf16 v[176:179], v[80:83], v[212:215], v[176:179]
    ds_write_b128 v44, v[160:163] offset:32768
    v_mfma_f32_16x16x32_bf16 v[176:179], v[96:99], v[216:219], v[176:179]
    v_mfma_f32_16x16x32_bf16 v[176:179], v[112:115], v[220:223], v[176:179]
    v_mfma_f32_16x16x32_bf16 v[180:183], v[116:119], v[220:223], v[180:183]
    ds_write_b128 v45, v[164:167] offset:33792
    v_mfma_f32_16x16x32_bf16 v[180:183], v[100:103], v[216:219], v[180:183]
    v_mfma_f32_16x16x32_bf16 v[180:183], v[84:87], v[212:215], v[180:183]
    v_mfma_f32_16x16x32_bf16 v[180:183], v[68:71], v[208:211], v[180:183]
    ds_write_b128 v46, v[168:171] offset:34816
    v_mfma_f32_16x16x32_bf16 v[184:187], v[72:75], v[208:211], v[184:187]
    v_mfma_f32_16x16x32_bf16 v[184:187], v[88:91], v[212:215], v[184:187]
    v_mfma_f32_16x16x32_bf16 v[184:187], v[104:107], v[216:219], v[184:187]
    ds_write_b128 v47, v[172:175] offset:35840
    v_mfma_f32_16x16x32_bf16 v[184:187], v[120:123], v[220:223], v[184:187]
    v_mfma_f32_16x16x32_bf16 v[188:191], v[124:127], v[220:223], v[188:191]
    ds_write_b128 v44, v[176:179] offset:36864
    v_mfma_f32_16x16x32_bf16 v[188:191], v[108:111], v[216:219], v[188:191]
    v_mfma_f32_16x16x32_bf16 v[188:191], v[92:95], v[212:215], v[188:191]
    v_mfma_f32_16x16x32_bf16 v[188:191], v[76:79], v[208:211], v[188:191]
    ds_write_b128 v45, v[180:183] offset:37888
    s_nop 2
    ds_write_b128 v46, v[184:187] offset:38912
    s_nop 2
    ds_write_b128 v47, v[188:191] offset:39936
    v_mul_u32_u24 v42, 1792, v25
    v_lshl_add_u32 v42, v26, 4, v42
    s_lshl_b32 s66, s46, 2
    s_add_u32 s66, s66, s29
    s_mul_i32 s61, s66, 28672
    s_lshl_b32 s66, s47, 7
    s_add_u32 s61, s61, s66
    s_waitcnt lgkmcnt(0)
    s_barrier
    ds_read_b128 v[128:131], v27 offset:0
    ds_read_b128 v[132:135], v27 offset:256
    ds_read_b128 v[136:139], v28 offset:0
    ds_read_b128 v[140:143], v28 offset:256
    ds_read_b128 v[144:147], v27 offset:8192
    ds_read_b128 v[148:151], v27 offset:8448
    ds_read_b128 v[152:155], v28 offset:8192
    ds_read_b128 v[156:159], v28 offset:8448
    ds_read_b128 v[160:163], v27 offset:16384
    ds_read_b128 v[164:167], v27 offset:16640
    ds_read_b128 v[168:171], v28 offset:16384
    ds_read_b128 v[172:175], v28 offset:16640
    ds_read_b128 v[176:179], v27 offset:24576
    ds_read_b128 v[180:183], v27 offset:24832
    ds_read_b128 v[184:187], v28 offset:24576
    ds_read_b128 v[188:191], v28 offset:24832
    s_waitcnt lgkmcnt(8)
    v_add_f32 v128, v128, v144
    v_add_f32 v129, v129, v145
    v_add_f32 v130, v130, v146
    v_add_f32 v131, v131, v147
    v_add_f32 v132, v132, v148
    v_add_f32 v133, v133, v149
    v_add_f32 v134, v134, v150
    v_add_f32 v135, v135, v151
    v_add_f32 v136, v136, v152
    v_add_f32 v137, v137, v153
    v_add_f32 v138, v138, v154
    v_add_f32 v139, v139, v155
    v_add_f32 v140, v140, v156
    v_add_f32 v141, v141, v157
    v_add_f32 v142, v142, v158
    v_add_f32 v143, v143, v159
    s_waitcnt lgkmcnt(4)
    v_add_f32 v128, v128, v160
    v_add_f32 v129, v129, v161
    v_add_f32 v130, v130, v162
    v_add_f32 v131, v131, v163
    v_add_f32 v132, v132, v164
    v_add_f32 v133, v133, v165
    v_add_f32 v134, v134, v166
    v_add_f32 v135, v135, v167
    v_add_f32 v136, v136, v168
    v_add_f32 v137, v137, v169
    v_add_f32 v138, v138, v170
    v_add_f32 v139, v139, v171
    v_add_f32 v140, v140, v172
    v_add_f32 v141, v141, v173
    v_add_f32 v142, v142, v174
    v_add_f32 v143, v143, v175
    s_waitcnt lgkmcnt(0)
    v_add_f32 v128, v128, v176
    v_add_f32 v129, v129, v177
    v_add_f32 v130, v130, v178
    v_add_f32 v131, v131, v179
    v_add_f32 v132, v132, v180
    v_add_f32 v133, v133, v181
    v_add_f32 v134, v134, v182
    v_add_f32 v135, v135, v183
    v_add_f32 v136, v136, v184
    v_add_f32 v137, v137, v185
    v_add_f32 v138, v138, v186
    v_add_f32 v139, v139, v187
    v_add_f32 v140, v140, v188
    v_add_f32 v141, v141, v189
    v_add_f32 v142, v142, v190
    v_add_f32 v143, v143, v191
    v_cvt_pk_bf16_f32 v128, v128, v129
    v_cvt_pk_bf16_f32 v129, v130, v131
    v_cvt_pk_bf16_f32 v130, v132, v133
    v_cvt_pk_bf16_f32 v131, v134, v135
    v_cvt_pk_bf16_f32 v132, v136, v137
    v_cvt_pk_bf16_f32 v133, v138, v139
    v_cvt_pk_bf16_f32 v134, v140, v141
    v_cvt_pk_bf16_f32 v135, v142, v143
    s_add_u32 s66, s61, 14336
    buffer_store_dwordx4 v[128:131], v42, s[32:35], s61 offen
    buffer_store_dwordx4 v[132:135], v42, s[32:35], s66 offen
    s_branch F_fin
F_spin20:
    s_mov_b32 s99, 0x200000
F_spin20a:
    s_sleep 4
    buffer_load_dword v24, v25, s[40:43], s79 offen sc1
    s_waitcnt vmcnt(0)
    s_sub_u32 s99, s99, 1
    s_cbranch_scc1 F_spin20r
    v_cmp_gt_u32 vcc, 1, v24
    s_nop 0
    s_cmp_lg_u64 vcc, 0
    s_cbranch_scc1 F_spin20a
    s_branch F_spin20r
F_p3b:
    v_and_b32 v27, 15, v1
    v_lshrrev_b32 v26, 4, v1
    v_mul_u32_u24 v42, 1792, v27
    v_and_b32 v30, 1, v26
    v_lshl_add_u32 v42, v30, 5, v42
    v_lshrrev_b32 v30, 1, v26
    v_lshl_add_u32 v42, v30, 4, v42
    s_lshl_b32 s58, s46, 16
    s_lshl_b32 s66, s29, 14
    s_add_u32 s58, s58, s66
    s_add_u32 s58, s58, 75497472
    s_waitcnt vmcnt(8)
    buffer_store_dword v4, v3, s[40:43], s62 offen sc1
    s_barrier
    v_cmp_gt_u32 vcc, 1, v24
    s_nop 0
    s_cmp_lg_u64 vcc, 0
    s_cbranch_scc1 F_spin21
F_spin21r:
    s_add_u32 m0, s20, 0
    s_add_u32 s67, s58, 0
    buffer_load_dwordx4 v15, s[40:43], s67 offen offset:0 sc1 lds
    buffer_load_dwordx4 v15, s[40:43], s67 offen offset:1024 sc1 lds
    buffer_load_dwordx4 v15, s[40:43], s67 offen offset:2048 sc1 lds
    buffer_load_dwordx4 v15, s[40:43], s67 offen offset:3072 sc1 lds
    s_add_u32 m0, s20, 4096
    s_add_u32 s67, s58, 4096
    buffer_load_dwordx4 v15, s[40:43], s67 offen offset:0 sc1 lds
    buffer_load_dwordx4 v15, s[40:43], s67 offen offset:1024 sc1 lds
    buffer_load_dwordx4 v15, s[40:43], s67 offen offset:2048 sc1 lds
    buffer_load_dwordx4 v15, s[40:43], s67 offen offset:3072 sc1 lds
    s_add_u32 m0, s20, 32768
    s_add_u32 s67, s58, 8192
    buffer_load_dwordx4 v15, s[40:43], s67 offen offset:0 sc1 lds
    buffer_load_dwordx4 v15, s[40:43], s67 offen offset:1024 sc1 lds
    buffer_load_dwordx4 v15, s[40:43], s67 offen offset:2048 sc1 lds
    buffer_load_dwordx4 v15, s[40:43], s67 offen offset:3072 sc1 lds
    s_add_u32 m0, s20, 36864
    s_add_u32 s67, s58, 12288
    buffer_load_dwordx4 v15, s[40:43], s67 offen offset:0 sc1 lds
    buffer_load_dwordx4 v15, s[40:43], s67 offen offset:1024 sc1 lds
    buffer_load_dwordx4 v15, s[40:43], s67 offen offset:2048 sc1 lds
    buffer_load_dwordx4 v15, s[40:43], s67 offen offset:3072 sc1 lds
    s_waitcnt vmcnt(0)
    s_barrier
    ds_read_b128 v[64:67], v15 offset:0
    ds_read_b128 v[68:71], v15 offset:1024
    ds_read_b128 v[72:75], v15 offset:2048
    ds_read_b128 v[76:79], v15 offset:3072
    s_mul_i32 s61, s46, 114688
    s_lshl_b32 s66, s29, 8
    s_add_u32 s61, s61, s66
    s_add_u32 s61, s61, 896
    s_cmp_eq_u32 s29, 3
    s_cselect_b32 s66, s8, s61
    s_waitcnt lgkmcnt(0)
    v_mfma_f32_16x16x32_bf16 v[128:131], a[192:195], v[64:67], 0
    ds_read_b128 v[80:83], v15 offset:4096
    v_mfma_f32_16x16x32_bf16 v[132:135], a[196:199], v[64:67], 0
    v_mfma_f32_16x16x32_bf16 v[136:139], a[200:203], v[64:67], 0
    ds_read_b128 v[84:87], v15 offset:5120
    v_mfma_f32_16x16x32_bf16 v[140:143], a[204:207], v[64:67], 0
    v_mfma_f32_16x16x32_bf16 v[144:147], a[208:211], v[64:67], 0
    ds_read_b128 v[88:91], v15 offset:6144
    v_mfma_f32_16x16x32_bf16 v[148:151], a[212:215], v[64:67], 0
    v_mfma_f32_16x16x32_bf16 v[152:155], a[216:219], v[64:67], 0
    ds_read_b128 v[92:95], v15 offset:7168
    v_mfma_f32_16x16x32_bf16 v[156:159], a[220:223], v[64:67], 0
    v_mfma_f32_16x16x32_bf16 v[188:191], a[220:223], v[68:71], 0
    v_mfma_f32_16x16x32_bf16 v[184:187], a[216:219], v[68:71], 0
    v_mfma_f32_16x16x32_bf16 v[180:183], a[212:215], v[68:71], 0
    v_mfma_f32_16x16x32_bf16 v[176:179], a[208:211], v[68:71], 0
    v_mfma_f32_16x16x32_bf16 v[172:175], a[204:207], v[68:71], 0
    v_mfma_f32_16x16x32_bf16 v[168:171], a[200:203], v[68:71], 0
    v_mfma_f32_16x16x32_bf16 v[164:167], a[196:199], v[68:71], 0
    v_mfma_f32_16x16x32_bf16 v[160:163], a[192:195], v[68:71], 0
    v_mfma_f32_16x16x32_bf16 v[192:195], a[192:195], v[72:75], 0
    v_mfma_f32_16x16x32_bf16 v[196:199], a[196:199], v[72:75], 0
    v_mfma_f32_16x16x32_bf16 v[200:203], a[200:203], v[72:75], 0
    v_mfma_f32_16x16x32_bf16 v[204:207], a[204:207], v[72:75], 0
    v_mfma_f32_16x16x32_bf16 v[208:211], a[208:211], v[72:75], 0
    v_mfma_f32_16x16x32_bf16 v[212:215], a[212:215], v[72:75], 0
    v_mfma_f32_16x16x32_bf16 v[216:219], a[216:219], v[72:75], 0
    v_mfma_f32_16x16x32_bf16 v[220:223], a[220:223], v[72:75], 0
    v_mfma_f32_16x16x32_bf16 v[252:255], a[220:223], v[76:79], 0
    v_mfma_f32_16x16x32_bf16 v[248:251], a[216:219], v[76:79], 0
    v_mfma_f32_16x16x32_bf16 v[244:247], a[212:215], v[76:79], 0
    v_mfma_f32_16x16x32_bf16 v[240:243], a[208:211], v[76:79], 0
    v_mfma_f32_16x16x32_bf16 v[236:239], a[204:207], v[76:79], 0
    v_mfma_f32_16x16x32_bf16 v[232:235], a[200:203], v[76:79], 0
    v_mfma_f32_16x16x32_bf16 v[228:231], a[196:199], v[76:79], 0
    v_mfma_f32_16x16x32_bf16 v[224:227], a[192:195], v[76:79], 0
    s_waitcnt lgkmcnt(0)
    v_mfma_f32_16x16x32_bf16 v[128:131], a[224:227], v[80:83], v[128:131]
    ds_read_b128 v[64:67], v15 offset:32768
    s_add_u32 s67, s23, 65536
    v_mfma_f32_16x16x32_bf16 v[132:135], a[228:231], v[80:83], v[132:135]
    buffer_load_dwordx4 a[192:195], v15, s[40:43], s67 offen offset:0 sc1
    v_mfma_f32_16x16x32_bf16 v[136:139], a[232:235], v[80:83], v[136:139]
    ds_read_b128 v[68:71], v15 offset:33792
    v_mfma_f32_16x16x32_bf16 v[140:143], a[236:239], v[80:83], v[140:143]
    v_mfma_f32_16x16x32_bf16 v[144:147], a[240:243], v[80:83], v[144:147]
    ds_read_b128 v[72:75], v15 offset:34816
    v_mfma_f32_16x16x32_bf16 v[148:151], a[244:247], v[80:83], v[148:151]
    buffer_load_dwordx4 a[196:199], v15, s[40:43], s67 offen offset:1024 sc1
    v_mfma_f32_16x16x32_bf16 v[152:155], a[248:251], v[80:83], v[152:155]
    ds_read_b128 v[76:79], v15 offset:35840
    v_mfma_f32_16x16x32_bf16 v[156:159], a[252:255], v[80:83], v[156:159]
    v_mfma_f32_16x16x32_bf16 v[188:191], a[252:255], v[84:87], v[188:191]
    v_mfma_f32_16x16x32_bf16 v[184:187], a[248:251], v[84:87], v[184:187]
    buffer_load_dwordx4 a[200:203], v15, s[40:43], s67 offen offset:2048 sc1
    v_mfma_f32_16x16x32_bf16 v[180:183], a[244:247], v[84:87], v[180:183]
    v_mfma_f32_16x16x32_bf16 v[176:179], a[240:243], v[84:87], v[176:179]
    v_mfma_f32_16x16x32_bf16 v[172:175], a[236:239], v[84:87], v[172:175]
    v_mfma_f32_16x16x32_bf16 v[168:171], a[232:235], v[84:87], v[168:171]
    buffer_load_dwordx4 a[204:207], v15, s[40:43], s67 offen offset:3072 sc1
    v_mfma_f32_16x16x32_bf16 v[164:167], a[228:231], v[84:87], v[164:167]
    v_mfma_f32_16x16x32_bf16 v[160:163], a[224:227], v[84:87], v[160:163]
    s_add_u32 s67, s23, 69632
    v_mfma_f32_16x16x32_bf16 v[192:195], a[224:227], v[88:91], v[192:195]
    v_mfma_f32_16x16x32_bf16 v[196:199], a[228:231], v[88:91], v[196:199]
    buffer_load_dwordx4 a[208:211], v15, s[40:43], s67 offen offset:0 sc1
    v_mfma_f32_16x16x32_bf16 v[200:203], a[232:235], v[88:91], v[200:203]
    v_mfma_f32_16x16x32_bf16 v[204:207], a[236:239], v[88:91], v[204:207]
    v_mfma_f32_16x16x32_bf16 v[208:211], a[240:243], v[88:91], v[208:211]
    v_mfma_f32_16x16x32_bf16 v[212:215], a[244:247], v[88:91], v[212:215]
    buffer_load_dwordx4 a[212:215], v15, s[40:43], s67 offen offset:1024 sc1
    v_mfma_f32_16x16x32_bf16 v[216:219], a[248:251], v[88:91], v[216:219]
    v_mfma_f32_16x16x32_bf16 v[220:223], a[252:255], v[88:91], v[220:223]
    v_mfma_f32_16x16x32_bf16 v[252:255], a[252:255], v[92:95], v[252:255]
    v_mfma_f32_16x16x32_bf16 v[248:251], a[248:251], v[92:95], v[248:251]
    buffer_load_dwordx4 a[216:219], v15, s[40:43], s67 offen offset:2048 sc1
    v_mfma_f32_16x16x32_bf16 v[244:247], a[244:247], v[92:95], v[244:247]
    v_mfma_f32_16x16x32_bf16 v[240:243], a[240:243], v[92:95], v[240:243]
    v_mfma_f32_16x16x32_bf16 v[236:239], a[236:239], v[92:95], v[236:239]
    v_mfma_f32_16x16x32_bf16 v[232:235], a[232:235], v[92:95], v[232:235]
    buffer_load_dwordx4 a[220:223], v15, s[40:43], s67 offen offset:3072 sc1
    v_mfma_f32_16x16x32_bf16 v[228:231], a[228:231], v[92:95], v[228:231]
    v_mfma_f32_16x16x32_bf16 v[224:227], a[224:227], v[92:95], v[224:227]
    s_waitcnt lgkmcnt(0)
    v_mfma_f32_16x16x32_bf16 v[128:131], a[0:3], v[64:67], v[128:131]
    ds_read_b128 v[80:83], v15 offset:36864
    s_add_u32 s67, s23, 73728
    v_mfma_f32_16x16x32_bf16 v[132:135], a[4:7], v[64:67], v[132:135]
    buffer_load_dwordx4 a[224:227], v15, s[40:43], s67 offen offset:0 sc1
    v_mfma_f32_16x16x32_bf16 v[136:139], a[8:11], v[64:67], v[136:139]
    ds_read_b128 v[84:87], v15 offset:37888
    v_mfma_f32_16x16x32_bf16 v[140:143], a[12:15], v[64:67], v[140:143]
    v_mfma_f32_16x16x32_bf16 v[144:147], a[16:19], v[64:67], v[144:147]
    ds_read_b128 v[88:91], v15 offset:38912
    v_mfma_f32_16x16x32_bf16 v[148:151], a[20:23], v[64:67], v[148:151]
    buffer_load_dwordx4 a[228:231], v15, s[40:43], s67 offen offset:1024 sc1
    v_mfma_f32_16x16x32_bf16 v[152:155], a[24:27], v[64:67], v[152:155]
    ds_read_b128 v[92:95], v15 offset:39936
    v_mfma_f32_16x16x32_bf16 v[156:159], a[28:31], v[64:67], v[156:159]
    v_mfma_f32_16x16x32_bf16 v[188:191], a[28:31], v[68:71], v[188:191]
    v_mfma_f32_16x16x32_bf16 v[184:187], a[24:27], v[68:71], v[184:187]
    buffer_load_dwordx4 a[232:235], v15, s[40:43], s67 offen offset:2048 sc1
    v_mfma_f32_16x16x32_bf16 v[180:183], a[20:23], v[68:71], v[180:183]
    v_mfma_f32_16x16x32_bf16 v[176:179], a[16:19], v[68:71], v[176:179]
    v_mfma_f32_16x16x32_bf16 v[172:175], a[12:15], v[68:71], v[172:175]
    v_mfma_f32_16x16x32_bf16 v[168:171], a[8:11], v[68:71], v[168:171]
    buffer_load_dwordx4 a[236:239], v15, s[40:43], s67 offen offset:3072 sc1
    v_mfma_f32_16x16x32_bf16 v[164:167], a[4:7], v[68:71], v[164:167]
    v_mfma_f32_16x16x32_bf16 v[160:163], a[0:3], v[68:71], v[160:163]
    s_add_u32 s67, s23, 77824
    v_mfma_f32_16x16x32_bf16 v[192:195], a[0:3], v[72:75], v[192:195]
    v_mfma_f32_16x16x32_bf16 v[196:199], a[4:7], v[72:75], v[196:199]
    buffer_load_dwordx4 a[240:243], v15, s[40:43], s67 offen offset:0 sc1
    v_mfma_f32_16x16x32_bf16 v[200:203], a[8:11], v[72:75], v[200:203]
    v_mfma_f32_16x16x32_bf16 v[204:207], a[12:15], v[72:75], v[204:207]
    v_mfma_f32_16x16x32_bf16 v[208:211], a[16:19], v[72:75], v[208:211]
    v_mfma_f32_16x16x32_bf16 v[212:215], a[20:23], v[72:75], v[212:215]
    buffer_load_dwordx4 a[244:247], v15, s[40:43], s67 offen offset:1024 sc1
    v_mfma_f32_16x16x32_bf16 v[216:219], a[24:27], v[72:75], v[216:219]
    v_mfma_f32_16x16x32_bf16 v[220:223], a[28:31], v[72:75], v[220:223]
    v_mfma_f32_16x16x32_bf16 v[252:255], a[28:31], v[76:79], v[252:255]
    v_mfma_f32_16x16x32_bf16 v[248:251], a[24:27], v[76:79], v[248:251]
    buffer_load_dwordx4 a[248:251], v15, s[40:43], s67 offen offset:2048 sc1
    v_mfma_f32_16x16x32_bf16 v[244:247], a[20:23], v[76:79], v[244:247]
    v_mfma_f32_16x16x32_bf16 v[240:243], a[16:19], v[76:79], v[240:243]
    v_mfma_f32_16x16x32_bf16 v[236:239], a[12:15], v[76:79], v[236:239]
    v_mfma_f32_16x16x32_bf16 v[232:235], a[8:11], v[76:79], v[232:235]
    buffer_load_dwordx4 a[252:255], v15, s[40:43], s67 offen offset:3072 sc1
    v_mfma_f32_16x16x32_bf16 v[228:231], a[4:7], v[76:79], v[228:231]
    v_mfma_f32_16x16x32_bf16 v[224:227], a[0:3], v[76:79], v[224:227]
    s_waitcnt lgkmcnt(0)
    v_mfma_f32_16x16x32_bf16 v[128:131], a[32:35], v[80:83], v[128:131]
    ds_read_b128 v[64:67], v15 offset:8192
    s_add_u32 s67, s23, 81920
    v_mfma_f32_16x16x32_bf16 v[132:135], a[36:39], v[80:83], v[132:135]
    buffer_load_dwordx4 a[0:3], v15, s[40:43], s67 offen offset:0 sc1
    v_mfma_f32_16x16x32_bf16 v[136:139], a[40:43], v[80:83], v[136:139]
    ds_read_b128 v[68:71], v15 offset:9216
    v_mfma_f32_16x16x32_bf16 v[140:143], a[44:47], v[80:83], v[140:143]
    v_mfma_f32_16x16x32_bf16 v[144:147], a[48:51], v[80:83], v[144:147]
    ds_read_b128 v[72:75], v15 offset:10240
    v_mfma_f32_16x16x32_bf16 v[148:151], a[52:55], v[80:83], v[148:151]
    v_mfma_f32_16x16x32_bf16 v[152:155], a[56:59], v[80:83], v[152:155]
    ds_read_b128 v[76:79], v15 offset:11264
    v_mfma_f32_16x16x32_bf16 v[156:159], a[60:63], v[80:83], v[156:159]
    v_mfma_f32_16x16x32_bf16 v[188:191], a[60:63], v[84:87], v[188:191]
    v_mfma_f32_16x16x32_bf16 v[184:187], a[56:59], v[84:87], v[184:187]
    buffer_load_dwordx4 a[4:7], v15, s[40:43], s67 offen offset:1024 sc1
    v_mfma_f32_16x16x32_bf16 v[180:183], a[52:55], v[84:87], v[180:183]
    v_mfma_f32_16x16x32_bf16 v[176:179], a[48:51], v[84:87], v[176:179]
    v_mfma_f32_16x16x32_bf16 v[172:175], a[44:47], v[84:87], v[172:175]
    v_mfma_f32_16x16x32_bf16 v[168:171], a[40:43], v[84:87], v[168:171]
    v_mfma_f32_16x16x32_bf16 v[164:167], a[36:39], v[84:87], v[164:167]
    v_mfma_f32_16x16x32_bf16 v[160:163], a[32:35], v[84:87], v[160:163]
    v_mfma_f32_16x16x32_bf16 v[192:195], a[32:35], v[88:91], v[192:195]
    v_mfma_f32_16x16x32_bf16 v[196:199], a[36:39], v[88:91], v[196:199]
    buffer_load_dwordx4 a[8:11], v15, s[40:43], s67 offen offset:2048 sc1
    v_mfma_f32_16x16x32_bf16 v[200:203], a[40:43], v[88:91], v[200:203]
    v_mfma_f32_16x16x32_bf16 v[204:207], a[44:47], v[88:91], v[204:207]
    v_mfma_f32_16x16x32_bf16 v[208:211], a[48:51], v[88:91], v[208:211]
    v_mfma_f32_16x16x32_bf16 v[212:215], a[52:55], v[88:91], v[212:215]
    v_mfma_f32_16x16x32_bf16 v[216:219], a[56:59], v[88:91], v[216:219]
    v_mfma_f32_16x16x32_bf16 v[220:223], a[60:63], v[88:91], v[220:223]
    v_mfma_f32_16x16x32_bf16 v[252:255], a[60:63], v[92:95], v[252:255]
    v_mfma_f32_16x16x32_bf16 v[248:251], a[56:59], v[92:95], v[248:251]
    buffer_load_dwordx4 a[12:15], v15, s[40:43], s67 offen offset:3072 sc1
    v_mfma_f32_16x16x32_bf16 v[244:247], a[52:55], v[92:95], v[244:247]
    v_mfma_f32_16x16x32_bf16 v[240:243], a[48:51], v[92:95], v[240:243]
    v_mfma_f32_16x16x32_bf16 v[236:239], a[44:47], v[92:95], v[236:239]
    v_mfma_f32_16x16x32_bf16 v[232:235], a[40:43], v[92:95], v[232:235]
    v_mfma_f32_16x16x32_bf16 v[228:231], a[36:39], v[92:95], v[228:231]
    v_mfma_f32_16x16x32_bf16 v[224:227], a[32:35], v[92:95], v[224:227]
    s_waitcnt lgkmcnt(0)
    v_mfma_f32_16x16x32_bf16 v[128:131], a[64:67], v[64:67], v[128:131]
    ds_read_b128 v[80:83], v15 offset:12288
    s_add_u32 s67, s23, 86016
    v_mfma_f32_16x16x32_bf16 v[132:135], a[68:71], v[64:67], v[132:135]
    buffer_load_dwordx4 a[16:19], v15, s[40:43], s67 offen offset:0 sc1
    v_mfma_f32_16x16x32_bf16 v[136:139], a[72:75], v[64:67], v[136:139]
    ds_read_b128 v[84:87], v15 offset:13312
    v_mfma_f32_16x16x32_bf16 v[140:143], a[76:79], v[64:67], v[140:143]
    v_mfma_f32_16x16x32_bf16 v[144:147], a[80:83], v[64:67], v[144:147]
    ds_read_b128 v[88:91], v15 offset:14336
    v_mfma_f32_16x16x32_bf16 v[148:151], a[84:87], v[64:67], v[148:151]
    buffer_load_dwordx4 a[20:23], v15, s[40:43], s67 offen offset:1024 sc1
    v_mfma_f32_16x16x32_bf16 v[152:155], a[88:91], v[64:67], v[152:155]
    ds_read_b128 v[92:95], v15 offset:15360
    v_mfma_f32_16x16x32_bf16 v[156:159], a[92:95], v[64:67], v[156:159]
    v_mfma_f32_16x16x32_bf16 v[188:191], a[92:95], v[68:71], v[188:191]
    v_mfma_f32_16x16x32_bf16 v[184:187], a[88:91], v[68:71], v[184:187]
    buffer_load_dwordx4 a[24:27], v15, s[40:43], s67 offen offset:2048 sc1
    v_mfma_f32_16x16x32_bf16 v[180:183], a[84:87], v[68:71], v[180:183]
    v_mfma_f32_16x16x32_bf16 v[176:179], a[80:83], v[68:71], v[176:179]
    v_mfma_f32_16x16x32_bf16 v[172:175], a[76:79], v[68:71], v[172:175]
    v_mfma_f32_16x16x32_bf16 v[168:171], a[72:75], v[68:71], v[168:171]
    buffer_load_dwordx4 a[28:31], v15, s[40:43], s67 offen offset:3072 sc1
    v_mfma_f32_16x16x32_bf16 v[164:167], a[68:71], v[68:71], v[164:167]
    v_mfma_f32_16x16x32_bf16 v[160:163], a[64:67], v[68:71], v[160:163]
    s_add_u32 s67, s23, 90112
    v_mfma_f32_16x16x32_bf16 v[192:195], a[64:67], v[72:75], v[192:195]
    v_mfma_f32_16x16x32_bf16 v[196:199], a[68:71], v[72:75], v[196:199]
    buffer_load_dwordx4 a[32:35], v15, s[40:43], s67 offen offset:0 sc1
    v_mfma_f32_16x16x32_bf16 v[200:203], a[72:75], v[72:75], v[200:203]
    v_mfma_f32_16x16x32_bf16 v[204:207], a[76:79], v[72:75], v[204:207]
    v_mfma_f32_16x16x32_bf16 v[208:211], a[80:83], v[72:75], v[208:211]
    v_mfma_f32_16x16x32_bf16 v[212:215], a[84:87], v[72:75], v[212:215]
    buffer_load_dwordx4 a[36:39], v15, s[40:43], s67 offen offset:1024 sc1
    v_mfma_f32_16x16x32_bf16 v[216:219], a[88:91], v[72:75], v[216:219]
    v_mfma_f32_16x16x32_bf16 v[220:223], a[92:95], v[72:75], v[220:223]
    v_mfma_f32_16x16x32_bf16 v[252:255], a[92:95], v[76:79], v[252:255]
    v_mfma_f32_16x16x32_bf16 v[248:251], a[88:91], v[76:79], v[248:251]
    buffer_load_dwordx4 a[40:43], v15, s[40:43], s67 offen offset:2048 sc1
    v_mfma_f32_16x16x32_bf16 v[244:247], a[84:87], v[76:79], v[244:247]
    v_mfma_f32_16x16x32_bf16 v[240:243], a[80:83], v[76:79], v[240:243]
    v_mfma_f32_16x16x32_bf16 v[236:239], a[76:79], v[76:79], v[236:239]
    v_mfma_f32_16x16x32_bf16 v[232:235], a[72:75], v[76:79], v[232:235]
    buffer_load_dwordx4 a[44:47], v15, s[40:43], s67 offen offset:3072 sc1
    v_mfma_f32_16x16x32_bf16 v[228:231], a[68:71], v[76:79], v[228:231]
    v_mfma_f32_16x16x32_bf16 v[224:227], a[64:67], v[76:79], v[224:227]
    s_waitcnt lgkmcnt(0)
    v_mfma_f32_16x16x32_bf16 v[128:131], a[96:99], v[80:83], v[128:131]
    ds_read_b128 v[64:67], v15 offset:40960
    s_add_u32 s67, s23, 94208
    v_mfma_f32_16x16x32_bf16 v[132:135], a[100:103], v[80:83], v[132:135]
    buffer_load_dwordx4 a[48:51], v15, s[40:43], s67 offen offset:0 sc1
    v_mfma_f32_16x16x32_bf16 v[136:139], a[104:107], v[80:83], v[136:139]
    ds_read_b128 v[68:71], v15 offset:41984
    v_mfma_f32_16x16x32_bf16 v[140:143], a[108:111], v[80:83], v[140:143]
    v_mfma_f32_16x16x32_bf16 v[144:147], a[112:115], v[80:83], v[144:147]
    ds_read_b128 v[72:75], v15 offset:43008
    v_mfma_f32_16x16x32_bf16 v[148:151], a[116:119], v[80:83], v[148:151]
    v_mfma_f32_16x16x32_bf16 v[152:155], a[120:123], v[80:83], v[152:155]
    ds_read_b128 v[76:79], v15 offset:44032
    v_mfma_f32_16x16x32_bf16 v[156:159], a[124:127], v[80:83], v[156:159]
    v_mfma_f32_16x16x32_bf16 v[188:191], a[124:127], v[84:87], v[188:191]
    v_mfma_f32_16x16x32_bf16 v[184:187], a[120:123], v[84:87], v[184:187]
    buffer_load_dwordx4 a[52:55], v15, s[40:43], s67 offen offset:1024 sc1
    v_mfma_f32_16x16x32_bf16 v[180:183], a[116:119], v[84:87], v[180:183]
    v_mfma_f32_16x16x32_bf16 v[176:179], a[112:115], v[84:87], v[176:179]
    v_mfma_f32_16x16x32_bf16 v[172:175], a[108:111], v[84:87], v[172:175]
    v_mfma_f32_16x16x32_bf16 v[168:171], a[104:107], v[84:87], v[168:171]
    v_mfma_f32_16x16x32_bf16 v[164:167], a[100:103], v[84:87], v[164:167]
    v_mfma_f32_16x16x32_bf16 v[160:163], a[96:99], v[84:87], v[160:163]
    v_mfma_f32_16x16x32_bf16 v[192:195], a[96:99], v[88:91], v[192:195]
    v_mfma_f32_16x16x32_bf16 v[196:199], a[100:103], v[88:91], v[196:199]
    buffer_load_dwordx4 a[56:59], v15, s[40:43], s67 offen offset:2048 sc1
    v_mfma_f32_16x16x32_bf16 v[200:203], a[104:107], v[88:91], v[200:203]
    v_mfma_f32_16x16x32_bf16 v[204:207], a[108:111], v[88:91], v[204:207]
    v_mfma_f32_16x16x32_bf16 v[208:211], a[112:115], v[88:91], v[208:211]
    v_mfma_f32_16x16x32_bf16 v[212:215], a[116:119], v[88:91], v[212:215]
    v_mfma_f32_16x16x32_bf16 v[216:219], a[120:123], v[88:91], v[216:219]
    v_mfma_f32_16x16x32_bf16 v[220:223], a[124:127], v[88:91], v[220:223]
    v_mfma_f32_16x16x32_bf16 v[252:255], a[124:127], v[92:95], v[252:255]
    v_mfma_f32_16x16x32_bf16 v[248:251], a[120:123], v[92:95], v[248:251]
    buffer_load_dwordx4 a[60:63], v15, s[40:43], s67 offen offset:3072 sc1
    v_mfma_f32_16x16x32_bf16 v[244:247], a[116:119], v[92:95], v[244:247]
    v_mfma_f32_16x16x32_bf16 v[240:243], a[112:115], v[92:95], v[240:243]
    v_mfma_f32_16x16x32_bf16 v[236:239], a[108:111], v[92:95], v[236:239]
    v_mfma_f32_16x16x32_bf16 v[232:235], a[104:107], v[92:95], v[232:235]
    v_mfma_f32_16x16x32_bf16 v[228:231], a[100:103], v[92:95], v[228:231]
    v_mfma_f32_16x16x32_bf16 v[224:227], a[96:99], v[92:95], v[224:227]
    s_waitcnt lgkmcnt(0)
    v_mfma_f32_16x16x32_bf16 v[128:131], a[128:131], v[64:67], v[128:131]
    ds_read_b128 v[80:83], v15 offset:45056
    s_add_u32 s67, s23, 98304
    v_mfma_f32_16x16x32_bf16 v[132:135], a[132:135], v[64:67], v[132:135]
    buffer_load_dwordx4 a[64:67], v15, s[40:43], s67 offen offset:0 sc1
    v_mfma_f32_16x16x32_bf16 v[136:139], a[136:139], v[64:67], v[136:139]
    ds_read_b128 v[84:87], v15 offset:46080
    v_mfma_f32_16x16x32_bf16 v[140:143], a[140:143], v[64:67], v[140:143]
    v_mfma_f32_16x16x32_bf16 v[144:147], a[144:147], v[64:67], v[144:147]
    ds_read_b128 v[88:91], v15 offset:47104
    v_mfma_f32_16x16x32_bf16 v[148:151], a[148:151], v[64:67], v[148:151]
    buffer_load_dwordx4 a[68:71], v15, s[40:43], s67 offen offset:1024 sc1
    v_mfma_f32_16x16x32_bf16 v[152:155], a[152:155], v[64:67], v[152:155]
    ds_read_b128 v[92:95], v15 offset:48128
    v_mfma_f32_16x16x32_bf16 v[156:159], a[156:159], v[64:67], v[156:159]
    v_mfma_f32_16x16x32_bf16 v[188:191], a[156:159], v[68:71], v[188:191]
    v_mfma_f32_16x16x32_bf16 v[184:187], a[152:155], v[68:71], v[184:187]
    buffer_load_dwordx4 a[72:75], v15, s[40:43], s67 offen offset:2048 sc1
    v_mfma_f32_16x16x32_bf16 v[180:183], a[148:151], v[68:71], v[180:183]
    v_mfma_f32_16x16x32_bf16 v[176:179], a[144:147], v[68:71], v[176:179]
    v_mfma_f32_16x16x32_bf16 v[172:175], a[140:143], v[68:71], v[172:175]
    v_mfma_f32_16x16x32_bf16 v[168:171], a[136:139], v[68:71], v[168:171]
    buffer_load_dwordx4 a[76:79], v15, s[40:43], s67 offen offset:3072 sc1
    v_mfma_f32_16x16x32_bf16 v[164:167], a[132:135], v[68:71], v[164:167]
    v_mfma_f32_16x16x32_bf16 v[160:163], a[128:131], v[68:71], v[160:163]
    s_add_u32 s67, s23, 102400
    v_mfma_f32_16x16x32_bf16 v[192:195], a[128:131], v[72:75], v[192:195]
    v_mfma_f32_16x16x32_bf16 v[196:199], a[132:135], v[72:75], v[196:199]
    buffer_load_dwordx4 a[80:83], v15, s[40:43], s67 offen offset:0 sc1
    v_mfma_f32_16x16x32_bf16 v[200:203], a[136:139], v[72:75], v[200:203]
    v_mfma_f32_16x16x32_bf16 v[204:207], a[140:143], v[72:75], v[204:207]
    v_mfma_f32_16x16x32_bf16 v[208:211], a[144:147], v[72:75], v[208:211]
    v_mfma_f32_16x16x32_bf16 v[212:215], a[148:151], v[72:75], v[212:215]
    buffer_load_dwordx4 a[84:87], v15, s[40:43], s67 offen offset:1024 sc1
    v_mfma_f32_16x16x32_bf16 v[216:219], a[152:155], v[72:75], v[216:219]
    v_mfma_f32_16x16x32_bf16 v[220:223], a[156:159], v[72:75], v[220:223]
    v_mfma_f32_16x16x32_bf16 v[252:255], a[156:159], v[76:79], v[252:255]
    v_mfma_f32_16x16x32_bf16 v[248:251], a[152:155], v[76:79], v[248:251]
    buffer_load_dwordx4 a[88:91], v15, s[40:43], s67 offen offset:2048 sc1
    v_mfma_f32_16x16x32_bf16 v[244:247], a[148:151], v[76:79], v[244:247]
    v_mfma_f32_16x16x32_bf16 v[240:243], a[144:147], v[76:79], v[240:243]
    v_mfma_f32_16x16x32_bf16 v[236:239], a[140:143], v[76:79], v[236:239]
    v_mfma_f32_16x16x32_bf16 v[232:235], a[136:139], v[76:79], v[232:235]
    buffer_load_dwordx4 a[92:95], v15, s[40:43], s67 offen offset:3072 sc1
    v_mfma_f32_16x16x32_bf16 v[228:231], a[132:135], v[76:79], v[228:231]
    v_mfma_f32_16x16x32_bf16 v[224:227], a[128:131], v[76:79], v[224:227]
    s_waitcnt lgkmcnt(0)
    v_mfma_f32_16x16x32_bf16 v[128:131], a[160:163], v[80:83], v[128:131]
    ds_read_b128 v[64:67], v15 offset:16384
    s_add_u32 s67, s23, 106496
    v_mfma_f32_16x16x32_bf16 v[132:135], a[164:167], v[80:83], v[132:135]
    buffer_load_dwordx4 a[96:99], v15, s[40:43], s67 offen offset:0 sc1
    v_mfma_f32_16x16x32_bf16 v[136:139], a[168:171], v[80:83], v[136:139]
    ds_read_b128 v[68:71], v15 offset:17408
    v_mfma_f32_16x16x32_bf16 v[140:143], a[172:175], v[80:83], v[140:143]
    v_mfma_f32_16x16x32_bf16 v[144:147], a[176:179], v[80:83], v[144:147]
    ds_read_b128 v[72:75], v15 offset:18432
    v_mfma_f32_16x16x32_bf16 v[148:151], a[180:183], v[80:83], v[148:151]
    buffer_load_dwordx4 a[100:103], v15, s[40:43], s67 offen offset:1024 sc1
    v_mfma_f32_16x16x32_bf16 v[152:155], a[184:187], v[80:83], v[152:155]
    ds_read_b128 v[76:79], v15 offset:19456
    v_mfma_f32_16x16x32_bf16 v[156:159], a[188:191], v[80:83], v[156:159]
    v_mfma_f32_16x16x32_bf16 v[188:191], a[188:191], v[84:87], v[188:191]
    v_mfma_f32_16x16x32_bf16 v[184:187], a[184:187], v[84:87], v[184:187]
    buffer_load_dwordx4 a[104:107], v15, s[40:43], s67 offen offset:2048 sc1
    v_mfma_f32_16x16x32_bf16 v[180:183], a[180:183], v[84:87], v[180:183]
    v_mfma_f32_16x16x32_bf16 v[176:179], a[176:179], v[84:87], v[176:179]
    v_mfma_f32_16x16x32_bf16 v[172:175], a[172:175], v[84:87], v[172:175]
    v_mfma_f32_16x16x32_bf16 v[168:171], a[168:171], v[84:87], v[168:171]
    buffer_load_dwordx4 a[108:111], v15, s[40:43], s67 offen offset:3072 sc1
    v_mfma_f32_16x16x32_bf16 v[164:167], a[164:167], v[84:87], v[164:167]
    v_mfma_f32_16x16x32_bf16 v[160:163], a[160:163], v[84:87], v[160:163]
    s_add_u32 s67, s23, 110592
    v_mfma_f32_16x16x32_bf16 v[192:195], a[160:163], v[88:91], v[192:195]
    v_mfma_f32_16x16x32_bf16 v[196:199], a[164:167], v[88:91], v[196:199]
    buffer_load_dwordx4 a[112:115], v15, s[40:43], s67 offen offset:0 sc1
    v_mfma_f32_16x16x32_bf16 v[200:203], a[168:171], v[88:91], v[200:203]
    v_mfma_f32_16x16x32_bf16 v[204:207], a[172:175], v[88:91], v[204:207]
    v_mfma_f32_16x16x32_bf16 v[208:211], a[176:179], v[88:91], v[208:211]
    v_mfma_f32_16x16x32_bf16 v[212:215], a[180:183], v[88:91], v[212:215]
    buffer_load_dwordx4 a[116:119], v15, s[40:43], s67 offen offset:1024 sc1
    v_mfma_f32_16x16x32_bf16 v[216:219], a[184:187], v[88:91], v[216:219]
    v_mfma_f32_16x16x32_bf16 v[220:223], a[188:191], v[88:91], v[220:223]
    v_mfma_f32_16x16x32_bf16 v[252:255], a[188:191], v[92:95], v[252:255]
    v_mfma_f32_16x16x32_bf16 v[248:251], a[184:187], v[92:95], v[248:251]
    buffer_load_dwordx4 a[120:123], v15, s[40:43], s67 offen offset:2048 sc1
    v_mfma_f32_16x16x32_bf16 v[244:247], a[180:183], v[92:95], v[244:247]
    v_mfma_f32_16x16x32_bf16 v[240:243], a[176:179], v[92:95], v[240:243]
    v_mfma_f32_16x16x32_bf16 v[236:239], a[172:175], v[92:95], v[236:239]
    v_mfma_f32_16x16x32_bf16 v[232:235], a[168:171], v[92:95], v[232:235]
    buffer_load_dwordx4 a[124:127], v15, s[40:43], s67 offen offset:3072 sc1
    v_mfma_f32_16x16x32_bf16 v[228:231], a[164:167], v[92:95], v[228:231]
    v_mfma_f32_16x16x32_bf16 v[224:227], a[160:163], v[92:95], v[224:227]
    s_waitcnt vmcnt(40) lgkmcnt(0)
    v_mfma_f32_16x16x32_bf16 v[128:131], a[192:195], v[64:67], v[128:131]
    ds_read_b128 v[80:83], v15 offset:20480
    s_add_u32 s67, s23, 114688
    v_mfma_f32_16x16x32_bf16 v[132:135], a[196:199], v[64:67], v[132:135]
    buffer_load_dwordx4 a[128:131], v15, s[40:43], s67 offen offset:0 sc1
    v_mfma_f32_16x16x32_bf16 v[136:139], a[200:203], v[64:67], v[136:139]
    ds_read_b128 v[84:87], v15 offset:21504
    v_mfma_f32_16x16x32_bf16 v[140:143], a[204:207], v[64:67], v[140:143]
    v_mfma_f32_16x16x32_bf16 v[144:147], a[208:211], v[64:67], v[144:147]
    ds_read_b128 v[88:91], v15 offset:22528
    v_mfma_f32_16x16x32_bf16 v[148:151], a[212:215], v[64:67], v[148:151]
    v_mfma_f32_16x16x32_bf16 v[152:155], a[216:219], v[64:67], v[152:155]
    ds_read_b128 v[92:95], v15 offset:23552
    v_mfma_f32_16x16x32_bf16 v[156:159], a[220:223], v[64:67], v[156:159]
    v_mfma_f32_16x16x32_bf16 v[188:191], a[220:223], v[68:71], v[188:191]
    v_mfma_f32_16x16x32_bf16 v[184:187], a[216:219], v[68:71], v[184:187]
    buffer_load_dwordx4 a[132:135], v15, s[40:43], s67 offen offset:1024 sc1
    v_mfma_f32_16x16x32_bf16 v[180:183], a[212:215], v[68:71], v[180:183]
    v_mfma_f32_16x16x32_bf16 v[176:179], a[208:211], v[68:71], v[176:179]
    v_mfma_f32_16x16x32_bf16 v[172:175], a[204:207], v[68:71], v[172:175]
    v_mfma_f32_16x16x32_bf16 v[168:171], a[200:203], v[68:71], v[168:171]
    v_mfma_f32_16x16x32_bf16 v[164:167], a[196:199], v[68:71], v[164:167]
    v_mfma_f32_16x16x32_bf16 v[160:163], a[192:195], v[68:71], v[160:163]
    v_mfma_f32_16x16x32_bf16 v[192:195], a[192:195], v[72:75], v[192:195]
    v_mfma_f32_16x16x32_bf16 v[196:199], a[196:199], v[72:75], v[196:199]
    buffer_load_dwordx4 a[136:139], v15, s[40:43], s67 offen offset:2048 sc1
    v_mfma_f32_16x16x32_bf16 v[200:203], a[200:203], v[72:75], v[200:203]
    v_mfma_f32_16x16x32_bf16 v[204:207], a[204:207], v[72:75], v[204:207]
    v_mfma_f32_16x16x32_bf16 v[208:211], a[208:211], v[72:75], v[208:211]
    v_mfma_f32_16x16x32_bf16 v[212:215], a[212:215], v[72:75], v[212:215]
    v_mfma_f32_16x16x32_bf16 v[216:219], a[216:219], v[72:75], v[216:219]
    v_mfma_f32_16x16x32_bf16 v[220:223], a[220:223], v[72:75], v[220:223]
    v_mfma_f32_16x16x32_bf16 v[252:255], a[220:223], v[76:79], v[252:255]
    v_mfma_f32_16x16x32_bf16 v[248:251], a[216:219], v[76:79], v[248:251]
    buffer_load_dwordx4 a[140:143], v15, s[40:43], s67 offen offset:3072 sc1
    v_mfma_f32_16x16x32_bf16 v[244:247], a[212:215], v[76:79], v[244:247]
    v_mfma_f32_16x16x32_bf16 v[240:243], a[208:211], v[76:79], v[240:243]
    v_mfma_f32_16x16x32_bf16 v[236:239], a[204:207], v[76:79], v[236:239]
    v_mfma_f32_16x16x32_bf16 v[232:235], a[200:203], v[76:79], v[232:235]
    v_mfma_f32_16x16x32_bf16 v[228:231], a[196:199], v[76:79], v[228:231]
    v_mfma_f32_16x16x32_bf16 v[224:227], a[192:195], v[76:79], v[224:227]
    s_waitcnt vmcnt(36) lgkmcnt(0)
    v_mfma_f32_16x16x32_bf16 v[128:131], a[224:227], v[80:83], v[128:131]
    ds_read_b128 v[64:67], v15 offset:49152
    s_add_u32 s67, s23, 118784
    v_mfma_f32_16x16x32_bf16 v[132:135], a[228:231], v[80:83], v[132:135]
    buffer_load_dwordx4 a[144:147], v15, s[40:43], s67 offen offset:0 sc1
    v_mfma_f32_16x16x32_bf16 v[136:139], a[232:235], v[80:83], v[136:139]
    ds_read_b128 v[68:71], v15 offset:50176
    v_mfma_f32_16x16x32_bf16 v[140:143], a[236:239], v[80:83], v[140:143]
    v_mfma_f32_16x16x32_bf16 v[144:147], a[240:243], v[80:83], v[144:147]
    ds_read_b128 v[72:75], v15 offset:51200
    v_mfma_f32_16x16x32_bf16 v[148:151], a[244:247], v[80:83], v[148:151]
    buffer_load_dwordx4 a[148:151], v15, s[40:43], s67 offen offset:1024 sc1
    v_mfma_f32_16x16x32_bf16 v[152:155], a[248:251], v[80:83], v[152:155]
    ds_read_b128 v[76:79], v15 offset:52224
    v_mfma_f32_16x16x32_bf16 v[156:159], a[252:255], v[80:83], v[156:159]
    v_mfma_f32_16x16x32_bf16 v[188:191], a[252:255], v[84:87], v[188:191]
    v_mfma_f32_16x16x32_bf16 v[184:187], a[248:251], v[84:87], v[184:187]
    buffer_load_dwordx4 a[152:155], v15, s[40:43], s67 offen offset:2048 sc1
    v_mfma_f32_16x16x32_bf16 v[180:183], a[244:247], v[84:87], v[180:183]
    v_mfma_f32_16x16x32_bf16 v[176:179], a[240:243], v[84:87], v[176:179]
    v_mfma_f32_16x16x32_bf16 v[172:175], a[236:239], v[84:87], v[172:175]
    v_mfma_f32_16x16x32_bf16 v[168:171], a[232:235], v[84:87], v[168:171]
    buffer_load_dwordx4 a[156:159], v15, s[40:43], s67 offen offset:3072 sc1
    v_mfma_f32_16x16x32_bf16 v[164:167], a[228:231], v[84:87], v[164:167]
    v_mfma_f32_16x16x32_bf16 v[160:163], a[224:227], v[84:87], v[160:163]
    s_add_u32 s67, s23, 122880
    v_mfma_f32_16x16x32_bf16 v[192:195], a[224:227], v[88:91], v[192:195]
    v_mfma_f32_16x16x32_bf16 v[196:199], a[228:231], v[88:91], v[196:199]
    buffer_load_dwordx4 a[160:163], v15, s[40:43], s67 offen offset:0 sc1
    v_mfma_f32_16x16x32_bf16 v[200:203], a[232:235], v[88:91], v[200:203]
    v_mfma_f32_16x16x32_bf16 v[204:207], a[236:239], v[88:91], v[204:207]
    v_mfma_f32_16x16x32_bf16 v[208:211], a[240:243], v[88:91], v[208:211]
    v_mfma_f32_16x16x32_bf16 v[212:215], a[244:247], v[88:91], v[212:215]
    buffer_load_dwordx4 a[164:167], v15, s[40:43], s67 offen offset:1024 sc1
    v_mfma_f32_16x16x32_bf16 v[216:219], a[248:251], v[88:91], v[216:219]
    v_mfma_f32_16x16x32_bf16 v[220:223], a[252:255], v[88:91], v[220:223]
    v_mfma_f32_16x16x32_bf16 v[252:255], a[252:255], v[92:95], v[252:255]
    v_mfma_f32_16x16x32_bf16 v[248:251], a[248:251], v[92:95], v[248:251]
    buffer_load_dwordx4 a[168:171], v15, s[40:43], s67 offen offset:2048 sc1
    v_mfma_f32_16x16x32_bf16 v[244:247], a[244:247], v[92:95], v[244:247]
    v_mfma_f32_16x16x32_bf16 v[240:243], a[240:243], v[92:95], v[240:243]
    v_mfma_f32_16x16x32_bf16 v[236:239], a[236:239], v[92:95], v[236:239]
    v_mfma_f32_16x16x32_bf16 v[232:235], a[232:235], v[92:95], v[232:235]
    buffer_load_dwordx4 a[172:175], v15, s[40:43], s67 offen offset:3072 sc1
    v_mfma_f32_16x16x32_bf16 v[228:231], a[228:231], v[92:95], v[228:231]
    v_mfma_f32_16x16x32_bf16 v[224:227], a[224:227], v[92:95], v[224:227]
    s_waitcnt vmcnt(32) lgkmcnt(0)
    v_mfma_f32_16x16x32_bf16 v[128:131], a[0:3], v[64:67], v[128:131]
    ds_read_b128 v[80:83], v15 offset:53248
    s_add_u32 s67, s23, 126976
    v_mfma_f32_16x16x32_bf16 v[132:135], a[4:7], v[64:67], v[132:135]
    buffer_load_dwordx4 a[176:179], v15, s[40:43], s67 offen offset:0 sc1
    v_mfma_f32_16x16x32_bf16 v[136:139], a[8:11], v[64:67], v[136:139]
    ds_read_b128 v[84:87], v15 offset:54272
    v_mfma_f32_16x16x32_bf16 v[140:143], a[12:15], v[64:67], v[140:143]
    v_mfma_f32_16x16x32_bf16 v[144:147], a[16:19], v[64:67], v[144:147]
    ds_read_b128 v[88:91], v15 offset:55296
    v_mfma_f32_16x16x32_bf16 v[148:151], a[20:23], v[64:67], v[148:151]
    v_mfma_f32_16x16x32_bf16 v[152:155], a[24:27], v[64:67], v[152:155]
    ds_read_b128 v[92:95], v15 offset:56320
    v_mfma_f32_16x16x32_bf16 v[156:159], a[28:31], v[64:67], v[156:159]
    v_mfma_f32_16x16x32_bf16 v[188:191], a[28:31], v[68:71], v[188:191]
    v_mfma_f32_16x16x32_bf16 v[184:187], a[24:27], v[68:71], v[184:187]
    buffer_load_dwordx4 a[180:183], v15, s[40:43], s67 offen offset:1024 sc1
    v_mfma_f32_16x16x32_bf16 v[180:183], a[20:23], v[68:71], v[180:183]
    v_mfma_f32_16x16x32_bf16 v[176:179], a[16:19], v[68:71], v[176:179]
    v_mfma_f32_16x16x32_bf16 v[172:175], a[12:15], v[68:71], v[172:175]
    v_mfma_f32_16x16x32_bf16 v[168:171], a[8:11], v[68:71], v[168:171]
    v_mfma_f32_16x16x32_bf16 v[164:167], a[4:7], v[68:71], v[164:167]
    v_mfma_f32_16x16x32_bf16 v[160:163], a[0:3], v[68:71], v[160:163]
    v_mfma_f32_16x16x32_bf16 v[192:195], a[0:3], v[72:75], v[192:195]
    v_mfma_f32_16x16x32_bf16 v[196:199], a[4:7], v[72:75], v[196:199]
    buffer_load_dwordx4 a[184:187], v15, s[40:43], s67 offen offset:2048 sc1
    v_mfma_f32_16x16x32_bf16 v[200:203], a[8:11], v[72:75], v[200:203]
    v_mfma_f32_16x16x32_bf16 v[204:207], a[12:15], v[72:75], v[204:207]
    v_mfma_f32_16x16x32_bf16 v[208:211], a[16:19], v[72:75], v[208:211]
    v_mfma_f32_16x16x32_bf16 v[212:215], a[20:23], v[72:75], v[212:215]
    v_mfma_f32_16x16x32_bf16 v[216:219], a[24:27], v[72:75], v[216:219]
    v_mfma_f32_16x16x32_bf16 v[220:223], a[28:31], v[72:75], v[220:223]
    v_mfma_f32_16x16x32_bf16 v[252:255], a[28:31], v[76:79], v[252:255]
    v_mfma_f32_16x16x32_bf16 v[248:251], a[24:27], v[76:79], v[248:251]
    buffer_load_dwordx4 a[188:191], v15, s[40:43], s67 offen offset:3072 sc1
    v_mfma_f32_16x16x32_bf16 v[244:247], a[20:23], v[76:79], v[244:247]
    v_mfma_f32_16x16x32_bf16 v[240:243], a[16:19], v[76:79], v[240:243]
    v_mfma_f32_16x16x32_bf16 v[236:239], a[12:15], v[76:79], v[236:239]
    v_mfma_f32_16x16x32_bf16 v[232:235], a[8:11], v[76:79], v[232:235]
    v_mfma_f32_16x16x32_bf16 v[228:231], a[4:7], v[76:79], v[228:231]
    v_mfma_f32_16x16x32_bf16 v[224:227], a[0:3], v[76:79], v[224:227]
    s_waitcnt vmcnt(32) lgkmcnt(0)
    v_mfma_f32_16x16x32_bf16 v[128:131], a[32:35], v[80:83], v[128:131]
    ds_read_b128 v[64:67], v15 offset:24576
    v_mfma_f32_16x16x32_bf16 v[132:135], a[36:39], v[80:83], v[132:135]
    v_mfma_f32_16x16x32_bf16 v[136:139], a[40:43], v[80:83], v[136:139]
    ds_read_b128 v[68:71], v15 offset:28672
    v_mfma_f32_16x16x32_bf16 v[140:143], a[44:47], v[80:83], v[140:143]
    v_mfma_f32_16x16x32_bf16 v[144:147], a[48:51], v[80:83], v[144:147]
    ds_read_b128 v[72:75], v15 offset:57344
    v_mfma_f32_16x16x32_bf16 v[148:151], a[52:55], v[80:83], v[148:151]
    v_mfma_f32_16x16x32_bf16 v[152:155], a[56:59], v[80:83], v[152:155]
    ds_read_b128 v[76:79], v15 offset:61440
    v_mfma_f32_16x16x32_bf16 v[156:159], a[60:63], v[80:83], v[156:159]
    v_mfma_f32_16x16x32_bf16 v[188:191], a[60:63], v[84:87], v[188:191]
    v_mfma_f32_16x16x32_bf16 v[184:187], a[56:59], v[84:87], v[184:187]
    v_mfma_f32_16x16x32_bf16 v[180:183], a[52:55], v[84:87], v[180:183]
    v_mfma_f32_16x16x32_bf16 v[176:179], a[48:51], v[84:87], v[176:179]
    v_mfma_f32_16x16x32_bf16 v[172:175], a[44:47], v[84:87], v[172:175]
    v_mfma_f32_16x16x32_bf16 v[168:171], a[40:43], v[84:87], v[168:171]
    v_mfma_f32_16x16x32_bf16 v[164:167], a[36:39], v[84:87], v[164:167]
    v_mfma_f32_16x16x32_bf16 v[160:163], a[32:35], v[84:87], v[160:163]
    v_mfma_f32_16x16x32_bf16 v[192:195], a[32:35], v[88:91], v[192:195]
    v_mfma_f32_16x16x32_bf16 v[196:199], a[36:39], v[88:91], v[196:199]
    v_mfma_f32_16x16x32_bf16 v[200:203], a[40:43], v[88:91], v[200:203]
    v_mfma_f32_16x16x32_bf16 v[204:207], a[44:47], v[88:91], v[204:207]
    v_mfma_f32_16x16x32_bf16 v[208:211], a[48:51], v[88:91], v[208:211]
    v_mfma_f32_16x16x32_bf16 v[212:215], a[52:55], v[88:91], v[212:215]
    v_mfma_f32_16x16x32_bf16 v[216:219], a[56:59], v[88:91], v[216:219]
    v_mfma_f32_16x16x32_bf16 v[220:223], a[60:63], v[88:91], v[220:223]
    v_mfma_f32_16x16x32_bf16 v[252:255], a[60:63], v[92:95], v[252:255]
    v_mfma_f32_16x16x32_bf16 v[248:251], a[56:59], v[92:95], v[248:251]
    v_mfma_f32_16x16x32_bf16 v[244:247], a[52:55], v[92:95], v[244:247]
    v_mfma_f32_16x16x32_bf16 v[240:243], a[48:51], v[92:95], v[240:243]
    v_mfma_f32_16x16x32_bf16 v[236:239], a[44:47], v[92:95], v[236:239]
    v_mfma_f32_16x16x32_bf16 v[232:235], a[40:43], v[92:95], v[232:235]
    v_mfma_f32_16x16x32_bf16 v[228:231], a[36:39], v[92:95], v[228:231]
    v_mfma_f32_16x16x32_bf16 v[224:227], a[32:35], v[92:95], v[224:227]
    s_waitcnt vmcnt(0) lgkmcnt(0)
    v_mfma_f32_16x16x32_bf16 v[128:131], a[64:67], v[64:67], v[128:131]
    ds_read_b128 v[80:83], v15 offset:25600
    v_mfma_f32_16x16x32_bf16 v[128:131], a[96:99], v[68:71], v[128:131]
    v_mfma_f32_16x16x32_bf16 v[128:131], a[128:131], v[72:75], v[128:131]
    ds_read_b128 v[84:87], v15 offset:29696
    v_mfma_f32_16x16x32_bf16 v[128:131], a[160:163], v[76:79], v[128:131]
    v_mfma_f32_16x16x32_bf16 v[132:135], a[164:167], v[76:79], v[132:135]
    ds_read_b128 v[88:91], v15 offset:58368
    v_mfma_f32_16x16x32_bf16 v[132:135], a[132:135], v[72:75], v[132:135]
    v_mfma_f32_16x16x32_bf16 v[132:135], a[100:103], v[68:71], v[132:135]
    ds_read_b128 v[92:95], v15 offset:62464
    v_mfma_f32_16x16x32_bf16 v[132:135], a[68:71], v[64:67], v[132:135]
    v_mfma_f32_16x16x32_bf16 v[136:139], a[72:75], v[64:67], v[136:139]
    v_mfma_f32_16x16x32_bf16 v[136:139], a[104:107], v[68:71], v[136:139]
    v_mfma_f32_16x16x32_bf16 v[136:139], a[136:139], v[72:75], v[136:139]
    v_mfma_f32_16x16x32_bf16 v[136:139], a[168:171], v[76:79], v[136:139]
    v_mfma_f32_16x16x32_bf16 v[140:143], a[172:175], v[76:79], v[140:143]
    v_mfma_f32_16x16x32_bf16 v[140:143], a[140:143], v[72:75], v[140:143]
    v_mfma_f32_16x16x32_bf16 v[140:143], a[108:111], v[68:71], v[140:143]
    v_mfma_f32_16x16x32_bf16 v[140:143], a[76:79], v[64:67], v[140:143]
    v_mfma_f32_16x16x32_bf16 v[144:147], a[80:83], v[64:67], v[144:147]
    v_mfma_f32_16x16x32_bf16 v[144:147], a[112:115], v[68:71], v[144:147]
    v_mfma_f32_16x16x32_bf16 v[144:147], a[144:147], v[72:75], v[144:147]
    v_mfma_f32_16x16x32_bf16 v[144:147], a[176:179], v[76:79], v[144:147]
    v_mfma_f32_16x16x32_bf16 v[148:151], a[180:183], v[76:79], v[148:151]
    v_mfma_f32_16x16x32_bf16 v[148:151], a[148:151], v[72:75], v[148:151]
    v_mfma_f32_16x16x32_bf16 v[148:151], a[116:119], v[68:71], v[148:151]
    v_mfma_f32_16x16x32_bf16 v[148:151], a[84:87], v[64:67], v[148:151]
    v_mfma_f32_16x16x32_bf16 v[152:155], a[88:91], v[64:67], v[152:155]
    v_mfma_f32_16x16x32_bf16 v[152:155], a[120:123], v[68:71], v[152:155]
    v_mfma_f32_16x16x32_bf16 v[152:155], a[152:155], v[72:75], v[152:155]
    v_mfma_f32_16x16x32_bf16 v[152:155], a[184:187], v[76:79], v[152:155]
    v_mfma_f32_16x16x32_bf16 v[156:159], a[188:191], v[76:79], v[156:159]
    v_mfma_f32_16x16x32_bf16 v[156:159], a[156:159], v[72:75], v[156:159]
    v_mfma_f32_16x16x32_bf16 v[156:159], a[124:127], v[68:71], v[156:159]
    v_mfma_f32_16x16x32_bf16 v[156:159], a[92:95], v[64:67], v[156:159]
    s_waitcnt lgkmcnt(0)
    v_mfma_f32_16x16x32_bf16 v[160:163], a[64:67], v[80:83], v[160:163]
    ds_read_b128 v[64:67], v15 offset:26624
    v_mfma_f32_16x16x32_bf16 v[160:163], a[96:99], v[84:87], v[160:163]
    v_cvt_pk_bf16_f32 v128, v128, v129
    v_cvt_pk_bf16_f32 v129, v130, v131
    v_mfma_f32_16x16x32_bf16 v[160:163], a[128:131], v[88:91], v[160:163]
    ds_read_b128 v[68:71], v15 offset:30720
    v_cvt_pk_bf16_f32 v130, v132, v133
    v_mfma_f32_16x16x32_bf16 v[160:163], a[160:163], v[92:95], v[160:163]
    v_cvt_pk_bf16_f32 v131, v134, v135
    v_cvt_pk_bf16_f32 v136, v136, v137
    v_mfma_f32_16x16x32_bf16 v[164:167], a[164:167], v[92:95], v[164:167]
    ds_read_b128 v[72:75], v15 offset:59392
    v_cvt_pk_bf16_f32 v137, v138, v139
    v_mfma_f32_16x16x32_bf16 v[164:167], a[132:135], v[88:91], v[164:167]
    v_cvt_pk_bf16_f32 v138, v140, v141
    v_cvt_pk_bf16_f32 v139, v142, v143
    v_mfma_f32_16x16x32_bf16 v[164:167], a[100:103], v[84:87], v[164:167]
    ds_read_b128 v[76:79], v15 offset:63488
    v_cvt_pk_bf16_f32 v144, v144, v145
    v_mfma_f32_16x16x32_bf16 v[164:167], a[68:71], v[80:83], v[164:167]
    v_cvt_pk_bf16_f32 v145, v146, v147
    v_cvt_pk_bf16_f32 v146, v148, v149
    v_mfma_f32_16x16x32_bf16 v[168:171], a[72:75], v[80:83], v[168:171]
    v_cvt_pk_bf16_f32 v147, v150, v151
    v_cvt_pk_bf16_f32 v152, v152, v153
    v_mfma_f32_16x16x32_bf16 v[168:171], a[104:107], v[84:87], v[168:171]
    v_cvt_pk_bf16_f32 v153, v154, v155
    v_cvt_pk_bf16_f32 v154, v156, v157
    v_mfma_f32_16x16x32_bf16 v[168:171], a[136:139], v[88:91], v[168:171]
    v_cvt_pk_bf16_f32 v155, v158, v159
    s_nop 0
    v_permlane16_swap_b32 v128, v130
    v_mfma_f32_16x16x32_bf16 v[168:171], a[168:171], v[92:95], v[168:171]
    v_permlane16_swap_b32 v129, v131
    v_permlane16_swap_b32 v136, v138
    v_mfma_f32_16x16x32_bf16 v[172:175], a[172:175], v[92:95], v[172:175]
    v_permlane16_swap_b32 v137, v139
    v_permlane16_swap_b32 v144, v146
    v_mfma_f32_16x16x32_bf16 v[172:175], a[140:143], v[88:91], v[172:175]
    v_permlane16_swap_b32 v145, v147
    v_permlane16_swap_b32 v152, v154
    v_mfma_f32_16x16x32_bf16 v[172:175], a[108:111], v[84:87], v[172:175]
    v_permlane16_swap_b32 v153, v155
    v_mfma_f32_16x16x32_bf16 v[172:175], a[76:79], v[80:83], v[172:175]
    v_mfma_f32_16x16x32_bf16 v[176:179], a[80:83], v[80:83], v[176:179]
    buffer_store_dwordx4 v[128:131], v42, s[32:35], s61 offen offset:0
    v_mfma_f32_16x16x32_bf16 v[176:179], a[112:115], v[84:87], v[176:179]
    v_mfma_f32_16x16x32_bf16 v[176:179], a[144:147], v[88:91], v[176:179]
    v_mfma_f32_16x16x32_bf16 v[176:179], a[176:179], v[92:95], v[176:179]
    v_mfma_f32_16x16x32_bf16 v[180:183], a[180:183], v[92:95], v[180:183]
    v_mfma_f32_16x16x32_bf16 v[180:183], a[148:151], v[88:91], v[180:183]
    buffer_store_dwordx4 v[136:139], v42, s[32:35], s61 offen offset:64
    v_mfma_f32_16x16x32_bf16 v[180:183], a[116:119], v[84:87], v[180:183]
    v_mfma_f32_16x16x32_bf16 v[180:183], a[84:87], v[80:83], v[180:183]
    v_mfma_f32_16x16x32_bf16 v[184:187], a[88:91], v[80:83], v[184:187]
    v_mfma_f32_16x16x32_bf16 v[184:187], a[120:123], v[84:87], v[184:187]
    v_mfma_f32_16x16x32_bf16 v[184:187], a[152:155], v[88:91], v[184:187]
    buffer_store_dwordx4 v[144:147], v42, s[32:35], s66 offen offset:128
    v_mfma_f32_16x16x32_bf16 v[184:187], a[184:187], v[92:95], v[184:187]
    v_mfma_f32_16x16x32_bf16 v[188:191], a[188:191], v[92:95], v[188:191]
    v_mfma_f32_16x16x32_bf16 v[188:191], a[156:159], v[88:91], v[188:191]
    v_mfma_f32_16x16x32_bf16 v[188:191], a[124:127], v[84:87], v[188:191]
    v_mfma_f32_16x16x32_bf16 v[188:191], a[92:95], v[80:83], v[188:191]
    buffer_store_dwordx4 v[152:155], v42, s[32:35], s66 offen offset:192
    s_add_u32 s61, s61, 28672
    s_add_u32 s66, s66, 28672
    s_waitcnt lgkmcnt(0)
    v_mfma_f32_16x16x32_bf16 v[192:195], a[64:67], v[64:67], v[192:195]
    ds_read_b128 v[80:83], v15 offset:27648
    v_mfma_f32_16x16x32_bf16 v[192:195], a[96:99], v[68:71], v[192:195]
    v_cvt_pk_bf16_f32 v160, v160, v161
    v_cvt_pk_bf16_f32 v161, v162, v163
    v_mfma_f32_16x16x32_bf16 v[192:195], a[128:131], v[72:75], v[192:195]
    ds_read_b128 v[84:87], v15 offset:31744
    v_cvt_pk_bf16_f32 v162, v164, v165
    v_mfma_f32_16x16x32_bf16 v[192:195], a[160:163], v[76:79], v[192:195]
    v_cvt_pk_bf16_f32 v163, v166, v167
    v_cvt_pk_bf16_f32 v168, v168, v169
    v_mfma_f32_16x16x32_bf16 v[196:199], a[164:167], v[76:79], v[196:199]
    ds_read_b128 v[88:91], v15 offset:60416
    v_cvt_pk_bf16_f32 v169, v170, v171
    v_mfma_f32_16x16x32_bf16 v[196:199], a[132:135], v[72:75], v[196:199]
    v_cvt_pk_bf16_f32 v170, v172, v173
    v_cvt_pk_bf16_f32 v171, v174, v175
    v_mfma_f32_16x16x32_bf16 v[196:199], a[100:103], v[68:71], v[196:199]
    ds_read_b128 v[92:95], v15 offset:64512
    v_cvt_pk_bf16_f32 v176, v176, v177
    v_mfma_f32_16x16x32_bf16 v[196:199], a[68:71], v[64:67], v[196:199]
    v_cvt_pk_bf16_f32 v177, v178, v179
    v_cvt_pk_bf16_f32 v178, v180, v181
    v_mfma_f32_16x16x32_bf16 v[200:203], a[72:75], v[64:67], v[200:203]
    v_cvt_pk_bf16_f32 v179, v182, v183
    v_cvt_pk_bf16_f32 v184, v184, v185
    v_mfma_f32_16x16x32_bf16 v[200:203], a[104:107], v[68:71], v[200:203]
    v_cvt_pk_bf16_f32 v185, v186, v187
    v_cvt_pk_bf16_f32 v186, v188, v189
    v_mfma_f32_16x16x32_bf16 v[200:203], a[136:139], v[72:75], v[200:203]
    v_cvt_pk_bf16_f32 v187, v190, v191
    s_nop 0
    v_permlane16_swap_b32 v160, v162
    v_mfma_f32_16x16x32_bf16 v[200:203], a[168:171], v[76:79], v[200:203]
    v_permlane16_swap_b32 v161, v163
    v_permlane16_swap_b32 v168, v170
    v_mfma_f32_16x16x32_bf16 v[204:207], a[172:175], v[76:79], v[204:207]
    v_permlane16_swap_b32 v169, v171
    v_permlane16_swap_b32 v176, v178
    v_mfma_f32_16x16x32_bf16 v[204:207], a[140:143], v[72:75], v[204:207]
    v_permlane16_swap_b32 v177, v179
    v_permlane16_swap_b32 v184, v186
    v_mfma_f32_16x16x32_bf16 v[204:207], a[108:111], v[68:71], v[204:207]
    v_permlane16_swap_b32 v185, v187
    v_mfma_f32_16x16x32_bf16 v[204:207], a[76:79], v[64:67], v[204:207]
    v_mfma_f32_16x16x32_bf16 v[208:211], a[80:83], v[64:67], v[208:211]
    buffer_store_dwordx4 v[160:163], v42, s[32:35], s61 offen offset:0
    v_mfma_f32_16x16x32_bf16 v[208:211], a[112:115], v[68:71], v[208:211]
    v_mfma_f32_16x16x32_bf16 v[208:211], a[144:147], v[72:75], v[208:211]
    v_mfma_f32_16x16x32_bf16 v[208:211], a[176:179], v[76:79], v[208:211]
    v_mfma_f32_16x16x32_bf16 v[212:215], a[180:183], v[76:79], v[212:215]
    v_mfma_f32_16x16x32_bf16 v[212:215], a[148:151], v[72:75], v[212:215]
    buffer_store_dwordx4 v[168:171], v42, s[32:35], s61 offen offset:64
    v_mfma_f32_16x16x32_bf16 v[212:215], a[116:119], v[68:71], v[212:215]
    v_mfma_f32_16x16x32_bf16 v[212:215], a[84:87], v[64:67], v[212:215]
    v_mfma_f32_16x16x32_bf16 v[216:219], a[88:91], v[64:67], v[216:219]
    v_mfma_f32_16x16x32_bf16 v[216:219], a[120:123], v[68:71], v[216:219]
    v_mfma_f32_16x16x32_bf16 v[216:219], a[152:155], v[72:75], v[216:219]
    buffer_store_dwordx4 v[176:179], v42, s[32:35], s66 offen offset:128
    v_mfma_f32_16x16x32_bf16 v[216:219], a[184:187], v[76:79], v[216:219]
    v_mfma_f32_16x16x32_bf16 v[220:223], a[188:191], v[76:79], v[220:223]
    v_mfma_f32_16x16x32_bf16 v[220:223], a[156:159], v[72:75], v[220:223]
    v_mfma_f32_16x16x32_bf16 v[220:223], a[124:127], v[68:71], v[220:223]
    v_mfma_f32_16x16x32_bf16 v[220:223], a[92:95], v[64:67], v[220:223]
    buffer_store_dwordx4 v[184:187], v42, s[32:35], s66 offen offset:192
    s_add_u32 s61, s61, 28672
    s_add_u32 s66, s66, 28672
    s_waitcnt lgkmcnt(0)
    v_mfma_f32_16x16x32_bf16 v[224:227], a[64:67], v[80:83], v[224:227]
    v_mfma_f32_16x16x32_bf16 v[224:227], a[96:99], v[84:87], v[224:227]
    v_cvt_pk_bf16_f32 v192, v192, v193
    v_cvt_pk_bf16_f32 v193, v194, v195
    v_mfma_f32_16x16x32_bf16 v[224:227], a[128:131], v[88:91], v[224:227]
    v_cvt_pk_bf16_f32 v194, v196, v197
    v_cvt_pk_bf16_f32 v195, v198, v199
    v_mfma_f32_16x16x32_bf16 v[224:227], a[160:163], v[92:95], v[224:227]
    v_cvt_pk_bf16_f32 v200, v200, v201
    v_cvt_pk_bf16_f32 v201, v202, v203
    v_mfma_f32_16x16x32_bf16 v[228:231], a[164:167], v[92:95], v[228:231]
    v_cvt_pk_bf16_f32 v202, v204, v205
    v_cvt_pk_bf16_f32 v203, v206, v207
    v_mfma_f32_16x16x32_bf16 v[228:231], a[132:135], v[88:91], v[228:231]
    v_cvt_pk_bf16_f32 v208, v208, v209
    v_cvt_pk_bf16_f32 v209, v210, v211
    v_mfma_f32_16x16x32_bf16 v[228:231], a[100:103], v[84:87], v[228:231]
    v_cvt_pk_bf16_f32 v210, v212, v213
    v_cvt_pk_bf16_f32 v211, v214, v215
    v_mfma_f32_16x16x32_bf16 v[228:231], a[68:71], v[80:83], v[228:231]
    v_cvt_pk_bf16_f32 v216, v216, v217
    v_cvt_pk_bf16_f32 v217, v218, v219
    v_mfma_f32_16x16x32_bf16 v[232:235], a[72:75], v[80:83], v[232:235]
    v_cvt_pk_bf16_f32 v218, v220, v221
    v_cvt_pk_bf16_f32 v219, v222, v223
    s_nop 0
    v_mfma_f32_16x16x32_bf16 v[232:235], a[104:107], v[84:87], v[232:235]
    v_permlane16_swap_b32 v192, v194
    v_permlane16_swap_b32 v193, v195
    v_mfma_f32_16x16x32_bf16 v[232:235], a[136:139], v[88:91], v[232:235]
    v_permlane16_swap_b32 v200, v202
    v_permlane16_swap_b32 v201, v203
    v_mfma_f32_16x16x32_bf16 v[232:235], a[168:171], v[92:95], v[232:235]
    v_permlane16_swap_b32 v208, v210
    v_permlane16_swap_b32 v209, v211
    v_mfma_f32_16x16x32_bf16 v[236:239], a[172:175], v[92:95], v[236:239]
    v_permlane16_swap_b32 v216, v218
    v_permlane16_swap_b32 v217, v219
    v_mfma_f32_16x16x32_bf16 v[236:239], a[140:143], v[88:91], v[236:239]
    v_mfma_f32_16x16x32_bf16 v[236:239], a[108:111], v[84:87], v[236:239]
    v_mfma_f32_16x16x32_bf16 v[236:239], a[76:79], v[80:83], v[236:239]
    v_mfma_f32_16x16x32_bf16 v[240:243], a[80:83], v[80:83], v[240:243]
    buffer_store_dwordx4 v[192:195], v42, s[32:35], s61 offen offset:0
    v_mfma_f32_16x16x32_bf16 v[240:243], a[112:115], v[84:87], v[240:243]
    v_mfma_f32_16x16x32_bf16 v[240:243], a[144:147], v[88:91], v[240:243]
    v_mfma_f32_16x16x32_bf16 v[240:243], a[176:179], v[92:95], v[240:243]
    v_mfma_f32_16x16x32_bf16 v[244:247], a[180:183], v[92:95], v[244:247]
    v_mfma_f32_16x16x32_bf16 v[244:247], a[148:151], v[88:91], v[244:247]
    buffer_store_dwordx4 v[200:203], v42, s[32:35], s61 offen offset:64
    v_mfma_f32_16x16x32_bf16 v[244:247], a[116:119], v[84:87], v[244:247]
    v_mfma_f32_16x16x32_bf16 v[244:247], a[84:87], v[80:83], v[244:247]
    v_mfma_f32_16x16x32_bf16 v[248:251], a[88:91], v[80:83], v[248:251]
    v_mfma_f32_16x16x32_bf16 v[248:251], a[120:123], v[84:87], v[248:251]
    v_mfma_f32_16x16x32_bf16 v[248:251], a[152:155], v[88:91], v[248:251]
    buffer_store_dwordx4 v[208:211], v42, s[32:35], s66 offen offset:128
    v_mfma_f32_16x16x32_bf16 v[248:251], a[184:187], v[92:95], v[248:251]
    v_mfma_f32_16x16x32_bf16 v[252:255], a[188:191], v[92:95], v[252:255]
    v_mfma_f32_16x16x32_bf16 v[252:255], a[156:159], v[88:91], v[252:255]
    v_mfma_f32_16x16x32_bf16 v[252:255], a[124:127], v[84:87], v[252:255]
    v_mfma_f32_16x16x32_bf16 v[252:255], a[92:95], v[80:83], v[252:255]
    buffer_store_dwordx4 v[216:219], v42, s[32:35], s66 offen offset:192
    s_add_u32 s61, s61, 28672
    s_add_u32 s66, s66, 28672
    v_cvt_pk_bf16_f32 v224, v224, v225
    v_cvt_pk_bf16_f32 v225, v226, v227
    v_cvt_pk_bf16_f32 v226, v228, v229
    v_cvt_pk_bf16_f32 v227, v230, v231
    v_cvt_pk_bf16_f32 v232, v232, v233
    v_cvt_pk_bf16_f32 v233, v234, v235
    v_cvt_pk_bf16_f32 v234, v236, v237
    v_cvt_pk_bf16_f32 v235, v238, v239
    v_cvt_pk_bf16_f32 v240, v240, v241
    v_cvt_pk_bf16_f32 v241, v242, v243
    v_cvt_pk_bf16_f32 v242, v244, v245
    v_cvt_pk_bf16_f32 v243, v246, v247
    v_cvt_pk_bf16_f32 v248, v248, v249
    v_cvt_pk_bf16_f32 v249, v250, v251
    v_cvt_pk_bf16_f32 v250, v252, v253
    v_cvt_pk_bf16_f32 v251, v254, v255
    s_nop 0
    v_permlane16_swap_b32 v224, v226
    v_permlane16_swap_b32 v225, v227
    v_permlane16_swap_b32 v232, v234
    v_permlane16_swap_b32 v233, v235
    v_permlane16_swap_b32 v240, v242
    v_permlane16_swap_b32 v241, v243
    v_permlane16_swap_b32 v248, v250
    v_permlane16_swap_b32 v249, v251
    buffer_store_dwordx4 v[224:227], v42, s[32:35], s61 offen offset:0
    buffer_store_dwordx4 v[232:235], v42, s[32:35], s61 offen offset:64
    buffer_store_dwordx4 v[240:243], v42, s[32:35], s66 offen offset:128
    buffer_store_dwordx4 v[248:251], v42, s[32:35], s66 offen offset:192
    s_add_u32 s61, s61, 28672
    s_add_u32 s66, s66, 28672
F_fin:
F_end:
    s_endpgm
F_spin21:
    s_mov_b32 s99, 0x200000
F_spin21a:
    s_sleep 4
    buffer_load_dword v24, v25, s[40:43], s79 offen sc1
    s_waitcnt vmcnt(0)
    s_sub_u32 s99, s99, 1
    s_cbranch_scc1 F_spin21r
    v_cmp_gt_u32 vcc, 1, v24
    s_nop 0
    s_cmp_lg_u64 vcc, 0
    s_cbranch_scc1 F_spin21a
    s_branch F_spin21r
.fill (131072 + 256 - (. - concat_heads__compressed_kv_cla__linear_kernel_hedgehog__prompt_kernel)) / 4, 4, 0xbf800000
.section .rodata,"a"
.p2align 6
.amdhsa_kernel concat_heads__compressed_kv_cla__linear_kernel_hedgehog__prompt_kernel
  .amdhsa_next_free_vgpr 512
  .amdhsa_next_free_sgpr 102
  .amdhsa_accum_offset 256
  .amdhsa_group_segment_fixed_size 0
  .amdhsa_kernarg_size 104
  .amdhsa_user_sgpr_count 2
  .amdhsa_user_sgpr_kernarg_segment_ptr 1
  .amdhsa_system_sgpr_workgroup_id_x 1
  .amdhsa_float_denorm_mode_32 1
.end_amdhsa_kernel
```
